```python
import torch

def _softmax(x, axis=-1):
    return torch.softmax(x, dim=axis)
def _gelu(x):
    return torch.nn.functional.gelu(x, approximate="tanh")
def _silu(x):
    return torch.nn.functional.silu(x)
def _sigmoid(x):
    return torch.sigmoid(x)
def _layernorm(x, axis=-1, eps=1e-5):
    m = x.mean(dim=axis, keepdim=True)
    v = x.var(dim=axis, keepdim=True, unbiased=False)
    return (x - m) / torch.sqrt(v + eps)
def _scatter_add(tgt, idx, src, axis=0):
    return tgt.clone().index_add_(axis, idx, src)
def _segment_sum(src, seg, n):
    out = torch.zeros((n,) + src.shape[1:], dtype=src.dtype)
    return out.index_add_(0, seg, src)
def _pad(x, pw):
    flat = tuple(v for pair in reversed(pw) for v in pair)
    return torch.nn.functional.pad(x, flat)

kernel_name = 'concat_heads__ssm_conv_s4d__spectral_gfnet__prompt'

def setup_inputs():

    _w = (lambda a: (lambda t: t.to(torch.bfloat16) if t.is_floating_point() else t)(torch.as_tensor(a)))
    def _A_setup():
        Bsz, L, D, N = 1, 2048, 448, 256
        return {
            "u": _w((lambda *s: torch.randn(*s, dtype=torch.bfloat16) * 0.05)(Bsz, L, D)),
            "log_A_real": _w((lambda *s: torch.randn(*s, dtype=torch.bfloat16) * 6.4)(D, N) * 0.5),
            "A_imag": _w((lambda *s: torch.randn(*s, dtype=torch.bfloat16) * 0.05)(D, N) * 3.14),
            "C_real": _w((lambda *s: torch.randn(*s, dtype=torch.bfloat16) * 0.05)(D, N) / N ** 0.5),
            "C_imag": _w((lambda *s: torch.randn(*s, dtype=torch.bfloat16) * 0.05)(D, N) / N ** 0.5),
            "log_dt": _w((lambda *s: torch.randn(*s, dtype=torch.bfloat16) * 0.05)(D) * 0.5 - 4.0),
            "D_skip": _w((lambda *s: torch.randn(*s, dtype=torch.bfloat16) * 0.05)(D)),
        }
    _A_in = _A_setup()

    def _B_setup():
        B, S, D = 1, 2048, 448
        Df = D // 2 + 1
        return {
            "x": _w((lambda *s: torch.randn(*s, dtype=torch.bfloat16) * 0.05)(B, S, D)),
            "w_r": _w((lambda *s: torch.randn(*s, dtype=torch.bfloat16) * 0.8)(S, Df) * 0.02),
            "w_i": _w((lambda *s: torch.randn(*s, dtype=torch.bfloat16) * 0.8)(S, Df) * 0.02),
        }
    _B_in = _B_setup()

    return {
        "A_u": _A_in["u"],
        "A_log_A_real": _A_in["log_A_real"],
        "A_A_imag": _A_in["A_imag"],
        "A_C_real": _A_in["C_real"],
        "A_C_imag": _A_in["C_imag"],
        "A_log_dt": _A_in["log_dt"],
        "A_D_skip": _A_in["D_skip"],
        "B_x": _B_in["x"],
        "B_w_r": _B_in["w_r"],
        "B_w_i": _B_in["w_i"],
    }

def reference(A_u, A_log_A_real, A_A_imag, A_C_real, A_C_imag, A_log_dt, A_D_skip, B_x, B_w_r, B_w_i):
    def _A_ref(u, log_A_real, A_imag, C_real, C_imag, log_dt, D_skip):
        L = u.shape[1]
        dt = torch.exp(log_dt)
        A = -torch.exp(log_A_real) + 1j * A_imag
        C = (C_real + 1j * C_imag) * dt[:, None]
        pos = (lambda x, dt: x.to(dt))(torch.arange(L), log_dt.dtype)
        P = torch.exp((A * dt[:, None])[:, :, None] * pos[None, None, :])
        K = 2.0 * torch.einsum("dn,dnl->dl", C, P).real
        L2 = 2 * L
        u_t = (lambda x, *d: x.permute(*d))(u, 0, 2, 1)
        Kf = (lambda x, *a, **k: torch.fft.rfft(x.float(), *a, **k))(K, L2)
        Uf = (lambda x, *a, **k: torch.fft.rfft(x.float(), *a, **k))(u_t, L2)
        y = (lambda x, *a, **k: torch.fft.irfft(x, *a, **k).to(torch.bfloat16))(Uf * Kf[None, :, :], L2)[:, :, :L]
        y = (lambda x, *d: x.permute(*d))(y, 0, 2, 1)
        return y + u * D_skip[None, None, :]

    def _B_ref(x, w_r, w_i):
        B, S, D = x.shape
        X = (lambda x, axes=(-2,-1): torch.fft.rfft2(x.float(), dim=axes))(x, axes=(-2, -1))
        W = w_r + 1j * w_i
        X = X * W
        y = (lambda x, s, axes=(-2,-1): torch.fft.irfft2(x, s=s, dim=axes).to(torch.bfloat16))(X, (S, D), axes=(-2, -1))
        return y

    a = _A_ref(A_u, A_log_A_real, A_A_imag, A_C_real, A_C_imag, A_log_dt, A_D_skip)
    b = _B_ref(B_x, B_w_r, B_w_i)
    return torch.concatenate([a, b], axis=-1)
```

```asm
; @launch grid=(352,1,1) block=(512,1,1) lds=80640
.amdgcn_target "amdgcn-amd-amdhsa--gfx950"
.text
.globl concat_heads__ssm_conv_s4d__spectral_gfnet__prompt_kernel
.p2align 8
.type concat_heads__ssm_conv_s4d__spectral_gfnet__prompt_kernel,@function
concat_heads__ssm_conv_s4d__spectral_gfnet__prompt_kernel:
    s_cmp_ge_u32 s2, 352
    s_cbranch_scc1 L_exit
    s_load_dwordx16 s[4:19], s[0:1], 0
    s_load_dwordx8 s[20:27], s[0:1], 64
    s_load_dwordx2 s[28:29], s[0:1], 96
    s_getpc_b64 s[30:31]
L_pc:
    v_lshrrev_b32 v2, 6, v0
    v_and_b32 v3, 63, v0
    v_readfirstlane_b32 s32, v2
    v_lshlrev_b32 v1, 4, v3
    s_lshr_b32 s34, s2, 3
    s_sub_u32 s34, s34, 12
    s_lshl3_add_u32 s34, s34, s32
    s_cmp_ge_u32 s34, 16
    s_cbranch_scc1 L_nopf
    s_mul_i32 s34, s34, 3072
    v_lshl_add_u32 v4, v1, 3, s34
    s_mov_b64 exec, 0xffffff
    global_load_dword v0, v4, s[30:31]
    s_mov_b64 exec, -1
L_nopf:
    s_add_u32 s30, s30, L_tab-L_pc
    s_addc_u32 s31, s31, 0
    s_cmp_lt_u32 s2, 128
    s_cbranch_scc1 L_Bm
    s_sub_u32 s44, s2, 128
    s_lshl3_add_u32 s51, s44, s32
    s_lshl_b32 s36, s51, 7
    v_lshl_add_u32 v2, v3, 1, s36
    v_lshrrev_b32 v50, 5, v3
    v_and_b32 v51, 3, v3
    v_lshl_add_u32 v50, v50, 2, v51
    v_mul_u32_u24 v50, 896, v50
    v_and_b32 v51, 28, v3
    v_lshl_add_u32 v50, v51, 2, v50
    s_and_b32 s45, s44, 31
    s_lshr_b32 s46, s44, 5
    s_lshl3_add_u32 s37, s45, s32
    s_lshl_b32 s38, s46, 7
    s_mul_i32 s39, s37, 7168
    s_add_u32 s39, s39, s38
    s_lshl_b32 s36, s44, 2
    s_waitcnt lgkmcnt(0)
    global_load_short_d16_hi v32, v2, s[6:7] nt
    global_load_short_d16_hi v33, v2, s[8:9] nt
    global_load_short_d16_hi v34, v2, s[10:11] nt
    global_load_short_d16_hi v35, v2, s[12:13] nt
    s_add_u32 s10, s4, s39
    s_addc_u32 s11, s5, 0
    s_add_u32 s40, s28, s38
    s_addc_u32 s41, s29, 0
    s_load_dword s33, s[40:41], 256
    s_load_dword s50, s[14:15], s36
    s_branch L_A
L_exit:
    s_endpgm
L_Bm:
    s_lshl_b32 s39, s32, 10
    s_mov_b32 m0, s39
    s_add_u32 s36, s30, s39
    s_addc_u32 s37, s31, 0
    global_load_lds_dwordx4 v1, s[36:37]
    s_and_b32 s45, s2, 15
    s_lshl_b32 s36, s45, 11
    s_add_u32 s36, s36, s39
    s_add_u32 s36, s36, 58368
    s_add_u32 m0, s39, 8192
    s_add_u32 s36, s30, s36
    s_addc_u32 s37, s31, 0
    s_cmp_ge_u32 s32, 2
    s_cbranch_scc1 L_B_n2
    global_load_lds_dwordx4 v1, s[36:37]
L_B_n2:
    s_lshl_b32 s36, s32, 8
    s_add_u32 s36, s36, s2
    s_mul_i32 s36, s36, 896
    s_mul_i32 s49, s32, 1792
    s_add_u32 s49, s49, 14336
    v_add_u32 v87, 114688, v1
    s_waitcnt lgkmcnt(0)
    s_add_u32 s26, s18, s36
    s_addc_u32 s27, s19, 0
    s_mov_b32 m0, s49
    s_mov_b32 exec_hi, 0x00ffffff
    global_load_lds_dwordx4 v1, s[26:27] nt
    s_add_u32 m0, s49, 896
    s_nop 0
    global_load_lds_dwordx4 v87, s[26:27] nt
    s_mov_b32 exec_hi, -1
    s_load_dword s33, s[28:29], 0
    s_setprio 1
L_B:
    s_mov_b32 s3, 65537
    s_and_b32 s36, s2, 7
    s_sub_u32 s37, 16, s36
    s_cmp_eq_u32 s36, 0
    s_cselect_b32 s37, 8, s37
    s_bitcmp1_b32 s2, 3
    s_cselect_b32 s36, s37, s36
    s_lshr_b32 s18, s2, 4
    s_lshl3_add_u32 s19, s36, s18
    s_lshl_b32 s37, s36, 12
    s_add_u32 s37, s37, 91136
    s_lshl_b32 s38, s45, 11
    s_add_u32 s38, s38, 152576
    s_cmp_lt_u32 s32, 6
    s_cselect_b32 s38, s38, 2048
    s_cmp_lt_u32 s32, 4
    s_cselect_b32 s37, s37, s38
    s_cselect_b32 s51, 0, 55552
    s_add_u32 s37, s37, s39
    s_add_u32 s51, s51, s39
    s_add_u32 s51, s51, 10240
    s_add_u32 s4, s30, s37
    s_addc_u32 s5, s31, 0
    s_lshl_b32 s37, s39, 1
    s_add_u32 s37, s37, 25600
    s_add_u32 s6, s30, s37
    s_addc_u32 s7, s31, 0
    s_and_b32 s37, s36, 1
    s_lshl3_add_u32 s37, s37, s32
    s_lshl_b32 s37, s37, 10
    s_add_u32 s37, s37, 41984
    s_add_u32 s8, s30, s37
    s_addc_u32 s9, s31, 0
    s_and_b32 s47, s32, 1
    s_mov_b32 s40, s22
    s_mov_b32 s41, s23
    s_mov_b32 s42, 921600
    s_mov_b32 s43, 0x20000
    s_mov_b32 s22, 921600
    s_mov_b32 s23, 0x20000
    s_lshl4_add_u32 s38, s32, s36
    s_mul_i32 s18, s18, 56
    s_sub_u32 s37, 405, s18
    s_bitcmp1_b32 s19, 2
    s_cselect_b32 s44, -1, 1
    s_cselect_b32 s18, s37, s18
    s_cselect_b32 s10, 86, 0
    s_cselect_b32 s11, 30, 56
    s_lshl_b32 s18, s18, 1
    s_movk_i32 s37, 450
    s_mul_i32 s48, s38, s37
    s_mul_i32 s48, s48, s44
    s_add_u32 s48, s48, s18
    s_and_b32 s48, s48, 31
    v_lshrrev_b32 v2, 3, v3
    v_lshl_add_u32 v2, v2, 7, s38
    v_mul_i32_i24 v2, s44, v2
    v_and_b32 v84, 0x70, v1
    v_and_b32 v85, 32, v3
    v_lshlrev_b32 v85, 1, v85
    v_xor_b32 v84, v84, v85
    v_and_b32 v2, 0x7ff, v2
    v_subrev_u32 v84, s48, v84
    v_xor_b32 v83, 0x400, v2
    v_mad_u32_u24 v2, v2, s37, v84
    v_mad_u32_u24 v83, v83, s37, v84
    s_lshl_b32 s50, s32, 11
    s_add_u32 s50, s50, 35072
    s_add_u32 s10, s10, s48
    s_add_u32 s11, s11, s48
    v_and_b32 v80, 15, v3
    v_lshrrev_b32 v85, 4, v3
    v_mul_i32_i24 v81, s44, v80
    v_lshlrev_b32 v81, 1, v81
    v_add_u32 v82, s11, v81
    v_add_u32 v81, s10, v81
    v_and_b32 v84, 16, v3
    v_lshlrev_b32 v84, 2, v84
    v_xor_b32 v81, v81, v84
    v_xor_b32 v82, v82, v84
    v_lshl_add_u32 v84, v85, 9, s50
    v_add_u32 v81, v81, v84
    v_add_u32 v82, v82, v84
    v_lshlrev_b32 v80, 5, v80
    v_lshl_add_u32 v80, v85, 3, v80
    s_mul_i32 s36, s2, 16384
    s_lshl_b32 s38, s47, 13
    s_lshr_b32 s37, s32, 1
    s_lshl_b32 s39, s37, 8
    s_add_u32 s38, s38, s39
    s_add_u32 s38, s38, s36
    s_add_u32 s38, s38, 4194304
    s_add_u32 s10, s28, s38
    s_addc_u32 s11, s29, 0
    v_and_b32 v84, 3, v3
    v_and_b32 v85, 60, v3
    v_lshlrev_b32 v84, 3, v84
    v_lshl_add_u32 v84, v85, 3, v84
    v_add_u32 v84, s49, v84
    v_cmp_lt_u32 vcc, 47, v3
    v_add_u32 v85, 512, v84
    v_add_u32 v86, 384, v84
    v_cndmask_b32 v85, v85, v86, vcc
    s_lshl_b32 s38, s32, 3
    s_mul_i32 s39, s37, 384
    s_lshl_b32 s36, s47, 10
    v_add_u32 v86, s36, v1
    s_lshl_b32 s46, s37, 6
    s_mul_i32 s48, s47, 528
    s_add_u32 s48, s48, s46
    s_lshl_b32 s47, s47, 8
    s_add_u32 s47, s47, s46
    s_mul_i32 s45, s32, 2144
    s_mul_i32 s46, s32, 2240
    v_and_b32 v88, 7, v3
    v_add_u32 v6, 2, v88
    v_lshrrev_b32 v5, 1, v88
    v_lshrrev_b32 v7, 2, v88
    v_add_u32 v5, 1, v5
    v_add_u32 v7, 3, v7
    v_mov_b32 v4, v88
    s_waitcnt lgkmcnt(0)
    s_add_u32 s33, s33, 1
    s_and_b32 s34, s33, 3
    v_xor_b32 v4, s34, v4
    v_xor_b32 v5, s34, v5
    v_xor_b32 v6, s34, v6
    v_xor_b32 v7, s34, v7
    v_lshl_or_b32 v4, v4, 15, v4
    v_lshl_or_b32 v5, v5, 15, v5
    v_lshl_or_b32 v6, v6, 15, v6
    v_lshl_or_b32 v7, v7, 15, v7
    v_and_b32 v4, s3, v4
    v_and_b32 v5, s3, v5
    v_and_b32 v6, s3, v6
    v_and_b32 v7, s3, v7
    s_mov_b32 s35, 0x8000
    s_brev_b32 s49, 1
    s_waitcnt vmcnt(0)
    s_barrier
    s_setprio 3
    ds_read_b64_tr_b16 v[88:89], v84 offset:0
    ds_read_b64_tr_b16 v[90:91], v85 offset:0
    ds_read_b128 v[8:11], v1 offset:0
    ds_read_b128 v[12:15], v1 offset:1024
    ds_read_b64_tr_b16 v[92:93], v84 offset:896
    ds_read_b64_tr_b16 v[94:95], v85 offset:896
    ds_read_b128 v[16:19], v1 offset:2048
    ds_read_b128 v[20:23], v1 offset:3072
    ds_read_b128 v[24:27], v1 offset:4096
    ds_read_b128 v[28:31], v1 offset:5120
    ds_read_b128 v[120:123], v1 offset:7168
    ds_read_b128 v[116:119], v1 offset:6144
    ds_read_b128 v[32:35], v86 offset:8192
    s_mov_b32 m0, s51
    s_nop 0
    global_load_lds_dwordx4 v1, s[4:5]
    s_waitcnt lgkmcnt(9)
    v_mfma_f32_16x16x32_bf16 v[96:99], v[88:91], v[8:11], 0
    v_mfma_f32_16x16x32_bf16 v[100:103], v[88:91], v[12:15], 0
    global_load_dwordx4 v[52:55], v1, s[6:7] offset:0
    s_waitcnt lgkmcnt(7)
    v_mfma_f32_16x16x32_bf16 v[104:107], v[92:95], v[8:11], 0
    v_mfma_f32_16x16x32_bf16 v[108:111], v[92:95], v[12:15], 0
    global_load_dwordx4 v[60:63], v1, s[8:9] offset:0
    s_waitcnt lgkmcnt(3)
    s_nop 1
    v_mul_f32_e64 v112, v100, v20
    v_mul_f32_e64 v113, v96, v20
    v_mul_f32_e64 v114, v101, v21
    v_mul_f32_e64 v115, v97, v21
    v_fma_f32 v96, v96, v16, -v112
    v_fma_f32 v100, v100, v16, v113
    v_fma_f32 v97, v97, v17, -v114
    v_fma_f32 v101, v101, v17, v115
    v_mul_f32_e64 v112, v102, v22
    v_mul_f32_e64 v113, v98, v22
    v_mul_f32_e64 v114, v103, v23
    v_mul_f32_e64 v115, v99, v23
    v_fma_f32 v98, v98, v18, -v112
    v_fma_f32 v102, v102, v18, v113
    v_fma_f32 v99, v99, v19, -v114
    v_fma_f32 v103, v103, v19, v115
    v_cvt_pk_bf16_f32 v88, v96, v100
    v_cvt_pk_bf16_f32 v89, v97, v101
    v_cvt_pk_bf16_f32 v90, v98, v102
    v_cvt_pk_bf16_f32 v91, v99, v103
    s_nop 1
    v_mfma_f32_16x16x32_bf16 v[96:99], v[24:27], v[88:91], 0
    v_mfma_f32_16x16x32_bf16 v[100:103], v[28:31], v[88:91], 0
    v_mul_f32 v112, v108, v20
    v_mul_f32_e64 v113, v104, v20
    v_mul_f32_e64 v114, v109, v21
    v_mul_f32_e64 v115, v105, v21
    v_fma_f32 v104, v104, v16, -v112
    v_fma_f32 v108, v108, v16, v113
    v_fma_f32 v105, v105, v17, -v114
    v_fma_f32 v109, v109, v17, v115
    v_mul_f32_e64 v112, v110, v22
    v_mul_f32_e64 v113, v106, v22
    v_mul_f32_e64 v114, v111, v23
    v_mul_f32_e64 v115, v107, v23
    v_fma_f32 v106, v106, v18, -v112
    v_fma_f32 v110, v110, v18, v113
    v_fma_f32 v107, v107, v19, -v114
    v_fma_f32 v111, v111, v19, v115
    v_cvt_pk_bf16_f32 v92, v104, v108
    v_cvt_pk_bf16_f32 v93, v105, v109
    v_cvt_pk_bf16_f32 v94, v106, v110
    v_cvt_pk_bf16_f32 v95, v107, v111
    s_nop 1
    v_mfma_f32_16x16x32_bf16 v[104:107], v[24:27], v[92:95], 0
    v_mfma_f32_16x16x32_bf16 v[108:111], v[28:31], v[92:95], 0
    s_waitcnt lgkmcnt(2)
    v_add_u32_e64 v122, s38, v122
    v_add_u32 v123, s39, v123
    v_cvt_pk_bf16_f32 v88, v96, v100
    s_nop 3
    v_cvt_pk_bf16_f32 v89, v104, v108
    ds_write_b64 v122, v[88:89] offset:0
    v_cvt_pk_bf16_f32 v90, v97, v101
    v_cvt_pk_bf16_f32 v91, v105, v109
    ds_write_b64 v122, v[90:91] offset:96
    v_cvt_pk_bf16_f32 v92, v98, v102
    v_cvt_pk_bf16_f32 v93, v106, v110
    ds_write_b64 v122, v[92:93] offset:192
    v_cvt_pk_bf16_f32 v94, v99, v103
    v_cvt_pk_bf16_f32 v95, v107, v111
    ds_write_b64 v122, v[94:95] offset:288
    s_waitcnt lgkmcnt(0)
    s_barrier
    ds_read_b128 v[84:87], v123 offset:0
    ds_read_b128 v[88:91], v123 offset:1552
    ds_read_b128 v[92:95], v123 offset:3104
    ds_read_b128 v[96:99], v123 offset:4656
    s_waitcnt lgkmcnt(3)
    v_mfma_f32_16x16x32_bf16 v[100:103], v[32:35], v[84:87], 0
    s_waitcnt lgkmcnt(2)
    v_mfma_f32_16x16x32_bf16 v[104:107], v[32:35], v[88:91], 0
    s_waitcnt lgkmcnt(1)
    v_mfma_f32_16x16x32_bf16 v[108:111], v[32:35], v[92:95], 0
    s_waitcnt lgkmcnt(0)
    v_mfma_f32_16x16x32_bf16 v[112:115], v[32:35], v[96:99], 0
    s_nop 1
    v_cvt_pk_bf16_f32 v84, v100, v101
    s_nop 0
    v_cvt_pk_bf16_f32 v85, v104, v105
    s_nop 0
    v_cvt_pk_bf16_f32 v86, v108, v109
    s_nop 0
    v_cvt_pk_bf16_f32 v87, v112, v113
    v_bfi_b32 v84, s3, v4, v84
    v_bfi_b32 v85, s3, v5, v85
    v_bfi_b32 v86, s3, v6, v86
    v_bfi_b32 v87, s3, v7, v87
    global_store_dwordx4 v116, v[84:87], s[10:11] offset:0 sc1
    v_cvt_pk_bf16_f32 v88, v102, v103
    v_cvt_pk_bf16_f32 v89, v106, v107
    v_cvt_pk_bf16_f32 v90, v110, v111
    v_cvt_pk_bf16_f32 v91, v114, v115
    v_bfi_b32 v88, s3, v4, v88
    v_bfi_b32 v89, s3, v5, v89
    v_bfi_b32 v90, s3, v6, v90
    v_bfi_b32 v91, s3, v7, v91
    global_store_dwordx4 v116, v[88:91], s[10:11] offset:1024 sc1
    s_waitcnt vmcnt(2)
    s_barrier
    s_nop 0
    s_setprio 1
    ds_read_b128 v[36:39], v1 offset:10240
    ds_read_b128 v[40:43], v1 offset:11264
    ds_read_b128 v[44:47], v1 offset:12288
    ds_read_b128 v[48:51], v1 offset:13312
    s_lshl_b32 s36, s19, 7
    s_mul_i32 s38, s32, 32768
    s_add_u32 s38, s38, s36
    s_add_u32 s38, s38, 4194304
    s_add_u32 s12, s28, s38
    s_addc_u32 s13, s29, 0
    s_mul_i32 s36, s2, 16384
    s_lshl_b32 s38, s32, 7
    s_add_u32 s38, s38, s36
    s_add_u32 s38, s38, 4194304
    s_add_u32 s16, s28, s38
    s_addc_u32 s17, s29, 0
    s_lshl_b32 s38, s32, 7
    s_add_u32 s38, s38, s2
    s_mul_i32 s38, s38, 1792
    s_add_u32 s38, s38, 896
    s_add_u32 s24, s24, s38
    s_addc_u32 s25, s25, 0
    v_add_u32_e64 v120, s47, v120
    v_add_u32_e64 v121, s48, v121
    v_mov_b32_e64 v122, v80
    v_mov_b32_e64 v94, v81
    v_mov_b32_e64 v95, v82
    v_add_u32 v123, 2144, v120
    v_add_u32 v125, 262144, v117
    v_add_u32 v3, 2048, v119
    v_xor_b32_e64 v24, s49, v24
    v_xor_b32_e64 v28, s35, v28
    v_xor_b32_e64 v25, s49, v25
    v_xor_b32_e64 v29, s35, v29
    v_xor_b32_e64 v26, s49, v26
    v_xor_b32_e64 v30, s35, v30
    v_xor_b32_e64 v27, s49, v27
    v_xor_b32_e64 v31, s35, v31
    v_alignbit_b32 v56, v52, v52, 16
    v_alignbit_b32 v57, v53, v53, 16
    v_alignbit_b32 v58, v54, v54, 16
    v_alignbit_b32 v59, v55, v55, 16
    v_xor_b32_e64 v56, s35, v56
    v_xor_b32_e64 v57, s35, v57
    v_xor_b32_e64 v58, s35, v58
    v_xor_b32_e64 v59, s35, v59
    v_alignbit_b32 v64, v60, v60, 16
    v_alignbit_b32 v65, v61, v61, 16
    v_alignbit_b32 v66, v62, v62, 16
    v_alignbit_b32 v67, v63, v63, 16
    v_xor_b32_e64 v64, s35, v64
    v_xor_b32_e64 v65, s35, v65
    v_xor_b32_e64 v66, s35, v66
    v_xor_b32 v67, s35, v67
    s_cmp_lt_u32 s2, 96
    s_cbranch_scc1 L_B_s1
    s_sleep 10
L_B_s1:
    s_sleep 18
    global_load_dwordx4 v[84:87], v117, s[12:13] sc1
    global_load_dwordx4 v[88:91], v125, s[12:13] sc1
    s_add_u32 s8, s24, 1835008
    s_addc_u32 s9, s25, 0
    s_waitcnt lgkmcnt(0)
    s_setprio 1
    s_mov_b32 s52, 0
    s_waitcnt vmcnt(0)
    s_branch L_x1_w
L_x1_p:
    global_load_dwordx4 v[84:87], v117, s[12:13] sc1
    global_load_dwordx4 v[88:91], v125, s[12:13] sc1
    s_waitcnt vmcnt(0)
L_x1_w:
    s_add_u32 s52, s52, 1
    v_xor_b32_e64 v92, v84, v4
    v_bitop3_b32 v92, v92, v85, v5 bitop3:0xf6
    v_bitop3_b32 v92, v92, v86, v6 bitop3:0xf6
    v_bitop3_b32 v92, v92, v87, v7 bitop3:0xf6
    v_bitop3_b32 v92, v92, v88, v4 bitop3:0xf6
    v_bitop3_b32 v92, v92, v89, v5 bitop3:0xf6
    v_bitop3_b32 v92, v92, v90, v6 bitop3:0xf6
    v_bitop3_b32 v92, v92, v91, v7 bitop3:0xf6
    v_and_b32_e64 v92, s3, v92
    v_cmp_ne_u32 vcc, 0, v92
    s_cbranch_vccz L_x1_d
    s_cmp_gt_u32 s52, 100000
    s_cbranch_scc1 L_x1_d
    s_wqm_b64 vcc, vcc
    s_mov_b32 s36, 0x0f0f0f0f
    s_mov_b32 s37, s36
    s_lshr_b64 s[38:39], vcc, 4
    s_or_b64 s[38:39], s[38:39], vcc
    s_and_b64 s[38:39], s[38:39], s[36:37]
    s_lshl_b64 vcc, s[38:39], 4
    s_or_b64 exec, vcc, s[38:39]
    s_sleep 2
    s_branch L_x1_p
L_x1_d:
    s_mov_b64 exec, -1
    s_add_u32 m0, s50, 18432
    s_nop 0
    buffer_load_dwordx4 v2, s[20:23], s18 offen lds
    s_add_u32 m0, s50, 19456
    s_nop 0
    buffer_load_dwordx4 v83, s[20:23], s18 offen lds
    s_add_u32 m0, s50, 0
    s_nop 0
    buffer_load_dwordx4 v2, s[40:43], s18 offen lds
    s_add_u32 m0, s50, 1024
    s_nop 0
    buffer_load_dwordx4 v83, s[40:43], s18 offen lds
    v_mov_b32_e64 v2, v81
    v_mov_b32_e64 v0, v82
    v_swap_b32 v86, v88
    v_swap_b32 v87, v89
    s_mov_b32 m0, s45
    s_nop 0
    v_mfma_f32_16x16x32_bf16 v[92:95], v[36:39], v[84:87], 0
    v_mfma_f32_16x16x32_bf16 v[96:99], v[40:43], v[84:87], 0
    v_mfma_f32_16x16x32_bf16 v[100:103], v[36:39], v[88:91], 0
    v_mfma_f32_16x16x32_bf16 v[104:107], v[40:43], v[88:91], 0
    global_load_dwordx4 v[32:35], v1, s[6:7] offset:1024
    v_mov_b32_e64 v118, v125
    v_xor_b32 v4, 0x10000, v4
    v_xor_b32 v5, 0x10000, v5
    v_xor_b32 v6, 0x10000, v6
    v_xor_b32 v7, 0x10000, v7
    v_cvt_pk_bf16_f32 v108, v92, v96
    ds_write_addtid_b32 v108 offset:17920
    v_cvt_pk_bf16_f32 v109, v93, v97
    ds_write_addtid_b32 v109 offset:18176
    v_cvt_pk_bf16_f32 v110, v94, v98
    ds_write_addtid_b32 v110 offset:18448
    v_cvt_pk_bf16_f32 v111, v95, v99
    ds_write_addtid_b32 v111 offset:18704
    v_cvt_pk_bf16_f32 v112, v100, v104
    ds_write_addtid_b32 v112 offset:18976
    v_cvt_pk_bf16_f32 v113, v101, v105
    ds_write_addtid_b32 v113 offset:19232
    v_cvt_pk_bf16_f32 v114, v102, v106
    ds_write_addtid_b32 v114 offset:19504
    v_cvt_pk_bf16_f32 v115, v103, v107
    ds_write_addtid_b32 v115 offset:19760
    s_waitcnt lgkmcnt(0)
    s_barrier
    ds_read2_b32 v[84:85], v120 offset0:0 offset1:8
    ds_read2_b32 v[86:87], v123 offset0:0 offset1:8
    ds_read2_b32 v[88:89], v120 offset0:4 offset1:12
    ds_read2_b32 v[90:91], v123 offset0:4 offset1:12
    s_nop 0
    s_waitcnt vmcnt(1)
    ds_read_u16_d16_hi v76, v2 offset:0
    ds_read_u16_d16_hi v68, v2 offset:18432
    ds_read_u16_d16_hi v77, v2 offset:128
    ds_read_u16_d16_hi v69, v2 offset:18560
    ds_read_u16_d16_hi v78, v2 offset:256
    ds_read_u16_d16_hi v70, v2 offset:18688
    ds_read_u16_d16_hi v79, v2 offset:384
    ds_read_u16_d16_hi v71, v2 offset:18816
    s_waitcnt lgkmcnt(10)
    v_mfma_f32_16x16x32_bf16 v[92:95], v[52:55], v[84:87], 0
    v_mfma_f32_16x16x32_bf16 v[96:99], v[56:59], v[84:87], 0
    ds_read_u16_d16_hi v80, v0 offset:0
    ds_read_u16_d16_hi v72, v0 offset:18432
    ds_read_u16_d16_hi v81, v0 offset:128
    ds_read_u16_d16_hi v73, v0 offset:18560
    s_waitcnt lgkmcnt(12)
    v_mfma_f32_16x16x32_bf16 v[100:103], v[52:55], v[88:91], 0
    v_mfma_f32_16x16x32_bf16 v[104:107], v[56:59], v[88:91], 0
    ds_read_u16_d16_hi v82, v0 offset:256
    ds_read_u16_d16_hi v74, v0 offset:18688
    ds_read_u16_d16_hi v83, v0 offset:384
    ds_read_u16_d16_hi v75, v0 offset:18816
    s_waitcnt lgkmcnt(8)
    s_mov_b32 m0, s46
    s_bitcmp1_b32 s19, 2
    s_cbranch_scc1 L_B_mir
    v_mul_f32_e64 v108, v96, v76
    v_mul_f32_e64 v109, v92, v76
    v_mul_f32_e64 v110, v97, v77
    v_mul_f32_e64 v111, v93, v77
    v_fma_f32 v92, v92, v68, -v108
    v_fma_f32 v96, v96, v68, v109
    v_fma_f32 v93, v93, v69, -v110
    v_fma_f32 v97, v97, v69, v111
    v_mul_f32_e64 v108, v98, v78
    v_mul_f32_e64 v109, v94, v78
    v_mul_f32_e64 v110, v99, v79
    v_mul_f32_e64 v111, v95, v79
    v_fma_f32 v94, v94, v70, -v108
    v_fma_f32 v98, v98, v70, v109
    v_fma_f32 v95, v95, v71, -v110
    v_fma_f32 v99, v99, v71, v111
    v_cvt_pk_bf16_f32 v84, v92, v96
    v_cvt_pk_bf16_f32 v85, v93, v97
    v_cvt_pk_bf16_f32 v86, v94, v98
    v_cvt_pk_bf16_f32 v87, v95, v99
    s_nop 1
    v_mfma_f32_16x16x32_bf16 v[92:95], v[60:63], v[84:87], 0
    v_mfma_f32_16x16x32_bf16 v[96:99], v[64:67], v[84:87], 0
    s_waitcnt lgkmcnt(0)
    v_mul_f32_e64 v108, v104, v80
    v_mul_f32_e64 v109, v100, v80
    v_mul_f32_e64 v110, v105, v81
    v_mul_f32_e64 v111, v101, v81
    v_fma_f32 v100, v100, v72, -v108
    v_fma_f32 v104, v104, v72, v109
    v_fma_f32 v101, v101, v73, -v110
    v_fma_f32 v105, v105, v73, v111
    v_mul_f32_e64 v108, v106, v82
    v_mul_f32_e64 v109, v102, v82
    v_mul_f32_e64 v110, v107, v83
    v_mul_f32_e64 v111, v103, v83
    v_fma_f32 v102, v102, v74, -v108
    v_fma_f32 v106, v106, v74, v109
    v_fma_f32 v103, v103, v75, -v110
    v_fma_f32 v107, v107, v75, v111
    v_cvt_pk_bf16_f32 v88, v100, v104
    v_cvt_pk_bf16_f32 v89, v101, v105
    v_cvt_pk_bf16_f32 v90, v102, v106
    v_cvt_pk_bf16_f32 v91, v103, v107
    s_nop 1
    v_mfma_f32_16x16x32_bf16 v[100:103], v[60:63], v[88:91], 0
    v_mfma_f32_16x16x32_bf16 v[104:107], v[64:67], v[88:91], 0
    s_branch L_B_mj
L_B_mir:
    v_mul_f32_e64 v108, v96, v76
    v_mul_f32_e64 v109, v92, v76
    v_mul_f32_e64 v110, v97, v77
    v_mul_f32_e64 v111, v93, v77
    v_fma_f32 v92, v92, v68, v108
    v_fma_f32 v96, v96, v68, -v109
    v_fma_f32 v93, v93, v69, v110
    v_fma_f32 v97, v97, v69, -v111
    v_mul_f32_e64 v108, v98, v78
    v_mul_f32_e64 v109, v94, v78
    v_mul_f32_e64 v110, v99, v79
    v_mul_f32_e64 v111, v95, v79
    v_fma_f32 v94, v94, v70, v108
    v_fma_f32 v98, v98, v70, -v109
    v_fma_f32 v95, v95, v71, v110
    v_fma_f32 v99, v99, v71, -v111
    v_cvt_pk_bf16_f32 v84, v92, v96
    v_cvt_pk_bf16_f32 v85, v93, v97
    v_cvt_pk_bf16_f32 v86, v94, v98
    v_cvt_pk_bf16_f32 v87, v95, v99
    s_nop 1
    v_mfma_f32_16x16x32_bf16 v[92:95], v[60:63], v[84:87], 0
    v_mfma_f32_16x16x32_bf16 v[96:99], v[64:67], v[84:87], 0
    s_waitcnt lgkmcnt(0)
    v_mul_f32_e64 v108, v104, v80
    v_mul_f32_e64 v109, v100, v80
    v_mul_f32_e64 v110, v105, v81
    v_mul_f32_e64 v111, v101, v81
    v_fma_f32 v100, v100, v72, v108
    v_fma_f32 v104, v104, v72, -v109
    v_fma_f32 v101, v101, v73, v110
    v_fma_f32 v105, v105, v73, -v111
    v_mul_f32_e64 v108, v106, v82
    v_mul_f32_e64 v109, v102, v82
    v_mul_f32_e64 v110, v107, v83
    v_mul_f32_e64 v111, v103, v83
    v_fma_f32 v102, v102, v74, v108
    v_fma_f32 v106, v106, v74, -v109
    v_fma_f32 v103, v103, v75, v110
    v_fma_f32 v107, v107, v75, -v111
    v_cvt_pk_bf16_f32 v88, v100, v104
    v_cvt_pk_bf16_f32 v89, v101, v105
    v_cvt_pk_bf16_f32 v90, v102, v106
    v_cvt_pk_bf16_f32 v91, v103, v107
    s_nop 0
    s_nop 1
    v_mfma_f32_16x16x32_bf16 v[100:103], v[60:63], v[88:91], 0
    v_mfma_f32_16x16x32_bf16 v[104:107], v[64:67], v[88:91], 0
L_B_mj:
    v_cvt_pk_bf16_f32 v108, v92, v96
    ds_write_addtid_b32 v108 offset:0
    v_cvt_pk_bf16_f32 v109, v93, v97
    ds_write_addtid_b32 v109 offset:264
    v_cvt_pk_bf16_f32 v110, v94, v98
    ds_write_addtid_b32 v110 offset:528
    v_cvt_pk_bf16_f32 v111, v95, v99
    ds_write_addtid_b32 v111 offset:792
    v_cvt_pk_bf16_f32 v112, v100, v104
    ds_write_addtid_b32 v112 offset:1088
    v_cvt_pk_bf16_f32 v113, v101, v105
    ds_write_addtid_b32 v113 offset:1352
    v_cvt_pk_bf16_f32 v114, v102, v106
    ds_write_addtid_b32 v114 offset:1616
    v_cvt_pk_bf16_f32 v115, v103, v107
    ds_write_addtid_b32 v115 offset:1880
    s_waitcnt lgkmcnt(0)
    s_barrier
    ds_read_b64 v[84:85], v121 offset:0
    ds_read_b64 v[86:87], v121 offset:2240
    ds_read_b64 v[88:89], v121 offset:8
    ds_read_b64 v[90:91], v121 offset:2248
    s_waitcnt lgkmcnt(2)
    v_mfma_f32_16x16x32_bf16 v[92:95], v[44:47], v[84:87], 0
    v_mfma_f32_16x16x32_bf16 v[96:99], v[48:51], v[84:87], 0
    s_waitcnt lgkmcnt(0)
    v_mfma_f32_16x16x32_bf16 v[100:103], v[44:47], v[88:91], 0
    v_mfma_f32_16x16x32_bf16 v[104:107], v[48:51], v[88:91], 0
    s_nop 4
    v_cvt_pk_bf16_f32 v108, v92, v96
    v_cvt_pk_bf16_f32 v109, v93, v97
    s_nop 0
    v_cvt_pk_bf16_f32 v110, v100, v104
    v_cvt_pk_bf16_f32 v111, v101, v105
    v_bfi_b32 v108, s3, v4, v108
    v_bfi_b32 v109, s3, v5, v109
    v_bfi_b32 v110, s3, v6, v110
    v_bfi_b32 v111, s3, v7, v111
    global_store_dwordx4 v117, v[108:111], s[12:13] sc1
    v_cvt_pk_bf16_f32 v112, v94, v98
    v_cvt_pk_bf16_f32 v113, v95, v99
    v_cvt_pk_bf16_f32 v114, v102, v106
    v_cvt_pk_bf16_f32 v115, v103, v107
    v_bfi_b32 v112, s3, v4, v112
    v_bfi_b32 v113, s3, v5, v113
    v_bfi_b32 v114, s3, v6, v114
    v_bfi_b32 v115, s3, v7, v115
    global_store_dwordx4 v118, v[112:115], s[12:13] sc1
    v_add_u32 v92, 69888, v1
    ds_read_b128 v[8:11], v92 offset:0
    ds_read_b128 v[40:43], v92 offset:1024
    ds_read_b128 v[12:15], v92 offset:2048
    ds_read_b128 v[36:39], v92 offset:3072
    s_nop 0
    s_waitcnt vmcnt(2)
    v_alignbit_b32 v124, v32, v32, 16
    v_alignbit_b32 v125, v33, v33, 16
    v_alignbit_b32 v126, v34, v34, 16
    v_alignbit_b32 v127, v35, v35, 16
    v_xor_b32_e64 v124, s35, v124
    v_xor_b32_e64 v125, s35, v125
    v_xor_b32_e64 v126, s35, v126
    v_xor_b32 v127, s35, v127
    s_waitcnt lgkmcnt(0)
    s_cmp_lt_u32 s2, 96
    s_cbranch_scc1 L_B_s2
    s_sleep 8
L_B_s2:
    s_sleep 24
    s_mov_b32 s53, 0
L_x2_p:
    global_load_dwordx4 v[84:87], v119, s[16:17] sc1
    global_load_dwordx4 v[88:91], v3, s[16:17] sc1
    s_waitcnt vmcnt(0)
    s_add_u32 s53, s53, 1
    v_xor_b32_e64 v92, v84, v4
    v_bitop3_b32 v92, v92, v85, v5 bitop3:0xf6
    v_bitop3_b32 v92, v92, v86, v6 bitop3:0xf6
    v_bitop3_b32 v92, v92, v87, v7 bitop3:0xf6
    v_bitop3_b32 v92, v92, v88, v4 bitop3:0xf6
    v_bitop3_b32 v92, v92, v89, v5 bitop3:0xf6
    v_bitop3_b32 v92, v92, v90, v6 bitop3:0xf6
    v_bitop3_b32 v92, v92, v91, v7 bitop3:0xf6
    v_and_b32_e64 v92, s3, v92
    v_cmp_ne_u32 vcc, 0, v92
    s_cbranch_vccz L_x2_d
    s_cmp_gt_u32 s53, 100000
    s_cbranch_scc1 L_x2_d
    s_wqm_b64 vcc, vcc
    s_mov_b32 s36, 0x0f0f0f0f
    s_mov_b32 s37, s36
    s_lshr_b64 s[38:39], vcc, 4
    s_or_b64 s[38:39], s[38:39], vcc
    s_and_b64 s[38:39], s[38:39], s[36:37]
    s_lshl_b64 vcc, s[38:39], 4
    s_or_b64 exec, vcc, s[38:39]
    s_sleep 2
    s_branch L_x2_p
L_x2_d:
    s_mov_b64 exec, -1
    v_swap_b32 v86, v88
    v_swap_b32 v87, v89
    s_mov_b32 m0, s45
    s_nop 0
    v_mfma_f32_16x16x32_bf16 v[92:95], v[8:11], v[84:87], 0
    v_mfma_f32_16x16x32_bf16 v[96:99], v[40:43], v[84:87], 0
    v_mfma_f32_16x16x32_bf16 v[100:103], v[8:11], v[88:91], 0
    v_mfma_f32_16x16x32_bf16 v[104:107], v[40:43], v[88:91], 0
    s_nop 5
    v_cvt_pk_bf16_f32 v108, v92, v96
    ds_write_addtid_b32 v108 offset:17920
    v_cvt_pk_bf16_f32 v109, v93, v97
    ds_write_addtid_b32 v109 offset:18176
    v_cvt_pk_bf16_f32 v110, v94, v98
    ds_write_addtid_b32 v110 offset:18448
    v_cvt_pk_bf16_f32 v111, v95, v99
    ds_write_addtid_b32 v111 offset:18704
    v_cvt_pk_bf16_f32 v112, v100, v104
    ds_write_addtid_b32 v112 offset:18976
    v_cvt_pk_bf16_f32 v113, v101, v105
    ds_write_addtid_b32 v113 offset:19232
    v_cvt_pk_bf16_f32 v114, v102, v106
    ds_write_addtid_b32 v114 offset:19504
    v_cvt_pk_bf16_f32 v115, v103, v107
    ds_write_addtid_b32 v115 offset:19760
    s_waitcnt lgkmcnt(0)
    s_barrier
    ds_read2_b32 v[84:85], v120 offset0:0 offset1:4
    ds_read2_b32 v[86:87], v123 offset0:0 offset1:4
    ds_read2_b32 v[88:89], v120 offset0:8 offset1:12
    ds_read2_b32 v[90:91], v123 offset0:8 offset1:12
    s_waitcnt lgkmcnt(2)
    v_mfma_f32_16x16x32_bf16 v[92:95], v[84:87], v[24:27], 0
    v_mfma_f32_16x16x32_bf16 v[96:99], v[84:87], v[28:31], 0
    s_waitcnt lgkmcnt(0)
    v_mfma_f32_16x16x32_bf16 v[100:103], v[88:91], v[32:35], 0
    v_mfma_f32_16x16x32_bf16 v[104:107], v[88:91], v[124:127], 0
    s_nop 6
    v_add_f32 v108, v92, v100
    v_add_f32_e64 v109, v93, v101
    v_add_f32_e64 v110, v94, v102
    v_add_f32_e64 v111, v95, v103
    v_add_f32_e64 v112, v96, v104
    v_add_f32_e64 v113, v97, v105
    v_add_f32_e64 v114, v98, v106
    v_add_f32_e64 v115, v99, v107
    v_sub_f32_e64 v92, v92, v100
    v_sub_f32_e64 v93, v93, v101
    v_sub_f32_e64 v94, v94, v102
    v_sub_f32_e64 v95, v95, v103
    v_sub_f32_e64 v96, v96, v104
    v_sub_f32_e64 v97, v97, v105
    v_sub_f32_e64 v98, v98, v106
    v_sub_f32_e64 v99, v99, v107
    v_mul_f32_e64 v100, v112, v20
    v_mul_f32_e64 v101, v108, v20
    v_mul_f32_e64 v102, v113, v21
    v_mul_f32_e64 v103, v109, v21
    v_fma_f32 v108, v108, v16, v100
    v_fma_f32 v112, v112, v16, -v101
    v_fma_f32 v109, v109, v17, v102
    v_fma_f32 v113, v113, v17, -v103
    v_mul_f32_e64 v100, v114, v22
    v_mul_f32_e64 v101, v110, v22
    v_mul_f32_e64 v102, v115, v23
    v_mul_f32_e64 v103, v111, v23
    v_fma_f32 v110, v110, v18, v100
    v_fma_f32 v114, v114, v18, -v101
    v_fma_f32 v111, v111, v19, v102
    v_fma_f32 v115, v115, v19, -v103
    v_cvt_pk_bf16_f32 v84, v108, v112
    v_cvt_pk_bf16_f32 v85, v109, v113
    v_cvt_pk_bf16_f32 v86, v110, v114
    v_cvt_pk_bf16_f32 v87, v111, v115
    v_mul_f32_e64 v100, v96, v20
    v_mul_f32_e64 v101, v92, v20
    v_mul_f32_e64 v102, v97, v21
    v_mul_f32_e64 v103, v93, v21
    v_fma_f32 v92, v92, v16, v100
    v_fma_f32 v96, v96, v16, -v101
    v_fma_f32 v93, v93, v17, v102
    v_fma_f32 v97, v97, v17, -v103
    v_mul_f32_e64 v100, v98, v22
    v_mul_f32_e64 v101, v94, v22
    v_mul_f32_e64 v102, v99, v23
    v_mul_f32_e64 v103, v95, v23
    v_fma_f32 v94, v94, v18, v100
    v_fma_f32 v98, v98, v18, -v101
    v_fma_f32 v95, v95, v19, v102
    v_fma_f32 v99, v99, v19, -v103
    v_cvt_pk_bf16_f32 v88, v92, v96
    v_cvt_pk_bf16_f32 v89, v93, v97
    v_cvt_pk_bf16_f32 v90, v94, v98
    v_cvt_pk_bf16_f32 v91, v95, v99
    v_mfma_f32_16x16x32_bf16 v[92:95], v[84:87], v[12:15], 0
    v_mfma_f32_16x16x32_bf16 v[96:99], v[84:87], v[36:39], 0
    v_mfma_f32_16x16x32_bf16 v[100:103], v[88:91], v[12:15], 0
    v_mfma_f32_16x16x32_bf16 v[104:107], v[88:91], v[36:39], 0
    s_nop 0
    s_nop 4
    v_cvt_pk_bf16_f32 v108, v92, v93
    v_cvt_pk_bf16_f32 v109, v94, v95
    global_store_dwordx2 v122, v[108:109], s[24:25] sc1
    v_cvt_pk_bf16_f32 v112, v100, v101
    v_cvt_pk_bf16_f32 v113, v102, v103
    global_store_dwordx2 v122, v[112:113], s[8:9] sc1
    v_cvt_pk_bf16_f32 v110, v96, v97
    v_cvt_pk_bf16_f32 v111, v98, v99
    v_cvt_pk_bf16_f32 v114, v104, v105
    v_cvt_pk_bf16_f32 v115, v106, v107
    s_mov_b32 exec_lo, 0x0fff0fff
    s_mov_b32 exec_hi, 0x0fff0fff
    global_store_dwordx2 v122, v[110:111], s[24:25] offset:512 sc1
    global_store_dwordx2 v122, v[114:115], s[8:9] offset:512 sc1
    s_or_b32 s36, s2, s32
    s_cmp_lg_u32 s36, 0
    s_cbranch_scc1 L_B_noep
    s_mov_b64 exec, 1
    v_mov_b32_e64 v2, 0
    v_mov_b32_e64 v3, s33
    global_store_dword v2, v3, s[28:29] sc1
L_B_noep:
    s_endpgm
L_A:
    s_setprio 2
    s_mov_b32 s3, 65537
    s_lshl_b32 s49, s32, 10
    global_load_dwordx4 v[8:11], v50, s[10:11] offset:0 nt
    s_lshl_b32 s36, s32, 2
    s_add_u32 s36, s36, 9216
    v_mov_b32 v62, s36
    v_mov_b32 v61, 0
    ds_write_b32 v62, v61
    v_and_b32 v63, 7, v3
    v_lshlrev_b32 v63, 2, v63
    v_mov_b32 v61, 1
    s_mul_i32 s47, s32, 8704
    s_mov_b32 m0, s47
    s_lshr_b32 s48, s32, 2
    s_lshl_b32 s35, s32, 4
    v_mov_b32 v100, 0x3fb8aa3b
    s_mov_b32 s4, 0x41000000
    s_mov_b32 s5, 0x41000000
    s_mov_b32 s6, 0x43800000
    s_mov_b32 s7, 0x43800000
    s_and_b32 s8, s32, 3
    s_lshl_b32 s39, s8, 10
    v_add_u32 v109, s39, v1
    v_lshrrev_b32 v2, 1, v109
    s_waitcnt lgkmcnt(0)
    s_cmp_eq_u32 s48, 0
    s_cselect_b32 s36, 16, 0
    s_lshl_b32 s50, s50, s36
    s_and_b32 s50, s50, 0xffff0000
    v_mul_f32 v101, s50, v100
    v_exp_f32 v101, v101
    s_nop 0
    v_cvt_pk_bf16_f32 v101, v101, v101
    v_lshlrev_b32 v31, 16, v101
    s_barrier
    v_bfe_u32 v12, v3, 2, 3
    v_mul_u32_u24 v12, 1040, v12
    v_lshrrev_b32 v110, 5, v3
    v_and_b32 v111, 3, v3
    v_lshl_add_u32 v111, v110, 2, v111
    v_lshl_add_u32 v12, v111, 1, v12
    v_xor_b32 v12, s35, v12
    v_lshrrev_b32 v111, 3, v3
    v_and_b32 v16, 0x70, v1
    v_lshl_add_u32 v13, v111, 7, v16
    v_lshl_add_u32 v16, v111, 12, v16
    v_xor_b32 v13, s35, v13
    v_add_u32 v13, s49, v13
    v_and_b32 v111, 31, v3
    v_mul_u32_u24 v17, 272, v111
    v_lshl_add_u32 v17, v110, 4, v17
    s_add_u32 s36, s47, 10240
    v_add_u32 v17, s36, v17
    v_and_b32 v111, 7, v3
    v_add_u32 v6, 2, v111
    v_lshrrev_b32 v5, 1, v111
    v_lshrrev_b32 v7, 2, v111
    v_add_u32 v5, 1, v5
    v_add_u32 v7, 3, v7
    v_mov_b32 v4, v111
    s_waitcnt lgkmcnt(0)
    s_add_u32 s33, s33, 1
    s_and_b32 s34, s33, 3
    v_xor_b32 v4, s34, v4
    v_xor_b32 v5, s34, v5
    v_xor_b32 v6, s34, v6
    v_xor_b32 v7, s34, v7
    v_lshl_or_b32 v4, v4, 15, v4
    v_lshl_or_b32 v5, v5, 15, v5
    v_lshl_or_b32 v6, v6, 15, v6
    v_lshl_or_b32 v7, v7, 15, v7
    v_and_b32 v4, s3, v4
    v_and_b32 v5, s3, v5
    v_and_b32 v6, s3, v6
    v_and_b32 v7, s3, v7
    s_add_u32 s42, s30, 12288
    s_addc_u32 s43, s31, 0
    s_add_u32 s14, s30, 19456
    s_addc_u32 s15, s31, 0
    s_waitcnt vmcnt(1)
    global_load_dwordx4 v[24:27], v109, s[42:43] offset:3072
    global_load_dwordx2 v[28:29], v2, s[14:15]
    global_load_dwordx4 v[52:55], v1, s[42:43]
    global_load_dwordx4 v[56:59], v1, s[42:43] offset:1024
    global_load_dwordx4 v[112:115], v1, s[14:15] offset:2048
    v_mul_f32_e64 v101, v32, v100
    v_mul_f32_e64 v103, v33, v31
    v_exp_f32_e64 v101, v101
    v_and_b32 v104, 0x7fffffff, v34
    v_and_b32 v108, 0x7fffffff, v35
    v_cvt_pk_bf16_f32 v101, v101, v101
    v_mul_f32_e64 v103, 0x3e22f983, v103
    v_lshlrev_b32_e64 v101, 16, v101
    v_max_u32_e64 v104, v104, v108
    v_mul_f32 v102, v101, v31
    v_mul_f32 v102, 0xbfb8aa3b, v102
    v_pk_mul_f32 v[66:67], v[102:103], s[4:5]
    s_mul_i32 s37, s37, 14336
    s_add_u32 s37, s37, s38
    v_pk_mul_f32 v[74:75], v[102:103], s[6:7]
    s_add_u32 s24, s24, s37
    s_addc_u32 s25, s25, 0
    v_max_u32_dpp v104, v104, v104 row_shr:1 row_mask:0xf bank_mask:0xf
    s_add_u32 s16, s16, s38
    s_addc_u32 s17, s17, 0
    v_exp_f32 v66, v66
    s_lshl3_add_u32 s37, s46, s32
    s_lshl_b32 s37, s37, 15
    s_lshl_b32 s36, s45, 7
    v_fract_f32 v67, v67
    s_add_u32 s37, s37, s36
    s_add_u32 s37, s37, 131072
    v_exp_f32 v70, v102
    s_lshl_b32 s51, s51, 10
    s_add_u32 s51, s51, 131072
    v_fract_f32_e64 v71, v103
    s_mov_b64 s[12:13], s[20:21]
    s_add_u32 s18, s28, s37
    v_max_u32_dpp v104, v104, v104 row_shr:2 row_mask:0xf bank_mask:0xf
    s_addc_u32 s19, s29, 0
    s_add_u32 s20, s28, s51
    s_addc_u32 s21, s29, 0
    v_exp_f32 v74, v74
    v_fract_f32_e64 v75, v75
    v_cos_f32_e64 v64, v67
    v_sin_f32_e64 v65, v67
    v_max_u32_dpp v104, v104, v104 row_shr:4 row_mask:0xf bank_mask:0xf
    v_cos_f32_e64 v68, v71
    v_sin_f32_e64 v69, v71
    v_max_u32_dpp v104, v104, v104 row_shr:8 row_mask:0xf bank_mask:0xf
    v_cos_f32_e64 v72, v75
    v_sin_f32_e64 v73, v75
    v_pk_mul_f32 v[64:65], v[64:65], v[66:67] op_sel_hi:[1,0]
    v_pk_mul_f32 v[68:69], v[68:69], v[70:71] op_sel_hi:[1,0]
    v_pk_mul_f32 v[72:73], v[72:73], v[74:75] op_sel_hi:[1,0]
    v_max_u32_dpp v104, v104, v104 row_bcast:15 row_mask:0xa bank_mask:0xf
    v_pk_mul_f32 v[66:67], v[64:65], v[64:65] op_sel:[1,1] op_sel_hi:[0,1]
    v_pk_mul_f32 v[70:71], v[68:69], v[68:69] op_sel:[1,1] op_sel_hi:[0,1]
    v_pk_mul_f32 v[74:75], v[72:73], v[72:73] op_sel:[1,1] op_sel_hi:[0,1]
    v_cvt_pk_f16_f32 v39, v64, -v65
    v_cvt_pk_f16_f32 v36, v68, v69
    v_cvt_pk_f16_f32 v44, v72, v73
    v_pk_fma_f32 v[64:65], v[64:65], v[64:65], v[66:67] op_sel_hi:[0,1,1] neg_lo:[0,0,1]
    v_pk_fma_f32 v[68:69], v[68:69], v[68:69], v[70:71] op_sel_hi:[0,1,1] neg_lo:[0,0,1]
    v_pk_fma_f32 v[72:73], v[72:73], v[72:73], v[74:75] op_sel_hi:[0,1,1] neg_lo:[0,0,1]
    v_max_u32_dpp v104, v104, v104 row_bcast:31 row_mask:0xc bank_mask:0xf
    v_pk_mul_f32 v[66:67], v[64:65], v[64:65] op_sel:[1,1] op_sel_hi:[0,1]
    v_pk_mul_f32 v[70:71], v[68:69], v[68:69] op_sel:[1,1] op_sel_hi:[0,1]
    v_pk_mul_f32 v[74:75], v[72:73], v[72:73] op_sel:[1,1] op_sel_hi:[0,1]
    v_cvt_pk_f16_f32 v40, v64, -v65
    v_cvt_pk_f16_f32 v37, v68, v69
    v_cvt_pk_f16_f32 v45, v72, v73
    v_pk_fma_f32 v[64:65], v[64:65], v[64:65], v[66:67] op_sel_hi:[0,1,1] neg_lo:[0,0,1]
    v_pk_fma_f32 v[68:69], v[68:69], v[68:69], v[70:71] op_sel_hi:[0,1,1] neg_lo:[0,0,1]
    v_pk_fma_f32 v[72:73], v[72:73], v[72:73], v[74:75] op_sel_hi:[0,1,1] neg_lo:[0,0,1]
    v_readlane_b32 s38, v104, 63
    v_pk_mul_f32 v[66:67], v[64:65], v[64:65] op_sel:[1,1] op_sel_hi:[0,1]
    v_pk_mul_f32 v[74:75], v[72:73], v[72:73] op_sel:[1,1] op_sel_hi:[0,1]
    s_lshr_b32 s38, s38, 23
    v_cvt_pk_f16_f32 v41, v64, -v65
    s_max_u32 s38, s38, 1
    v_cvt_pk_f16_f32 v38, v68, v69
    v_cvt_pk_f16_f32 v46, v72, v73
    s_min_u32 s38, s38, 252
    v_pk_fma_f32 v[64:65], v[64:65], v[64:65], v[66:67] op_sel_hi:[0,1,1] neg_lo:[0,0,1]
    s_sub_u32 s4, 254, s38
    v_pk_fma_f32 v[72:73], v[72:73], v[72:73], v[74:75] op_sel_hi:[0,1,1] neg_lo:[0,0,1]
    v_pk_mul_f32 v[66:67], v[64:65], v[64:65] op_sel:[1,1] op_sel_hi:[0,1]
    s_lshl_b32 s4, s4, 23
    v_cvt_pk_f16_f32 v42, v64, -v65
    s_mov_b32 s5, s4
    v_cvt_pk_f16_f32 v47, v72, v73
    v_pk_fma_f32 v[64:65], v[64:65], v[64:65], v[66:67] op_sel_hi:[0,1,1] neg_lo:[0,0,1]
    s_add_u32 s38, s38, 1
    v_cvt_pk_f16_f32 v43, v64, -v65
    s_lshl_b32 s38, s38, 23
    v_pk_mul_f32 v[104:105], v[34:35], s[4:5]
    v_mul_f32 v30, s38, v31
    v_mov_b32 v64, 0x3c00
    v_cvt_pk_f16_f32 v48, v104, v105
    s_waitcnt vmcnt(5)
    v_pk_mul_f16 v67, v39, v40 op_sel:[0,0] op_sel_hi:[0,1]
    ds_write_b16 v12, v8 offset:0
    v_pk_mul_f16 v69, v39, v41 op_sel:[0,0] op_sel_hi:[0,1]
    ds_write_b16_d16_hi v12, v8 offset:128
    v_pk_mul_f16 v70, v40, v41 op_sel:[0,0] op_sel_hi:[0,1]
    ds_write_b16 v12, v9 offset:256
    v_pk_mul_f16 v73, v39, v42 op_sel:[0,0] op_sel_hi:[0,1]
    ds_write_b16_d16_hi v12, v9 offset:384
    ds_write_b16 v12, v10 offset:512
    v_pk_mul_f16 v74, v40, v42 op_sel:[0,0] op_sel_hi:[0,1]
    ds_write_b16_d16_hi v12, v10 offset:640
    v_pk_mul_f16 v76, v41, v42 op_sel:[0,0] op_sel_hi:[0,1]
    ds_write_b16 v12, v11 offset:768
    v_pk_fma_f16 v67, v39, v40, v67 op_sel:[1,1,0] op_sel_hi:[1,0,1] neg_lo:[0,1,0]
    ds_write_b16_d16_hi v12, v11 offset:896
    v_pk_fma_f16 v69, v39, v41, v69 op_sel:[1,1,0] op_sel_hi:[1,0,1] neg_lo:[0,1,0]
    ds_write_b32 v62, v61
    ds_write_addtid_b32 v39 offset:10512
    v_pk_fma_f16 v70, v40, v41, v70 op_sel:[1,1,0] op_sel_hi:[1,0,1] neg_lo:[0,1,0]
    ds_write_addtid_b32 v40 offset:10784
    v_pk_fma_f16 v73, v39, v42, v73 op_sel:[1,1,0] op_sel_hi:[1,0,1] neg_lo:[0,1,0]
    ds_write_addtid_b32 v41 offset:11328
    v_pk_fma_f16 v74, v40, v42, v74 op_sel:[1,1,0] op_sel_hi:[1,0,1] neg_lo:[0,1,0]
    ds_write_addtid_b32 v42 offset:12416
    v_pk_fma_f16 v76, v41, v42, v76 op_sel:[1,1,0] op_sel_hi:[1,0,1] neg_lo:[0,1,0]
    ds_write_addtid_b32 v43 offset:14592
    ds_write_addtid_b32 v64 offset:10240
    v_pk_mul_f16 v71, v67, v41 op_sel:[0,0] op_sel_hi:[0,1]
    v_pk_mul_f16 v75, v67, v42 op_sel:[0,0] op_sel_hi:[0,1]
    ds_write_addtid_b32 v67 offset:11056
    v_pk_mul_f16 v77, v69, v42 op_sel:[0,0] op_sel_hi:[0,1]
    v_pk_mul_f16 v78, v70, v42 op_sel:[0,0] op_sel_hi:[0,1]
    ds_write_addtid_b32 v69 offset:11600
    v_pk_mul_f16 v80, v39, v43 op_sel:[0,0] op_sel_hi:[0,1]
    v_pk_mul_f16 v81, v40, v43 op_sel:[0,0] op_sel_hi:[0,1]
    ds_write_addtid_b32 v70 offset:11872
    v_pk_fma_f16 v71, v67, v41, v71 op_sel:[1,1,0] op_sel_hi:[1,0,1] neg_lo:[0,1,0]
    v_pk_fma_f16 v75, v67, v42, v75 op_sel:[1,1,0] op_sel_hi:[1,0,1] neg_lo:[0,1,0]
    ds_write_addtid_b32 v73 offset:12688
    v_pk_fma_f16 v77, v69, v42, v77 op_sel:[1,1,0] op_sel_hi:[1,0,1] neg_lo:[0,1,0]
    v_pk_fma_f16 v78, v70, v42, v78 op_sel:[1,1,0] op_sel_hi:[1,0,1] neg_lo:[0,1,0]
    ds_write_addtid_b32 v74 offset:12960
    v_pk_fma_f16 v80, v39, v43, v80 op_sel:[1,1,0] op_sel_hi:[1,0,1] neg_lo:[0,1,0]
    v_pk_fma_f16 v81, v40, v43, v81 op_sel:[1,1,0] op_sel_hi:[1,0,1] neg_lo:[0,1,0]
    ds_write_addtid_b32 v76 offset:13504
    v_pk_mul_f16 v79, v71, v42 op_sel:[0,0] op_sel_hi:[0,1]
    v_pk_mul_f16 v82, v67, v43 op_sel:[0,0] op_sel_hi:[0,1]
    ds_read_b32 v62, v63 offset:9216
    v_pk_mul_f16 v83, v41, v43 op_sel:[0,0] op_sel_hi:[0,1]
    v_pk_mul_f16 v84, v69, v43 op_sel:[0,0] op_sel_hi:[0,1]
    ds_write_addtid_b32 v71 offset:12144
    v_pk_mul_f16 v85, v70, v43 op_sel:[0,0] op_sel_hi:[0,1]
    v_pk_mul_f16 v86, v71, v43 op_sel:[0,0] op_sel_hi:[0,1]
    ds_write_addtid_b32 v75 offset:13232
    v_pk_fma_f16 v79, v71, v42, v79 op_sel:[1,1,0] op_sel_hi:[1,0,1] neg_lo:[0,1,0]
    ds_write_addtid_b32 v77 offset:13776
    v_pk_fma_f16 v82, v67, v43, v82 op_sel:[1,1,0] op_sel_hi:[1,0,1] neg_lo:[0,1,0]
    v_pk_fma_f16 v83, v41, v43, v83 op_sel:[1,1,0] op_sel_hi:[1,0,1] neg_lo:[0,1,0]
    ds_write_addtid_b32 v78 offset:14048
    v_pk_fma_f16 v84, v69, v43, v84 op_sel:[1,1,0] op_sel_hi:[1,0,1] neg_lo:[0,1,0]
    v_pk_fma_f16 v85, v70, v43, v85 op_sel:[1,1,0] op_sel_hi:[1,0,1] neg_lo:[0,1,0]
    ds_write_addtid_b32 v80 offset:14864
    v_pk_fma_f16 v86, v71, v43, v86 op_sel:[1,1,0] op_sel_hi:[1,0,1] neg_lo:[0,1,0]
    ds_write_addtid_b32 v81 offset:15136
    s_waitcnt lgkmcnt(6)
L_uwy:
    v_cmp_ne_u32_e64 vcc, 1, v62
    s_cbranch_vccz L_uoky
    ds_read_b32 v62, v63 offset:9216
    s_waitcnt lgkmcnt(0)
    s_branch L_uwy
L_uoky:
    ds_read_b128 v[20:23], v13
    v_pk_mul_f16 v87, v42, v43 op_sel:[0,0] op_sel_hi:[0,1]
    v_pk_mul_f16 v88, v73, v43 op_sel:[0,0] op_sel_hi:[0,1]
    ds_write_addtid_b32 v79 offset:14320
    v_pk_mul_f16 v89, v74, v43 op_sel:[0,0] op_sel_hi:[0,1]
    ds_write_addtid_b32 v82 offset:15408
    v_pk_mul_f16 v90, v75, v43 op_sel:[0,0] op_sel_hi:[0,1]
    ds_write_addtid_b32 v83 offset:15680
    v_pk_fma_f16 v87, v42, v43, v87 op_sel:[1,1,0] op_sel_hi:[1,0,1] neg_lo:[0,1,0]
    v_pk_fma_f16 v88, v73, v43, v88 op_sel:[1,1,0] op_sel_hi:[1,0,1] neg_lo:[0,1,0]
    ds_write_addtid_b32 v84 offset:15952
    v_pk_fma_f16 v89, v74, v43, v89 op_sel:[1,1,0] op_sel_hi:[1,0,1] neg_lo:[0,1,0]
    ds_write_addtid_b32 v85 offset:16224
    v_pk_fma_f16 v90, v75, v43, v90 op_sel:[1,1,0] op_sel_hi:[1,0,1] neg_lo:[0,1,0]
    ds_write_addtid_b32 v86 offset:16496
    s_nop 0
    s_waitcnt lgkmcnt(6)
    v_bfi_b32 v20, s3, v4, v20
    v_bfi_b32 v21, s3, v5, v21
    v_bfi_b32 v22, s3, v6, v22
    v_bfi_b32 v23, s3, v7, v23
    global_store_dwordx4 v16, v[20:23], s[18:19] sc1
    v_pk_mul_f16 v91, v76, v43 op_sel:[0,0] op_sel_hi:[0,1]
    v_pk_mul_f16 v92, v77, v43 op_sel:[0,0] op_sel_hi:[0,1]
    ds_write_addtid_b32 v87 offset:16768
    v_pk_mul_f16 v93, v78, v43 op_sel:[0,0] op_sel_hi:[0,1]
    v_pk_mul_f16 v94, v79, v43 op_sel:[0,0] op_sel_hi:[0,1]
    ds_write_addtid_b32 v88 offset:17040
    v_pk_fma_f16 v91, v76, v43, v91 op_sel:[1,1,0] op_sel_hi:[1,0,1] neg_lo:[0,1,0]
    v_pk_fma_f16 v92, v77, v43, v92 op_sel:[1,1,0] op_sel_hi:[1,0,1] neg_lo:[0,1,0]
    ds_write_addtid_b32 v89 offset:17312
    v_pk_fma_f16 v93, v78, v43, v93 op_sel:[1,1,0] op_sel_hi:[1,0,1] neg_lo:[0,1,0]
    v_pk_fma_f16 v94, v79, v43, v94 op_sel:[1,1,0] op_sel_hi:[1,0,1] neg_lo:[0,1,0]
    ds_write_addtid_b32 v90 offset:17584
    s_waitcnt vmcnt(1)
    v_add_u32 v14, s35, v112
    v_mov_b32_e64 v15, v113
    v_mov_b32 v18, v114
    s_cmp_ge_u32 s2, 256
    s_cbranch_scc1 L_A_nw2
    s_lshr_b32 s36, s44, 3
    s_sub_u32 s36, s36, 0
    s_lshl3_add_u32 s36, s36, s32
    s_lshl_b32 s36, s36, 4
    s_and_b32 s39, s2, 7
    s_add_u32 s36, s36, s39
    s_sub_u32 vcc_lo, 16, s39
    s_cmp_eq_u32 s39, 0
    s_cselect_b32 vcc_lo, 8, vcc_lo
    s_sub_u32 vcc_lo, vcc_lo, s39
    s_mul_i32 s36, s36, 450
    s_mul_i32 vcc_lo, vcc_lo, 450
    v_bfe_u32 v49, v3, 3, 1
    v_and_b32_e64 v51, 7, v3
    v_mul_u32_u24_e64 v49, vcc_lo, v49
    v_lshlrev_b32_e64 v51, 7, v51
    v_min_u32 v51, 448, v51
    v_add3_u32 v49, v49, v51, s36
    s_mov_b64 exec, 0x1f1f
    global_load_ushort v0, v49, s[12:13]
    global_load_ushort v0, v49, s[22:23]
    s_nop 0
    s_mov_b64 exec, -1
L_A_nw2:
    v_pk_mul_f16 v65, v48, v36 op_sel:[0,0] op_sel_hi:[0,1]
    v_pk_mul_f16 v66, v48, v37 op_sel:[0,0] op_sel_hi:[0,1]
    ds_write_addtid_b32 v91 offset:17856
    v_pk_mul_f16 v68, v48, v38 op_sel:[0,0] op_sel_hi:[0,1]
    ds_write_addtid_b32 v92 offset:18128
    v_pk_mul_f16 v72, v48, v44 op_sel:[0,0] op_sel_hi:[0,1]
    ds_write_addtid_b32 v93 offset:18400
    v_pk_mul_f16 v76, v48, v45 op_sel:[0,0] op_sel_hi:[0,1]
    ds_write_addtid_b32 v94 offset:18672
    v_pk_mul_f16 v80, v48, v46 op_sel:[0,0] op_sel_hi:[0,1]
    ds_read_b128 v[96:99], v17 offset:0
    v_pk_mul_f16 v84, v48, v47 op_sel:[0,0] op_sel_hi:[0,1]
    ds_read_b128 v[100:103], v17 offset:32
    v_pk_fma_f16 v65, v48, v36, v65 op_sel:[1,1,0] op_sel_hi:[1,0,1] neg_lo:[0,1,0]
    v_pk_fma_f16 v66, v48, v37, v66 op_sel:[1,1,0] op_sel_hi:[1,0,1] neg_lo:[0,1,0]
    ds_read_b128 v[104:107], v17 offset:64
    v_pk_fma_f16 v68, v48, v38, v68 op_sel:[1,1,0] op_sel_hi:[1,0,1] neg_lo:[0,1,0]
    ds_read_b128 v[108:111], v17 offset:96
    v_pk_fma_f16 v72, v48, v44, v72 op_sel:[1,1,0] op_sel_hi:[1,0,1] neg_lo:[0,1,0]
    ds_read_b128 v[112:115], v17 offset:128
    v_pk_fma_f16 v76, v48, v45, v76 op_sel:[1,1,0] op_sel_hi:[1,0,1] neg_lo:[0,1,0]
    ds_read_b128 v[116:119], v17 offset:160
    v_pk_fma_f16 v80, v48, v46, v80 op_sel:[1,1,0] op_sel_hi:[1,0,1] neg_lo:[0,1,0]
    ds_read_b128 v[120:123], v17 offset:192
    v_pk_fma_f16 v84, v48, v47, v84 op_sel:[1,1,0] op_sel_hi:[1,0,1] neg_lo:[0,1,0]
    ds_read_b128 v[124:127], v17 offset:224
    v_pk_mul_f16 v67, v66, v36 op_sel:[0,0] op_sel_hi:[0,1]
    v_pk_mul_f16 v69, v68, v36 op_sel:[0,0] op_sel_hi:[0,1]
    ds_write_addtid_b32 v48 offset:10240
    v_pk_mul_f16 v70, v68, v37 op_sel:[0,0] op_sel_hi:[0,1]
    v_pk_mul_f16 v73, v66, v44 op_sel:[0,0] op_sel_hi:[0,1]
    ds_write_addtid_b32 v65 offset:10512
    v_pk_mul_f16 v74, v68, v44 op_sel:[0,0] op_sel_hi:[0,1]
    v_pk_mul_f16 v77, v68, v45 op_sel:[0,0] op_sel_hi:[0,1]
    ds_write_addtid_b32 v66 offset:10784
    v_pk_mul_f16 v78, v72, v45 op_sel:[0,0] op_sel_hi:[0,1]
    ds_write_addtid_b32 v68 offset:11328
    v_pk_fma_f16 v67, v66, v36, v67 op_sel:[1,1,0] op_sel_hi:[1,0,1] neg_lo:[0,1,0]
    v_pk_fma_f16 v69, v68, v36, v69 op_sel:[1,1,0] op_sel_hi:[1,0,1] neg_lo:[0,1,0]
    ds_write_addtid_b32 v72 offset:12416
    v_pk_fma_f16 v70, v68, v37, v70 op_sel:[1,1,0] op_sel_hi:[1,0,1] neg_lo:[0,1,0]
    v_pk_fma_f16 v73, v66, v44, v73 op_sel:[1,1,0] op_sel_hi:[1,0,1] neg_lo:[0,1,0]
    ds_write_addtid_b32 v76 offset:13504
    v_pk_fma_f16 v74, v68, v44, v74 op_sel:[1,1,0] op_sel_hi:[1,0,1] neg_lo:[0,1,0]
    v_pk_fma_f16 v77, v68, v45, v77 op_sel:[1,1,0] op_sel_hi:[1,0,1] neg_lo:[0,1,0]
    ds_write_addtid_b32 v80 offset:14592
    v_pk_fma_f16 v78, v72, v45, v78 op_sel:[1,1,0] op_sel_hi:[1,0,1] neg_lo:[0,1,0]
    ds_write_addtid_b32 v84 offset:15680
    v_pk_mul_f16 v71, v70, v36 op_sel:[0,0] op_sel_hi:[0,1]
    v_pk_mul_f16 v75, v70, v44 op_sel:[0,0] op_sel_hi:[0,1]
    ds_write_addtid_b32 v67 offset:11056
    v_pk_mul_f16 v79, v74, v45 op_sel:[0,0] op_sel_hi:[0,1]
    v_pk_mul_f16 v81, v72, v46 op_sel:[0,0] op_sel_hi:[0,1]
    ds_write_addtid_b32 v69 offset:11600
    v_pk_mul_f16 v82, v76, v46 op_sel:[0,0] op_sel_hi:[0,1]
    v_pk_mul_f16 v83, v78, v46 op_sel:[0,0] op_sel_hi:[0,1]
    ds_write_addtid_b32 v70 offset:11872
    v_pk_fma_f16 v71, v70, v36, v71 op_sel:[1,1,0] op_sel_hi:[1,0,1] neg_lo:[0,1,0]
    ds_write_addtid_b32 v73 offset:12688
    v_pk_fma_f16 v75, v70, v44, v75 op_sel:[1,1,0] op_sel_hi:[1,0,1] neg_lo:[0,1,0]
    v_pk_fma_f16 v79, v74, v45, v79 op_sel:[1,1,0] op_sel_hi:[1,0,1] neg_lo:[0,1,0]
    ds_write_addtid_b32 v74 offset:12960
    v_pk_fma_f16 v81, v72, v46, v81 op_sel:[1,1,0] op_sel_hi:[1,0,1] neg_lo:[0,1,0]
    v_pk_fma_f16 v82, v76, v46, v82 op_sel:[1,1,0] op_sel_hi:[1,0,1] neg_lo:[0,1,0]
    ds_write_addtid_b32 v77 offset:13776
    v_pk_fma_f16 v83, v78, v46, v83 op_sel:[1,1,0] op_sel_hi:[1,0,1] neg_lo:[0,1,0]
    ds_write_addtid_b32 v78 offset:14048
    ds_write_addtid_b32 v71 offset:12144
    ds_write_addtid_b32 v75 offset:13232
    ds_write_addtid_b32 v79 offset:14320
    ds_write_addtid_b32 v81 offset:14864
    ds_write_addtid_b32 v82 offset:15136
    ds_write_addtid_b32 v83 offset:15408
    ds_read_b128 v[64:67], v17 offset:0
    ds_read_b128 v[68:71], v17 offset:32
    ds_read_b128 v[72:75], v17 offset:64
    ds_read_b128 v[76:79], v17 offset:96
    ds_read_b128 v[80:83], v17 offset:128
    ds_read_b128 v[84:87], v17 offset:160
    ds_read_b128 v[88:91], v17 offset:192
    ds_read_b128 v[92:95], v17 offset:224
    s_waitcnt lgkmcnt(7)
    v_mfma_f32_32x32x16_f16 v[32:47], v[64:67], v[96:99], 0
    s_and_b32 s39, s32, 1
    s_lshl_b32 s39, s39, 9
    s_and_b32 s38, s32, 2
    s_lshl_b32 s38, s38, 6
    s_add_u32 s39, s39, s38
    s_mul_i32 s9, s48, 34816
    s_add_u32 s39, s39, s9
    s_waitcnt lgkmcnt(6)
    v_mfma_f32_32x32x16_f16 v[32:47], v[68:71], v[100:103], v[32:47]
    v_add_u32_e64 v18, s39, v18
    s_mul_i32 s50, s48, 8704
    s_add_u32 s50, s50, 66560
    s_lshl_b32 s39, s8, 8
    s_add_u32 s51, s50, s39
    s_sub_u32 s51, s51, 32768
    v_mov_b32 v51, s50
    s_waitcnt lgkmcnt(5)
    v_mfma_f32_32x32x16_f16 v[32:47], v[72:75], v[104:107], v[32:47]
    v_mov_b32_e64 v2, s9
    s_mul_i32 s39, s48, 16640
    s_lshl_b32 s38, s8, 10
    s_add_u32 s39, s39, s38
    v_add_u32 v50, s39, v1
    s_add_u32 s22, s18, 0
    s_addc_u32 s23, s19, 0
    s_waitcnt lgkmcnt(4)
    v_mfma_f32_32x32x16_f16 v[32:47], v[76:79], v[108:111], v[32:47]
    s_add_u32 s26, s20, 0
    s_addc_u32 s27, s21, 0
    s_mul_i32 s39, s32, 1152
    v_add_u32_e64 v15, s39, v15
    s_mul_i32 s10, s32, 5120
    s_mul_i32 s11, s48, 5120
    s_lshl_b32 s38, s8, 9
    s_waitcnt lgkmcnt(3)
    v_mfma_f32_32x32x16_f16 v[32:47], v[80:83], v[112:115], v[32:47]
    s_add_u32 s11, s11, s38
    s_bfe_u32 s39, s32, 0x10001
    s_and_b32 s12, s32, 1
    s_lshl_b32 s12, s12, 5
    s_mul_i32 s13, s39, 16640
    s_sub_u32 s13, s13, s12
    s_mul_i32 s14, s39, 5120
    s_waitcnt lgkmcnt(2)
    v_mfma_f32_32x32x16_f16 v[32:47], v[84:87], v[116:119], v[32:47]
    s_lshl_b32 s15, s39, 12
    s_add_u32 s15, s15, 47104
    v_add_u32_e64 v53, s10, v53
    v_add_u32_e64 v52, s11, v52
    v_add_u32_e64 v56, s13, v56
    v_add_u32_e64 v57, s14, v57
    v_xor_b32 v58, s12, v58
    s_waitcnt lgkmcnt(1)
    v_mfma_f32_32x32x16_f16 v[32:47], v[88:91], v[120:123], v[32:47]
    v_add_u32_e64 v59, s49, v59
    v_add_u32_e64 v58, s15, v58
    v_mov_b32_e64 v12, v55
    v_mov_b32 v13, v16
    s_waitcnt lgkmcnt(0)
    v_mfma_f32_32x32x16_f16 v[32:47], v[92:95], v[124:127], v[32:47]
    ds_write_addtid_b32 v30 offset:13312
    v_add_u32_sdwa v84, v24, v51 dst_sel:DWORD dst_unused:UNUSED_PAD src0_sel:WORD_0 src1_sel:DWORD
    v_add_u32_sdwa v85, v24, v51 dst_sel:DWORD dst_unused:UNUSED_PAD src0_sel:WORD_1 src1_sel:DWORD
    v_add_u32_sdwa v86, v25, v51 dst_sel:DWORD dst_unused:UNUSED_PAD src0_sel:WORD_0 src1_sel:DWORD
    v_add_u32_sdwa v87, v25, v51 dst_sel:DWORD dst_unused:UNUSED_PAD src0_sel:WORD_1 src1_sel:DWORD
    v_add_u32_sdwa v88, v26, v51 dst_sel:DWORD dst_unused:UNUSED_PAD src0_sel:WORD_0 src1_sel:DWORD
    v_add_u32_sdwa v89, v26, v51 dst_sel:DWORD dst_unused:UNUSED_PAD src0_sel:WORD_1 src1_sel:DWORD
    s_nop 0
    s_nop 4
    ds_write_addtid_b32 v32 offset:10240
    v_add_u32_sdwa v90, v27, v51 dst_sel:DWORD dst_unused:UNUSED_PAD src0_sel:WORD_0 src1_sel:DWORD
    ds_write_addtid_b32 v33 offset:10496
    v_add_u32_sdwa v91, v27, v51 dst_sel:DWORD dst_unused:UNUSED_PAD src0_sel:WORD_1 src1_sel:DWORD
    ds_write_addtid_b32 v34 offset:10752
    v_add_u32_sdwa v92, v28, v51 dst_sel:DWORD dst_unused:UNUSED_PAD src0_sel:WORD_0 src1_sel:DWORD
    ds_write_addtid_b32 v35 offset:11008
    v_add_u32_sdwa v93, v28, v51 dst_sel:DWORD dst_unused:UNUSED_PAD src0_sel:WORD_1 src1_sel:DWORD
    ds_write_addtid_b32 v36 offset:11264
    v_add_u32_sdwa v94, v29, v51 dst_sel:DWORD dst_unused:UNUSED_PAD src0_sel:WORD_0 src1_sel:DWORD
    ds_write_addtid_b32 v37 offset:11520
    v_mov_b32_e64 v80, 0
    ds_write_addtid_b32 v38 offset:11776
    v_mov_b32_e64 v81, 0
    ds_write_addtid_b32 v39 offset:12032
    v_mov_b32_e64 v82, 0
    ds_write_addtid_b32 v40 offset:12288
    v_mov_b32_e64 v83, 0
    ds_write_addtid_b32 v41 offset:12544
    v_mov_b32_e64 v112, v56
    ds_write_addtid_b32 v42 offset:12800
    v_mov_b32_e64 v113, v57
    ds_write_addtid_b32 v43 offset:13056
    v_mov_b32_e64 v114, v58
    v_mov_b32_e64 v115, v59
    s_cmp_ge_u32 s32, 4
    s_cbranch_scc1 L_A_nf
    s_add_u32 s36, s30, 22528
    s_addc_u32 s37, s31, 0
    global_load_dwordx4 v[20:23], v1, s[36:37] offset:0
    global_load_dwordx4 v[60:63], v1, s[36:37] offset:1024
    global_load_dwordx4 v[56:59], v1, s[36:37] offset:2048
L_A_nf:
    s_mov_b32 m0, s51
    s_waitcnt lgkmcnt(0)
    s_barrier
    global_load_dwordx4 v[124:127], v1, s[20:21] offset:0 sc1
    ds_read_b32 v76, v2 offset:13312
    ds_read_b32 v77, v2 offset:22016
    ds_read_b32 v78, v2 offset:30720
    ds_read_b32 v79, v2 offset:39424
    ds_read_b32 v64, v18 offset:0
    ds_read_b32 v65, v18 offset:8704
    ds_read_b32 v66, v18 offset:17408
    ds_read_b32 v67, v18 offset:26112
    ds_read_b32 v68, v18 offset:1024
    ds_read_b32 v69, v18 offset:9728
    ds_read_b32 v70, v18 offset:18432
    ds_read_b32 v71, v18 offset:27136
    ds_read_b32 v72, v18 offset:2048
    ds_read_b32 v73, v18 offset:10752
    ds_read_b32 v74, v18 offset:19456
    s_waitcnt lgkmcnt(14)
    ds_read_b32 v75, v18 offset:28160
    s_waitcnt lgkmcnt(8)
    v_mul_f32_e64 v64, v64, v76
    v_mul_f32_e64 v66, v66, v78
    v_fmac_f32_e64 v64, v65, v77
    v_fmac_f32_e64 v66, v67, v79
    v_add_f32_e64 v64, v64, v66
    ds_write_addtid_b32 v64 offset:32768
    s_waitcnt lgkmcnt(5)
    v_mul_f32 v68, v68, v76
    v_mul_f32_e64 v70, v70, v78
    v_fmac_f32_e64 v68, v69, v77
    v_fmac_f32_e64 v70, v71, v79
    v_add_f32_e64 v68, v68, v70
    ds_write_addtid_b32 v68 offset:33792
    s_waitcnt lgkmcnt(2)
    v_mul_f32 v72, v72, v76
    v_mul_f32_e64 v74, v74, v78
    v_fmac_f32_e64 v72, v73, v77
    v_fmac_f32_e64 v74, v75, v79
    v_add_f32_e64 v72, v72, v74
    ds_write_addtid_b32 v72 offset:34816
    ds_write_b32 v51, v80 offset:3072
    s_cmp_lt_u32 s32, 2
    s_cbranch_scc0 L_A_nz
    ds_write_b128 v53, v[80:83]
L_A_nz:
    s_waitcnt lgkmcnt(0)
    s_barrier
    s_cmp_eq_u32 s8, 0
    s_cbranch_scc1 L_A_ne1
    ds_read_b32 v64, v84
    ds_read_b32 v65, v85
    ds_read_b32 v66, v86
    ds_read_b32 v67, v87
    ds_read_b32 v68, v88
    ds_read_b32 v69, v89
    ds_read_b32 v70, v90
    ds_read_b32 v71, v91
    ds_read_b32 v72, v92
    ds_read_b32 v73, v93
    ds_read_b32 v74, v94
L_A_ne1:
    s_cmp_eq_u32 s32, 4
    s_cbranch_scc0 L_A_nz2
    s_mov_b32 exec_hi, 0
    ds_write_b128 v54, v[80:83]
    s_mov_b32 exec_hi, -1
L_A_nz2:
    s_cmp_eq_u32 s8, 0
    s_cbranch_scc1 L_A_ne2
    s_waitcnt lgkmcnt(3)
    v_cvt_pk_bf16_f32 v108, v64, v65
    v_cvt_pk_bf16_f32 v109, v66, v67
    v_cvt_pk_bf16_f32 v110, v68, v69
    v_cvt_pk_bf16_f32 v111, v70, v71
    ds_write_b128 v50, v[108:111] offset:22720
    s_waitcnt lgkmcnt(3)
    v_cvt_pk_bf16_f32 v104, v65, v66
    v_cvt_pk_bf16_f32 v105, v67, v68
    v_cvt_pk_bf16_f32 v106, v69, v70
    v_cvt_pk_bf16_f32 v107, v71, v72
    ds_write_b128 v50, v[104:107] offset:18560
    s_waitcnt lgkmcnt(3)
    v_cvt_pk_bf16_f32 v100, v66, v67
    v_cvt_pk_bf16_f32 v101, v68, v69
    v_cvt_pk_bf16_f32 v102, v70, v71
    v_cvt_pk_bf16_f32 v103, v72, v73
    ds_write_b128 v50, v[100:103] offset:14400
    s_waitcnt lgkmcnt(3)
    v_cvt_pk_bf16_f32 v96, v67, v68
    v_cvt_pk_bf16_f32 v97, v69, v70
    v_cvt_pk_bf16_f32 v98, v71, v72
    v_cvt_pk_bf16_f32 v99, v73, v74
    ds_write_b128 v50, v[96:99] offset:10240
L_A_ne2:
    s_mov_b32 s54, 0
    s_waitcnt vmcnt(0)
    s_branch L_u_w
L_u_p:
    global_load_dwordx4 v[124:127], v1, s[20:21] sc1
    s_waitcnt vmcnt(0)
L_u_w:
    s_add_u32 s54, s54, 1
    v_xor_b32 v2, v124, v4
    v_bitop3_b32 v2, v2, v125, v5 bitop3:0xf6
    v_bitop3_b32 v2, v2, v126, v6 bitop3:0xf6
    v_bitop3_b32 v2, v2, v127, v7 bitop3:0xf6
    v_and_b32_e64 v2, s3, v2
    v_cmp_ne_u32 vcc, 0, v2
    s_cbranch_vccz L_u_d
    s_cmp_gt_u32 s54, 100000
    s_cbranch_scc1 L_u_d
    s_wqm_b64 vcc, vcc
    s_mov_b32 s36, 0x0f0f0f0f
    s_mov_b32 s37, s36
    s_lshr_b64 s[38:39], vcc, 4
    s_or_b64 s[38:39], s[38:39], vcc
    s_and_b64 s[38:39], s[38:39], s[36:37]
    s_lshl_b64 vcc, s[38:39], 4
    s_or_b64 exec, vcc, s[38:39]
    s_sleep 2
    s_branch L_u_p
L_u_d:
    s_mov_b64 exec, -1
    ds_write_b128 v52, v[124:127]
    v_xor_b32 v4, 0x10000, v4
    v_xor_b32 v5, 0x10000, v5
    v_xor_b32 v6, 0x10000, v6
    v_xor_b32 v7, 0x10000, v7
    s_waitcnt lgkmcnt(0)
    s_barrier
    s_cmp_ge_u32 s32, 4
    s_cbranch_scc1 L_A_noconv
    s_setprio 0
    ds_read_b64 v[48:49], v112 offset:4032
    ds_read_b64 v[50:51], v112 offset:4040
    ds_read_b128 v[64:67], v113 offset:480
    ds_read_b64 v[52:53], v112 offset:3008
    ds_read_b64 v[54:55], v112 offset:3016
    ds_read_b128 v[68:71], v113 offset:992
    ds_read_b128 v[72:75], v113 offset:1504
    ds_read_b128 v[76:79], v113 offset:2016
    ds_read_b64 v[88:89], v112 offset:1984
    ds_read_b64 v[90:91], v112 offset:1992
    s_waitcnt lgkmcnt(7)
    v_mfma_f32_16x16x32_bf16 v[32:35], v[48:51], v[64:67], 0
    ds_read_b64 v[80:81], v112 offset:3968
    ds_read_b64 v[82:83], v112 offset:3976
    s_waitcnt lgkmcnt(7)
    v_mfma_f32_16x16x32_bf16 v[36:39], v[52:55], v[64:67], 0
    ds_read_b128 v[96:99], v113 offset:448
    s_waitcnt lgkmcnt(7)
    v_mfma_f32_16x16x32_bf16 v[36:39], v[48:51], v[68:71], v[36:39]
    ds_read_b64 v[84:85], v112 offset:2944
    v_mfma_f32_16x16x32_bf16 v[40:43], v[52:55], v[68:71], 0
    ds_read_b64 v[86:87], v112 offset:2952
    s_waitcnt lgkmcnt(8)
    v_mfma_f32_16x16x32_bf16 v[40:43], v[48:51], v[72:75], v[40:43]
    ds_read_b128 v[100:103], v113 offset:960
    v_mfma_f32_16x16x32_bf16 v[44:47], v[52:55], v[72:75], 0
    ds_read_b128 v[104:107], v113 offset:1472
    s_waitcnt lgkmcnt(9)
    v_mfma_f32_16x16x32_bf16 v[44:47], v[48:51], v[76:79], v[44:47]
    ds_read_b128 v[108:111], v113 offset:1984
    s_waitcnt lgkmcnt(8)
    v_mfma_f32_16x16x32_bf16 v[40:43], v[88:91], v[64:67], v[40:43]
    ds_read_b64 v[92:93], v112 offset:1920
    v_mfma_f32_16x16x32_bf16 v[44:47], v[88:91], v[68:71], v[44:47]
    ds_read_b64 v[94:95], v112 offset:1928
    s_waitcnt lgkmcnt(7)
    v_mfma_f32_16x16x32_bf16 v[32:35], v[80:83], v[96:99], v[32:35]
    ds_read_b64 v[48:49], v112 offset:3904
    s_waitcnt lgkmcnt(6)
    v_mfma_f32_16x16x32_bf16 v[36:39], v[84:87], v[96:99], v[36:39]
    ds_read_b64 v[50:51], v112 offset:3912
    s_waitcnt lgkmcnt(6)
    v_mfma_f32_16x16x32_bf16 v[36:39], v[80:83], v[100:103], v[36:39]
    ds_read_b128 v[64:67], v113 offset:416
    v_mfma_f32_16x16x32_bf16 v[40:43], v[84:87], v[100:103], v[40:43]
    ds_read_b64 v[52:53], v112 offset:2880
    s_waitcnt lgkmcnt(7)
    v_mfma_f32_16x16x32_bf16 v[40:43], v[80:83], v[104:107], v[40:43]
    ds_read_b64 v[54:55], v112 offset:2888
    v_mfma_f32_16x16x32_bf16 v[44:47], v[84:87], v[104:107], v[44:47]
    ds_read_b128 v[68:71], v113 offset:928
    s_waitcnt lgkmcnt(8)
    v_mfma_f32_16x16x32_bf16 v[44:47], v[80:83], v[108:111], v[44:47]
    ds_read_b128 v[72:75], v113 offset:1440
    s_waitcnt lgkmcnt(7)
    v_mfma_f32_16x16x32_bf16 v[40:43], v[92:95], v[96:99], v[40:43]
    ds_read_b128 v[76:79], v113 offset:1952
    v_mfma_f32_16x16x32_bf16 v[44:47], v[92:95], v[100:103], v[44:47]
    s_waitcnt lgkmcnt(5)
    v_mfma_f32_16x16x32_bf16 v[32:35], v[48:51], v[64:67], v[32:35]
    ds_read_b64 v[80:81], v112 offset:3840
    ds_read_b64 v[82:83], v112 offset:3848
    s_waitcnt lgkmcnt(5)
    v_mfma_f32_16x16x32_bf16 v[36:39], v[52:55], v[64:67], v[36:39]
    ds_read_b128 v[96:99], v113 offset:384
    s_waitcnt lgkmcnt(5)
    v_mfma_f32_16x16x32_bf16 v[36:39], v[48:51], v[68:71], v[36:39]
    ds_read_b64 v[84:85], v112 offset:2816
    v_mfma_f32_16x16x32_bf16 v[40:43], v[52:55], v[68:71], v[40:43]
    ds_read_b64 v[86:87], v112 offset:2824
    s_waitcnt lgkmcnt(6)
    v_mfma_f32_16x16x32_bf16 v[40:43], v[48:51], v[72:75], v[40:43]
    ds_read_b128 v[100:103], v113 offset:896
    v_mfma_f32_16x16x32_bf16 v[44:47], v[52:55], v[72:75], v[44:47]
    ds_read_b128 v[104:107], v113 offset:1408
    s_waitcnt lgkmcnt(7)
    v_mfma_f32_16x16x32_bf16 v[44:47], v[48:51], v[76:79], v[44:47]
    ds_read_b128 v[108:111], v113 offset:1920
    s_waitcnt lgkmcnt(5)
    v_mfma_f32_16x16x32_bf16 v[32:35], v[80:83], v[96:99], v[32:35]
    ds_read_b64 v[48:49], v112 offset:3776
    ds_read_b64 v[50:51], v112 offset:3784
    s_waitcnt lgkmcnt(5)
    v_mfma_f32_16x16x32_bf16 v[36:39], v[84:87], v[96:99], v[36:39]
    ds_read_b128 v[64:67], v113 offset:352
    s_waitcnt lgkmcnt(5)
    v_mfma_f32_16x16x32_bf16 v[36:39], v[80:83], v[100:103], v[36:39]
    ds_read_b64 v[52:53], v112 offset:2752
    v_mfma_f32_16x16x32_bf16 v[40:43], v[84:87], v[100:103], v[40:43]
    ds_read_b64 v[54:55], v112 offset:2760
    s_waitcnt lgkmcnt(6)
    v_mfma_f32_16x16x32_bf16 v[40:43], v[80:83], v[104:107], v[40:43]
    ds_read_b128 v[68:71], v113 offset:864
    v_mfma_f32_16x16x32_bf16 v[44:47], v[84:87], v[104:107], v[44:47]
    ds_read_b128 v[72:75], v113 offset:1376
    s_waitcnt lgkmcnt(7)
    v_mfma_f32_16x16x32_bf16 v[44:47], v[80:83], v[108:111], v[44:47]
    ds_read_b128 v[76:79], v113 offset:1888
    s_waitcnt lgkmcnt(5)
    v_mfma_f32_16x16x32_bf16 v[32:35], v[48:51], v[64:67], v[32:35]
    ds_read_b64 v[80:81], v112 offset:3712
    ds_read_b64 v[82:83], v112 offset:3720
    s_waitcnt lgkmcnt(5)
    v_mfma_f32_16x16x32_bf16 v[36:39], v[52:55], v[64:67], v[36:39]
    ds_read_b128 v[96:99], v113 offset:320
    s_waitcnt lgkmcnt(5)
    v_mfma_f32_16x16x32_bf16 v[36:39], v[48:51], v[68:71], v[36:39]
    ds_read_b64 v[84:85], v112 offset:2688
    v_mfma_f32_16x16x32_bf16 v[40:43], v[52:55], v[68:71], v[40:43]
    ds_read_b64 v[86:87], v112 offset:2696
    s_waitcnt lgkmcnt(6)
    v_mfma_f32_16x16x32_bf16 v[40:43], v[48:51], v[72:75], v[40:43]
    ds_read_b128 v[100:103], v113 offset:832
    v_mfma_f32_16x16x32_bf16 v[44:47], v[52:55], v[72:75], v[44:47]
    ds_read_b128 v[104:107], v113 offset:1344
    s_waitcnt lgkmcnt(7)
    v_mfma_f32_16x16x32_bf16 v[44:47], v[48:51], v[76:79], v[44:47]
    ds_read_b128 v[108:111], v113 offset:1856
    s_waitcnt lgkmcnt(5)
    v_mfma_f32_16x16x32_bf16 v[32:35], v[80:83], v[96:99], v[32:35]
    ds_read_b64 v[48:49], v112 offset:3648
    ds_read_b64 v[50:51], v112 offset:3656
    s_waitcnt lgkmcnt(5)
    v_mfma_f32_16x16x32_bf16 v[36:39], v[84:87], v[96:99], v[36:39]
    ds_read_b128 v[64:67], v113 offset:288
    s_waitcnt lgkmcnt(5)
    v_mfma_f32_16x16x32_bf16 v[36:39], v[80:83], v[100:103], v[36:39]
    ds_read_b64 v[52:53], v112 offset:2624
    v_mfma_f32_16x16x32_bf16 v[40:43], v[84:87], v[100:103], v[40:43]
    ds_read_b64 v[54:55], v112 offset:2632
    s_waitcnt lgkmcnt(6)
    v_mfma_f32_16x16x32_bf16 v[40:43], v[80:83], v[104:107], v[40:43]
    ds_read_b128 v[68:71], v113 offset:800
    v_mfma_f32_16x16x32_bf16 v[44:47], v[84:87], v[104:107], v[44:47]
    ds_read_b128 v[72:75], v113 offset:1312
    s_waitcnt lgkmcnt(7)
    v_mfma_f32_16x16x32_bf16 v[44:47], v[80:83], v[108:111], v[44:47]
    ds_read_b128 v[76:79], v113 offset:1824
    s_waitcnt lgkmcnt(5)
    v_mfma_f32_16x16x32_bf16 v[32:35], v[48:51], v[64:67], v[32:35]
    ds_read_b64 v[80:81], v112 offset:3584
    ds_read_b64 v[82:83], v112 offset:3592
    s_waitcnt lgkmcnt(5)
    v_mfma_f32_16x16x32_bf16 v[36:39], v[52:55], v[64:67], v[36:39]
    ds_read_b128 v[96:99], v113 offset:256
    s_waitcnt lgkmcnt(5)
    v_mfma_f32_16x16x32_bf16 v[36:39], v[48:51], v[68:71], v[36:39]
    ds_read_b64 v[84:85], v112 offset:2560
    v_mfma_f32_16x16x32_bf16 v[40:43], v[52:55], v[68:71], v[40:43]
    ds_read_b64 v[86:87], v112 offset:2568
    s_waitcnt lgkmcnt(6)
    v_mfma_f32_16x16x32_bf16 v[40:43], v[48:51], v[72:75], v[40:43]
    ds_read_b128 v[100:103], v113 offset:768
    v_mfma_f32_16x16x32_bf16 v[44:47], v[52:55], v[72:75], v[44:47]
    ds_read_b128 v[104:107], v113 offset:1280
    s_waitcnt lgkmcnt(7)
    v_mfma_f32_16x16x32_bf16 v[44:47], v[48:51], v[76:79], v[44:47]
    ds_read_b128 v[108:111], v113 offset:1792
    s_waitcnt lgkmcnt(5)
    v_mfma_f32_16x16x32_bf16 v[32:35], v[80:83], v[96:99], v[32:35]
    ds_read_b64 v[48:49], v112 offset:3520
    ds_read_b64 v[50:51], v112 offset:3528
    s_waitcnt lgkmcnt(5)
    v_mfma_f32_16x16x32_bf16 v[36:39], v[84:87], v[96:99], v[36:39]
    ds_read_b128 v[64:67], v113 offset:224
    s_waitcnt lgkmcnt(5)
    v_mfma_f32_16x16x32_bf16 v[36:39], v[80:83], v[100:103], v[36:39]
    ds_read_b64 v[52:53], v112 offset:2496
    v_mfma_f32_16x16x32_bf16 v[40:43], v[84:87], v[100:103], v[40:43]
    ds_read_b64 v[54:55], v112 offset:2504
    s_nop 0
    s_waitcnt lgkmcnt(6)
    v_mfma_f32_16x16x32_bf16 v[40:43], v[80:83], v[104:107], v[40:43]
    ds_read_b128 v[68:71], v113 offset:736
    v_mfma_f32_16x16x32_bf16 v[44:47], v[84:87], v[104:107], v[44:47]
    ds_read_b128 v[72:75], v113 offset:1248
    s_waitcnt lgkmcnt(7)
    v_mfma_f32_16x16x32_bf16 v[44:47], v[80:83], v[108:111], v[44:47]
    ds_read_b128 v[76:79], v113 offset:1760
    s_waitcnt lgkmcnt(5)
    v_mfma_f32_16x16x32_bf16 v[32:35], v[48:51], v[64:67], v[32:35]
    ds_read_b64 v[80:81], v112 offset:3456
    ds_read_b64 v[82:83], v112 offset:3464
    s_waitcnt lgkmcnt(5)
    v_mfma_f32_16x16x32_bf16 v[36:39], v[52:55], v[64:67], v[36:39]
    ds_read_b128 v[96:99], v113 offset:192
    s_waitcnt lgkmcnt(5)
    v_mfma_f32_16x16x32_bf16 v[36:39], v[48:51], v[68:71], v[36:39]
    ds_read_b64 v[84:85], v112 offset:2432
    v_mfma_f32_16x16x32_bf16 v[40:43], v[52:55], v[68:71], v[40:43]
    ds_read_b64 v[86:87], v112 offset:2440
    s_waitcnt lgkmcnt(6)
    v_mfma_f32_16x16x32_bf16 v[40:43], v[48:51], v[72:75], v[40:43]
    ds_read_b128 v[100:103], v113 offset:704
    v_mfma_f32_16x16x32_bf16 v[44:47], v[52:55], v[72:75], v[44:47]
    ds_read_b128 v[104:107], v113 offset:1216
    s_waitcnt lgkmcnt(7)
    v_mfma_f32_16x16x32_bf16 v[44:47], v[48:51], v[76:79], v[44:47]
    ds_read_b128 v[108:111], v113 offset:1728
    s_waitcnt lgkmcnt(5)
    v_mfma_f32_16x16x32_bf16 v[32:35], v[80:83], v[96:99], v[32:35]
    ds_read_b64 v[48:49], v112 offset:3392
    ds_read_b64 v[50:51], v112 offset:3400
    s_waitcnt lgkmcnt(5)
    v_mfma_f32_16x16x32_bf16 v[36:39], v[84:87], v[96:99], v[36:39]
    ds_read_b128 v[64:67], v113 offset:160
    s_waitcnt lgkmcnt(5)
    v_mfma_f32_16x16x32_bf16 v[36:39], v[80:83], v[100:103], v[36:39]
    ds_read_b64 v[52:53], v112 offset:2368
    s_waitcnt vmcnt(0)
    v_mfma_f32_16x16x32_bf16 v[40:43], v[84:87], v[100:103], v[40:43]
    ds_read_b64 v[54:55], v112 offset:2376
    s_cmp_eq_u32 s12, 0
    s_cselect_b64 vcc, -1, 0
    s_waitcnt lgkmcnt(6)
    v_mfma_f32_16x16x32_bf16 v[40:43], v[80:83], v[104:107], v[40:43]
    ds_read_b128 v[68:71], v113 offset:672
    s_add_u32 s13, s13, s12
    v_mfma_f32_16x16x32_bf16 v[44:47], v[84:87], v[104:107], v[44:47]
    ds_read_b128 v[72:75], v113 offset:1184
    v_cndmask_b32_e64 v20, v21, v20, vcc
    v_add_u32 v22, s14, v22
    s_waitcnt lgkmcnt(7)
    v_mfma_f32_16x16x32_bf16 v[44:47], v[80:83], v[108:111], v[44:47]
    ds_read_b128 v[76:79], v113 offset:1696
    v_add_u32_e64 v23, s14, v23
    v_add_u32 v20, s13, v20
    s_waitcnt lgkmcnt(5)
    v_mfma_f32_16x16x32_bf16 v[32:35], v[48:51], v[64:67], v[32:35]
    ds_read_b64 v[80:81], v112 offset:3328
    ds_read_b64 v[82:83], v112 offset:3336
    s_waitcnt lgkmcnt(5)
    v_mfma_f32_16x16x32_bf16 v[36:39], v[52:55], v[64:67], v[36:39]
    ds_read_b128 v[96:99], v113 offset:128
    s_waitcnt lgkmcnt(5)
    v_mfma_f32_16x16x32_bf16 v[36:39], v[48:51], v[68:71], v[36:39]
    ds_read_b64 v[84:85], v112 offset:2304
    ds_read_b64 v[86:87], v112 offset:2312
    v_mfma_f32_16x16x32_bf16 v[40:43], v[52:55], v[68:71], v[40:43]
    ds_read_b128 v[100:103], v113 offset:640
    s_nop 0
    s_waitcnt lgkmcnt(7)
    v_mfma_f32_16x16x32_bf16 v[40:43], v[48:51], v[72:75], v[40:43]
    ds_read_b128 v[104:107], v113 offset:1152
    ds_read_b128 v[108:111], v113 offset:1664
    v_mfma_f32_16x16x32_bf16 v[44:47], v[52:55], v[72:75], v[44:47]
    ds_read_b64 v[88:89], v22 offset:0
    s_waitcnt lgkmcnt(9)
    v_mfma_f32_16x16x32_bf16 v[44:47], v[48:51], v[76:79], v[44:47]
    ds_read_b64 v[90:91], v23 offset:0
    s_waitcnt lgkmcnt(7)
    v_mfma_f32_16x16x32_bf16 v[32:35], v[80:83], v[96:99], v[32:35]
    ds_read_b64 v[48:49], v112 offset:3264
    ds_read_b64 v[50:51], v112 offset:3272
    s_waitcnt lgkmcnt(7)
    v_mfma_f32_16x16x32_bf16 v[36:39], v[84:87], v[96:99], v[36:39]
    ds_read_b128 v[64:67], v113 offset:96
    s_waitcnt lgkmcnt(7)
    v_mfma_f32_16x16x32_bf16 v[36:39], v[80:83], v[100:103], v[36:39]
    ds_read_b64 v[52:53], v112 offset:2240
    ds_read_b64 v[54:55], v112 offset:2248
    v_mfma_f32_16x16x32_bf16 v[40:43], v[84:87], v[100:103], v[40:43]
    ds_read_b128 v[68:71], v113 offset:608
    s_waitcnt lgkmcnt(9)
    v_mfma_f32_16x16x32_bf16 v[40:43], v[80:83], v[104:107], v[40:43]
    ds_read_b128 v[72:75], v113 offset:1120
    ds_read_b128 v[76:79], v113 offset:1632
    v_mfma_f32_16x16x32_bf16 v[44:47], v[84:87], v[104:107], v[44:47]
    ds_read_b64 v[92:93], v22 offset:256
    s_waitcnt lgkmcnt(11)
    v_mfma_f32_16x16x32_bf16 v[44:47], v[80:83], v[108:111], v[44:47]
    ds_read_b64 v[94:95], v23 offset:256
    s_waitcnt lgkmcnt(10)
    v_mfma_f32_16x16x32_bf16 v[24:27], v[88:91], v[60:63], 0
    v_mfma_f32_16x16x32_bf16 v[116:119], v[88:91], v[56:59], 0
    s_waitcnt lgkmcnt(7)
    v_mfma_f32_16x16x32_bf16 v[32:35], v[48:51], v[64:67], v[32:35]
    ds_read_b64 v[80:81], v112 offset:3200
    ds_read_b64 v[82:83], v112 offset:3208
    s_waitcnt lgkmcnt(7)
    v_mfma_f32_16x16x32_bf16 v[36:39], v[52:55], v[64:67], v[36:39]
    ds_read_b128 v[96:99], v113 offset:64
    s_waitcnt lgkmcnt(7)
    v_mfma_f32_16x16x32_bf16 v[36:39], v[48:51], v[68:71], v[36:39]
    ds_read_b64 v[84:85], v112 offset:2176
    ds_read_b64 v[86:87], v112 offset:2184
    v_mfma_f32_16x16x32_bf16 v[40:43], v[52:55], v[68:71], v[40:43]
    ds_read_b128 v[100:103], v113 offset:576
    v_cvt_pk_bf16_f32 v124, v24, v25
    s_waitcnt lgkmcnt(9)
    v_mfma_f32_16x16x32_bf16 v[40:43], v[48:51], v[72:75], v[40:43]
    ds_read_b128 v[104:107], v113 offset:1088
    ds_read_b128 v[108:111], v113 offset:1600
    v_cvt_pk_bf16_f32 v125, v26, v27
    v_mfma_f32_16x16x32_bf16 v[44:47], v[52:55], v[72:75], v[44:47]
    ds_read_b64 v[88:89], v22 offset:512
    v_cvt_pk_bf16_f32 v120, v116, v117
    s_waitcnt lgkmcnt(11)
    v_mfma_f32_16x16x32_bf16 v[44:47], v[48:51], v[76:79], v[44:47]
    ds_read_b64 v[90:91], v23 offset:512
    v_cvt_pk_bf16_f32 v121, v118, v119
    s_waitcnt lgkmcnt(10)
    v_mfma_f32_16x16x32_bf16 v[24:27], v[92:95], v[60:63], 0
    v_mfma_f32_16x16x32_bf16 v[116:119], v[92:95], v[56:59], 0
    s_waitcnt lgkmcnt(7)
    v_mfma_f32_16x16x32_bf16 v[32:35], v[80:83], v[96:99], v[32:35]
    ds_read_b64 v[48:49], v112 offset:3136
    ds_read_b64 v[50:51], v112 offset:3144
    s_waitcnt lgkmcnt(7)
    v_mfma_f32_16x16x32_bf16 v[36:39], v[84:87], v[96:99], v[36:39]
    ds_read_b128 v[64:67], v113 offset:32
    s_waitcnt lgkmcnt(7)
    v_mfma_f32_16x16x32_bf16 v[36:39], v[80:83], v[100:103], v[36:39]
    ds_read_b64 v[52:53], v112 offset:2112
    ds_read_b64 v[54:55], v112 offset:2120
    v_mfma_f32_16x16x32_bf16 v[40:43], v[84:87], v[100:103], v[40:43]
    ds_read_b128 v[68:71], v113 offset:544
    v_cvt_pk_bf16_f32 v126, v24, v25
    s_waitcnt lgkmcnt(9)
    v_mfma_f32_16x16x32_bf16 v[40:43], v[80:83], v[104:107], v[40:43]
    ds_read_b128 v[72:75], v113 offset:1056
    ds_read_b128 v[76:79], v113 offset:1568
    v_cvt_pk_bf16_f32 v127, v26, v27
    v_mfma_f32_16x16x32_bf16 v[44:47], v[84:87], v[104:107], v[44:47]
    ds_read_b64 v[92:93], v22 offset:768
    v_cvt_pk_bf16_f32 v122, v116, v117
    s_waitcnt lgkmcnt(11)
    v_mfma_f32_16x16x32_bf16 v[44:47], v[80:83], v[108:111], v[44:47]
    ds_read_b64 v[94:95], v23 offset:768
    v_cvt_pk_bf16_f32 v123, v118, v119
    s_waitcnt lgkmcnt(10)
    v_mfma_f32_16x16x32_bf16 v[24:27], v[88:91], v[60:63], 0
    v_mfma_f32_16x16x32_bf16 v[116:119], v[88:91], v[56:59], 0
    s_waitcnt lgkmcnt(7)
    v_mfma_f32_16x16x32_bf16 v[32:35], v[48:51], v[64:67], v[32:35]
    ds_read_b64 v[80:81], v112 offset:3072
    ds_read_b64 v[82:83], v112 offset:3080
    s_waitcnt lgkmcnt(7)
    v_mfma_f32_16x16x32_bf16 v[36:39], v[52:55], v[64:67], v[36:39]
    ds_read_b128 v[96:99], v113 offset:0
    s_waitcnt lgkmcnt(7)
    v_mfma_f32_16x16x32_bf16 v[36:39], v[48:51], v[68:71], v[36:39]
    ds_read_b64 v[84:85], v112 offset:2048
    v_mfma_f32_16x16x32_bf16 v[40:43], v[52:55], v[68:71], v[40:43]
    ds_read_b64 v[86:87], v112 offset:2056
    v_cvt_pk_bf16_f32 v16, v24, v25
    s_waitcnt lgkmcnt(8)
    v_mfma_f32_16x16x32_bf16 v[40:43], v[48:51], v[72:75], v[40:43]
    ds_read_b128 v[100:103], v113 offset:512
    v_cvt_pk_bf16_f32 v17, v26, v27
    v_mfma_f32_16x16x32_bf16 v[44:47], v[52:55], v[72:75], v[44:47]
    ds_read_b128 v[104:107], v113 offset:1024
    v_cvt_pk_bf16_f32 v28, v116, v117
    s_waitcnt lgkmcnt(9)
    v_mfma_f32_16x16x32_bf16 v[44:47], v[48:51], v[76:79], v[44:47]
    ds_read_b128 v[108:111], v113 offset:1536
    v_cvt_pk_bf16_f32 v29, v118, v119
    s_waitcnt lgkmcnt(8)
    v_mfma_f32_16x16x32_bf16 v[24:27], v[92:95], v[60:63], 0
    v_mfma_f32_16x16x32_bf16 v[116:119], v[92:95], v[56:59], 0
    s_waitcnt lgkmcnt(5)
    v_mfma_f32_16x16x32_bf16 v[32:35], v[80:83], v[96:99], v[32:35]
    ds_read_b64 v[64:65], v20 offset:64
    ds_read_b64 v[66:67], v20 offset:96
    s_waitcnt lgkmcnt(5)
    v_mfma_f32_16x16x32_bf16 v[36:39], v[84:87], v[96:99], v[36:39]
    ds_read_b64 v[68:69], v20 offset:272
    s_waitcnt lgkmcnt(5)
    v_mfma_f32_16x16x32_bf16 v[36:39], v[80:83], v[100:103], v[36:39]
    ds_read_b64 v[70:71], v20 offset:304
    v_mfma_f32_16x16x32_bf16 v[40:43], v[84:87], v[100:103], v[40:43]
    ds_read_b64 v[48:49], v20 offset:0
    v_cvt_pk_bf16_f32 v18, v24, v25
    s_waitcnt lgkmcnt(6)
    v_mfma_f32_16x16x32_bf16 v[40:43], v[80:83], v[104:107], v[40:43]
    ds_read_b64 v[50:51], v20 offset:32
    v_cvt_pk_bf16_f32 v19, v26, v27
    v_mfma_f32_16x16x32_bf16 v[44:47], v[84:87], v[104:107], v[44:47]
    ds_read_b64 v[52:53], v20 offset:208
    v_cvt_pk_bf16_f32 v30, v116, v117
    s_waitcnt lgkmcnt(7)
    v_mfma_f32_16x16x32_bf16 v[44:47], v[80:83], v[108:111], v[44:47]
    ds_read_b64 v[54:55], v20 offset:240
    v_cvt_pk_bf16_f32 v31, v118, v119
    s_waitcnt lgkmcnt(4)
    v_mfma_f32_16x16x32_bf16 v[40:43], v[124:127], v[64:67], v[40:43]
    v_mfma_f32_16x16x32_bf16 v[44:47], v[16:19], v[64:67], v[44:47]
    v_mfma_f32_16x16x32_bf16 v[40:43], v[120:123], v[68:71], v[40:43]
    v_mfma_f32_16x16x32_bf16 v[44:47], v[28:31], v[68:71], v[44:47]
    s_waitcnt lgkmcnt(0)
    v_mfma_f32_16x16x32_bf16 v[44:47], v[124:127], v[48:51], v[44:47]
    v_mfma_f32_16x16x32_bf16 v[44:47], v[120:123], v[52:55], v[44:47]
    v_cvt_pk_bf16_f32 v80, v32, v33
    v_cvt_pk_bf16_f32 v81, v34, v35
    ds_write_b64 v114, v[80:81] offset:0
    v_cvt_pk_bf16_f32 v82, v36, v37
    v_cvt_pk_bf16_f32 v83, v38, v39
    ds_write_b64 v114, v[82:83] offset:1024
    v_cvt_pk_bf16_f32 v84, v40, v41
    v_cvt_pk_bf16_f32 v85, v42, v43
    ds_write_b64 v114, v[84:85] offset:2048
    v_cvt_pk_bf16_f32 v86, v44, v45
    v_cvt_pk_bf16_f32 v87, v46, v47
    ds_write_b64 v114, v[86:87] offset:3072
    s_setprio 2
L_A_noconv:
    v_and_b32 v2, 28, v3
    v_lshlrev_b32 v2, 2, v2
    global_load_dwordx4 v[120:123], v2, s[16:17] offset:0
    s_waitcnt lgkmcnt(0)
    s_barrier
    ds_read_b128 v[60:63], v115
    s_waitcnt lgkmcnt(0)
    v_bfi_b32 v60, s3, v4, v60
    v_bfi_b32 v61, s3, v5, v61
    v_bfi_b32 v62, s3, v6, v62
    v_bfi_b32 v63, s3, v7, v63
    global_store_dwordx4 v1, v[60:63], s[26:27] sc1
    s_waitcnt vmcnt(1)
    v_lshlrev_b32 v72, 16, v8
    v_and_b32 v73, 0xffff0000, v8
    v_lshlrev_b32_e64 v74, 16, v120
    v_and_b32 v75, 0xffff0000, v120
    v_mul_f32_e64 v72, v72, v74
    v_mul_f32_e64 v73, v73, v75
    v_cvt_pk_bf16_f32 v72, v72, v73
    v_lshlrev_b32_e64 v64, 16, v72
    v_and_b32 v65, 0xffff0000, v72
    v_lshlrev_b32_e64 v72, 16, v9
    v_and_b32 v73, 0xffff0000, v9
    v_lshlrev_b32_e64 v74, 16, v121
    v_and_b32 v75, 0xffff0000, v121
    v_mul_f32_e64 v72, v72, v74
    v_mul_f32_e64 v73, v73, v75
    v_cvt_pk_bf16_f32 v72, v72, v73
    v_lshlrev_b32_e64 v66, 16, v72
    v_and_b32 v67, 0xffff0000, v72
    v_lshlrev_b32_e64 v72, 16, v10
    v_and_b32 v73, 0xffff0000, v10
    v_lshlrev_b32_e64 v74, 16, v122
    v_and_b32 v75, 0xffff0000, v122
    v_mul_f32_e64 v72, v72, v74
    v_mul_f32_e64 v73, v73, v75
    v_cvt_pk_bf16_f32 v72, v72, v73
    v_lshlrev_b32_e64 v68, 16, v72
    v_and_b32 v69, 0xffff0000, v72
    v_lshlrev_b32_e64 v72, 16, v11
    v_and_b32 v73, 0xffff0000, v11
    v_lshlrev_b32_e64 v74, 16, v123
    v_and_b32 v75, 0xffff0000, v123
    v_mul_f32_e64 v72, v72, v74
    v_mul_f32_e64 v73, v73, v75
    v_cvt_pk_bf16_f32 v72, v72, v73
    v_lshlrev_b32_e64 v70, 16, v72
    v_and_b32 v71, 0xffff0000, v72
    s_sleep 11
    s_mov_b32 s55, 0
L_y_p:
    global_load_dwordx4 v[76:79], v13, s[22:23] sc1
    s_waitcnt vmcnt(0)
    s_add_u32 s55, s55, 1
    v_xor_b32_e64 v72, v76, v4
    v_bitop3_b32 v72, v72, v77, v5 bitop3:0xf6
    v_bitop3_b32 v72, v72, v78, v6 bitop3:0xf6
    v_bitop3_b32 v72, v72, v79, v7 bitop3:0xf6
    v_and_b32_e64 v72, s3, v72
    v_cmp_ne_u32_e64 vcc, 0, v72
    s_cbranch_vccz L_y_d
    s_cmp_gt_u32 s55, 100000
    s_cbranch_scc1 L_y_d
    s_wqm_b64 vcc, vcc
    s_mov_b32 s36, 0x0f0f0f0f
    s_mov_b32 s37, s36
    s_lshr_b64 s[38:39], vcc, 4
    s_or_b64 s[38:39], s[38:39], vcc
    s_and_b64 s[38:39], s[38:39], s[36:37]
    s_lshl_b64 vcc, s[38:39], 4
    s_or_b64 exec, vcc, s[38:39]
    s_sleep 2
    s_branch L_y_p
L_y_d:
    s_mov_b64 exec, -1
    ds_write_b128 v15, v[76:79]
    s_waitcnt lgkmcnt(0)
    s_barrier
    ds_read_b64_tr_b16 v[76:77], v14 offset:55296
    ds_read_b64_tr_b16 v[78:79], v14 offset:55872
    s_waitcnt lgkmcnt(1)
    v_lshlrev_b32 v72, 16, v76
    v_and_b32 v73, 0xffff0000, v76
    v_add_f32_e64 v72, v72, v64
    v_add_f32_e64 v73, v73, v65
    v_cvt_pk_bf16_f32 v80, v72, v73
    v_lshlrev_b32_e64 v72, 16, v77
    v_and_b32 v73, 0xffff0000, v77
    v_add_f32_e64 v72, v72, v66
    v_add_f32_e64 v73, v73, v67
    v_cvt_pk_bf16_f32 v81, v72, v73
    s_waitcnt lgkmcnt(0)
    v_lshlrev_b32 v72, 16, v78
    v_and_b32 v73, 0xffff0000, v78
    v_add_f32_e64 v72, v72, v68
    v_add_f32_e64 v73, v73, v69
    v_cvt_pk_bf16_f32 v82, v72, v73
    v_lshlrev_b32_e64 v72, 16, v79
    v_and_b32 v73, 0xffff0000, v79
    v_add_f32_e64 v72, v72, v70
    v_add_f32_e64 v73, v73, v71
    v_cvt_pk_bf16_f32 v83, v72, v73
    global_store_dwordx4 v12, v[80:83], s[24:25] sc1
    s_or_b32 s38, s45, s32
    s_cmp_lg_u32 s38, 0
    s_cbranch_scc1 L_A_noep
    s_mov_b64 exec, 1
    v_mov_b32 v2, 256
    v_mov_b32_e64 v3, s33
    global_store_dword v2, v3, s[40:41] sc1
L_A_noep:
    s_endpgm
.p2align 8
.type L_tab,@object
L_tab:
.octa 0x3f803f803f803f803f803f803f803f80,0xbedebf20bf48bf673f483f673f7a3f80,0xbf20be643e643f203e643f203f673f80,0x3f7a3f673edebe64bede3e643f483f80
.octa 0xbe64bf67bf67be64bf67be643f203f80,0xbf483e643f7a3f20bf7abf203ede3f80,0x3f673f20bf20bf67bf20bf673e643f80,0xa754bf80a6543f80a554bf80248d3f80
.octa 0xbf673f203f20bf673f20bf67be643f80,0x3f483e64bf7a3f203f7abf20bede3f80,0x3e64bf673f67be643f67be64bf203f80,0xbf7a3f67bedebe643ede3e64bf483f80
.octa 0x3f20be64be643f20be643f20bf673f80,0x3edebf203f48bf67bf483f67bf7a3f80,0xbf803f80bf803f80bf803f80bf803f80,0x0
.octa 0x3f803f803f803f803f803f803f803f80,0x3ede3e64a554be64248d3e643ede3f20,0xbf20bf67bf80bf67bf80bf67bf20be64,0xbf7abf20261f3f20a554bf20bf7abf67
.octa 0xbe643f203f803f203f803f20be64bf67,0x3f483f67a742bf6725b03f673f48be64,0x3f67be64bf80be64bf80be643f673f20,0xa765bf80a60d3f80a5f7bf8025b03f80
.octa 0xbf67be643f80be643f80be64bf673f20,0xbf483f67a777bf67261f3f67bf48be64,0x3e643f20bf803f20bf803f203e64bf67,0x3f7abf20258d3f20a731bf203f7abf67
.octa 0x3f20bf673f80bf673f80bf673f20be64,0xbede3e64a796be64a68d3e64bede3f20,0xbf803f80bf803f80bf803f80bf803f80,0x0
.octa 0x3f803f803f803f803f803f803f803f80,0x3f7a3f673f483f20bf48bf20bedebe64,0x3f673f203e64be643e64be64bf20bf67,0x3f483e64bedebf673ede3f673f7a3f20
.octa 0x3f20be64bf67bf67bf67bf67be643f20,0x3edebf20bf7abe643f7a3e64bf48bf67,0x3e64bf67bf203f20bf203f203f67be64,0xa777bf80a58e3f80a731bf80261f3f80
.octa 0xbe64bf673f203f203f203f20bf67be64,0xbedebf203f7abe64bf7a3e643f48bf67,0xbf20be643f67bf673f67bf673e643f20,0xbf483e643edebf67bede3f67bf7a3f20
.octa 0xbf673f20be64be64be64be643f20bf67,0xbf7a3f67bf483f203f48bf203edebe64,0xbf803f80bf803f80bf803f80bf803f80,0x0
.octa 0x3f803f803f803f80,0xbf7abf80bf7abf67,0x3f673f803f673f20,0xbf48bf80bf48be64
.octa 0x3f203f803f20be64,0xbedebf80bede3f20,0x3e643f803e64bf67,0xa742bf80a68d3f80
.octa 0xbe643f80be64bf67,0x3edebf803ede3f20,0xbf203f80bf20be64,0x3f48bf803f48be64
.octa 0xbf673f80bf673f20,0x3f7abf803f7abf67,0xbf803f80bf803f80,0x0
.octa 0x80008000800080008000800080008000,0x3f673f483f203edebf20bedebe648000,0xbf48bf7abf7abf48bf7abf48bede8000,0xbe643ede3f673f7abf67bf7abf208000
.octa 0x3f7a3edebedebf7abedebf7abf488000,0xbf20bf7abe643f483e64bf48bf678000,0xbede3f483f48bede3f48bedebf7a8000,0x3f80a69fbf80268d3f80a50dbf808000
.octa 0xbedebf483f483ede3f483edebf7a8000,0xbf203f7abe64bf483e643f48bf678000,0x3f7abedebede3f7abede3f7abf488000,0xbe64bede3f67bf7abf673f7abf208000
.octa 0xbf483f7abf7a3f48bf7a3f48bede8000,0x3f67bf483f20bedebf203edebe648000,0xa7d4271f26d4270da5d4258da50d8000,0x0
.octa 0x80008000800080008000800080008000,0x3f673f7a3f803f7abf80bf7abf67bf48,0x3f483edea5d4bedea50dbedebf48bf7a,0xbe64bf48bf80bf483f803f483e64bede
.octa 0xbf7abf4826543f48258d3f483f7a3ede,0xbf203ede3f803edebf80bede3f203f7a,0x3ede3f7aa69fbf7aa5d4bf7abede3f48,0x3f80a7b1bf8026b03f80a5d4bf80258d
.octa 0x3edebf7a26d43f7a260d3f7abedebf48,0xbf20bede3f80bedebf803ede3f20bf7a,0xbf7a3f48a7c2bf48a630bf483f7abede,0xbe643f48bf803f483f80bf483e643ede
.octa 0x3f48bede271f3ede26543edebf483f7a,0x3f67bf7a3f80bf7abf803f7abf673f48,0xa7e52831268d2730a6772654a630260d,0x0
.octa 0x80008000800080008000800080008000,0x3e643ede3f203f48bf20bf48bf67bf7a,0x3ede3f483f7a3f7a3f7a3f7a3f483ede,0x3f203f7a3f673edebf67bede3e643f48
.octa 0x3f483f7a3edebede3edebedebf7abf48,0x3f673f48be64bf7a3e643f7a3f20bede,0x3f7a3edebf48bf48bf48bf483ede3f7a,0x3f80270dbf8026d43f80a630bf80260d
.octa 0x3f7abedebf483f48bf483f483edebf7a,0x3f67bf48be643f7a3e64bf7a3f203ede,0x3f48bf7a3ede3ede3ede3edebf7a3f48,0x3f20bf7a3f67bedebf673ede3e64bf48
.octa 0x3edebf483f7abf7a3f7abf7a3f48bede,0x3e64bede3f20bf48bf203f48bf673f7a,0xa7f7a78d260e2754a7b126b0a69f268d,0x0
.octa 0x8000800080008000,0x3e64a50dbe64bede,0xbede258d3ede3f48,0x3f20a5d4bf20bf7a
.octa 0xbf48260d3f483f7a,0x3f67a630bf67bf48,0xbf7a26543f7a3ede,0x3f80a677bf802654
.octa 0xbf7a268d3f7abede,0x3f67a69fbf673f48,0xbf4826b03f48bf7a,0x3f20a7b1bf203f7a
.octa 0xbede26d43edebf48,0x3e64270dbe643ede,0xa7c226f7270d26d4,0x0
.octa 0x3f8000003f8000003f8000003f800000,0x3f7fc6003f7fe6383f7ff98e3f800000,0x3f7f181a3f7f98e63f7fe6383f800000,0x3f7df69c3f7f181a3f7fc6003f800000
.octa 0x3f7c620b3f7e63ec3f7f98e63f800000,0x3f7a5b1d3f7d7c833f7f5eee3f800000,0x3f77e2bd3f7c620b3f7f181a3f800000,0x3f74fa0b3f7b14be3f7ec46d3f800000
.octa 0x3f71a2573f7994e03f7e63ec3f800000,0x3f6ddd243f77e2bd3f7df69c3f800000,0x3f69ac2a3f75fead3f7d7c833f800000,0x3f65114d3f73e9123f7cf5a53f800000
.octa 0x3f600ea43f71a2573f7c620b3f800000,0x3f5aa6753f6f2af03f7bc1bb3f800000,0x3f54db313f6c835e3f7b14be3f800000,0x3f4eaf7a3f69ac2a3f7a5b1d3f800000
.octa 0x3f8000003f8000003f8000003f800000,0x3f7ec46d3f7f181a3f7f5eee3f7f98e6,0x3f7b14be3f7c620b3f7d7c833f7e63ec,0x3f74fa0b3f77e2bd3f7a5b1d3f7c620b
.octa 0x3f6c835e3f71a2573f75fead3f7994e0,0x3f61c5983f69ac2a3f706cb13f75fead,0x3f54db313f600ea43f69ac2a3f71a257,0x3f45e4033f54db313f61c5983f6c835e
.octa 0x3f3504f33f48261c3f58c2eb3f66a5e5,0x3f2267993f3a06693f4eaf7a3f600ea4,0x3f0e39da3f2a95b03f4397f43f58c2eb,0x3ef15aea3f19efeb3f378a4d3f50c899
.octa 0x3ec3ef153f0833413f2a95b03f48261c,0x3e94a0313eeaffac3f1cca6b3f3ee268,0x3e47c5c23ec3ef153f0e39da3f3504f3,0x3dc8bd363e9b7b853efdec9f3f2a95b0
.octa 0x3f8000003f8000003f8000003f800000,0x3f7cf5a53f7d7c833f7df69c3f7e63ec,0x3f73e9123f75fead3f77e2bd3f7994e0,0x3f65114d3f69ac2a3f6ddd243f71a257
.octa 0x3f50c8993f58c2eb3f600ea43f66a5e5,0x3f378a4d3f4397f43f4eaf7a3f58c2eb,0x3f19efeb3f2a95b03f3a06693f48261c,0x3ef15aea3f0e39da3f2267993f3504f3
.octa 0x3ea91a563ede26023f0833413f1f9d07,0x3e39aaee3e9b7b853ed7a83d3f083341,0x3ce5c1433e2b86c03e9b7b853ede2602,0xbe00e9413ce5c1433e39aaee3ea91a56
.octa 0xbe8dbd62bde54da23d65aa203e63dc87,0xbed7a83dbe7fc568bd8f7f7c3de54da2,0xbf0e39dabec3ef15be47c5c2248d3132,0xbf2d3eb9bf02113abea24f04bde54da2
.octa 0x3f8000003f8000003f8000003f800000,0x3f7a5b1d3f7b14be3f7bc1bb3f7c620b,0x3f69ac2a3f6c835e3f6f2af03f71a257,0x3f4eaf7a3f54db313f5aa6753f600ea4
.octa 0x3f2a95b03f3504f33f3ee2683f48261c,0x3efdec9f3f0e39da3f1cca6b3f2a95b0,0x3e9b7b853ec3ef153eeaffac3f083341,0x3dc8bd363e47c5c23e94a0313ec3ef15
.octa 0xbde54da2248d31323de54da23e63dc87,0xbea24f04be47c5c2bd8f7f7c3d65aa20,0xbf02113abec3ef15be7fc568bde54da2,0xbf2d3eb9bf0e39dabed7a83dbe8dbd62
.octa 0xbf50c899bf3504f3bf1423cdbede2602,0xbf6b1db0bf54db31bf378a4dbf1423cd,0xbf7b14bebf6c835ebf54db31bf3504f3,0xbf7ff98ebf7b14bebf6b1db0bf50c899
.octa 0x80000000800000008000000080000000,0xbd2c49b7bce5c143bc65c70c80000000,0xbdac22aebd65aa20bce5c14380000000,0xbe00e941bdac22aebd2c49b780000000
.octa 0xbe2b86c0bde54da2bd65aa2080000000,0xbe55d687be0f2533bd8f7f7c80000000,0xbe7fc568be2b86c0bdac22ae80000000,0xbe94a031be47c5c2bdc8bd3680000000
.octa 0xbea91a56be63dc87bde54da280000000,0xbebd47dbbe7fc568be00e94180000000,0xbed11f9bbe8dbd62be0f253380000000,0xbee49898be9b7b85be1d59f080000000
.octa 0xbef7aa01bea91a56be2b86c080000000,0xbf052598beb69719be39aaee80000000,0xbf0e39dabec3ef15be47c5c280000000,0xbf170daabed11f9bbe55d68780000000
.octa 0x80000000800000008000000080000000,0xbdc8bd36bdac22aebd8f7f7cbd65aa20,0xbe47c5c2be2b86c0be0f2533bde54da2,0xbe94a031be7fc568be55d687be2b86c0
.octa 0xbec3ef15bea91a56be8dbd62be63dc87,0xbef15aeabed11f9bbeafdd25be8dbd62,0xbf0e39dabef7aa01bed11f9bbea91a56,0xbf226799bf0e39dabef15aeabec3ef15
.octa 0xbf3504f3bf1f9d07bf083341bede2602,0xbf45e403bf2fdf08bf170daabef7aa01,0xbf54db31bf3ee268bf2529febf083341,0xbf61c598bf4c8bf3bf32767cbf1423cd
.octa 0xbf6c835ebf58c2ebbf3ee268bf1f9d07,0xbf74fa0bbf63712cbf4a5e20bf2a95b0,0xbf7b14bebf6c835ebf54db31bf3504f3,0xbf7ec46dbf73e912bf5e4c69bf3ee268
.octa 0x80000000800000008000000080000000,0xbe1d59f0be0f2533be00e941bde54da2,0xbe9b7b85be8dbd62be7fc568be63dc87,0xbee49898bed11f9bbebd47dbbea91a56
.octa 0xbf1423cdbf083341bef7aa01bede2602,0xbf32767cbf2529febf170daabf083341,0xbf4c8bf3bf3ee268bf2fdf08bf1f9d07,0xbf61c598bf54db31bf45e403bf3504f3
.octa 0xbf71a257bf66a5e5bf58c2ebbf48261c,0xbf7bc1bbbf73e912bf682ee0bf58c2eb,0xbf7fe638bf7c620bbf73e912bf66a5e5,0xbf7df69cbf7fe638bf7bc1bbbf71a257
.octa 0xbf75feadbf7e63ecbf7f98e6bf7994e0,0xbf682ee0bf77e2bdbf7f5eeebf7e63ec,0xbf54db31bf6c835ebf7b14bebf800000,0xbf3c7927bf5c7efcbf72cbd1bf7e63ec
.octa 0x80000000800000008000000080000000,0xbe55d687be47c5c2be39aaeebe2b86c0,0xbed11f9bbec3ef15beb69719bea91a56,0xbf170daabf0e39dabf052598bef7aa01
.octa 0xbf3ee268bf3504f3bf2a95b0bf1f9d07,0xbf5e4c69bf54db31bf4a5e20bf3ee268,0xbf73e912bf6c835ebf63712cbf58c2eb,0xbf7ec46dbf7b14bebf74fa0bbf6c835e
.octa 0xbf7e63ecbf800000bf7e63ecbf7994e0,0xbf72cbd1bf7b14bebf7f5eeebf7f98e6,0xbf5c7efcbf6c835ebf77e2bdbf7e63ec,0xbf3c7927bf54db31bf682ee0bf75fead
.octa 0xbf1423cdbf3504f3bf50c899bf66a5e5,0xbeca8c72bf0e39dabf32767cbf50c899,0xbe47c5c2bec3ef15bf0e39dabf3504f3,0x3c65c70cbe47c5c2beca8c72bf1423cd
.octa 0x3f8000003f8000003f8000003f80,0x3f6d3ec43f353f353ec43f6d00003f80,0x3f35bf353f80248d3f353f3500003f80,0xbec4bf6d3f35bf353f6d3ec400003f80
.octa 0xbf80a554250dbf803f80248d00003f80,0xbec43f6dbf35bf353f6dbec400003f80,0x3f353f35bf80a5543f35bf3500003f80,0x3f6dbec4bf353f353ec4bf6d00003f80
.octa 0x25d4bf80a58d3f80250dbf8000003f80,0xbf6dbec43f353f35bec4bf6d00003f80,0xbf353f353f8025b0bf35bf3500003f80,0x3ec43f6d3f35bf35bf6dbec400003f80
.octa 0x3f80261f25d4bf80bf80a55400003f80,0x3ec4bf6dbf35bf35bf6d3ec400003f80,0xbf35bf35bf80a5f7bf353f3500003f80,0xbf6d3ec4bf353f35bec43f6d00003f80
.octa 0x3f8000003f8000003f8000003f80,0x3ec4bf6d3f35bf353f6dbec43f80248d,0xbf353f35bf80a554bf35bf35250dbf80,0x3f6dbec43f353f35bec43f6dbf80a554
.octa 0xbf80a5f725d4bf803f8025b0a58d3f80,0x3f6d3ec4bf353f35bec4bf6d3f8025b0,0xbf35bf353f80261fbf353f3525d4bf80,0x3ec43f6dbf35bf353f6d3ec4bf80a5f7
.octa 0x2677bf80a6543f802630bf80a60d3f80,0xbec43f6d3f35bf35bf6d3ec43f80261f,0x3f35bf35bf80a7423f353f352630bf80,0xbf6d3ec43f353f353ec4bf6dbf80a731
.octa 0x3f80a60d269fbf80bf80a742a6543f80,0xbf6dbec4bf353f353ec43f6d3f80a68d,0x3f353f353f80a60d3f35bf352677bf80,0xbec4bf6dbf35bf35bf6dbec4bf80a742
.octa 0x3f8000003f8000003f8000003f80,0xbf6dbec4bf35bf35bec4bf6d250dbf80,0x3f35bf353f8025b03f353f35a58d3f80,0x3ec43f6dbf353f35bf6dbec425d4bf80
.octa 0xbf80a7312630bf803f80261fa60d3f80,0x3ec4bf6d3f353f35bf6d3ec42630bf80,0x3f353f35bf80a7423f35bf35a6543f80,0xbf6d3ec43f35bf35bec43f6d2677bf80
.octa 0x27b1bf80a6b03f80269fbf80a68d3f80,0x3f6d3ec4bf35bf353ec43f6d269fbf80,0xbf353f353f80a58ebf35bf35a6b03f80,0xbec4bf6dbf353f353f6d3ec427b1bf80
.octa 0x3f80258d27c2bf80bf80a777a6d43f80,0xbec43f6d3f353f353f6dbec4a70dbf80,0xbf35bf35bf80a78dbf353f35a6f73f80,0x3f6dbec43f35bf353ec4bf6d27c2bf80
.octa 0x3f8000003f8000003f8000003f80,0xbec43f6dbf353f35bf6d3ec4bf80a554,0xbf353f35bf80a5f7bf35bf3525d4bf80,0xbf6d3ec4bf35bf353ec4bf6d3f80261f
.octa 0xbf80a7422677bf803f80a68da6543f80,0xbf6dbec43f35bf353ec43f6dbf80a742,0xbf35bf353f80a60dbf353f35269fbf80,0xbec4bf6d3f353f35bf6dbec43f80a60d
.octa 0x27c2bf80a6f73f80a70dbf80a6d43f80,0x3ec4bf6dbf353f353f6dbec4bf80a777,0x3f35bf35bf80a78d3f353f3527c2bf80,0x3f6dbec4bf35bf35bec43f6d3f80258d
.octa 0x3f80268da68dbf80bf80a796a71f3f80,0x3f6d3ec43f35bf35bec4bf6dbf80a796,0x3f353f353f8028163f35bf35a68dbf80,0x3ec43f6d3f353f353f6d3ec43f80268d
.octa 0x3f8080003f8080003f8080003f808000,0x3ec4bf6d3f35bf353f6dbec43f808000,0xbf35bf35248dbf803f35bf353f808000,0xbf6d3ec4bf35bf353ec4bf6d3f808000
.octa 0xa5543f80bf80a50d248dbf803f808000,0x3f6d3ec4bf353f35bec4bf6d3f808000,0x3f35bf35a5543f80bf35bf353f808000,0xbec4bf6d3f353f35bf6dbec43f808000
.octa 0xbf80a5d43f80258dbf80a50d3f808000,0xbec43f6d3f35bf35bf6d3ec43f808000,0x3f353f3525b0bf80bf353f353f808000,0x3f6dbec4bf35bf35bec43f6d3f808000
.octa 0x261fbf80bf80a5d4a5543f803f808000,0xbf6dbec4bf353f353ec43f6d3f808000,0xbf353f35a5f73f803f353f353f808000,0x3ec43f6d3f353f353f6d3ec43f808000
.octa 0x3f8080003f8080003f8080003f808000,0xbf6dbec4bf35bf35bec4bf6d248dbf80,0x3f353f35a5543f80bf353f35bf80a50d,0xbec4bf6d3f35bf353f6d3ec4a5543f80
.octa 0xa5f73f80bf80a5d425b0bf803f80258d,0x3ec4bf6d3f353f35bf6d3ec425b0bf80,0xbf353f35261fbf803f353f35bf80a5d4,0x3f6dbec4bf353f353ec4bf6da5f73f80
.octa 0xbf80a6773f802654bf80a6303f80260d,0x3f6d3ec4bf35bf353ec43f6d261fbf80,0xbf35bf35a7423f803f35bf35bf80a630,0x3ec43f6d3f35bf35bf6dbec4a7313f80
.octa 0xa60dbf80bf80a69fa7423f803f802654,0xbec43f6d3f353f353f6dbec4a68dbf80,0x3f35bf35a60dbf80bf35bf35bf80a677,0xbf6d3ec4bf353f35bec43f6da7423f80
.octa 0x3f8080003f8080003f8080003f808000,0xbec43f6dbf353f35bf6d3ec4bf80a50d,0xbf35bf3525b0bf803f35bf353f80258d,0x3f6dbec43f353f35bec43f6dbf80a5d4
.octa 0xa7313f80bf80a630261fbf803f80260d,0xbf6dbec43f35bf353ec43f6dbf80a630,0x3f35bf35a7423f80bf35bf353f802654,0x3ec43f6dbf35bf353f6d3ec4bf80a677
.octa 0xbf80a7b13f8026b0bf80a69f3f80268d,0x3ec4bf6dbf353f353f6dbec4bf80a69f,0x3f353f35a58ebf80bf353f353f8026b0,0xbf6d3ec43f353f353ec4bf6dbf80a7b1
.octa 0x258dbf80bf80a7c2a7773f803f8026d4,0x3f6d3ec43f35bf35bec4bf6dbf80270d,0xbf353f35a78d3f803f353f353f8026f7,0xbec4bf6dbf35bf35bf6dbec4bf80a7c2
.octa 0x3f8080003f8080003f8080003f808000,0x3f6d3ec43f353f353ec43f6da5543f80,0x3f353f35a5f73f80bf353f35bf80a5d4,0x3ec43f6dbf353f35bf6dbec4261fbf80
.octa 0xa7423f80bf80a677a68dbf803f802654,0xbec43f6dbf35bf353f6dbec4a7423f80,0xbf353f35a60dbf803f353f35bf80a69f,0xbf6d3ec43f35bf35bec43f6da60dbf80
.octa 0xbf80a7c23f8026f7bf80270d3f8026d4,0xbf6dbec43f353f35bec4bf6da7773f80,0xbf35bf35a78d3f803f35bf35bf80a7c2,0xbec4bf6dbf353f353f6d3ec4258dbf80
.octa 0x268dbf80bf80268da7963f803f80271f,0x3ec4bf6dbf35bf35bf6d3ec4a7963f80,0x3f35bf352816bf80bf35bf35bf80268d,0x3f6dbec43f35bf353ec4bf6d268dbf80
.octa 0x0,0x10000000100000001000000010,0x20000000200000002000000020,0x30000000300000003000000030
.octa 0x40000000400000004000000040,0x50000000500000005000000050,0x60000000600000006000000060,0x70000000700000007000000070
.octa 0x400000000800000400000000080,0x410000000900000401000000090,0x420000000a000004020000000a0,0x430000000b000004030000000b0
.octa 0x440000000c000004040000000c0,0x450000000d000004050000000d0,0x460000000e000004060000000e0,0x470000000f000004070000000f0
.octa 0x1000000010000008000000000800,0x1010000010100008001000000810,0x1020000010200008002000000820,0x1030000010300008003000000830
.octa 0x1040000010400008004000000840,0x1050000010500008005000000850,0x1060000010600008006000000860,0x1070000010700008007000000870
.octa 0x1400000010800008400000000880,0x1410000010900008401000000890,0x1420000010a000084020000008a0,0x1430000010b000084030000008b0
.octa 0x1440000010c000084040000008c0,0x1450000010d000084050000008d0,0x1460000010e000084060000008e0,0x1470000010f000084070000008f0
.octa 0x2000000020000010000000001000,0x2010000020100010001000001010,0x2020000020200010002000001020,0x2030000020300010003000001030
.octa 0x2040000020400010004000001040,0x2050000020500010005000001050,0x2060000020600010006000001060,0x2070000020700010007000001070
.octa 0x2400000020800010400000001080,0x2410000020900010401000001090,0x2420000020a000104020000010a0,0x2430000020b000104030000010b0
.octa 0x2440000020c000104040000010c0,0x2450000020d000104050000010d0,0x2460000020e000104060000010e0,0x2470000020f000104070000010f0
.octa 0x3000000030000018000000001800,0x3010000030100018001000001810,0x3020000030200018002000001820,0x3030000030300018003000001830
.octa 0x3040000030400018004000001840,0x3050000030500018005000001850,0x3060000030600018006000001860,0x3070000030700018007000001870
.octa 0x3400000030800018400000001880,0x3410000030900018401000001890,0x3420000030a000184020000018a0,0x3430000030b000184030000018b0
.octa 0x3440000030c000184040000018c0,0x3450000030d000184050000018d0,0x3460000030e000184060000018e0,0x3470000030f000184070000018f0
.octa 0x7000000070000000000000004600,0x8840000076100000001000004810,0xa08000007c200000002000004a20,0xb8c0000082300000003000004c30
.octa 0x7060000088400000044000004604,0x88a000008e500000045000004814,0xa0e0000094600000046000004a24,0xb92000009a700000047000004c34
.octa 0x70c00000a0800000010800004608,0x89000000a6900000011800004818,0xa1400000aca00000012800004a28,0xb9800000b2b00000013800004c38
.octa 0x71200000b8c0000005480000460c,0x89600000bed0000005580000481c,0xa1a00000c4e00000056800004a2c,0xb9e00000caf00000057800004c3c
.octa 0x70100000718000001180000056c0,0x88500000779000001190000058d0,0xa09000007da0000011a000005ae0,0xb8d0000083b0000011b000005cf0
.octa 0x7070000089c0000015c0000056c4,0x88b000008fd0000015d0000058d4,0xa0f0000095e0000015e000005ae4,0xb93000009bf0000015f000005cf4
.octa 0x70d00000a20000001288000056c8,0x89100000a81000001298000058d8,0xa1500000ae20000012a800005ae8,0xb9900000b430000012b800005cf8
.octa 0x71300000ba40000016c8000056cc,0x89700000c050000016d8000058dc,0xa1b00000c660000016e800005aec,0xb9f00000cc70000016f800005cfc
.octa 0x7020000073000000230000006780,0x8860000079100000231000006990,0xa0a000007f200000232000006ba0,0xb8e0000085300000233000006db0
.octa 0x708000008b400000274000006784,0x88c0000091500000275000006994,0xa100000097600000276000006ba4,0xb94000009d700000277000006db4
.octa 0x70e00000a3800000240800006788,0x89200000a9900000241800006998,0xa1600000afa00000242800006ba8,0xb9a00000b5b00000243800006db8
.octa 0x71400000bbc0000028480000678c,0x89800000c1d0000028580000699c,0xa1c00000c7e00000286800006bac,0xba000000cdf00000287800006dbc
.octa 0x7030000074800000348000007840,0x887000007a900000349000007a50,0xa0b0000080a0000034a000007c60,0xb8f0000086b0000034b000007e70
.octa 0x709000008cc0000038c000007844,0x88d0000092d0000038d000007a54,0xa110000098e0000038e000007c64,0xb95000009ef0000038f000007e74
.octa 0x70f00000a5000000358800007848,0x89300000ab100000359800007a58,0xa1700000b120000035a800007c68,0xb9b00000b730000035b800007e78
.octa 0x71500000bd40000039c80000784c,0x89900000c350000039d800007a5c,0xa1d00000c960000039e800007c6c,0xba100000cf70000039f800007e7c
.octa 0x80003612800036128000361280003592,0xb5b635e5b57e3604b502360f80003592,0xb60f3502b5e535b6b57e360480003592,0xb604b57eb60f3502b5b635e580003592
.octa 0xb57eb604b60fb502b5e535b680003592,0x3502b60fb5e5b5b6b604357e80003592,0x35e5b5b6b57eb604b60f350280003592,0x36129bf29ba1b612b6121b2180003592
.octa 0x35e535b6357eb604b60fb50280003592,0x3502360f35e5b5b6b604b57e80003592,0xb57e3604360fb502b5e5b5b680003592,0xb604357e360f3502b5b6b5e580003592
.octa 0xb60fb50235e535b6b57eb60480003592,0xb5b6b5e5357e3604b502b60f80003592,0x9c72b6121c2136129ba1b61280003592,0x35b6b5e5b57e36043502b60f80003592
.octa 0x80003612800036128000361280003612,0xb6121b21b60f3502b604357eb5e535b6,0x9ba1b612b57eb604b5e5b5b6b60fb502,0x36129bf235e5b5b63502b60fb57eb604
.octa 0x1c21361235e535b6360fb502357eb604,0xb6121c4ab57e360435b635e5360fb502,0x9c72b612b60fb502b57e360435e535b6,0x36129c8d9c72b612b6121c4a1c213612
.octa 0x1ca13612360fb502b57eb604b5e535b6,0xb6121cb6357e360435b6b5e5b60fb502,0x9ccab612b5e535b6360f3502b57eb604,0x36129dcab5e5b5b63502360f357eb604
.octa 0x1cf23612357eb604b5e535b6360fb502,0xb6129d21360f3502b604b57e35e535b6,0x9d0db6121cf236129ccab6121ca13612,0x36129ddeb60f35023604b57eb5e535b6
.octa 0x80003612800036128000361280003612,0xb5b6b5e5b5e5b5b6b604b57eb60fb502,0x360f3502360fb50235e5b5b6357eb604,0xb604357eb57e36043502360f35e535b6
.octa 0x357eb604b57eb604b60fb502b5e535b6,0x3502360f360f350235b6b5e5b57eb604,0xb5e5b5b6b5e535b6357e3604360fb502,0x36129dca9ccab612b6121cb61ca13612
.octa 0xb5e535b635e535b6357eb604b60fb502,0x3502b60fb60f350235b635e5357eb604,0x357e3604357eb604b60f350235e535b6,0xb604b57e357e36043502b60fb5e535b6
.octa 0x360fb502b60fb50235e535b6b57eb604,0xb5b635e535e5b5b6b604357e360fb502,0x9e4ab6121d4a36129d36b6121d213612,0x35b635e5b5e5b5b63604357eb60fb502
.octa 0x800035928000361280003612,0x9b21b592b502b60fb57eb604,0x1ba13592357e360435e535b6,0x9bf2b592b5b6b5e5b60fb502
.octa 0x1c21359235e535b6360fb502,0x9c4ab592b604b57eb5e535b6,0x1c723592360f3502357eb604,0x9c8db592b6129d211cf23612
.octa 0x1ca13592360fb502b57eb604,0x9cb6b592b604357e35e535b6,0x1cca359235e5b5b6b60fb502,0x9dcab592b5b635e5360fb502
.octa 0x1cf23592357eb604b5e535b6,0x1d21b592b502360f357eb604,0x1d0d35921da1b6121d723612,0x9ddeb5923502360fb57eb604
.octa 0x360fb502b5e535b6357eb60480003592,0x3604357eb60f350235b6b5e580003592,0x357e3604b60fb50235e5b5b680003592,0xb502360fb5e5b5b63604b57e80003592
.octa 0xb5e535b6b57eb604360fb50280003592,0xb6121cb69c72b61236129bf280003592,0xb5e5b5b6357eb604360f350280003592,0xb502b60f35e5b5b63604357e80003592
.octa 0x357eb604360fb50235e535b680003592,0x3604b57e360f350235b635e580003592,0x360f350235e535b6357e360480003592,0x35b635e5357e36043502360f80003592
.octa 0x0,0x0,0x0,0x0
.octa 0x1d213612b57eb60435e535b6b60fb502,0xb6129cf235e5b5b6b502360fb57eb604,0x9d36b61235e535b6b60f3502357eb604,0x36129df2b57e3604b5b6b5e5360fb502
.octa 0x1d4a3612b60fb502357eb60435e535b6,0xb6129ca29d36b61236129dde1cf23612,0x9e4ab612360fb502357e3604b5e535b6,0x36129e03357e3604b5b635e5b60fb502
.octa 0x1d723612b5e535b6b60fb502b57eb604,0xb6129c22b5e5b5b6b502b60f357eb604,0x1da1b612357eb60435e5b5b6360fb502,0x36129e0d360f35023604357e35e535b6
.octa 0x0,0x0,0x0,0x0
.octa 0xb60fb502360fb502b5e535b6357eb604,0x3604b57eb57e3604b502b60f35e535b6,0xb57e3604b57eb604360f3502b5e535b6,0xb502b60f360f3502b5b635e5b57eb604
.octa 0x35e535b6b5e535b6b57eb604360fb502,0xb6121c219e5eb61236129e0d1d723612,0x35e5b5b635e535b6b57e3604b60fb502,0xb502360fb60f3502b5b6b5e5357eb604
.octa 0xb57eb604357eb604360fb50235e535b6,0x3604357e357e3604b502360fb5e535b6,0xb60f3502b60fb502b5e5b5b6b57eb604,0x35b6b5e535e5b5b63604b57e360fb502
.octa 0x0,0x0,0x0,0x0
.octa 0x1d213592b57eb60435e535b6,0x1cf2b59235b635e5b60fb502,0x1d363592b5e5b5b6360fb502,0x9df2b5923604357eb5e535b6
.octa 0x1d4a3592b60fb502357eb604,0x1ca2b59236129e2b1db63612,0x1e4a3592b60f3502b57eb604,0x9e03b5923604b57e35e535b6
.octa 0x1d723592b5e535b6b60fb502,0x1c22b59235b6b5e5360fb502,0x9da13592b57e3604b5e535b6,0x9e0db5923502b60f357eb604
.octa 0x0,0x0,0x0,0x0
.octa 0xd800000000000000000000000000,0xd810000004800000001000000002,0xd820000009000000002000000004,0xd83000000d800000003000000006
.octa 0xd840000000900000004000000410,0xd850000005100000005000000412,0xd860000009900000006000000414,0xd87000000e100000007000000416
.octa 0xd890000001200000008000000820,0xd8a0000005a00000009000000822,0xd8b000000a20000000a000000824,0xd8c000000ea0000000b000000826
.octa 0xd8d0000001b0000000c000000c30,0xd8e000000630000000d000000c32,0xd8f000000ab0000000e000000c34,0xd90000000f30000000f000000c36
.octa 0xd920000012000000010000001040,0xd930000016800000011000001042,0xd94000001b000000012000001044,0xd95000001f800000013000001046
.octa 0xd960000012900000014000001450,0xd970000017100000015000001452,0xd98000001b900000016000001454,0xd990000020100000017000001456
.octa 0xd9b0000013200000018000001860,0xd9c0000017a00000019000001862,0xd9d000001c20000001a000001864,0xd9e0000020a0000001b000001866
.octa 0xd9f0000013b0000001c000001c70,0xda0000001830000001d000001c72,0xda1000001cb0000001e000001c74,0xda2000002130000001f000001c76
.octa 0xda40000000080000020000000008,0xda5000000488000002100000000a,0xda6000000908000002200000000c,0xda7000000d88000002300000000e
.octa 0xda80000000980000024000000418,0xda9000000518000002500000041a,0xdaa000000998000002600000041c,0xdab000000e18000002700000041e
.octa 0xdad0000001280000028000000828,0xdae0000005a8000002900000082a,0xdaf000000a28000002a00000082c,0xdb0000000ea8000002b00000082e
.octa 0xdb10000001b8000002c000000c38,0xdb2000000638000002d000000c3a,0xdb3000000ab8000002e000000c3c,0xdb4000000f38000002f000000c3e
.octa 0xdb60000012080000030000001048,0xdb7000001688000003100000104a,0xdb8000001b08000003200000104c,0xdb9000001f88000003300000104e
.octa 0xdba0000012980000034000001458,0xdbb000001718000003500000145a,0xdbc000001b98000003600000145c,0xdbd000002018000003700000145e
.octa 0xdbf0000013280000038000001868,0xdc00000017a8000003900000186a,0xdc1000001c28000003a00000186c,0xdc20000020a8000003b00000186e
.octa 0xdc30000013b8000003c000001c78,0xdc4000001838000003d000001c7a,0xdc5000001cb8000003e000001c7c,0xdc6000002138000003f000001c7e
.octa 0x28000000280000000000,0x28040000291000000010,0x280800002a2000000020,0x280c00002b3000000030
.octa 0x100000281000002c4000000040,0x100000281400002d5000000050,0x100000281800002e6000000060,0x100000281c00002f7000000070
.octa 0x20000028200000308000001000,0x20000028240000319000001010,0x2000002828000032a000001020,0x200000282c000033b000001030
.octa 0x3000002830000034c000001040,0x3000002834000035d000001050,0x3000002838000036e000001060,0x300000283c000037f000001070
.octa 0x40000028400000390000002000,0x400000284400003a1000002010,0x400000284800003b2000002020,0x400000284c00003c3000002030
.octa 0x500000285000003d4000002040,0x500000285400003e5000002050,0x500000285800003f6000002060,0x500000285c0000407000002070
.octa 0x60000028600000418000003000,0x60000028640000429000003010,0x6000002868000043a000003020,0x600000286c000044b000003030
.octa 0x7000002870000045c000003040,0x7000002874000046d000003050,0x7000002878000047e000003060,0x700000287c000048f000003070
.octa 0x29000000281000004000,0x29040000292000004010,0x290800002a3000004020,0x290c00002b4000004030
.octa 0x100000291000002c5000004040,0x100000291400002d6000004050,0x100000291800002e7000004060,0x100000291c00002f8000004070
.octa 0x20000029200000309000005000,0x2000002924000031a000005010,0x2000002928000032b000005020,0x200000292c000033c000005030
.octa 0x3000002930000034d000005040,0x3000002934000035e000005050,0x3000002938000036f000005060,0x300000293c0000380000005070
.octa 0x40000029400000391000006000,0x400000294400003a2000006010,0x400000294800003b3000006020,0x400000294c00003c4000006030
.octa 0x500000295000003d5000006040,0x500000295400003e6000006050,0x500000295800003f7000006060,0x500000295c0000408000006070
.octa 0x60000029600000419000007000,0x6000002964000042a000007010,0x6000002968000043b000007020,0x600000296c000044c000007030
.octa 0x7000002970000045d000007040,0x7000002974000046e000007050,0x7000002978000047f000007060,0x700000297c0000490000007070
.octa 0x38000000000000000200,0x700000038100000001000000210,0xe00000038200000002000000c00,0x1500000038300000003000000c10
.octa 0x10000048400000004000000220,0x710000048500000005000000230,0xe10000048600000006000000c20,0x1510000048700000007000000c30
.octa 0x20000058800000008000000240,0x720000058900000009000000250,0xe20000058a0000000a000000c40,0x1520000058b0000000b000000c50
.octa 0x30000068c0000000c000000260,0x730000068d0000000d000000270,0xe30000068e0000000e000000c60,0x1530000068f0000000f000000c70
.octa 0x40000079000000010000000280,0x740000079100000011000000290,0xe40000079200000012000000c80,0x1540000079300000013000000c90
.octa 0x500000894000000140000002a0,0x7500000895000000150000002b0,0xe50000089600000016000000ca0,0x1550000089700000017000000cb0
.octa 0x600000998000000180000002c0,0x7600000999000000190000002d0,0xe60000099a0000001a000000cc0,0x1560000099b0000001b000000cd0
.octa 0x700000a9c0000001c0000002e0,0x7700000a9d0000001d0000002f0,0xe700000a9e0000001e000000ce0,0x15700000a9f0000001f000000cf0
.octa 0x1c000000ba0000000a0000000300,0x23000000ba1000000a1000000310,0x2a000000ba2000000a2000000d00,0x31000000ba3000000a3000000d10
.octa 0x1c100000ca4000000a4000000320,0x23100000ca5000000a5000000330,0x2a100000ca6000000a6000000d20,0x31100000ca7000000a7000000d30
.octa 0x1c200000da8000000a8000000340,0x23200000da9000000a9000000350,0x2a200000daa000000aa000000d40,0x31200000dab000000ab000000d50
.octa 0x1c300000eac000000ac000000360,0x23300000ead000000ad000000370,0x2a300000eae000000ae000000d60,0x31300000eaf000000af000000d70
.octa 0x1c400000fb0000000b0000000380,0x23400000fb1000000b1000000390,0x2a400000fb2000000b2000000d80,0x31400000fb3000000b3000000d90
.octa 0x1c5000010b4000000b40000003a0,0x235000010b5000000b50000003b0,0x2a5000010b6000000b6000000da0,0x315000010b7000000b7000000db0
.octa 0x1c6000011b8000000b80000003c0,0x236000011b9000000b90000003d0,0x2a6000011ba000000ba000000dc0,0x316000011bb000000bb000000dd0
.octa 0x1c7000012bc000000bc0000003e0,0x237000012bd000000bd0000003f0,0x2a7000012be000000be000000de0,0x317000012bf000000bf000000df0
.octa 0xb800000000000000002000002838,0xb810000000400000004000003878,0xb8200000009000000060000048b8,0xb830000000d000000080000058f8
.octa 0xb84000000120000000a000002830,0xb85000000160000000c000003870,0xb860000001b0000000e0000048b0,0xb870000001f000000100000058f0
.octa 0xb890000002400000012000002828,0xb880000002000000014000003868,0xb8b0000002d000000160000048a8,0xb8a00000029000000180000058e8
.octa 0xb8d000000360000001a000002820,0xb8c000000320000001c000003860,0xb8f0000003f0000001e0000048a0,0xb8e0000003b000000200000058e0
.octa 0xb920000000080000003000002848,0xb930000000480000005000003888,0xb9000000009800000070000048c8,0xb910000000d80000009000005908
.octa 0xb96000000128000000b000002840,0xb97000000168000000d000003880,0xb940000001b8000000f0000048c0,0xb950000001f80000011000005900
.octa 0xb9b0000002480000013000002838,0xb9a0000002080000015000003878,0xb990000002d800000170000048b8,0xb9800000029800000190000058f8
.octa 0xb9f000000368000001b000002830,0xb9e000000328000001d000003870,0xb9d0000003f8000001f0000048b0,0xb9c0000003b800000210000058f0
.octa 0xba400000001000000a2000002858,0xba500000005000000a4000003898,0xba600000008000000a60000048d8,0xba70000000c000000a8000005918
.octa 0xba000000013000000aa000002850,0xba100000017000000ac000003890,0xba20000001a000000ae0000048d0,0xba30000001e000000b0000005910
.octa 0xbad00000025000000b2000002848,0xbac00000021000000b4000003888,0xbaf0000002c000000b60000048c8,0xbae00000028000000b8000005908
.octa 0xba900000037000000ba000002840,0xba800000033000000bc000003880,0xbab0000003e000000be0000048c0,0xbaa0000003a000000c0000005900
.octa 0xbb600000001800000a3000002868,0xbb700000005800000a50000038a8,0xbb400000008800000a70000048e8,0xbb50000000c800000a9000005928
.octa 0xbb200000013800000ab000002860,0xbb300000017800000ad0000038a0,0xbb00000001a800000af0000048e0,0xbb10000001e800000b1000005920
.octa 0xbbf00000025800000b3000002858,0xbbe00000021800000b5000003898,0xbbd0000002c800000b70000048d8,0xbbc00000028800000b9000005918
.octa 0xbbb00000037800000bb000002850,0xbba00000033800000bd000003890,0xbb90000003e800000bf0000048d0,0xbb80000003a800000c1000005910
.octa 0x10001000100000000000100000000,0x10001000100010000000100000001,0x10001000000000001000000010000,0x10001000000010001000000010001
.octa 0x100000001000100000000,0x100010001000100000001,0x10000,0x10000000000010001
.octa 0x10001000100000000000100000000,0x10001000100010000000100000001,0x10001000000000001000000010000,0x10001000000010001000000010001
.octa 0x100000001000100000000,0x100010001000100000001,0x10000,0x10000000000010001
.octa 0x10001000100000000000100000000,0x10001000100010000000100000001,0x10001000000000001000000010000,0x10001000000010001000000010001
.octa 0x100000001000100000000,0x100010001000100000001,0x10000,0x10000000000010001
.octa 0x10001000100000000000100000000,0x10001000100010000000100000001,0x10001000000000001000000010000,0x10001000000010001000000010001
.octa 0x100000001000100000000,0x100010001000100000001,0x10000,0x10000000000010001
.octa 0x10001000100000000000100000000,0x10001000100010000000100000001,0x10001000000000001000000010000,0x10001000000010001000000010001
.octa 0x100000001000100000000,0x100010001000100000001,0x10000,0x10000000000010001
.octa 0x10001000100000000000100000000,0x10001000100010000000100000001,0x10001000000000001000000010000,0x10001000000010001000000010001
.octa 0x100000001000100000000,0x100010001000100000001,0x10000,0x10000000000010001
.octa 0x10001000100000000000100000000,0x10001000100010000000100000001,0x10001000000000001000000010000,0x10001000000010001000000010001
.octa 0x100000001000100000000,0x100010001000100000001,0x10000,0x10000000000010001
.octa 0x10001000100000000000100000000,0x10001000100010000000100000001,0x10001000000000001000000010000,0x10001000000010001000000010001
.octa 0x100000001000100000000,0x100010001000100000001,0x10000,0x10000000000010001
.octa 0xc000c000c000c000c000c000c000c00,0xc000c000c000c000c000c000c000c00,0xc000c000c000c000c000c000c000c00,0xc000c000c000c000c000c000c000c00
.octa 0xc000c000c000c000c000c000c000c00,0xc000c000c000c000c000c000c000c00,0xc000c000c000c000c000c000c000c00,0xc000c000c000c000c000c000c000c00
.octa 0xc000c000c000c000c000c000c000c00,0xc000c000c000c000c000c000c000c00,0xc000c000c000c000c000c000c000c00,0xc000c000c000c000c000c000c000c00
.octa 0xc000c000c000c000c000c000c000c00,0xc000c000c000c000c000c000c000c00,0xc000c000c000c000c000c000c000c00,0xc000c000c000c000c000c000c000c00
.octa 0xc000c000c000c000c000c000c000c00,0xc000c000c000c000c000c000c000c00,0xc000c000c000c000c000c000c000c00,0xc000c000c000c000c000c000c000c00
.octa 0xc000c000c000c000c000c000c000c00,0xc000c000c000c000c000c000c000c00,0xc000c000c000c000c000c000c000c00,0xc000c000c000c000c000c000c000c00
.octa 0xc000c000c000c000c000c000c000c00,0xc000c000c000c000c000c000c000c00,0xc000c000c000c000c000c000c000c00,0xc000c000c000c000c000c000c000c00
.octa 0xc000c000c000c000c000c000c000c00,0xc000c000c000c000c000c000c000c00,0xc000c000c000c000c000c000c000c00,0xc000c000c000c000c000c000c000c00
.octa 0xc000c000c000c000c000c000c000c00,0xc000c000c000c000c000c000c000c00,0xc000c000c000c000c000c000c000c00,0xc000c000c000c000c000c000c000c00
.octa 0xc000c000c000c000c000c000c000c00,0xc000c000c000c000c000c000c000c00,0xc000c000c000c000c000c000c000c00,0xc000c000c000c000c000c000c000c00
.octa 0xc000c000c000c000c000c000c000c00,0xc000c000c000c000c000c000c000c00,0xc000c000c000c000c000c000c000c00,0xc000c000c000c000c000c000c000c00
.octa 0xc000c000c000c000c000c000c000c00,0xc000c000c000c000c000c000c000c00,0xc000c000c000c000c000c000c000c00,0xc000c000c000c000c000c000c000c00
.octa 0xc000c000c000c000c000c000c000c00,0xc000c000c000c000c000c000c000c00,0xc000c000c000c000c000c000c000c00,0xc000c000c000c000c000c000c000c00
.octa 0xc000c000c000c000c000c000c000c00,0xc000c000c000c000c000c000c000c00,0xc000c000c000c000c000c000c000c00,0xc000c000c000c000c000c000c000c00
.octa 0xc000c000c000c000c000c000c000c00,0xc000c000c000c000c000c000c000c00,0xc000c000c000c000c000c000c000c00,0xc000c000c000c000c000c000c000c00
.octa 0xc000c000c000c000c000c000c000c00,0xc000c000c000c000c000c000c000c00,0xc000c000c000c000c000c000c000c00,0xc000c000c000c000c000c000c000c00
.octa 0xc000c000c000c000c000c000c000c00,0xc000c000c000c000c000c000c000c00,0xc000c000c000c000c000c000c000c00,0xc000c000c000c000c000c000c000c00
.octa 0xc000c000c000c000c000c000c000c00,0xc000c000c000c000c000c000c000c00,0xc000c000c000c000c000c000c000c00,0xc000c000c000c000c000c000c000c00
.octa 0xc000c000c000c000c000c000c000c00,0xc000c000c000c000c000c000c000c00,0xc000c000c000c000c000c000c000c00,0xc000c000c000c000c000c000c000c00
.octa 0xc000c000c000c000c000c000c000c00,0xc000c000c000c000c000c000c000c00,0xc000c000c000c000c000c000c000c00,0xc000c000c000c000c000c000c000c00
.octa 0xc000c000c000c000c000c000c000c00,0xc000c000c000c000c000c000c000c00,0xc000c000c000c000c000c000c000c00,0xc000c000c000c000c000c000c000c00
.octa 0xc000c000c000c000c000c000c000c00,0xc000c000c000c000c000c000c000c00,0xc000c000c000c000c000c000c000c00,0xc000c000c000c000c000c000c000c00
.octa 0xc000c000c000c000c000c000c000c00,0xc000c000c000c000c000c000c000c00,0xc000c000c000c000c000c000c000c00,0xc000c000c000c000c000c000c000c00
.octa 0xc000c000c000c000c000c000c000c00,0xa000c000c000c000c000c000c000c00,0x9c009c809d009d809e009e809f009f8,0x98009880990099809a009a809b009b8
.octa 0x9400948095009580960096809700978,0x9000908091009180920092809300938,0x8c008c808d008d808e008e808f008f8,0x88008880890089808a008a808b008b8
.octa 0x8400848085008580860086808700878,0xc000808081008180820082808300838,0xc000c000c000c000c000c000c000c00,0xc000c000c000c000c000c000c000c00
.octa 0xc000c000c000c000c000c000c000c00,0xc000c000c000c000c000c000c000c00,0x9fc0c000c000c000c000c000c000c00,0x9bc09c409cc09d409dc09e409ec09f4
.octa 0x97c0984098c0994099c09a409ac09b4,0x93c0944094c0954095c0964096c0974,0x8fc0904090c0914091c0924092c0934,0x8bc08c408cc08d408dc08e408ec08f4
.octa 0x87c0884088c0894089c08a408ac08b4,0x83c0844084c0854085c0864086c0874,0xc000804080c0814081c0824082c0834,0xc000c000c000c000c000c000c000c00
.octa 0xc000c000c000c000c000c000c000c00,0xc000c000c000c000c000c000c000c00,0xc000c000c000c000c000c000c000c00,0xc000c000c000c000c000c000c000c00
.octa 0xc000c000c000c000c000c000c000c00,0xc000c000c000c000c000c000c000c00,0xc000c000c000c000c000c000c000c00,0xc000c000c000c000c000c000c000c00
.octa 0xc000c000c000c000c000c000c000c00,0xc000c000c000c000c000c000c000c00,0xc000c000c000c000c000c000c000c00,0x80008000800080008000c000c000c00
.octa 0x77c077c077c07fc07fc07fc08000800,0x7780778077807f807f807f8077c077c,0x7740774077407f407f407f407780778,0x7700770077007f007f007f007740774
.octa 0x76c076c076c07ec07ec07ec07700770,0x7680768076807e807e807e8076c076c,0x7640764076407e407e407e407680768,0x7600760076007e007e007e007640764
.octa 0x75c075c075c07dc07dc07dc07600760,0x7580758075807d807d807d8075c075c,0x7540754075407d407d407d407580758,0x7500750075007d007d007d007540754
.octa 0x74c074c074c07cc07cc07cc07500750,0x7480748074807c807c807c8074c074c,0x7440744074407c407c407c407480748,0x7400740074007c007c007c007440744
.octa 0x73c073c073c07bc07bc07bc07400740,0x7380738073807b807b807b8073c073c,0x7340734073407b407b407b407380738,0x7300730073007b007b007b007340734
.octa 0x72c072c072c07ac07ac07ac07300730,0x7280728072807a807a807a8072c072c,0x7240724072407a407a407a407280728,0x7200720072007a007a007a007240724
.octa 0x71c071c071c079c079c079c07200720,0x71807180718079807980798071c071c,0x7140714071407940794079407180718,0x7100710071007900790079007140714
.octa 0x70c070c070c078c078c078c07100710,0x70807080708078807880788070c070c,0x7040704070407840784078407080708,0x7000700070007800780078007040704
.octa 0x67c067c067c06fc06fc06fc07000700,0x6780678067806f806f806f8067c067c,0x6740674067406f406f406f406780678,0x6700670067006f006f006f006740674
.octa 0x66c066c066c06ec06ec06ec06700670,0x6680668066806e806e806e8066c066c,0x6640664066406e406e406e406680668,0x6600660066006e006e006e006640664
.octa 0x65c065c065c06dc06dc06dc06600660,0x6580658065806d806d806d8065c065c,0x6540654065406d406d406d406580658,0x6500650065006d006d006d006540654
.octa 0x64c064c064c06cc06cc06cc06500650,0x6480648064806c806c806c8064c064c,0x6440644064406c406c406c406480648,0x6400640064006c006c006c006440644
.octa 0x63c063c063c06bc06bc06bc06400640,0x6380638063806b806b806b8063c063c,0x6340634063406b406b406b406380638,0x6300630063006b006b006b006340634
.octa 0x62c062c062c06ac06ac06ac06300630,0x6280628062806a806a806a8062c062c,0x6240624062406a406a406a406280628,0x6200620062006a006a006a006240624
.octa 0x61c061c061c069c069c069c06200620,0x61806180618069806980698061c061c,0x6140614061406940694069406180618,0x6100610061006900690069006140614
.octa 0x60c060c060c068c068c068c06100610,0x60806080608068806880688060c060c,0x6040604060406840684068406080608,0x6000600060006800680068006040604
.octa 0x47c047c04fc057c057c057c05fc0600,0x478047804f805780578057805f8047c,0x474047404f405740574057405f40478,0x470047004f005700570057005f00474
.octa 0x46c046c04ec056c056c056c05ec0470,0x468046804e805680568056805e8046c,0x464046404e405640564056405e40468,0x460046004e005600560056005e00464
.octa 0x45c045c04dc055c055c055c05dc0460,0x458045804d805580558055805d8045c,0x454045404d405540554055405d40458,0x450045004d005500550055005d00454
.octa 0x44c044c04cc054c054c054c05cc0450,0x448044804c805480548054805c8044c,0x444044404c405440544054405c40448,0x440044004c005400540054005c00444
.octa 0x43c043c04bc053c053c053c05bc0440,0x438043804b805380538053805b8043c,0x434043404b405340534053405b40438,0x430043004b005300530053005b00434
.octa 0x42c042c04ac052c052c052c05ac0430,0x428042804a805280528052805a8042c,0x424042404a405240524052405a40428,0x420042004a005200520052005a00424
.octa 0x41c041c049c051c051c051c059c0420,0x418041804980518051805180598041c,0x4140414049405140514051405940418,0x4100410049005100510051005900414
.octa 0x40c040c048c050c050c050c058c0410,0x408040804880508050805080588040c,0x4040404048405040504050405840408,0x4000400048005000500050005800404
.octa 0x7c00fc017c01fc027c02fc037c03fc,0x7800f8017801f8027802f8037803f8,0x7400f4017401f4027402f4037403f4,0x7000f0017001f0027002f0037003f0
.octa 0x6c00ec016c01ec026c02ec036c03ec,0x6800e8016801e8026802e8036803e8,0x6400e4016401e4026402e4036403e4,0x6000e0016001e0026002e0036003e0
.octa 0x5c00dc015c01dc025c02dc035c03dc,0x5800d8015801d8025802d8035803d8,0x5400d4015401d4025402d4035403d4,0x5000d0015001d0025002d0035003d0
.octa 0x4c00cc014c01cc024c02cc034c03cc,0x4800c8014801c8024802c8034803c8,0x4400c4014401c4024402c4034403c4,0x4000c0014001c0024002c0034003c0
.octa 0x3c00bc013c01bc023c02bc033c03bc,0x3800b8013801b8023802b8033803b8,0x3400b4013401b4023402b4033403b4,0x3000b0013001b0023002b0033003b0
.octa 0x2c00ac012c01ac022c02ac032c03ac,0x2800a8012801a8022802a8032803a8,0x2400a4012401a4022402a4032403a4,0x2000a0012001a0022002a0032003a0
.octa 0x1c009c011c019c021c029c031c039c,0x180098011801980218029803180398,0x140094011401940214029403140394,0x100090011001900210029003100390
.octa 0xc008c010c018c020c028c030c038c,0x80088010801880208028803080388,0x40084010401840204028403040384,0x80010001800200028003000380
.octa 0xc000c000c0000000c000c000c00,0xc000c000c0000000c000c000c00,0xc000c000c0000000c000c000c00,0xc000c000c0000000c000c000c00
.octa 0xc000c000c0000000c000c000c00,0xc000c000c0000000c000c000c00,0xc000c000c0000000c000c000c00,0xc000c000c0000000c000c000c00
.octa 0xc000c000c0000000c000c000c00,0xc000c000c0000000c000c000c00,0xc000c000c0000000c000c000c00,0xc000c000c0000000c000c000c00
.octa 0xc000c000c0000000c000c000c00,0xc000c000c0000000c000c000c00,0xc000c000c0000000c000c000c00,0xc000c000c0000000c000c000c00
.octa 0xc000c000c0000000c000c000c00,0xc000c000c0000000c000c000c00,0xc000c000c0000000c000c000c00,0xc000c000c0000000c000c000c00
.octa 0xc000c000c0000000c000c000c00,0xc000c000c0000000c000c000c00,0xc000c000c0000000c000c000c00,0xc000c000c0000000c000c000c00
.octa 0xc000c000c0000000c000c000c00,0xc000c000c0000000c000c000c00,0xc000c000c0000000c000c000c00,0xc000c000c0000000c000c000c00
.octa 0xc000c000c0000000c000c000c00,0xc000c000c0000000c000c000c00,0xc000c000c0000000c000c000c00,0xc000c000c0000000c000c000c00
.octa 0xc000c000c0000000c000c000c00,0xc000c000c0000000c000c000c00,0xc000c000c0000000c000c000c00,0xc000c000c0000000c000c000c00
.octa 0xc000c000c0000000c000c000c00,0xc000c000c0000000c000c000c00,0xc000c000c0000000c000c000c00,0xc000c000c0000000c000c000c00
.octa 0xc000c000c0000000c000c000c00,0xc000c000c0000000c000c000c00,0xc000c000c0000000c000c000c00,0xc000c000c0000000c000c000c00
.octa 0xc000c000c0000000c000c000c00,0xc000c000c0000000c000c000c00,0x9e809f009f800000c000c000c00,0x96809700978000009a809b009b8
.octa 0x8e808f008f80000092809300938,0x86808700878000008a808b008b8,0xc000c000c000000082808300838,0xc000c000c0000000c000c000c00
.octa 0xc000c000c0000000c000c000c00,0x9a409ac09b4000009e409ec09f4,0x924092c093400000964096c0974,0x8a408ac08b4000008e408ec08f4
.octa 0x824082c083400000864086c0874,0xc000c000c0000000c000c000c00,0xc000c000c0000000c000c000c00,0xc000c000c0000000c000c000c00
.octa 0xc000c000c0000000c000c000c00,0xc000c000c0000000c000c000c00,0xc000c000c0000000c000c000c00,0x7fc0800080000000c000c000c00
.octa 0x7f407780778000007f8077c077c,0x7ec07700770000007f007740774,0x7e407680768000007e8076c076c,0x7dc07600760000007e007640764
.octa 0x7d407580758000007d8075c075c,0x7cc07500750000007d007540754,0x7c407480748000007c8074c074c,0x7bc07400740000007c007440744
.octa 0x7b407380738000007b8073c073c,0x7ac07300730000007b007340734,0x7a407280728000007a8072c072c,0x79c07200720000007a007240724
.octa 0x7940718071800000798071c071c,0x78c071007100000079007140714,0x7840708070800000788070c070c,0x6fc070007000000078007040704
.octa 0x6f406780678000006f8067c067c,0x6ec06700670000006f006740674,0x6e406680668000006e8066c066c,0x6dc06600660000006e006640664
.octa 0x6d406580658000006d8065c065c,0x6cc06500650000006d006540654,0x6c406480648000006c8064c064c,0x6bc06400640000006c006440644
.octa 0x6b406380638000006b8063c063c,0x6ac06300630000006b006340634,0x6a406280628000006a8062c062c,0x69c06200620000006a006240624
.octa 0x6940618061800000698061c061c,0x68c061006100000069006140614,0x6840608060800000688060c060c,0x57c05fc06000000068006040604
.octa 0x57405f404780000057805f8047c,0x56c05ec04700000057005f00474,0x56405e404680000056805e8046c,0x55c05dc04600000056005e00464
.octa 0x55405d404580000055805d8045c,0x54c05cc04500000055005d00454,0x54405c404480000054805c8044c,0x53c05bc04400000054005c00444
.octa 0x53405b404380000053805b8043c,0x52c05ac04300000053005b00434,0x52405a404280000052805a8042c,0x51c059c04200000052005a00424
.octa 0x51405940418000005180598041c,0x50c058c04100000051005900414,0x50405840408000005080588040c,0x2fc037c03fc0000050005800404
.octa 0x2f4037403f4000002f8037803f8,0x2ec036c03ec000002f0037003f0,0x2e4036403e4000002e8036803e8,0x2dc035c03dc000002e0036003e0
.octa 0x2d4035403d4000002d8035803d8,0x2cc034c03cc000002d0035003d0,0x2c4034403c4000002c8034803c8,0x2bc033c03bc000002c0034003c0
.octa 0x2b4033403b4000002b8033803b8,0x2ac032c03ac000002b0033003b0,0x2a4032403a4000002a8032803a8,0x29c031c039c000002a0032003a0
.octa 0x294031403940000029803180398,0x28c030c038c0000029003100390,0x284030403840000028803080388,0xc000c000c000000028003000380
.octa 0x28000000d80000000000,0x28040000d81000000480,0x28080000d82000000900,0x280c0000d83000000d80
.octa 0x28100000d84000000090,0x28140000d85000000510,0x28180000d86000000990,0x281c0000d87000000e10
.octa 0x28200000d89000000120,0x28240000d8a0000005a0,0x28280000d8b000000a20,0x282c0000d8c000000ea0
.octa 0x28300000d8d0000001b0,0x28340000d8e000000630,0x28380000d8f000000ab0,0x283c0000d90000000f30
.octa 0x28400000d92000001200,0x28440000d93000001680,0x28480000d94000001b00,0x284c0000d95000001f80
.octa 0x28500000d96000001290,0x28540000d97000001710,0x28580000d98000001b90,0x285c0000d99000002010
.octa 0x28600000d9b000001320,0x28640000d9c0000017a0,0x28680000d9d000001c20,0x286c0000d9e0000020a0
.octa 0x28700000d9f0000013b0,0x28740000da0000001830,0x28780000da1000001cb0,0x287c0000da2000002130
.octa 0x29000000da4000000008,0x29040000da5000000488,0x29080000da6000000908,0x290c0000da7000000d88
.octa 0x29100000da8000000098,0x29140000da9000000518,0x29180000daa000000998,0x291c0000dab000000e18
.octa 0x29200000dad000000128,0x29240000dae0000005a8,0x29280000daf000000a28,0x292c0000db0000000ea8
.octa 0x29300000db10000001b8,0x29340000db2000000638,0x29380000db3000000ab8,0x293c0000db4000000f38
.octa 0x29400000db6000001208,0x29440000db7000001688,0x29480000db8000001b08,0x294c0000db9000001f88
.octa 0x29500000dba000001298,0x29540000dbb000001718,0x29580000dbc000001b98,0x295c0000dbd000002018
.octa 0x29600000dbf000001328,0x29640000dc00000017a8,0x29680000dc1000001c28,0x296c0000dc20000020a8
.octa 0x29700000dc30000013b8,0x29740000dc4000001838,0x29780000dc5000001cb8,0x297c0000dc6000002138
.octa 0xbe0000001f800004e9800003e58,0x20000000bf800002e1000005ed8,0xc000000021800004e9000003e50,0x22000000c1800002e0800005ed0
.octa 0xc200000023800004e8800003e48,0x24000000c3800002e0000005ec8,0xc400000025800004e8000003e40,0x26000000c5800002df800005ec0
.octa 0xc600000027800004e7800003e38,0x28000000c7800002df000005eb8,0xc800000029800004e7000003e30,0x2a000000c9800002de800005eb0
.octa 0xca0000002b800004e6800003e28,0x2c000000cb800002de000005ea8,0xcc0000002d800004e6000003e20,0x2e000000cd800002dd800005ea0
.octa 0xbf000000be800004ea000003e60,0x2100000020800002e1800005ee0,0xc1000000c0800004e9800003e58,0x2300000022800002e1000005ed8
.octa 0xc3000000c2800004e9000003e50,0x2500000024800002e0800005ed0,0xc5000000c4800004e8800003e48,0x2700000026800002e0000005ec8
.octa 0xc7000000c6800004e8000003e40,0x2900000028800002df800005ec0,0xc9000000c8800004e7800003e38,0x2b0000002a800002df000005eb8
.octa 0xcb000000ca800004e7000003e30,0x2d0000002c800002de800005eb0,0xcd000000cc800004e6800003e28,0x2f0000002e800002de000005ea8
.octa 0x20000000bf800004ea800003e68,0xc000000021800002e2000005ee8,0x22000000c1800004ea000003e60,0xc200000023800002e1800005ee0
.octa 0x24000000c3800004e9800003e58,0xc400000025800002e1000005ed8,0x26000000c5800004e9000003e50,0xc600000027800002e0800005ed0
.octa 0x28000000c7800004e8800003e48,0xc800000029800002e0000005ec8,0x2a000000c9800004e8000003e40,0xca0000002b800002df800005ec0
.octa 0x2c000000cb800004e7800003e38,0xcc0000002d800002df000005eb8,0x2e000000cd800004e7000003e30,0xce0000002f800002de800005eb0
.octa 0x2100000020800004eb000003e70,0xc1000000c0800002e2800005ef0,0x2300000022800004ea800003e68,0xc3000000c2800002e2000005ee8
.octa 0x2500000024800004ea000003e60,0xc5000000c4800002e1800005ee0,0x2700000026800004e9800003e58,0xc7000000c6800002e1000005ed8
.octa 0x2900000028800004e9000003e50,0xc9000000c8800002e0800005ed0,0x2b0000002a800004e8800003e48,0xcb000000ca800002e0000005ec8
.octa 0x2d0000002c800004e8000003e40,0xcd000000cc800002df800005ec0,0x2f0000002e800004e7800003e38,0xcf000000ce800002df000005eb8
.octa 0x3f803f803f803f803f803f803f803f80,0x3f803f803f803f803f803f803f800000,0x3f803f803f803f803f803f8000000000,0x3f803f803f803f803f80000000000000
.octa 0x3f803f803f803f800000000000000000,0x3f803f803f8000000000000000000000,0x3f803f80000000000000000000000000,0x3f800000000000000000000000000000
.octa 0x0,0x0,0x0,0x0
.octa 0x0,0x0,0x0,0x0
.octa 0x3f80,0x3f803f80,0x3f803f803f80,0x3f803f803f803f80
.octa 0x3f803f803f803f803f80,0x3f803f803f803f803f803f80,0x3f803f803f803f803f803f803f80,0x3f803f803f803f803f803f803f803f80
.octa 0x3f803f803f803f803f803f803f803f80,0x3f803f803f803f803f803f803f800000,0x3f803f803f803f803f803f8000000000,0x3f803f803f803f803f80000000000000
.octa 0x3f803f803f803f800000000000000000,0x3f803f803f8000000000000000000000,0x3f803f80000000000000000000000000,0x3f800000000000000000000000000000
.octa 0x0,0x0,0x0,0x0
.octa 0x0,0x0,0x0,0x0
.octa 0x3f80,0x3f803f80,0x3f803f803f80,0x3f803f803f803f80
.octa 0x3f803f803f803f803f80,0x3f803f803f803f803f803f80,0x3f803f803f803f803f803f803f80,0x3f803f803f803f803f803f803f803f80
.octa 0x0,0x0,0x0,0x0
.octa 0x0,0x0,0x0,0x0
.octa 0x0,0x0,0x0,0x0
.octa 0x0,0x0,0x0,0x0
.octa 0x0,0x0,0x0,0x0
.octa 0x0,0x0,0x0,0x0
.octa 0x0,0x0,0x0,0x0
.octa 0x0,0x0,0x0,0x0
.octa 0x3f803f803f803f803f803f803f800000,0x3f803f803f803f803f803f8000000000,0x3f803f803f803f803f80000000000000,0x3f803f803f803f800000000000000000
.octa 0x3f803f803f8000000000000000000000,0x3f803f80000000000000000000000000,0x3f800000000000000000000000000000,0x0
.octa 0x0,0x0,0x0,0x0
.octa 0x0,0x0,0x0,0x0
.octa 0x0,0x3f80,0x3f803f80,0x3f803f803f80
.octa 0x3f803f803f803f80,0x3f803f803f803f803f80,0x3f803f803f803f803f803f80,0x3f803f803f803f803f803f803f80
.octa 0x3f803f803f803f803f803f803f800000,0x3f803f803f803f803f803f8000000000,0x3f803f803f803f803f80000000000000,0x3f803f803f803f800000000000000000
.octa 0x3f803f803f8000000000000000000000,0x3f803f80000000000000000000000000,0x3f800000000000000000000000000000,0x0
.octa 0x0,0x0,0x0,0x0
.octa 0x0,0x0,0x0,0x0
.octa 0x0,0x3f80,0x3f803f80,0x3f803f803f80
.octa 0x3f803f803f803f80,0x3f803f803f803f803f80,0x3f803f803f803f803f803f80,0x3f803f803f803f803f803f803f80
.octa 0x3f8000003f8000003f8000003f80,0x3f6d3ec43f353f353ec43f6d00003f80,0x3f35bf353f80248d3f353f3500003f80,0xbec4bf6d3f35bf353f6d3ec400003f80
.octa 0xbf80a554250dbf803f80248d00003f80,0xbec43f6dbf35bf353f6dbec400003f80,0x3f353f35bf80a5543f35bf3500003f80,0x3f6dbec4bf353f353ec4bf6d00003f80
.octa 0x25d4bf80a58d3f80250dbf8000003f80,0xbf6dbec43f353f35bec4bf6d00003f80,0xbf353f353f8025b0bf35bf3500003f80,0x3ec43f6d3f35bf35bf6dbec400003f80
.octa 0x3f80261f25d4bf80bf80a55400003f80,0x3ec4bf6dbf35bf35bf6d3ec400003f80,0xbf35bf35bf80a5f7bf353f3500003f80,0xbf6d3ec4bf353f35bec43f6d00003f80
.octa 0x3f8000003f8000003f8000003f80,0x3ec4bf6d3f35bf353f6dbec43f80248d,0xbf353f35bf80a554bf35bf35250dbf80,0x3f6dbec43f353f35bec43f6dbf80a554
.octa 0xbf80a5f725d4bf803f8025b0a58d3f80,0x3f6d3ec4bf353f35bec4bf6d3f8025b0,0xbf35bf353f80261fbf353f3525d4bf80,0x3ec43f6dbf35bf353f6d3ec4bf80a5f7
.octa 0x2677bf80a6543f802630bf80a60d3f80,0xbec43f6d3f35bf35bf6d3ec43f80261f,0x3f35bf35bf80a7423f353f352630bf80,0xbf6d3ec43f353f353ec4bf6dbf80a731
.octa 0x3f80a60d269fbf80bf80a742a6543f80,0xbf6dbec4bf353f353ec43f6d3f80a68d,0x3f353f353f80a60d3f35bf352677bf80,0xbec4bf6dbf35bf35bf6dbec4bf80a742
.octa 0x3f8000003f8000003f8000003f80,0xbf6dbec4bf35bf35bec4bf6d250dbf80,0x3f35bf353f8025b03f353f35a58d3f80,0x3ec43f6dbf353f35bf6dbec425d4bf80
.octa 0xbf80a7312630bf803f80261fa60d3f80,0x3ec4bf6d3f353f35bf6d3ec42630bf80,0x3f353f35bf80a7423f35bf35a6543f80,0xbf6d3ec43f35bf35bec43f6d2677bf80
.octa 0x27b1bf80a6b03f80269fbf80a68d3f80,0x3f6d3ec4bf35bf353ec43f6d269fbf80,0xbf353f353f80a58ebf35bf35a6b03f80,0xbec4bf6dbf353f353f6d3ec427b1bf80
.octa 0x3f80258d27c2bf80bf80a777a6d43f80,0xbec43f6d3f353f353f6dbec4a70dbf80,0xbf35bf35bf80a78dbf353f35a6f73f80,0x3f6dbec43f35bf353ec4bf6d27c2bf80
.octa 0x3f8000003f8000003f8000003f80,0xbec43f6dbf353f35bf6d3ec4bf80a554,0xbf353f35bf80a5f7bf35bf3525d4bf80,0xbf6d3ec4bf35bf353ec4bf6d3f80261f
.octa 0xbf80a7422677bf803f80a68da6543f80,0xbf6dbec43f35bf353ec43f6dbf80a742,0xbf35bf353f80a60dbf353f35269fbf80,0xbec4bf6d3f353f35bf6dbec43f80a60d
.octa 0x27c2bf80a6f73f80a70dbf80a6d43f80,0x3ec4bf6dbf353f353f6dbec4bf80a777,0x3f35bf35bf80a78d3f353f3527c2bf80,0x3f6dbec4bf35bf35bec43f6d3f80258d
.octa 0x3f80268da68dbf80bf80a796a71f3f80,0x3f6d3ec43f35bf35bec4bf6dbf80a796,0x3f353f353f8028163f35bf35a68dbf80,0x3ec43f6d3f353f353f6d3ec43f80268d
.octa 0x80003f8080003f8080003f8080003f80,0xbf6d3ec4bf353f35bec43f6d80003f80,0xbf35bf35bf80248dbf353f3580003f80,0x3ec4bf6dbf35bf35bf6d3ec480003f80
.octa 0x3f80a554a50dbf80bf80248d80003f80,0x3ec43f6d3f35bf35bf6dbec480003f80,0xbf353f353f80a554bf35bf3580003f80,0xbf6dbec43f353f35bec4bf6d80003f80
.octa 0xa5d4bf80258d3f80a50dbf8080003f80,0x3f6dbec4bf353f353ec4bf6d80003f80,0x3f353f35bf8025b03f35bf3580003f80,0xbec43f6dbf35bf353f6dbec480003f80
.octa 0xbf80261fa5d4bf803f80a55480003f80,0xbec4bf6d3f35bf353f6d3ec480003f80,0x3f35bf353f80a5f73f353f3580003f80,0x3f6d3ec43f353f353ec43f6d80003f80
.octa 0x80003f8080003f8080003f8080003f80,0xbec4bf6dbf35bf35bf6dbec4bf80248d,0x3f353f353f80a5543f35bf35a50dbf80,0xbf6dbec4bf353f353ec43f6d3f80a554
.octa 0x3f80a5f7a5d4bf80bf8025b0258d3f80,0xbf6d3ec43f353f353ec4bf6dbf8025b0,0x3f35bf35bf80261f3f353f35a5d4bf80,0xbec43f6d3f35bf35bf6d3ec43f80a5f7
.octa 0xa677bf8026543f80a630bf80260d3f80,0x3ec43f6dbf35bf353f6d3ec4bf80261f,0xbf35bf353f80a742bf353f35a630bf80,0x3f6d3ec4bf353f35bec4bf6d3f80a731
.octa 0xbf80a60da69fbf803f80a74226543f80,0x3f6dbec43f353f35bec43f6dbf80a68d,0xbf353f35bf80a60dbf35bf35a677bf80,0x3ec4bf6d3f35bf353f6dbec43f80a742
.octa 0x80003f8080003f8080003f8080003f80,0x3f6dbec43f35bf353ec4bf6da50dbf80,0xbf35bf35bf8025b0bf353f35258d3f80,0xbec43f6d3f353f353f6dbec4a5d4bf80
.octa 0x3f80a731a630bf80bf80261f260d3f80,0xbec4bf6dbf353f353f6d3ec4a630bf80,0xbf353f353f80a742bf35bf3526543f80,0x3f6d3ec4bf35bf353ec43f6da677bf80
.octa 0xa7b1bf8026b03f80a69fbf80268d3f80,0xbf6d3ec43f35bf35bec43f6da69fbf80,0x3f353f35bf80a58e3f35bf3526b03f80,0x3ec4bf6d3f353f35bf6d3ec4a7b1bf80
.octa 0xbf80258da7c2bf803f80a77726d43f80,0x3ec43f6dbf353f35bf6dbec4270dbf80,0x3f35bf353f80a78d3f353f3526f73f80,0xbf6dbec4bf35bf35bec4bf6da7c2bf80
.octa 0x80003f8080003f8080003f8080003f80,0x3ec43f6d3f353f353f6d3ec43f80a554,0x3f353f353f80a5f73f35bf35a5d4bf80,0x3f6d3ec43f35bf35bec4bf6dbf80261f
.octa 0x3f80a742a677bf80bf80a68d26543f80,0x3f6dbec4bf35bf35bec43f6d3f80a742,0x3f35bf35bf80a60d3f353f35a69fbf80,0x3ec4bf6dbf353f353f6dbec4bf80a60d
.octa 0xa7c2bf8026f73f80270dbf8026d43f80,0xbec4bf6d3f353f35bf6dbec43f80a777,0xbf35bf353f80a78dbf353f35a7c2bf80,0xbf6dbec43f35bf353ec43f6dbf80258d
.octa 0xbf80268d268dbf803f80a796271f3f80,0xbf6d3ec4bf35bf353ec4bf6d3f80a796,0xbf353f35bf802816bf35bf35268dbf80,0xbec43f6dbf353f35bf6d3ec4bf80268d
.octa 0x3e163f7d3dc93f7f3d493f8000003f80,0x3f783e793f463f223edb3f6700003f80,0x3f18bf4e3f7fbdc93f3e3f2c00003f80,0xbf04bf5c3f22bf463f713eac00003f80
.octa 0xbf7d3e16bdc9bf7f3f80bd4900003f80,0xbe793f78bf46bf223f67bedb00003f80,0x3f4e3f18bf7f3dc93f2cbf3e00003f80,0x3f5cbf04bf223f463eacbf7100003f80
.octa 0xbe16bf7d3dc93f7fbd49bf8000003f80,0xbf78be793f463f22bedbbf6700003f80,0xbf183f4e3f7fbdc9bf3ebf2c00003f80,0x3f043f5c3f22bf46bf71beac00003f80
.octa 0x3f7dbe16bdc9bf7fbf803d4900003f80,0x3e79bf78bf46bf22bf673edb00003f80,0xbf4ebf18bf7f3dc9bf2c3f3e00003f80,0xbf5c3f04bf223f46beac3f7100003f80
.octa 0x3eac3f713e953f753e793f783e483f7b,0x3d49bf803ef1bf623f4ebf183f7bbe48,0xbedb3f67bf753e95bf5cbf04be48bf7b,0x3f3ebf2c3f623ef1be163f7dbf7b3e48
.octa 0xbf713eacbe95bf753f78be793e483f7b,0x3f803d49bef13f62bf18bf4e3f7bbe48,0xbf67bedb3f75be95bf043f5cbe48bf7b,0x3f2c3f3ebf62bef13f7d3e16bf7b3e48
.octa 0xbeacbf713e953f75be79bf783e483f7b,0xbd493f803ef1bf62bf4e3f183f7bbe48,0x3edbbf67bf753e953f5c3f04be48bf7b,0xbf3e3f2c3f623ef13e16bf7dbf7b3e48
.octa 0x3f71beacbe95bf75bf783e793e483f7b,0xbf80bd49bef13f623f183f4e3f7bbe48,0x3f673edb3f75be953f04bf5cbe48bf7b,0xbf2cbf3ebf62bef1bf7dbe16bf7b3e48
.octa 0x3f043f5c3ef13f623edb3f673ec43f6d,0xbf7d3e16bf75be95bf3ebf2cbec4bf6d,0x3e79bf783f62bef13f713eac3ec43f6d,0x3f4e3f18be953f75bf803d49bec4bf6d
.octa 0xbf5c3f04bef1bf623f67bedb3ec43f6d,0xbe16bf7d3f753e95bf2c3f3ebec4bf6d,0x3f783e79bf623ef13eacbf713ec43f6d,0xbf183f4e3e95bf753d493f80bec4bf6d
.octa 0xbf04bf5c3ef13f62bedbbf673ec43f6d,0x3f7dbe16bf75be953f3e3f2cbec4bf6d,0xbe793f783f62bef1bf71beac3ec43f6d,0xbf4ebf18be953f753f80bd49bec4bf6d
.octa 0x3f5cbf04bef1bf62bf673edb3ec43f6d,0x3e163f7d3f753e953f2cbf3ebec4bf6d,0xbf78be79bf623ef1beac3f713ec43f6d,0x3f18bf4e3e95bf75bd49bf80bec4bf6d
.octa 0x3f2c3f3e3f223f463f183f4e3f0e3f55,0x3eac3f71bdc93f7fbf043f5cbf553f0e,0xbd493f80bf463f22bf7dbe16bf0ebf55,0xbedb3f67bf7fbdc9be79bf783f55bf0e
.octa 0xbf3e3f2cbf22bf463f4ebf183f0e3f55,0xbf713eac3dc9bf7f3f5c3f04bf553f0e,0xbf80bd493f46bf22be163f7dbf0ebf55,0xbf67bedb3f7f3dc9bf783e793f55bf0e
.octa 0xbf2cbf3e3f223f46bf18bf4e3f0e3f55,0xbeacbf71bdc93f7f3f04bf5cbf553f0e,0x3d49bf80bf463f223f7d3e16bf0ebf55,0x3edbbf67bf7fbdc93e793f783f55bf0e
.octa 0x3f3ebf2cbf22bf46bf4e3f183f0e3f55,0x3f71beac3dc9bf7fbf5cbf04bf553f0e,0x3f803d493f46bf223e16bf7dbf0ebf55,0x3f673edb3f7f3dc93f78be793f55bf0e
.octa 0xbec43f6dbec43f6dbec43f6dbec43f6d,0xbf80248dbf6d3ec4bf353f35bec43f6d,0xbec4bf6dbf6dbec4bf6d3ec4bec43f6d,0x3f35bf35bec4bf6dbf80248dbec43f6d
.octa 0x3f6d3ec43ec4bf6dbf6dbec4bec43f6d,0x258d3f803f6dbec4bf35bf35bec43f6d,0xbf6d3ec43f6d3ec4bec4bf6dbec43f6d,0xbf35bf353ec43f6da50dbf80bec43f6d
.octa 0x3ec4bf6dbec43f6d3ec4bf6dbec43f6d,0x3f80a5f7bf6d3ec43f35bf35bec43f6d,0x3ec43f6dbf6dbec43f6dbec4bec43f6d,0xbf353f35bec4bf6d3f80a554bec43f6d
.octa 0xbf6dbec43ec4bf6d3f6d3ec4bec43f6d,0xa630bf803f6dbec43f353f35bec43f6d,0x3f6dbec43f6d3ec43ec43f6dbec43f6d,0x3f353f353ec43f6d258d3f80bec43f6d
.octa 0xbec43f6dbec43f6dbec43f6dbec43f6d,0xa50dbf80bec4bf6dbf35bf35bf6dbec4,0x3ec43f6d3f6d3ec43f6dbec43ec4bf6d,0xbf35bf35bf6d3ec4258d3f803f6d3ec4
.octa 0x3f6d3ec43ec4bf6dbf6dbec4bec43f6d,0xbf80261f3ec43f6d3f35bf35bf6dbec4,0x3f6dbec4bf6dbec43ec43f6d3ec4bf6d,0xbf353f353f6dbec4bf80261f3f6d3ec4
.octa 0x3ec4bf6dbec43f6d3ec4bf6dbec43f6d,0x268d3f80bec4bf6d3f353f35bf6dbec4,0xbec4bf6d3f6d3ec4bf6d3ec43ec4bf6d,0x3f353f35bf6d3ec4a677bf803f6d3ec4
.octa 0xbf6dbec43ec4bf6d3f6d3ec4bec43f6d,0x3f80a7653ec43f6dbf353f35bf6dbec4,0xbf6d3ec4bf6dbec4bec4bf6d3ec4bf6d,0x3f35bf353f6dbec43f80a7543f6d3ec4
.octa 0xbec43f6dbec43f6dbec43f6dbec43f6d,0x3f80a5543f6dbec43f35bf353ec4bf6d,0xbec4bf6dbf6dbec4bf6d3ec4bec43f6d,0xbf353f353ec43f6d3f80a5f73ec4bf6d
.octa 0x3f6d3ec43ec4bf6dbf6dbec4bec43f6d,0xa677bf80bf6d3ec43f353f353ec4bf6d,0xbf6d3ec43f6d3ec4bec4bf6dbec43f6d,0x3f353f35bec4bf6d268d3f803ec4bf6d
.octa 0x3ec4bf6dbec43f6d3ec4bf6dbec43f6d,0xbf80a58e3f6dbec4bf353f353ec4bf6d,0x3ec43f6dbf6dbec43f6dbec4bec43f6d,0x3f35bf353ec43f6dbf80a58e3ec4bf6d
.octa 0xbf6dbec43ec4bf6d3f6d3ec4bec43f6d,0x271f3f80bf6d3ec4bf35bf353ec4bf6d,0x3f6dbec43f6d3ec43ec43f6dbec43f6d,0xbf35bf35bec4bf6d26d4bf803ec4bf6d
.octa 0xbec43f6dbec43f6dbec43f6dbec43f6d,0x258d3f803ec43f6d3f353f353f6d3ec4,0x3ec43f6d3f6d3ec43f6dbec43ec4bf6d,0x3f353f353f6dbec4a630bf80bf6dbec4
.octa 0x3f6d3ec43ec4bf6dbf6dbec4bec43f6d,0x3f80a754bec4bf6dbf353f353f6d3ec4,0x3f6dbec4bf6dbec43ec43f6d3ec4bf6d,0x3f35bf35bf6d3ec43f80a765bf6dbec4
.octa 0x3ec4bf6dbec43f6d3ec4bf6dbec43f6d,0x26d4bf803ec43f6dbf35bf353f6d3ec4,0xbec4bf6d3f6d3ec4bf6d3ec43ec4bf6d,0xbf35bf353f6dbec4271f3f80bf6dbec4
.octa 0xbf6dbec43ec4bf6d3f6d3ec4bec43f6d,0xbf802816bec4bf6d3f35bf353f6d3ec4,0xbf6d3ec4bf6dbec4bec4bf6d3ec4bf6d,0xbf353f35bf6d3ec4bf802816bf6dbec4
.octa 0x3e953f753e483f7b3dc93f7f00003f80,0x3f7f3dc93f553f0e3ef13f6200003f80,0x3ef1bf623f7bbe483f463f2200003f80,0xbf22bf463f0ebf553f753e9500003f80
.octa 0xbf753e95be48bf7b3f7fbdc900003f80,0xbdc93f7fbf55bf0e3f62bef100003f80,0x3f623ef1bf7b3e483f22bf4600003f80,0x3f46bf22bf0e3f553e95bf7500003f80
.octa 0xbe95bf753e483f7bbdc9bf7f00003f80,0xbf7fbdc93f553f0ebef1bf6200003f80,0xbef13f623f7bbe48bf46bf2200003f80,0x3f223f463f0ebf55bf75be9500003f80
.octa 0x3f75be95be48bf7bbf7f3dc900003f80,0x3dc9bf7fbf55bf0ebf623ef100003f80,0xbf62bef1bf7b3e48bf223f4600003f80,0xbf463f22bf0e3f55be953f7500003f80
.octa 0x3f223f463f0e3f553ef13f623ec43f6d,0xbe95bf753e48bf7b3f22bf463f6dbec4,0xbdc93f7fbf553f0ebf75be95bec4bf6d,0x3ef1bf623f7b3e483dc93f7fbf6d3ec4
.octa 0xbf463f22bf0ebf553f62bef13ec43f6d,0x3f75be95be483f7bbf46bf223f6dbec4,0xbf7fbdc93f55bf0ebe953f75bec4bf6d,0x3f623ef1bf7bbe483f7fbdc9bf6d3ec4
.octa 0xbf22bf463f0e3f55bef1bf623ec43f6d,0x3e953f753e48bf7bbf223f463f6dbec4,0x3dc9bf7fbf553f0e3f753e95bec4bf6d,0xbef13f623f7b3e48bdc9bf7fbf6d3ec4
.octa 0x3f46bf22bf0ebf55bf623ef13ec43f6d,0xbf753e95be483f7b3f463f223f6dbec4,0x3f7f3dc93f55bf0e3e95bf75bec4bf6d,0xbf62bef1bf7bbe48bf7f3dc9bf6d3ec4
.octa 0x3f623ef13f553f0e3f463f223f353f35,0xbf463f22bf7b3e48bf75be95bf35bf35,0xbe95bf753f0ebf553f7fbdc93f353f35,0x3f7f3dc93e483f7bbf623ef1bf35bf35
.octa 0xbef13f62bf55bf0e3f22bf463f353f35,0xbf22bf463f7bbe48be953f75bf35bf35,0x3f75be95bf0e3f55bdc9bf7f3f353f35,0xbdc93f7fbe48bf7b3ef13f62bf35bf35
.octa 0xbf62bef13f553f0ebf46bf223f353f35,0x3f46bf22bf7b3e483f753e95bf35bf35,0x3e953f753f0ebf55bf7f3dc93f353f35,0xbf7fbdc93e483f7b3f62bef1bf35bf35
.octa 0x3ef1bf62bf55bf0ebf223f463f353f35,0x3f223f463f7bbe483e95bf75bf35bf35,0xbf753e95bf0e3f553dc93f7f3f353f35,0x3dc9bf7fbe48bf7bbef1bf62bf35bf35
.octa 0x3f7f3dc93f7b3e483f753e953f6d3ec4,0x3f623ef13f0e3f553dc93f7fbec43f6d,0x3f223f46be483f7bbf623ef1bf6dbec4,0x3e953f75bf553f0ebf46bf223ec4bf6d
.octa 0xbdc93f7fbf7bbe483e95bf753f6d3ec4,0xbef13f62bf0ebf553f7fbdc9bec43f6d,0xbf463f223e48bf7b3ef13f62bf6dbec4,0xbf753e953f55bf0ebf223f463ec4bf6d
.octa 0xbf7fbdc93f7b3e48bf75be953f6d3ec4,0xbf62bef13f0e3f55bdc9bf7fbec43f6d,0xbf22bf46be483f7b3f62bef1bf6dbec4,0xbe95bf75bf553f0e3f463f223ec4bf6d
.octa 0x3dc9bf7fbf7bbe48be953f753f6d3ec4,0x3ef1bf62bf0ebf55bf7f3dc9bec43f6d,0x3f46bf223e48bf7bbef1bf62bf6dbec4,0x3f75be953f55bf0e3f22bf463ec4bf6d
.octa 0xbf353f35bf353f35bf353f35bf353f35,0xbf6dbec4bf80248dbf6d3ec4bf353f35,0xa50dbf80bf35bf35bf80248dbf353f35,0x3f6dbec4a50dbf80bf6dbec4bf353f35
.octa 0x3f353f353f35bf35bf35bf35bf353f35,0xbec43f6d3f80a554bec4bf6dbf353f35,0xbf8025b03f353f35a50dbf80bf353f35,0xbec4bf6d258d3f803ec4bf6dbf353f35
.octa 0x3f35bf35bf353f353f35bf35bf353f35,0x3f6d3ec4bf8025b03f6dbec4bf353f35,0x260d3f80bf35bf353f80a554bf353f35,0xbf6d3ec4a5d4bf803f6d3ec4bf353f35
.octa 0xbf35bf353f35bf353f353f35bf353f35,0x3ec4bf6d3f80a5f73ec43f6dbf353f35,0x3f80a7313f353f35258d3f80bf353f35,0x3ec43f6d260d3f80bec43f6dbf353f35
.octa 0xbf353f35bf353f35bf353f35bf353f35,0x3ec4bf6da50dbf80bec4bf6dbf35bf35,0x258d3f803f353f353f80a5543f35bf35,0xbec4bf6dbf8025b0bec43f6d3f353f35
.octa 0x3f353f353f35bf35bf35bf35bf353f35,0xbf6dbec4260d3f803f6dbec4bf35bf35,0x3f80a731bf35bf35260d3f803f35bf35,0xbf6d3ec43f80a731bf6dbec43f353f35
.octa 0x3f35bf35bf353f353f35bf35bf353f35,0xbec43f6da677bf803ec43f6dbf35bf35,0xa69fbf803f353f35bf80a68d3f35bf35,0x3ec43f6dbf80a6543ec4bf6d3f353f35
.octa 0xbf35bf353f35bf353f353f35bf353f35,0x3f6d3ec426b03f80bf6d3ec4bf35bf35,0xbf80a58ebf35bf35a69fbf803f35bf35,0x3f6dbec43f80a7653f6d3ec43f353f35
.octa 0xbf353f35bf353f35bf353f35bf353f35,0x3f6d3ec43f80a5543f6dbec43f35bf35,0xa5d4bf80bf35bf35bf8025b0bf353f35,0xbf6d3ec4260d3f803f6d3ec43f35bf35
.octa 0x3f353f353f35bf35bf35bf35bf353f35,0x3ec4bf6dbf80a68d3ec43f6d3f35bf35,0xbf80a6543f353f35a677bf80bf353f35,0x3ec43f6da69fbf80bec43f6d3f35bf35
.octa 0x3f35bf35bf353f353f35bf35bf353f35,0xbf6dbec43f80a765bf6d3ec43f35bf35,0x26f73f80bf35bf353f80a765bf353f35,0x3f6dbec426f73f80bf6dbec43f35bf35
.octa 0xbf35bf353f35bf353f353f35bf353f35,0xbec43f6dbf80258dbec4bf6d3f35bf35,0x3f80a7963f353f35270d3f80bf353f35,0xbec4bf6da7d4bf803ec4bf6d3f35bf35
.octa 0xbf353f35bf353f35bf353f35bf353f35,0xbec43f6d258d3f803ec43f6d3f353f35,0x260d3f803f353f353f80a5f73f35bf35,0x3ec43f6d3f80a7313ec4bf6dbf35bf35
.octa 0x3f353f353f35bf35bf35bf35bf353f35,0x3f6d3ec4a69fbf80bf6d3ec43f353f35,0x3f80a765bf35bf3526b03f803f35bf35,0x3f6dbec4bf80a58e3f6d3ec4bf35bf35
.octa 0x3f35bf35bf353f353f35bf35bf353f35,0x3ec4bf6d270d3f80bec4bf6d3f353f35,0xa7d4bf803f353f35bf80258d3f35bf35,0xbec4bf6d3f80a796bec43f6dbf35bf35
.octa 0xbf35bf353f35bf353f353f35bf353f35,0xbf6dbec4a7e5bf803f6dbec43f353f35,0xbf8026d4bf35bf35a7e5bf803f35bf35,0xbf6d3ec4bf8026d4bf6dbec4bf35bf35
.octa 0x3edb3f673e953f753e163f7d00003f80,0x3f80bd493f623ef13f043f5c00003f80,0x3eacbf713f75be953f4e3f1800003f80,0xbf3ebf2c3ef1bf623f783e7900003f80
.octa 0xbf673edbbe95bf753f7dbe1600003f80,0x3d493f80bf62bef13f5cbf0400003f80,0x3f713eacbf753e953f18bf4e00003f80,0x3f2cbf3ebef13f623e79bf7800003f80
.octa 0xbedbbf673e953f75be16bf7d00003f80,0xbf803d493f623ef1bf04bf5c00003f80,0xbeac3f713f75be95bf4ebf1800003f80,0x3f3e3f2c3ef1bf62bf78be7900003f80
.octa 0x3f67bedbbe95bf75bf7d3e1600003f80,0xbd49bf80bf62bef1bf5c3f0400003f80,0xbf71beacbf753e95bf183f4e00003f80,0xbf2c3f3ebef13f62be793f7800003f80
.octa 0x3f5c3f043f463f223f2c3f3e3f0e3f55,0xbf18bf4ebdc9bf7f3edbbf673f55bf0e,0x3e793f78bf223f46bf80bd49bf0ebf55,0x3e16bf7d3f7fbdc93eac3f71bf553f0e
.octa 0xbf043f5cbf46bf223f3ebf2c3f0e3f55,0x3f4ebf183dc93f7fbf67bedb3f55bf0e,0xbf783e793f22bf46bd493f80bf0ebf55,0x3f7d3e16bf7f3dc93f71beacbf553f0e
.octa 0xbf5cbf043f463f22bf2cbf3e3f0e3f55,0x3f183f4ebdc9bf7fbedb3f673f55bf0e,0xbe79bf78bf223f463f803d49bf0ebf55,0xbe163f7d3f7fbdc9beacbf71bf553f0e
.octa 0x3f04bf5cbf46bf22bf3e3f2c3f0e3f55,0xbf4e3f183dc93f7f3f673edb3f55bf0e,0x3f78be793f22bf463d49bf80bf0ebf55,0xbf7dbe16bf7f3dc9bf713eacbf553f0e
.octa 0x3f80bd493f7f3dc93f783e793f6d3ec4,0xbeac3f71bf463f22bf7d3e16bf6dbec4,0xbf3ebf2c3dc9bf7f3f5cbf043f6d3ec4,0x3f67bedb3f223f46bf183f4ebf6dbec4
.octa 0x3d493f80bf7fbdc93e79bf783f6d3ec4,0xbf71beac3f46bf223e163f7dbf6dbec4,0x3f2cbf3ebdc93f7fbf04bf5c3f6d3ec4,0x3edb3f67bf22bf463f4e3f18bf6dbec4
.octa 0xbf803d493f7f3dc9bf78be793f6d3ec4,0x3eacbf71bf463f223f7dbe16bf6dbec4,0x3f3e3f2c3dc9bf7fbf5c3f043f6d3ec4,0xbf673edb3f223f463f18bf4ebf6dbec4
.octa 0xbd49bf80bf7fbdc9be793f783f6d3ec4,0x3f713eac3f46bf22be16bf7dbf6dbec4,0xbf2c3f3ebdc93f7f3f043f5c3f6d3ec4,0xbedbbf67bf22bf46bf4ebf18bf6dbec4
.octa 0x3f4ebf183f62bef13f71beac3f7bbe48,0x3f78be793f753e953f2c3f3e3e483f7b,0x3f7d3e163ef13f62bedb3f67bf7b3e48,0x3f5c3f04be953f75bf80bd49be48bf7b
.octa 0x3f183f4ebf623ef1beacbf713f7bbe48,0x3e793f78bf75be953f3ebf2c3e483f7b,0xbe163f7dbef1bf623f673edbbf7b3e48,0xbf043f5c3e95bf75bd493f80be48bf7b
.octa 0xbf4e3f183f62bef1bf713eac3f7bbe48,0xbf783e793f753e95bf2cbf3e3e483f7b,0xbf7dbe163ef13f623edbbf67bf7b3e48,0xbf5cbf04be953f753f803d49be48bf7b
.octa 0xbf18bf4ebf623ef13eac3f713f7bbe48,0xbe79bf78bf75be95bf3e3f2c3e483f7b,0x3e16bf7dbef1bf62bf67bedbbf7b3e48,0x3f04bf5c3e95bf753d49bf80be48bf7b
.octa 0xbf6d3ec4bf6d3ec4bf6d3ec4bf6d3ec4,0xbf35bf35bf6dbec4bf80248dbf6d3ec4,0x3ec4bf6dbec4bf6dbf6dbec4bf6d3ec4,0x3f80a5543ec4bf6dbf35bf35bf6d3ec4
.octa 0x3ec43f6d3f6dbec4bec4bf6dbf6d3ec4,0xbf353f353f6d3ec4a50dbf80bf6d3ec4,0xbf6dbec43ec43f6d3ec4bf6dbf6d3ec4,0xa5d4bf80bec43f6d3f35bf35bf6d3ec4
.octa 0x3f6dbec4bf6d3ec43f6dbec4bf6d3ec4,0x3f353f35bf6dbec43f80a554bf6d3ec4,0xbec43f6dbec4bf6d3f6d3ec4bf6d3ec4,0xbf80261f3ec4bf6d3f353f35bf6d3ec4
.octa 0xbec4bf6d3f6dbec43ec43f6dbf6d3ec4,0x3f35bf353f6d3ec4258d3f80bf6d3ec4,0x3f6d3ec43ec43f6dbec43f6dbf6d3ec4,0x26543f80bec43f6dbf353f35bf6d3ec4
.octa 0xbf6d3ec4bf6d3ec4bf6d3ec4bf6d3ec4,0x3f35bf353ec4bf6da50dbf80bec4bf6d,0xbec43f6d3ec43f6d3f6d3ec43f6dbec4,0xa5d4bf80bf6dbec4bf353f353ec43f6d
.octa 0x3ec43f6d3f6dbec4bec4bf6dbf6d3ec4,0xbf35bf35bec43f6d3f80a5f7bec4bf6d,0x3f6d3ec4bec4bf6dbec43f6d3f6dbec4,0xbf80a68d3f6d3ec4bf35bf353ec43f6d
.octa 0x3f6dbec4bf6d3ec43f6dbec4bf6d3ec4,0xbf353f353ec4bf6d26543f80bec4bf6d,0x3ec4bf6d3ec43f6dbf6dbec43f6dbec4,0x26b03f80bf6dbec43f35bf353ec43f6d
.octa 0xbec4bf6d3f6dbec43ec43f6dbf6d3ec4,0x3f353f35bec43f6dbf80a654bec4bf6d,0xbf6dbec4bec4bf6d3ec4bf6d3f6dbec4,0x3f80a7773f6d3ec43f353f353ec43f6d
.octa 0xbf6d3ec4bf6d3ec4bf6d3ec4bf6d3ec4,0x3f353f353f6d3ec43f80a5543f6dbec4,0x3ec4bf6dbec4bf6dbf6dbec4bf6d3ec4,0xbf80261fbec43f6d3f353f353f6dbec4
.octa 0x3ec43f6d3f6dbec4bec4bf6dbf6d3ec4,0x3f35bf35bf6dbec426543f803f6dbec4,0xbf6dbec43ec43f6d3ec4bf6dbf6d3ec4,0x26b03f803ec4bf6dbf353f353f6dbec4
.octa 0x3f6dbec4bf6d3ec43f6dbec4bf6d3ec4,0xbf35bf353f6d3ec4bf80a60d3f6dbec4,0xbec43f6dbec4bf6d3f6d3ec4bf6d3ec4,0x3f80a784bec43f6dbf35bf353f6dbec4
.octa 0xbec4bf6d3f6dbec43ec43f6dbf6d3ec4,0xbf353f35bf6dbec4a7c2bf803f6dbec4,0x3f6d3ec43ec43f6dbec43f6dbf6d3ec4,0x268dbf803ec4bf6d3f35bf353f6dbec4
.octa 0xbf6d3ec4bf6d3ec4bf6d3ec4bf6d3ec4,0xbf353f35bec43f6d258d3f803ec43f6d,0xbec43f6d3ec43f6d3f6d3ec43f6dbec4,0x26543f803f6d3ec43f35bf35bec4bf6d
.octa 0x3ec43f6d3f6dbec4bec4bf6dbf6d3ec4,0x3f353f353ec4bf6dbf80a6543ec43f6d,0x3f6d3ec4bec4bf6dbec43f6d3f6dbec4,0x3f80a777bf6dbec43f353f35bec4bf6d
.octa 0x3f6dbec4bf6d3ec43f6dbec4bf6d3ec4,0x3f35bf35bec43f6da7c2bf803ec43f6d,0x3ec4bf6d3ec43f6dbf6dbec43f6dbec4,0x268dbf803f6d3ec4bf353f35bec4bf6d
.octa 0xbec4bf6d3f6dbec43ec43f6dbf6d3ec4,0xbf35bf353ec4bf6d3f80a79f3ec43f6d,0xbf6dbec4bec4bf6d3ec4bf6d3f6dbec4,0xbf80281fbf6dbec4bf35bf35bec4bf6d
.octa 0x3f0e3f553ec43f6d3e483f7b00003f80,0x3f7bbe483f6d3ec43f0e3f5500003f80,0x3e48bf7b3f6dbec43f553f0e00003f80,0xbf55bf0e3ec4bf6d3f7b3e4800003f80
.octa 0xbf553f0ebec4bf6d3f7bbe4800003f80,0x3e483f7bbf6dbec43f55bf0e00003f80,0x3f7b3e48bf6d3ec43f0ebf5500003f80,0x3f0ebf55bec43f6d3e48bf7b00003f80
.octa 0xbf0ebf553ec43f6dbe48bf7b00003f80,0xbf7b3e483f6d3ec4bf0ebf5500003f80,0xbe483f7b3f6dbec4bf55bf0e00003f80,0x3f553f0e3ec4bf6dbf7bbe4800003f80
.octa 0x3f55bf0ebec4bf6dbf7b3e4800003f80,0xbe48bf7bbf6dbec4bf553f0e00003f80,0xbf7bbe48bf6d3ec4bf0e3f5500003f80,0xbf0e3f55bec43f6dbe483f7b00003f80
.octa 0x3f7b3e483f6d3ec43f553f0e3f353f35,0xbf55bf0ebec4bf6d3e48bf7b3f35bf35,0x3f0e3f55bec43f6dbf7b3e48bf35bf35,0xbe48bf7b3f6dbec43f0e3f55bf353f35
.octa 0xbe483f7bbf6dbec43f0ebf553f353f35,0x3f0ebf553ec43f6dbf7bbe483f35bf35,0xbf553f0e3ec4bf6d3e483f7bbf35bf35,0x3f7bbe48bf6d3ec43f55bf0ebf353f35
.octa 0xbf7bbe483f6d3ec4bf55bf0e3f353f35,0x3f553f0ebec4bf6dbe483f7b3f35bf35,0xbf0ebf55bec43f6d3f7bbe48bf35bf35,0x3e483f7b3f6dbec4bf0ebf55bf353f35
.octa 0x3e48bf7bbf6dbec4bf0e3f553f353f35,0xbf0e3f553ec43f6d3f7b3e483f35bf35,0x3f55bf0e3ec4bf6dbe48bf7bbf35bf35,0xbf7b3e48bf6d3ec4bf553f0ebf353f35
.octa 0x3f55bf0e3f6dbec43f7bbe483f80248d,0x3e483f7bbec43f6dbf553f0ebf80a554,0xbf7bbe48bec4bf6d3f0ebf553f8025b0,0x3f0ebf553f6d3ec4be483f7bbf80a5f7
.octa 0x3f0e3f55bf6d3ec4be48bf7b3f80261f,0xbf7b3e483ec4bf6d3f0e3f55bf80a731,0x3e48bf7b3ec43f6dbf55bf0e3f80a68d,0x3f553f0ebf6dbec43f7b3e48bf80a742
.octa 0xbf553f0e3f6dbec4bf7b3e483f80a654,0xbe48bf7bbec43f6d3f55bf0ebf80a754,0x3f7b3e48bec4bf6dbf0e3f553f80a60d,0xbf0e3f553f6d3ec43e48bf7bbf80a765
.octa 0xbf0ebf55bf6d3ec43e483f7b3f80a58e,0x3f7bbe483ec4bf6dbf0ebf55bf80a777,0xbe483f7b3ec43f6d3f553f0e3f80a137,0xbf55bf0ebf6dbec4bf7bbe48bf80a784
.octa 0x3e48bf7b3ec4bf6d3f0ebf553f35bf35,0x3f0ebf553f6dbec43f7b3e483f353f35,0x3f55bf0e3f6d3ec43e483f7bbf353f35,0x3f7bbe483ec43f6dbf553f0ebf35bf35
.octa 0x3f7b3e48bec43f6dbf55bf0e3f35bf35,0x3f553f0ebf6d3ec43e48bf7b3f353f35,0x3f0e3f55bf6dbec43f7bbe48bf353f35,0x3e483f7bbec4bf6d3f0e3f55bf35bf35
.octa 0xbe483f7b3ec4bf6dbf0e3f553f35bf35,0xbf0e3f553f6dbec4bf7bbe483f353f35,0xbf553f0e3f6d3ec4be48bf7bbf353f35,0xbf7b3e483ec43f6d3f55bf0ebf35bf35
.octa 0xbf7bbe48bec43f6d3f553f0e3f35bf35,0xbf55bf0ebf6d3ec4be483f7b3f353f35,0xbf0ebf55bf6dbec4bf7b3e48bf353f35,0xbe48bf7bbec4bf6dbf0ebf55bf35bf35
.octa 0xbf80248dbf80248dbf80248dbf80248d,0xbec4bf6dbf35bf35bf6dbec4bf80248d,0x3f35bf35a50dbf80bf35bf35bf80248d,0x3f6d3ec43f35bf35bec4bf6dbf80248d
.octa 0x258d3f803f80a554a50dbf80bf80248d,0xbf6d3ec43f353f353ec4bf6dbf80248d,0xbf35bf35258d3f803f35bf35bf80248d,0x3ec4bf6dbf353f353f6dbec4bf80248d
.octa 0x3f80a5f7bf8025b03f80a554bf80248d,0x3ec43f6dbf35bf353f6d3ec4bf80248d,0xbf353f35a5d4bf803f353f35bf80248d,0xbf6dbec43f35bf353ec43f6dbf80248d
.octa 0xa630bf803f80a5f7258d3f80bf80248d,0x3f6dbec43f353f35bec43f6dbf80248d,0x3f353f35260d3f80bf353f35bf80248d,0xbec43f6dbf353f35bf6d3ec4bf80248d
.octa 0xbf80248dbf80248dbf80248dbf80248d,0x3f6dbec43f35bf353ec4bf6da50dbf80,0xbf353f35258d3f803f353f353f80a554,0x3ec4bf6dbf35bf35bf6d3ec4258d3f80
.octa 0x260d3f803f80a5f7a5d4bf80bf8025b0,0xbec4bf6dbf353f353f6d3ec4a5d4bf80,0x3f353f35a630bf80bf353f353f80a5f7,0xbf6dbec43f353f35bec4bf6d260d3f80
.octa 0x3f80a742bf80a68d3f80a731bf80261f,0xbf6d3ec43f35bf35bec43f6da630bf80,0x3f35bf35268d3f80bf35bf353f80a731,0xbec43f6dbf35bf353f6dbec426543f80
.octa 0xa7b1bf803f80a754268d3f80bf80a68d,0x3ec43f6dbf353f35bf6dbec4a677bf80,0xbf35bf35a7b1bf803f35bf353f80a742,0x3f6d3ec43f353f353ec43f6d268d3f80
.octa 0xbf80248dbf80248dbf80248dbf80248d,0x3ec43f6d3f353f353f6d3ec43f80a554,0x3f35bf35a5d4bf80bf35bf35bf8025b0,0xbf6dbec4bf353f353ec43f6d3f80a5f7
.octa 0x26543f803f80a731a630bf80bf80261f,0x3f6dbec4bf35bf35bec43f6d3f80a731,0xbf35bf35268d3f803f35bf35bf80a68d,0xbec43f6d3f35bf35bf6d3ec43f80a742
.octa 0x3f80a765bf80a60d3f80a754bf80a654,0xbec4bf6d3f353f35bf6dbec43f80a754,0xbf353f35270dbf803f353f35bf80a60d,0x3f6d3ec4bf353f35bec4bf6d3f80a765
.octa 0x26d4bf803f80a78426f73f80bf80a58e,0xbf6d3ec4bf35bf353ec4bf6d3f80a777,0x3f353f35271f3f80bf353f35bf80a137,0x3ec4bf6d3f35bf353f6dbec43f80a784
.octa 0xbf80248dbf80248dbf80248dbf80248d,0xbf6d3ec4bf353f35bec43f6d258d3f80,0xbf353f35260d3f803f353f353f80a5f7,0xbec43f6d3f353f353f6dbec4a630bf80
.octa 0x268d3f803f80a742a677bf80bf80a68d,0x3ec43f6d3f35bf35bf6dbec4268d3f80,0x3f353f35a7b1bf80bf353f353f80a754,0x3f6d3ec4bf35bf353ec43f6da7b1bf80
.octa 0x3f80a784bf80a1373f80a777bf80a58e,0x3f6dbec4bf353f353ec4bf6d26f73f80,0x3f35bf35271f3f80bf35bf353f80a784,0x3ec4bf6d3f353f35bf6d3ec426d4bf80
.octa 0xa7e5bf803f80a79f27303f80bf80260d,0xbec4bf6d3f35bf353f6d3ec427303f80,0xbf35bf35260ebf803f35bf353f80a79f,0xbf6dbec4bf35bf35bec4bf6da7e5bf80
.octa 0x3f2c3f3e3ef13f623e793f7800003f80,0x3f71beac3f753e953f183f4e00003f80,0x3d49bf803f62bef13f5c3f0400003f80,0xbf67bedb3e95bf753f7d3e1600003f80
.octa 0xbf3e3f2cbef1bf623f78be7900003f80,0x3eac3f71bf75be953f4ebf1800003f80,0x3f803d49bf623ef13f04bf5c00003f80,0x3edbbf67be953f753e16bf7d00003f80
.octa 0xbf2cbf3e3ef13f62be79bf7800003f80,0xbf713eac3f753e95bf18bf4e00003f80,0xbd493f803f62bef1bf5cbf0400003f80,0x3f673edb3e95bf75bf7dbe1600003f80
.octa 0x3f3ebf2cbef1bf62bf783e7900003f80,0xbeacbf71bf75be95bf4e3f1800003f80,0xbf80bd49bf623ef1bf043f5c00003f80,0xbedb3f67be953f75be163f7d00003f80
.octa 0x3f7dbe163f7f3dc93f713eac3f553f0e,0xbf78be79bf22bf46bd49bf803f0ebf55,0x3f4e3f18bdc93f7fbf673edbbf55bf0e,0xbf04bf5c3f46bf223f3e3f2cbf0e3f55
.octa 0x3e163f7dbf7fbdc93eacbf713f553f0e,0x3e79bf783f223f46bf803d493f0ebf55,0xbf183f4e3dc9bf7f3edb3f67bf55bf0e,0x3f5cbf04bf463f223f2cbf3ebf0e3f55
.octa 0xbf7d3e163f7f3dc9bf71beac3f553f0e,0x3f783e79bf22bf463d493f803f0ebf55,0xbf4ebf18bdc93f7f3f67bedbbf55bf0e,0x3f043f5c3f46bf22bf3ebf2cbf0e3f55
.octa 0xbe16bf7dbf7fbdc9beac3f713f553f0e,0xbe793f783f223f463f80bd493f0ebf55,0x3f18bf4e3dc9bf7fbedbbf67bf55bf0e,0xbf5c3f04bf463f22bf2c3f3ebf0e3f55
.octa 0x3edbbf673f22bf463f4ebf183f6dbec4,0x3f2c3f3e3dc93f7fbf043f5cbf6d3ec4,0xbf713eacbf46bf223e16bf7d3f6dbec4,0x3d49bf803f7fbdc93e793f78bf6d3ec4
.octa 0x3f673edbbf223f46bf18bf4e3f6dbec4,0xbf3e3f2cbdc9bf7f3f5c3f04bf6d3ec4,0xbeacbf713f463f22bf7dbe163f6dbec4,0x3f803d49bf7f3dc93f78be79bf6d3ec4
.octa 0xbedb3f673f22bf46bf4e3f183f6dbec4,0xbf2cbf3e3dc93f7f3f04bf5cbf6d3ec4,0x3f71beacbf46bf22be163f7d3f6dbec4,0xbd493f803f7fbdc9be79bf78bf6d3ec4
.octa 0xbf67bedbbf223f463f183f4e3f6dbec4,0x3f3ebf2cbdc9bf7fbf5cbf04bf6d3ec4,0x3eac3f713f463f223f7d3e163f6dbec4,0xbf80bd49bf7f3dc9bf783e79bf6d3ec4
.octa 0xbf04bf5cbe95bf75bd49bf803e48bf7b,0xbe16bf7d3ef1bf623f67bedb3f7b3e48,0x3e79bf783f75be953f3e3f2cbe483f7b,0x3f18bf4e3f623ef1beac3f71bf7bbe48
.octa 0x3f5cbf043e953f75bf803d493e48bf7b,0x3f7dbe16bef13f62bedbbf673f7b3e48,0x3f783e79bf753e953f2cbf3ebe483f7b,0x3f4e3f18bf62bef13f713eacbf7bbe48
.octa 0x3f043f5cbe95bf753d493f803e48bf7b,0x3e163f7d3ef1bf62bf673edb3f7b3e48,0xbe793f783f75be95bf3ebf2cbe483f7b,0xbf183f4e3f623ef13eacbf71bf7bbe48
.octa 0xbf5c3f043e953f753f80bd493e48bf7b,0xbf7d3e16bef13f623edb3f673f7b3e48,0xbf78be79bf753e95bf2c3f3ebe483f7b,0xbf4ebf18bf62bef1bf71beacbf7bbe48
.octa 0xbf6dbec4bf6dbec4bf6dbec4bf6dbec4,0xa50dbf80bec4bf6dbf35bf35bf6dbec4,0x3f6dbec43ec4bf6dbec4bf6dbf6dbec4,0x3f353f353f6dbec4a50dbf80bf6dbec4
.octa 0xbec43f6d3f6d3ec43ec4bf6dbf6dbec4,0xbf8025b03ec43f6d3f35bf35bf6dbec4,0xbec4bf6dbec43f6d3f6dbec4bf6dbec4,0x3f35bf35bf6d3ec43f80a554bf6dbec4
.octa 0x3f6d3ec4bf6dbec43f6d3ec4bf6dbec4,0x260d3f80bec4bf6d3f353f35bf6dbec4,0xbf6d3ec43ec4bf6d3ec43f6dbf6dbec4,0xbf35bf353f6dbec4258d3f80bf6dbec4
.octa 0x3ec4bf6d3f6d3ec4bec43f6dbf6dbec4,0x3f80a7313ec43f6dbf353f35bf6dbec4,0x3ec43f6dbec43f6dbf6d3ec4bf6dbec4,0xbf353f35bf6d3ec4bf8025b0bf6dbec4
.octa 0xbf6dbec4bf6dbec4bf6dbec4bf6dbec4,0x3f80a5543f6dbec43f35bf353ec4bf6d,0xbf6d3ec4bec43f6d3ec43f6d3f6d3ec4,0x3f35bf35bec4bf6dbf8025b0bec43f6d
.octa 0xbec43f6d3f6d3ec43ec4bf6dbf6dbec4,0xa630bf80bf6d3ec43f353f353ec4bf6d,0x3ec43f6d3ec4bf6dbf6d3ec43f6d3ec4,0xbf35bf353ec43f6da630bf80bec43f6d
.octa 0x3f6d3ec4bf6dbec43f6d3ec4bf6dbec4,0xbf80a6543f6dbec4bf353f353ec4bf6d,0x3f6dbec4bec43f6dbec4bf6d3f6d3ec4,0xbf353f35bec4bf6d3f80a742bec43f6d
.octa 0x3ec4bf6d3f6d3ec4bec43f6dbf6dbec4,0x26d43f80bf6d3ec4bf35bf353ec4bf6d,0xbec4bf6d3ec4bf6d3f6dbec43f6d3ec4,0x3f353f353ec43f6d26b03f80bec43f6d
.octa 0xbf6dbec4bf6dbec4bf6dbec4bf6dbec4,0x258d3f803ec43f6d3f353f353f6d3ec4,0x3f6dbec43ec4bf6dbec4bf6dbf6dbec4,0xbf35bf35bf6d3ec4260d3f803f6d3ec4
.octa 0xbec43f6d3f6d3ec43ec4bf6dbf6dbec4,0x3f80a742bec4bf6dbf353f353f6d3ec4,0xbec4bf6dbec43f6d3f6dbec4bf6dbec4,0xbf353f353f6dbec4bf80a6543f6d3ec4
.octa 0x3f6d3ec4bf6dbec43f6d3ec4bf6dbec4,0x270dbf803ec43f6dbf35bf353f6d3ec4,0xbf6d3ec43ec4bf6d3ec43f6dbf6dbec4,0x3f353f35bf6d3ec4270dbf803f6d3ec4
.octa 0x3ec4bf6d3f6d3ec4bec43f6dbf6dbec4,0xbf80260dbec4bf6d3f35bf353f6d3ec4,0x3ec43f6dbec43f6dbf6d3ec4bf6dbec4,0x3f35bf353f6dbec43f80a78d3f6d3ec4
.octa 0xbf6dbec4bf6dbec4bf6dbec4bf6dbec4,0xbf8025b0bf6d3ec4bf353f35bec43f6d,0xbf6d3ec4bec43f6d3ec43f6d3f6d3ec4,0xbf353f353ec43f6d3f80a7313ec4bf6d
.octa 0xbec43f6d3f6d3ec43ec4bf6dbf6dbec4,0x26b03f803f6dbec4bf35bf35bec43f6d,0x3ec43f6d3ec4bf6dbf6d3ec43f6d3ec4,0x3f353f35bec4bf6d26d43f803ec4bf6d
.octa 0x3f6d3ec4bf6dbec43f6d3ec4bf6dbec4,0x3f80a78dbf6d3ec43f35bf35bec43f6d,0x3f6dbec4bec43f6dbec4bf6d3f6d3ec4,0x3f35bf353ec43f6dbf80260d3ec4bf6d
.octa 0x3ec4bf6d3f6d3ec4bec43f6dbf6dbec4,0x260ebf803f6dbec43f353f35bec43f6d,0xbec4bf6d3ec4bf6d3f6dbec43f6d3ec4,0xbf35bf35bec4bf6d260ebf803ec4bf6d
.octa 0x3f463f223f0e3f553e953f7500003f80,0x3f62bef13f7b3e483f223f4600003f80,0xbdc9bf7f3f55bf0e3f623ef100003f80,0xbf75be953e48bf7b3f7f3dc900003f80
.octa 0xbf223f46bf0ebf553f75be9500003f80,0x3ef13f62bf7bbe483f46bf2200003f80,0x3f7fbdc9bf553f0e3ef1bf6200003f80,0x3e95bf75be483f7b3dc9bf7f00003f80
.octa 0xbf46bf223f0e3f55be95bf7500003f80,0xbf623ef13f7b3e48bf22bf4600003f80,0x3dc93f7f3f55bf0ebf62bef100003f80,0x3f753e953e48bf7bbf7fbdc900003f80
.octa 0x3f22bf46bf0ebf55bf753e9500003f80,0xbef1bf62bf7bbe48bf463f2200003f80,0xbf7f3dc9bf553f0ebef13f6200003f80,0xbe953f75be483f7bbdc93f7f00003f80
.octa 0x3f62bef13f7bbe483f7f3dc93f6d3ec4,0xbf7f3dc9bf55bf0ebe95bf753ec4bf6d,0x3f753e953e483f7bbf463f22bf6dbec4,0xbf46bf223f0ebf553f623ef1bec43f6d
.octa 0x3ef13f62bf7b3e483dc9bf7f3f6d3ec4,0xbdc9bf7f3f553f0ebf753e953ec4bf6d,0xbe953f75be48bf7b3f223f46bf6dbec4,0x3f22bf46bf0e3f553ef1bf62bec43f6d
.octa 0xbf623ef13f7bbe48bf7fbdc93f6d3ec4,0x3f7fbdc9bf55bf0e3e953f753ec4bf6d,0xbf75be953e483f7b3f46bf22bf6dbec4,0x3f463f223f0ebf55bf62bef1bec43f6d
.octa 0xbef1bf62bf7b3e48bdc93f7f3f6d3ec4,0x3dc93f7f3f553f0e3f75be953ec4bf6d,0x3e95bf75be48bf7bbf22bf46bf6dbec4,0xbf223f46bf0e3f55bef13f62bec43f6d
.octa 0xbdc9bf7f3e48bf7b3ef1bf623f35bf35,0x3f753e953f0e3f55bdc93f7fbf353f35,0xbf223f46bf7bbe48be95bf753f35bf35,0xbef1bf623f55bf0e3f223f46bf353f35
.octa 0x3f7fbdc9be483f7bbf62bef13f35bf35,0xbe953f75bf0ebf553f7f3dc9bf353f35,0xbf46bf223f7b3e48bf753e953f35bf35,0x3f62bef1bf553f0e3f46bf22bf353f35
.octa 0x3dc93f7f3e48bf7bbef13f623f35bf35,0xbf75be953f0e3f553dc9bf7fbf353f35,0x3f22bf46bf7bbe483e953f753f35bf35,0x3ef13f623f55bf0ebf22bf46bf353f35
.octa 0xbf7f3dc9be483f7b3f623ef13f35bf35,0x3e95bf75bf0ebf55bf7fbdc9bf353f35,0x3f463f223f7b3e483f75be953f35bf35,0xbf623ef1bf553f0ebf463f22bf353f35
.octa 0xbf75be95bf55bf0ebf22bf46bec4bf6d,0xbf46bf22be48bf7b3ef1bf623f6dbec4,0xbef1bf623f0ebf553f7f3dc93ec43f6d,0xbdc9bf7f3f7bbe483e953f75bf6d3ec4
.octa 0x3e95bf753f553f0ebf463f22bec4bf6d,0x3f22bf463e483f7bbf62bef13f6dbec4,0x3f62bef1bf0e3f553dc9bf7f3ec43f6d,0x3f7fbdc9bf7b3e483f75be95bf6d3ec4
.octa 0x3f753e95bf55bf0e3f223f46bec4bf6d,0x3f463f22be48bf7bbef13f623f6dbec4,0x3ef13f623f0ebf55bf7fbdc93ec43f6d,0x3dc93f7f3f7bbe48be95bf75bf6d3ec4
.octa 0xbe953f753f553f0e3f46bf22bec4bf6d,0xbf223f463e483f7b3f623ef13f6dbec4,0xbf623ef1bf0e3f55bdc93f7f3ec43f6d,0xbf7f3dc9bf7b3e48bf753e95bf6d3ec4
.octa 0xbf35bf35bf35bf35bf35bf35bf35bf35,0x3ec4bf6da50dbf80bec4bf6dbf35bf35,0x3f80a5543f35bf35a50dbf80bf35bf35,0x3ec43f6d3f80a5543ec4bf6dbf35bf35
.octa 0xbf353f353f353f353f35bf35bf35bf35,0xbf6dbec4258d3f803f6dbec4bf35bf35,0xa5d4bf80bf353f353f80a554bf35bf35,0x3f6dbec4bf8025b03f6d3ec4bf35bf35
.octa 0x3f353f35bf35bf353f353f35bf35bf35,0xbec43f6da5d4bf803ec43f6dbf35bf35,0xbf80261f3f35bf35258d3f80bf35bf35,0xbec4bf6d3f80a5f7bec43f6dbf35bf35
.octa 0x3f35bf353f353f35bf353f35bf35bf35,0x3f6d3ec4260d3f80bf6d3ec4bf35bf35,0x26543f80bf353f35bf8025b0bf35bf35,0xbf6d3ec4bf80261fbf6dbec4bf35bf35
.octa 0xbf35bf35bf35bf35bf35bf35bf35bf35,0x3f6d3ec43f80a5543f6dbec43f35bf35,0xbf8025b0bf353f35258d3f803f353f35,0x3f6dbec4a5d4bf80bf6dbec4bf353f35
.octa 0xbf353f353f353f353f35bf35bf35bf35,0x3ec4bf6dbf80261f3ec43f6d3f35bf35,0x26543f803f35bf35bf80261f3f353f35,0xbec4bf6d26543f803ec4bf6dbf353f35
.octa 0x3f353f35bf35bf353f353f35bf35bf35,0xbf6dbec43f80a742bf6d3ec43f35bf35,0x3f80a754bf353f35a677bf803f353f35,0xbf6d3ec4a69fbf803f6d3ec4bf353f35
.octa 0x3f35bf353f353f35bf353f35bf35bf35,0xbec43f6dbf80a60dbec4bf6d3f35bf35,0x270dbf803f35bf353f80a7543f353f35,0x3ec43f6d26d43f80bec43f6dbf353f35
.octa 0xbf35bf35bf35bf35bf35bf35bf35bf35,0xbec43f6d258d3f803ec43f6d3f353f35,0x3f80a5f73f35bf35a5d4bf80bf35bf35,0xbec4bf6dbf80261fbec43f6d3f353f35
.octa 0xbf353f353f353f353f35bf35bf35bf35,0x3f6d3ec4a677bf80bf6d3ec43f353f35,0xa69fbf80bf353f353f80a742bf35bf35,0xbf6d3ec43f80a754bf6dbec43f353f35
.octa 0x3f353f35bf35bf353f353f35bf35bf35,0x3ec4bf6d26d43f80bec4bf6d3f353f35,0xbf80a1373f35bf3526d43f80bf35bf35,0x3ec43f6dbf80a1373ec4bf6d3f353f35
.octa 0x3f35bf353f353f35bf353f35bf35bf35,0xbf6dbec426d4bf803f6dbec43f353f35,0x27303f80bf353f35bf80258dbf35bf35,0x3f6dbec43f80a7963f6d3ec43f353f35
.octa 0xbf35bf35bf35bf35bf35bf35bf35bf35,0xbf6dbec4bf8025b0bf6d3ec4bf353f35,0xbf80261fbf353f35260d3f803f353f35,0xbf6d3ec426543f803f6d3ec43f35bf35
.octa 0xbf353f353f353f353f35bf35bf35bf35,0xbec43f6d3f80a754bec4bf6dbf353f35,0x26d43f803f35bf35bf80a60d3f353f35,0x3ec43f6d270dbf80bec43f6d3f35bf35
.octa 0x3f353f35bf35bf353f353f35bf35bf35,0x3f6d3ec4bf80258d3f6dbec4bf353f35,0x3f80a796bf353f3526d4bf803f353f35,0x3f6dbec427303f80bf6dbec43f35bf35
.octa 0x3f35bf353f353f35bf353f35bf35bf35,0x3ec4bf6d3f8027313ec43f6dbf353f35,0xa7f7bf803f35bf353f8027313f353f35,0xbec4bf6da7f7bf803ec4bf6d3f35bf35
.octa 0x3f5c3f043f223f463eac3f7100003f80,0x3f4ebf183f7f3dc93f2c3f3e00003f80,0xbe79bf783f46bf223f673edb00003f80,0xbf7dbe163dc9bf7f3f803d4900003f80
.octa 0xbf043f5cbf22bf463f71beac00003f80,0x3f183f4ebf7fbdc93f3ebf2c00003f80,0x3f78be79bf463f223edbbf6700003f80,0x3e16bf7dbdc93f7f3d49bf8000003f80
.octa 0xbf5cbf043f223f46beacbf7100003f80,0xbf4e3f183f7f3dc9bf2cbf3e00003f80,0x3e793f783f46bf22bf67bedb00003f80,0x3f7d3e163dc9bf7fbf80bd4900003f80
.octa 0x3f04bf5cbf22bf46bf713eac00003f80,0xbf18bf4ebf7fbdc9bf3e3f2c00003f80,0xbf783e79bf463f22bedb3f6700003f80,0xbe163f7dbdc93f7fbd493f8000003f80
.octa 0x3f2cbf3e3f62bef13f7dbe163f7b3e48,0xbf673edbbf75be95bf04bf5c3e48bf7b,0x3f80bd493ef13f62bf183f4ebf7bbe48,0xbf71beac3e95bf753f783e79be483f7b
.octa 0x3f3e3f2cbf623ef1be16bf7d3f7b3e48,0xbedbbf673f753e95bf5c3f043e48bf7b,0x3d493f80bef1bf623f4e3f18bf7bbe48,0x3eacbf71be953f753e79bf78be483f7b
.octa 0xbf2c3f3e3f62bef1bf7d3e163f7b3e48,0x3f67bedbbf75be953f043f5c3e48bf7b,0xbf803d493ef13f623f18bf4ebf7bbe48,0x3f713eac3e95bf75bf78be79be483f7b
.octa 0xbf3ebf2cbf623ef13e163f7d3f7b3e48,0x3edb3f673f753e953f5cbf043e48bf7b,0xbd49bf80bef1bf62bf4ebf18bf7bbe48,0xbeac3f71be953f75be793f78be483f7b
.octa 0xbf18bf4ebe95bf753d49bf803ec4bf6d,0x3f78be793f623ef13eac3f71bec43f6d,0xbe163f7dbf753e95bf2cbf3e3ec4bf6d,0xbf5cbf043ef1bf623f673edbbec43f6d
.octa 0x3f4ebf183e953f75bf80bd493ec4bf6d,0x3e793f78bf62bef13f71beacbec43f6d,0xbf7dbe163f75be95bf3e3f2c3ec4bf6d,0x3f04bf5cbef13f623edbbf67bec43f6d
.octa 0x3f183f4ebe95bf75bd493f803ec4bf6d,0xbf783e793f623ef1beacbf71bec43f6d,0x3e16bf7dbf753e953f2c3f3e3ec4bf6d,0x3f5c3f043ef1bf62bf67bedbbec43f6d
.octa 0xbf4e3f183e953f753f803d493ec4bf6d,0xbe79bf78bf62bef1bf713eacbec43f6d,0x3f7d3e163f75be953f3ebf2c3ec4bf6d,0xbf043f5cbef13f62bedb3f67bec43f6d
.octa 0xbf673edbbf7f3dc9bf78be79bf55bf0e,0xbf803d49bf46bf22be16bf7d3f0ebf55,0xbf71beacbdc9bf7f3f5cbf043f553f0e,0xbf3ebf2c3f22bf463f4e3f18bf0e3f55
.octa 0xbedbbf673f7fbdc9be793f78bf55bf0e,0xbd49bf803f463f22bf7d3e163f0ebf55,0x3eacbf713dc93f7fbf04bf5c3f553f0e,0x3f2cbf3ebf223f463f18bf4ebf0e3f55
.octa 0x3f67bedbbf7f3dc93f783e79bf55bf0e,0x3f80bd49bf46bf223e163f7d3f0ebf55,0x3f713eacbdc9bf7fbf5c3f043f553f0e,0x3f3e3f2c3f22bf46bf4ebf18bf0e3f55
.octa 0x3edb3f673f7fbdc93e79bf78bf55bf0e,0x3d493f803f463f223f7dbe163f0ebf55,0xbeac3f713dc93f7f3f043f5c3f553f0e,0xbf2c3f3ebf223f46bf183f4ebf0e3f55
.octa 0xbec4bf6dbec4bf6dbec4bf6dbec4bf6d,0x3f35bf353ec4bf6da50dbf80bec4bf6d,0x3f6d3ec43f6dbec43ec4bf6dbec4bf6d,0x258d3f803f6d3ec43f35bf35bec4bf6d
.octa 0xbf6d3ec43ec43f6d3f6dbec4bec4bf6d,0xbf35bf35bec43f6d3f80a554bec4bf6d,0x3ec4bf6dbf6d3ec43f6d3ec4bec4bf6d,0x3f80a5f7bf6dbec43f353f35bec4bf6d
.octa 0x3ec43f6dbec4bf6d3ec43f6dbec4bf6d,0xbf353f353ec4bf6d258d3f80bec4bf6d,0xbf6dbec43f6dbec4bec43f6dbec4bf6d,0xa630bf803f6d3ec4bf353f35bec4bf6d
.octa 0x3f6dbec43ec43f6dbf6d3ec4bec4bf6d,0x3f353f35bec43f6dbf8025b0bec4bf6d,0xbec43f6dbf6d3ec4bf6dbec4bec4bf6d,0xbf80a68dbf6dbec4bf35bf35bec4bf6d
.octa 0xbec4bf6dbec4bf6dbec4bf6dbec4bf6d,0x3f353f353f6d3ec43f80a5543f6dbec4,0xbf6dbec4bf6d3ec4bec43f6d3ec43f6d,0x3f80a5f73ec4bf6dbf35bf35bf6d3ec4
.octa 0xbf6d3ec43ec43f6d3f6dbec4bec4bf6d,0x3f35bf35bf6dbec4260d3f803f6dbec4,0xbec43f6d3f6dbec4bf6dbec43ec43f6d,0xa677bf80bec43f6d3f35bf35bf6d3ec4
.octa 0x3ec43f6dbec4bf6d3ec43f6dbec4bf6d,0xbf35bf353f6d3ec4bf80a68d3f6dbec4,0x3f6d3ec4bf6d3ec43ec4bf6d3ec43f6d,0xbf80a60d3ec4bf6d3f353f35bf6d3ec4
.octa 0x3f6dbec43ec43f6dbf6d3ec4bec4bf6d,0xbf353f35bf6dbec4a69fbf803f6dbec4,0x3ec4bf6d3f6dbec43f6d3ec43ec43f6d,0x26f73f80bec43f6dbf353f35bf6d3ec4
.octa 0xbec4bf6dbec4bf6dbec4bf6dbec4bf6d,0xbf353f35bec43f6d258d3f803ec43f6d,0x3f6d3ec43f6dbec43ec4bf6dbec4bf6d,0xa630bf80bf6dbec4bf353f353ec43f6d
.octa 0xbf6d3ec43ec43f6d3f6dbec4bec4bf6d,0x3f353f353ec4bf6dbf80a68d3ec43f6d,0x3ec4bf6dbf6d3ec43f6d3ec4bec4bf6d,0xbf80a60d3f6d3ec4bf35bf353ec43f6d
.octa 0x3ec43f6dbec4bf6d3ec43f6dbec4bf6d,0x3f35bf35bec43f6da7b1bf803ec43f6d,0xbf6dbec43f6dbec4bec43f6dbec4bf6d,0x270d3f80bf6dbec43f35bf353ec43f6d
.octa 0x3f6dbec43ec43f6dbf6d3ec4bec4bf6d,0xbf35bf353ec4bf6d3f80a7843ec43f6d,0xbec43f6dbf6d3ec4bf6dbec4bec4bf6d,0x3f80a79f3f6d3ec43f353f353ec43f6d
.octa 0xbec4bf6dbec4bf6dbec4bf6dbec4bf6d,0xbf35bf35bf6dbec4bf8025b0bf6d3ec4,0xbf6dbec4bf6d3ec4bec43f6d3ec43f6d,0xbf80a68dbec43f6d3f353f353f6dbec4
.octa 0xbf6d3ec43ec43f6d3f6dbec4bec4bf6d,0xbf353f353f6d3ec4a69fbf80bf6d3ec4,0xbec43f6d3f6dbec4bf6dbec43ec43f6d,0x26f73f803ec4bf6dbf353f353f6dbec4
.octa 0x3ec43f6dbec4bf6d3ec43f6dbec4bf6d,0x3f353f35bf6dbec43f80a784bf6d3ec4,0x3f6d3ec4bf6d3ec43ec4bf6d3ec43f6d,0x3f80a79fbec43f6dbf35bf353f6dbec4
.octa 0x3f6dbec43ec43f6dbf6d3ec4bec4bf6d,0x3f35bf353f6d3ec428313f80bf6d3ec4,0x3ec4bf6d3f6dbec43f6d3ec43ec43f6d,0x21b7bf803ec4bf6d3f35bf353f6dbec4
.octa 0x80003f8080003f8080003f8080003f80,0xbf6d3ec4bf353f35bec43f6d80003f80,0xbf35bf35bf80248dbf353f3580003f80,0x3ec4bf6dbf35bf35bf6d3ec480003f80
.octa 0x3f80a554a50dbf80bf80248d80003f80,0x3ec43f6d3f35bf35bf6dbec480003f80,0xbf353f353f80a554bf35bf3580003f80,0xbf6dbec43f353f35bec4bf6d80003f80
.octa 0xa5d4bf80258d3f80a50dbf8080003f80,0x3f6dbec4bf353f353ec4bf6d80003f80,0x3f353f35bf8025b03f35bf3580003f80,0xbec43f6dbf35bf353f6dbec480003f80
.octa 0xbf80261fa5d4bf803f80a55480003f80,0xbec4bf6d3f35bf353f6d3ec480003f80,0x3f35bf353f80a5f73f353f3580003f80,0x3f6d3ec43f353f353ec43f6d80003f80
.octa 0x80003f8080003f8080003f8080003f80,0xbec4bf6dbf35bf35bf6dbec4bf80248d,0x3f353f353f80a5543f35bf35a50dbf80,0xbf6dbec4bf353f353ec43f6d3f80a554
.octa 0x3f80a5f7a5d4bf80bf8025b0258d3f80,0xbf6d3ec43f353f353ec4bf6dbf8025b0,0x3f35bf35bf80261f3f353f35a5d4bf80,0xbec43f6d3f35bf35bf6d3ec43f80a5f7
.octa 0xa677bf8026543f80a630bf80260d3f80,0x3ec43f6dbf35bf353f6d3ec4bf80261f,0xbf35bf353f80a742bf353f35a630bf80,0x3f6d3ec4bf353f35bec4bf6d3f80a731
.octa 0xbf80a60da69fbf803f80a74226543f80,0x3f6dbec43f353f35bec43f6dbf80a68d,0xbf353f35bf80a60dbf35bf35a677bf80,0x3ec4bf6d3f35bf353f6dbec43f80a742
.octa 0x80003f8080003f8080003f8080003f80,0x3f6dbec43f35bf353ec4bf6da50dbf80,0xbf35bf35bf8025b0bf353f35258d3f80,0xbec43f6d3f353f353f6dbec4a5d4bf80
.octa 0x3f80a731a630bf80bf80261f260d3f80,0xbec4bf6dbf353f353f6d3ec4a630bf80,0xbf353f353f80a742bf35bf3526543f80,0x3f6d3ec4bf35bf353ec43f6da677bf80
.octa 0xa7b1bf8026b03f80a69fbf80268d3f80,0xbf6d3ec43f35bf35bec43f6da69fbf80,0x3f353f35bf80a58e3f35bf3526b03f80,0x3ec4bf6d3f353f35bf6d3ec4a7b1bf80
.octa 0xbf80258da7c2bf803f80a77726d43f80,0x3ec43f6dbf353f35bf6dbec4270dbf80,0x3f35bf353f80a78d3f353f3526f73f80,0xbf6dbec4bf35bf35bec4bf6da7c2bf80
.octa 0x80003f8080003f8080003f8080003f80,0x3ec43f6d3f353f353f6d3ec43f80a554,0x3f353f353f80a5f73f35bf35a5d4bf80,0x3f6d3ec43f35bf35bec4bf6dbf80261f
.octa 0x3f80a742a677bf80bf80a68d26543f80,0x3f6dbec4bf35bf35bec43f6d3f80a742,0x3f35bf35bf80a60d3f353f35a69fbf80,0x3ec4bf6dbf353f353f6dbec4bf80a60d
.octa 0xa7c2bf8026f73f80270dbf8026d43f80,0xbec4bf6d3f353f35bf6dbec43f80a777,0xbf35bf353f80a78dbf353f35a7c2bf80,0xbf6dbec43f35bf353ec43f6dbf80258d
.octa 0xbf80268d268dbf803f80a796271f3f80,0xbf6d3ec4bf35bf353ec4bf6d3f80a796,0xbf353f35bf802816bf35bf35268dbf80,0xbec43f6dbf353f35bf6d3ec4bf80268d
.octa 0x80003f8080003f8080003f8080003f80,0xbf713eacbf3e3f2cbedb3f67bd493f80,0xbf22bf46bf7fbdc9bf463f22bdc93f7f,0x3f04bf5cbf18bf4ebf783e79be163f7d
.octa 0x3f7b3e483e48bf7bbf7bbe48be483f7b,0x3e163f7d3f5cbf04bf4ebf18be793f78,0xbf623ef13f753e95bef1bf62be953f75,0xbf3ebf2c3edb3f67bd49bf80beac3f71
.octa 0x3ec4bf6dbec43f6d3ec4bf6dbec43f6d,0x3f803d49bf713eac3f3ebf2cbedb3f67,0x3e953f75bf62bef13f75be95bef13f62,0xbf4e3f18be79bf783f7d3e16bf043f5c
.octa 0xbf55bf0e3f0ebf553f553f0ebf0e3f55,0x3e79bf783f7dbe163f043f5cbf183f4e,0x3f7fbdc93f463f223dc93f7fbf223f46,0x3edb3f673d493f80beac3f71bf2c3f3e
.octa 0x80003f8080003f8080003f8080003f80,0xbeacbf71bf2cbf3ebf67bedbbf80bd49,0x3f223f463f7f3dc93f46bf223dc9bf7f,0xbf5cbf04bf4e3f183e793f783f7d3e16
.octa 0x3f7b3e483e48bf7bbf7bbe48be483f7b,0xbf7d3e163f043f5c3f18bf4ebf78be79,0x3f62bef1bf75be953ef13f623e95bf75,0xbf2c3f3e3f67bedbbf803d493f713eac
.octa 0x3ec4bf6dbec43f6d3ec4bf6dbec43f6d,0xbd493f80beacbf713f2c3f3ebf67bedb,0xbe95bf753f623ef1bf753e953ef1bf62,0x3f183f4ebf783e793e16bf7d3f5c3f04
.octa 0xbf55bf0e3f0ebf553f553f0ebf0e3f55,0x3f783e793e163f7dbf5c3f04bf4ebf18,0xbf7f3dc9bf46bf22bdc9bf7f3f22bf46,0x3f67bedb3f80bd493f713eac3f3e3f2c
.octa 0x80003f8080003f8080003f8080003f80,0x3f71beac3f3ebf2c3edbbf673d49bf80,0xbf22bf46bf7fbdc9bf463f22bdc93f7f,0xbf043f5c3f183f4e3f78be793e16bf7d
.octa 0x3f7b3e483e48bf7bbf7bbe48be483f7b,0xbe16bf7dbf5c3f043f4e3f183e79bf78,0xbf623ef13f753e95bef1bf62be953f75,0x3f3e3f2cbedbbf673d493f803eacbf71
.octa 0x3ec4bf6dbec43f6d3ec4bf6dbec43f6d,0xbf80bd493f71beacbf3e3f2c3edbbf67,0x3e953f75bf62bef13f75be95bef13f62,0x3f4ebf183e793f78bf7dbe163f04bf5c
.octa 0xbf55bf0e3f0ebf553f553f0ebf0e3f55,0xbe793f78bf7d3e16bf04bf5c3f18bf4e,0x3f7fbdc93f463f223dc93f7fbf223f46,0xbedbbf67bd49bf803eacbf713f2cbf3e
.octa 0x80003f8080003f8080003f8080003f80,0x3eac3f713f2c3f3e3f673edb3f803d49,0x3f223f463f7f3dc93f46bf223dc9bf7f,0x3f5c3f043f4ebf18be79bf78bf7dbe16
.octa 0x3f7b3e483e48bf7bbf7bbe48be483f7b,0x3f7dbe16bf04bf5cbf183f4e3f783e79,0x3f62bef1bf75be953ef13f623e95bf75,0x3f2cbf3ebf673edb3f80bd49bf71beac
.octa 0x3ec4bf6dbec43f6d3ec4bf6dbec43f6d,0x3d49bf803eac3f71bf2cbf3e3f673edb,0xbe95bf753f623ef1bf753e953ef1bf62,0xbf18bf4e3f78be79be163f7dbf5cbf04
.octa 0xbf55bf0e3f0ebf553f553f0ebf0e3f55,0xbf78be79be16bf7d3f5cbf043f4e3f18,0xbf7f3dc9bf46bf22bdc9bf7f3f22bf46,0xbf673edbbf803d49bf71beacbf3ebf2c
.octa 0x80003f8080003f8080003f8080003f80,0xbf753e95bf463f22bef13f62bdc93f7f,0xbf0ebf55bf7bbe48bf553f0ebe483f7b,0x3f22bf46bef1bf62bf7f3dc9be953f75
.octa 0x3f6d3ec43ec4bf6dbf6dbec4bec43f6d,0xbdc93f7f3f75be95bf22bf46bef13f62,0xbf7b3e483f553f0ebe48bf7bbf0e3f55,0xbef1bf623dc93f7f3e95bf75bf223f46
.octa 0x3f35bf35bf353f353f35bf35bf353f35,0x3f623ef1bf7fbdc93f75be95bf463f22,0xbe483f7bbf0ebf553f7b3e48bf553f0e,0xbf7f3dc93e95bf753f463f22bf623ef1
.octa 0xbec4bf6d3f6dbec43ec43f6dbf6d3ec4,0x3f46bf223f623ef1bdc93f7fbf753e95,0x3f553f0e3e483f7bbf0e3f55bf7b3e48,0xbe953f75bf223f46bf623ef1bf7f3dc9
.octa 0x80003f8080003f8080003f8080003f80,0xbe95bf75bf22bf46bf62bef1bf7fbdc9,0x3f0e3f553f7b3e483f55bf0e3e48bf7b,0xbf46bf22bf623ef13dc93f7f3f753e95
.octa 0x3f6d3ec43ec4bf6dbf6dbec4bec43f6d,0xbf7fbdc93e953f753f46bf22bf62bef1,0x3f7bbe48bf55bf0e3e483f7b3f0ebf55,0xbf623ef13f7fbdc9bf75be953f463f22
.octa 0x3f35bf35bf353f353f35bf35bf353f35,0xbef13f623dc9bf7f3e953f75bf22bf46,0x3e48bf7b3f0e3f55bf7bbe483f55bf0e,0x3dc93f7fbf75be953f22bf463ef13f62
.octa 0xbec4bf6d3f6dbec43ec43f6dbf6d3ec4,0x3f223f46bef13f62bf7fbdc9be95bf75,0xbf55bf0ebe48bf7b3f0ebf553f7bbe48,0x3f753e953f463f223ef13f623dc93f7f
.octa 0x80003f8080003f8080003f8080003f80,0x3f75be953f46bf223ef1bf623dc9bf7f,0xbf0ebf55bf7bbe48bf553f0ebe483f7b,0xbf223f463ef13f623f7fbdc93e95bf75
.octa 0x3f6d3ec43ec4bf6dbf6dbec4bec43f6d,0x3dc9bf7fbf753e953f223f463ef1bf62,0xbf7b3e483f553f0ebe48bf7bbf0e3f55,0x3ef13f62bdc9bf7fbe953f753f22bf46
.octa 0x3f35bf35bf353f353f35bf35bf353f35,0xbf62bef13f7f3dc9bf753e953f46bf22,0xbe483f7bbf0ebf553f7b3e48bf553f0e,0x3f7fbdc9be953f75bf46bf223f62bef1
.octa 0xbec4bf6d3f6dbec43ec43f6dbf6d3ec4,0xbf463f22bf62bef13dc9bf7f3f75be95,0x3f553f0e3e483f7bbf0e3f55bf7b3e48,0x3e95bf753f22bf463f62bef13f7fbdc9
.octa 0x80003f8080003f8080003f8080003f80,0x3e953f753f223f463f623ef13f7f3dc9,0x3f0e3f553f7b3e483f55bf0e3e48bf7b,0x3f463f223f62bef1bdc9bf7fbf75be95
.octa 0x3f6d3ec43ec4bf6dbf6dbec4bec43f6d,0x3f7f3dc9be95bf75bf463f223f623ef1,0x3f7bbe48bf55bf0e3e483f7b3f0ebf55,0x3f62bef1bf7f3dc93f753e95bf46bf22
.octa 0x3f35bf35bf353f353f35bf35bf353f35,0x3ef1bf62bdc93f7fbe95bf753f223f46,0x3e48bf7b3f0e3f55bf7bbe483f55bf0e,0xbdc9bf7f3f753e95bf223f46bef1bf62
.octa 0xbec4bf6d3f6dbec43ec43f6dbf6d3ec4,0xbf22bf463ef1bf623f7f3dc93e953f75,0xbf55bf0ebe48bf7b3f0ebf553f7bbe48,0xbf75be95bf46bf22bef1bf62bdc9bf7f
.octa 0x80003f8080003f8080003f8080003f80,0xbf783e79bf4e3f18bf043f5cbe163f7d,0xbef1bf62bf75be95bf623ef1be953f75,0x3f3ebf2cbeacbf71bf80bd49bedb3f67
.octa 0x3f553f0e3f0ebf55bf55bf0ebf0e3f55,0xbeac3f713f80bd49bedbbf67bf2c3f3e,0xbf7fbdc93f223f463dc9bf7fbf463f22,0xbe16bf7dbe793f783f18bf4ebf5c3f04
.octa 0x3f6dbec4bf6d3ec43f6dbec4bf6d3ec4,0x3f183f4ebf5cbf043f7d3e16bf783e79,0xbf223f46bdc9bf7f3f463f22bf7f3dc9,0xbf67bedb3f3ebf2c3eac3f71bf80bd49
.octa 0x3e48bf7b3f7b3e48be483f7bbf7bbe48,0x3f80bd493edb3f67bf2c3f3ebf71beac,0x3e953f75bef13f62bf753e95bf62bef1,0xbf5c3f04bf7d3e16bf78be79bf4ebf18
.octa 0x80003f8080003f8080003f8080003f80,0xbe79bf78bf18bf4ebf5cbf04bf7dbe16,0x3ef13f623f753e953f62bef13e95bf75,0xbf2cbf3ebf713eacbd493f803f673edb
.octa 0x3f553f0e3f0ebf55bf55bf0ebf0e3f55,0xbf71beac3d493f803f67bedbbf3ebf2c,0x3f7f3dc9bf22bf46bdc93f7f3f46bf22,0xbf7d3e163f783e79bf4ebf183f043f5c
.octa 0x3f6dbec4bf6d3ec43f6dbec4bf6d3ec4,0xbf4e3f183f04bf5cbe163f7dbe79bf78,0x3f22bf463dc93f7fbf46bf223f7fbdc9,0xbedb3f67bf2cbf3e3f71beacbd493f80
.octa 0x3e48bf7b3f7b3e48be483f7bbf7bbe48,0x3d493f80bf673edbbf3ebf2c3eacbf71,0xbe95bf753ef1bf623f75be953f623ef1,0x3f043f5c3e163f7dbe793f78bf183f4e
.octa 0x80003f8080003f8080003f8080003f80,0x3f78be793f4ebf183f04bf5c3e16bf7d,0xbef1bf62bf75be95bf623ef1be953f75,0xbf3e3f2c3eac3f713f803d493edbbf67
.octa 0x3f553f0e3f0ebf55bf55bf0ebf0e3f55,0x3eacbf71bf803d493edb3f673f2cbf3e,0xbf7fbdc93f223f463dc9bf7fbf463f22,0x3e163f7d3e79bf78bf183f4e3f5cbf04
.octa 0x3f6dbec4bf6d3ec43f6dbec4bf6d3ec4,0xbf18bf4e3f5c3f04bf7dbe163f78be79,0xbf223f46bdc9bf7f3f463f22bf7f3dc9,0x3f673edbbf3e3f2cbeacbf713f803d49
.octa 0x3e48bf7b3f7b3e48be483f7bbf7bbe48,0xbf803d49bedbbf673f2cbf3e3f713eac,0x3e953f75bef13f62bf753e95bf62bef1,0x3f5cbf043f7dbe163f783e793f4e3f18
.octa 0x80003f8080003f8080003f8080003f80,0x3e793f783f183f4e3f5c3f043f7d3e16,0x3ef13f623f753e953f62bef13e95bf75,0x3f2c3f3e3f71beac3d49bf80bf67bedb
.octa 0x3f553f0e3f0ebf55bf55bf0ebf0e3f55,0x3f713eacbd49bf80bf673edb3f3e3f2c,0x3f7f3dc9bf22bf46bdc93f7f3f46bf22,0x3f7dbe16bf78be793f4e3f18bf04bf5c
.octa 0x3f6dbec4bf6d3ec43f6dbec4bf6d3ec4,0x3f4ebf18bf043f5c3e16bf7d3e793f78,0x3f22bf463dc93f7fbf46bf223f7fbdc9,0x3edbbf673f2c3f3ebf713eac3d49bf80
.octa 0x3e48bf7b3f7b3e48be483f7bbf7bbe48,0xbd49bf803f67bedb3f3e3f2cbeac3f71,0xbe95bf753ef1bf623f75be953f623ef1,0xbf04bf5cbe16bf7d3e79bf783f18bf4e
.octa 0x80003f8080003f8080003f8080003f80,0xbf7b3e48bf553f0ebf0e3f55be483f7b,0xbec4bf6dbf6dbec4bf6d3ec4bec43f6d,0x3f55bf0ebe48bf7bbf7bbe48bf0e3f55
.octa 0x3f353f353f35bf35bf35bf35bf353f35,0xbf0e3f553f7b3e48be48bf7bbf553f0e,0xbf6dbec43ec43f6d3ec4bf6dbf6d3ec4,0x3e48bf7bbf0e3f553f55bf0ebf7b3e48
.octa 0x3f80a5f7bf8025b03f80a554bf80248d,0x3e483f7bbf0ebf553f553f0ebf7bbe48,0xbf6d3ec43ec4bf6d3ec43f6dbf6dbec4,0xbf0ebf553f7bbe48be483f7bbf55bf0e
.octa 0x3f35bf353f353f35bf353f35bf35bf35,0x3f553f0ebe483f7bbf7b3e48bf0ebf55,0xbec43f6dbf6d3ec4bf6dbec4bec4bf6d,0xbf7bbe48bf55bf0ebf0ebf55be48bf7b
.octa 0x80003f8080003f8080003f8080003f80,0xbe48bf7bbf0ebf55bf55bf0ebf7bbe48,0x3ec43f6d3f6d3ec43f6dbec43ec4bf6d,0xbf0ebf55bf7b3e48be483f7b3f553f0e
.octa 0x3f353f353f35bf35bf35bf35bf353f35,0xbf55bf0ebe483f7b3f7bbe48bf0ebf55,0x3f6d3ec4bec4bf6dbec43f6d3f6dbec4,0xbf7bbe483f553f0ebf0ebf553e483f7b
.octa 0x3f80a742bf80a68d3f80a731bf80261f,0xbf7b3e483f55bf0ebf0e3f553e48bf7b,0x3f6dbec4bec43f6dbec4bf6d3f6d3ec4,0xbf553f0ebe48bf7b3f7b3e48bf0e3f55
.octa 0x3f35bf353f353f35bf353f35bf35bf35,0xbf0e3f55bf7bbe48be48bf7b3f55bf0e,0x3ec4bf6d3f6dbec43f6d3ec43ec43f6d,0xbe483f7bbf0e3f55bf553f0ebf7b3e48
.octa 0x80003f8080003f8080003f8080003f80,0x3f7bbe483f55bf0e3f0ebf553e48bf7b,0xbec4bf6dbf6dbec4bf6d3ec4bec43f6d,0xbf553f0e3e483f7b3f7b3e483f0ebf55
.octa 0x3f353f353f35bf35bf35bf35bf353f35,0x3f0ebf55bf7bbe483e483f7b3f55bf0e,0xbf6dbec43ec43f6d3ec4bf6dbf6d3ec4,0xbe483f7b3f0ebf55bf553f0e3f7bbe48
.octa 0x3f80a765bf80a60d3f80a754bf80a654,0xbe48bf7b3f0e3f55bf55bf0e3f7b3e48,0xbf6d3ec43ec4bf6d3ec43f6dbf6dbec4,0x3f0e3f55bf7b3e483e48bf7b3f553f0e
.octa 0x3f35bf353f353f35bf353f35bf35bf35,0xbf55bf0e3e48bf7b3f7bbe483f0e3f55,0xbec43f6dbf6d3ec4bf6dbec4bec4bf6d,0x3f7b3e483f553f0e3f0e3f553e483f7b
.octa 0x80003f8080003f8080003f8080003f80,0x3e483f7b3f0e3f553f553f0e3f7b3e48,0x3ec43f6d3f6d3ec43f6dbec43ec4bf6d,0x3f0e3f553f7bbe483e48bf7bbf55bf0e
.octa 0x3f353f353f35bf35bf35bf35bf353f35,0x3f553f0e3e48bf7bbf7b3e483f0e3f55,0x3f6d3ec4bec4bf6dbec43f6d3f6dbec4,0x3f7b3e48bf55bf0e3f0e3f55be48bf7b
.octa 0x3f80a784bf80a1373f80a777bf80a58e,0x3f7bbe48bf553f0e3f0ebf55be483f7b,0x3f6dbec4bec43f6dbec4bf6d3f6d3ec4,0x3f55bf0e3e483f7bbf7bbe483f0ebf55
.octa 0x3f35bf353f353f35bf353f35bf35bf35,0x3f0ebf553f7b3e483e483f7bbf553f0e,0x3ec4bf6d3f6dbec43f6d3ec43ec43f6d,0x3e48bf7b3f0ebf553f55bf0e3f7bbe48
.octa 0x80003f8080003f8080003f8080003f80,0xbf7d3e16bf5c3f04bf183f4ebe793f78,0xbe95bf75bf62bef1bf753e95bef13f62,0x3f67bedbbd49bf80bf71beacbf2c3f3e
.octa 0x3f0e3f553f55bf0ebf0ebf55bf553f0e,0xbf3e3f2c3f673edb3d49bf80bf713eac,0xbf46bf223dc93f7f3f22bf46bf7f3dc9,0x3f04bf5cbf4e3f183f78be79bf7dbe16
.octa 0x3f6d3ec4bf6dbec43f6d3ec4bf6dbec4,0xbe793f78be16bf7d3f043f5cbf4ebf18,0xbf7fbdc93f46bf22bdc93f7fbf22bf46,0xbd49bf803f713eacbf2c3f3ebedbbf67
.octa 0x3f7bbe483e483f7bbf7b3e48be48bf7b,0x3eac3f71bf3e3f2cbf67bedb3d49bf80,0xbf623ef1bf75be95bef1bf623e95bf75,0xbf18bf4ebe79bf783e16bf7d3f04bf5c
.octa 0x80003f8080003f8080003f8080003f80,0xbe16bf7dbf04bf5cbf4ebf18bf78be79,0x3e953f753f623ef13f75be953ef1bf62,0xbedbbf67bf803d49beac3f713f3e3f2c
.octa 0x3f0e3f553f55bf0ebf0ebf55bf553f0e,0xbf2cbf3ebedb3f673f803d49beacbf71,0x3f463f22bdc9bf7fbf223f463f7fbdc9,0xbf5cbf043f183f4ebe79bf78be163f7d
.octa 0x3f6d3ec4bf6dbec43f6d3ec4bf6dbec4,0xbf78be793f7dbe16bf5c3f043f18bf4e,0x3f7f3dc9bf463f223dc9bf7f3f223f46,0xbf803d493eacbf713f3e3f2cbf673edb
.octa 0x3f7bbe483e483f7bbf7b3e48be48bf7b,0xbf713eacbf2cbf3e3edbbf673f803d49,0x3f62bef13f753e953ef13f62be953f75,0xbf4e3f18bf783e79bf7dbe16bf5cbf04
.octa 0x80003f8080003f8080003f8080003f80,0x3f7dbe163f5cbf043f18bf4e3e79bf78,0xbe95bf75bf62bef1bf753e95bef13f62,0xbf673edb3d493f803f713eac3f2cbf3e
.octa 0x3f0e3f553f55bf0ebf0ebf55bf553f0e,0x3f3ebf2cbf67bedbbd493f803f71beac,0xbf46bf223dc93f7f3f22bf46bf7f3dc9,0xbf043f5c3f4ebf18bf783e793f7d3e16
.octa 0x3f6d3ec4bf6dbec43f6d3ec4bf6dbec4,0x3e79bf783e163f7dbf04bf5c3f4e3f18,0xbf7fbdc93f46bf22bdc93f7fbf22bf46,0x3d493f80bf71beac3f2cbf3e3edb3f67
.octa 0x3f7bbe483e483f7bbf7b3e48be48bf7b,0xbeacbf713f3ebf2c3f673edbbd493f80,0xbf623ef1bf75be95bef1bf623e95bf75,0x3f183f4e3e793f78be163f7dbf043f5c
.octa 0x80003f8080003f8080003f8080003f80,0x3e163f7d3f043f5c3f4e3f183f783e79,0x3e953f753f623ef13f75be953ef1bf62,0x3edb3f673f80bd493eacbf71bf3ebf2c
.octa 0x3f0e3f553f55bf0ebf0ebf55bf553f0e,0x3f2c3f3e3edbbf67bf80bd493eac3f71,0x3f463f22bdc9bf7fbf223f463f7fbdc9,0x3f5c3f04bf18bf4e3e793f783e16bf7d
.octa 0x3f6d3ec4bf6dbec43f6d3ec4bf6dbec4,0x3f783e79bf7d3e163f5cbf04bf183f4e,0x3f7f3dc9bf463f223dc9bf7f3f223f46,0x3f80bd49beac3f71bf3ebf2c3f67bedb
.octa 0x3f7bbe483e483f7bbf7b3e48be48bf7b,0x3f71beac3f2c3f3ebedb3f67bf80bd49,0x3f62bef13f753e953ef13f62be953f75,0x3f4ebf183f78be793f7d3e163f5c3f04
.octa 0x80003f8080003f8080003f8080003f80,0xbf7f3dc9bf623ef1bf223f46be953f75,0xbe48bf7bbf55bf0ebf7b3e48bf0e3f55,0x3f75be953dc9bf7fbf62bef1bf463f22
.octa 0x3ec43f6d3f6dbec4bec4bf6dbf6d3ec4,0xbf623ef13f463f223e95bf75bf7f3dc9,0xbf0ebf55be483f7b3f55bf0ebf7bbe48,0x3f46bf22bf753e953f7f3dc9bf62bef1
.octa 0x3f353f35bf35bf353f353f35bf35bf35,0xbf223f463e95bf753dc93f7fbef1bf62,0xbf55bf0e3f7bbe48bf0e3f55be48bf7b,0x3ef1bf623f223f46bf753e953dc9bf7f
.octa 0x3f6d3ec4bec43f6dbf6dbec43ec4bf6d,0xbe953f75bf7f3dc9bef1bf623f22bf46,0xbf7bbe48bf0ebf553e48bf7b3f55bf0e,0x3dc9bf7f3ef1bf623f46bf223f75be95
.octa 0x80003f8080003f8080003f8080003f80,0xbdc9bf7fbef1bf62bf46bf22bf75be95,0x3e483f7b3f553f0e3f7bbe483f0ebf55,0xbe95bf75bf7fbdc9bef13f623f223f46
.octa 0x3ec43f6d3f6dbec4bec4bf6dbf6d3ec4,0xbef1bf62bf223f463f753e95bdc9bf7f,0x3f0e3f553e48bf7bbf553f0e3f7b3e48,0xbf22bf463e953f753dc9bf7fbef13f62
.octa 0x3f353f35bf35bf353f353f35bf35bf35,0xbf46bf223f753e95bf7f3dc93f62bef1,0x3f553f0ebf7b3e483f0ebf553e483f7b,0xbf62bef13f46bf223e953f75bf7fbdc9
.octa 0x3f6d3ec4bec43f6dbf6dbec43ec4bf6d,0xbf75be95bdc9bf7f3f62bef13f463f22,0x3f7b3e483f0e3f55be483f7bbf553f0e,0xbf7fbdc9bf62bef1bf22bf46be95bf75
.octa 0x80003f8080003f8080003f8080003f80,0x3f7fbdc93f62bef13f22bf463e95bf75,0xbe48bf7bbf55bf0ebf7b3e48bf0e3f55,0xbf753e95bdc93f7f3f623ef13f46bf22
.octa 0x3ec43f6d3f6dbec4bec4bf6dbf6d3ec4,0x3f62bef1bf46bf22be953f753f7fbdc9,0xbf0ebf55be483f7b3f55bf0ebf7bbe48,0xbf463f223f75be95bf7fbdc93f623ef1
.octa 0x3f353f35bf35bf353f353f35bf35bf35,0x3f22bf46be953f75bdc9bf7f3ef13f62,0xbf55bf0e3f7bbe48bf0e3f55be48bf7b,0xbef13f62bf22bf463f75be95bdc93f7f
.octa 0x3f6d3ec4bec43f6dbf6dbec43ec4bf6d,0x3e95bf753f7fbdc93ef13f62bf223f46,0xbf7bbe48bf0ebf553e48bf7b3f55bf0e,0xbdc93f7fbef13f62bf463f22bf753e95
.octa 0x80003f8080003f8080003f8080003f80,0x3dc93f7f3ef13f623f463f223f753e95,0x3e483f7b3f553f0e3f7bbe483f0ebf55,0x3e953f753f7f3dc93ef1bf62bf22bf46
.octa 0x3ec43f6d3f6dbec4bec4bf6dbf6d3ec4,0x3ef13f623f22bf46bf75be953dc93f7f,0x3f0e3f553e48bf7bbf553f0e3f7b3e48,0x3f223f46be95bf75bdc93f7f3ef1bf62
.octa 0x3f353f35bf35bf353f353f35bf35bf35,0x3f463f22bf75be953f7fbdc9bf623ef1,0x3f553f0ebf7b3e483f0ebf553e483f7b,0x3f623ef1bf463f22be95bf753f7f3dc9
.octa 0x3f6d3ec4bec43f6dbf6dbec43ec4bf6d,0x3f753e953dc93f7fbf623ef1bf46bf22,0x3f7b3e483f0e3f55be483f7bbf553f0e,0x3f7f3dc93f623ef13f223f463e953f75
.octa 0x80003f8080003f8080003f8080003f80,0xbf803d49bf673edbbf2c3f3ebeac3f71,0xbdc9bf7fbf46bf22bf7f3dc9bf223f46,0x3f7dbe163e79bf78bf4ebf18bf5c3f04
.octa 0x3e483f7b3f7bbe48be48bf7bbf7b3e48,0xbf783e793f183f4e3f04bf5cbf7dbe16,0xbe95bf75bef13f623f75be95bf62bef1,0x3f71beacbf80bd493f673edbbf2cbf3e
.octa 0x3ec43f6dbec4bf6d3ec43f6dbec4bf6d,0xbf673edb3f2cbf3ebeac3f71bd49bf80,0xbef1bf623f753e95bf623ef13e95bf75,0x3f5cbf043e163f7dbf78be793f18bf4e
.octa 0x3f0e3f55bf553f0ebf0ebf553f55bf0e,0xbf4e3f18bf5cbf043e16bf7d3f78be79,0xbf22bf463dc9bf7f3f46bf223f7f3dc9,0x3f3ebf2c3f71beac3f803d493f673edb
.octa 0x80003f8080003f8080003f8080003f80,0xbd49bf80bedbbf67bf3ebf2cbf71beac,0x3dc93f7f3f463f223f7fbdc93f22bf46,0xbe16bf7dbf78be79bf183f4e3f043f5c
.octa 0x3e483f7b3f7bbe48be48bf7bbf7b3e48,0xbe79bf78bf4e3f183f5c3f043e16bf7d,0x3e953f753ef1bf62bf753e953f623ef1,0xbeacbf71bd493f803edbbf67bf3e3f2c
.octa 0x3ec43f6dbec4bf6d3ec43f6dbec4bf6d,0xbedbbf673f3e3f2cbf71beac3f80bd49,0x3ef13f62bf75be953f62bef1be953f75,0xbf04bf5c3f7dbe16be793f78bf4ebf18
.octa 0x3f0e3f55bf553f0ebf0ebf553f55bf0e,0xbf18bf4e3f04bf5c3f7d3e163e793f78,0x3f223f46bdc93f7fbf463f22bf7fbdc9,0xbf2cbf3ebeacbf713d49bf803edbbf67
.octa 0x80003f8080003f8080003f8080003f80,0x3f80bd493f67bedb3f2cbf3e3eacbf71,0xbdc9bf7fbf46bf22bf7f3dc9bf223f46,0xbf7d3e16be793f783f4e3f183f5cbf04
.octa 0x3e483f7b3f7bbe48be48bf7bbf7b3e48,0x3f78be79bf18bf4ebf043f5c3f7d3e16,0xbe95bf75bef13f623f75be95bf62bef1,0xbf713eac3f803d49bf67bedb3f2c3f3e
.octa 0x3ec43f6dbec4bf6d3ec43f6dbec4bf6d,0x3f67bedbbf2c3f3e3eacbf713d493f80,0xbef1bf623f753e95bf623ef13e95bf75,0xbf5c3f04be16bf7d3f783e79bf183f4e
.octa 0x3f0e3f55bf553f0ebf0ebf553f55bf0e,0x3f4ebf183f5c3f04be163f7dbf783e79,0xbf22bf463dc9bf7f3f46bf223f7f3dc9,0xbf3e3f2cbf713eacbf80bd49bf67bedb
.octa 0x80003f8080003f8080003f8080003f80,0x3d493f803edb3f673f3e3f2c3f713eac,0x3dc93f7f3f463f223f7fbdc93f22bf46,0x3e163f7d3f783e793f18bf4ebf04bf5c
.octa 0x3e483f7b3f7bbe48be48bf7bbf7b3e48,0x3e793f783f4ebf18bf5cbf04be163f7d,0x3e953f753ef1bf62bf753e953f623ef1,0x3eac3f713d49bf80bedb3f673f3ebf2c
.octa 0x3ec43f6dbec4bf6d3ec43f6dbec4bf6d,0x3edb3f67bf3ebf2c3f713eacbf803d49,0x3ef13f62bf75be953f62bef1be953f75,0x3f043f5cbf7d3e163e79bf783f4e3f18
.octa 0x3f0e3f55bf553f0ebf0ebf553f55bf0e,0x3f183f4ebf043f5cbf7dbe16be79bf78,0x3f223f46bdc93f7fbf463f22bf7fbdc9,0x3f2c3f3e3eac3f71bd493f80bedb3f67
.octa 0x80003f8080003f8080003f8080003f80,0xbf6d3ec2bf363f34bec53f6cbb493f80,0xbf34bf36bf80bbc9bf363f34bbc93f80,0x3ec8bf6cbf33bf37bf6d3ec0bc173f80
.octa 0x3f803c493c49bf80bf80bc49bc493f80,0x3ebd3f6e3f38bf32bf6bbecbbc7b3f80,0xbf383f323f803c97bf32bf38bc973f80,0xbf6abece3f313f39bebabf6fbcb03f80
.octa 0x3cc9bf80bcc93f803cc9bf80bcc93f80,0x3f6fbeb7bf3a3f303ed1bf6abce23f80,0x3f2f3f3abf80bcfb3f3abf2fbcfb3f80,0xbed43f69bf2fbf3b3f70beb4bd0a3f80
.octa 0xbf80bd173d17bf803f803d17bd173f80,0xbeb1bf703f3cbf2e3f683ed7bd233f80,0x3f3dbf2d3f803d303f2d3f3dbd303f80,0x3f683ed93f2d3f3d3eae3f71bd3c3f80
.octa 0x80003f8080003f8080003f8080003f80,0xbec2bf6dbf34bf36bf6cbec5bf80bb49,0x3f343f363f803bc93f36bf343bc9bf80,0xbf6cbec8bf373f333ec03f6d3f803c17
.octa 0x3f803c493c49bf80bf80bc49bc493f80,0xbf6e3ebd3f323f383ecbbf6bbf80bc7b,0x3f38bf32bf80bc973f323f383c97bf80,0xbece3f6a3f39bf31bf6f3eba3f803cb0
.octa 0x3cc9bf80bcc93f803cc9bf80bcc93f80,0x3eb73f6fbf30bf3a3f6a3ed1bf80bce2,0xbf2fbf3a3f803cfbbf3a3f2f3cfbbf80,0x3f693ed4bf3b3f2fbeb4bf703f803d0a
.octa 0xbf80bd173d17bf803f803d17bd173f80,0x3f70beb13f2e3f3cbed73f68bf80bd23,0xbf3d3f2dbf80bd30bf2dbf3d3d30bf80,0x3ed9bf683f3dbf2d3f71beae3f803d3c
.octa 0x80003f8080003f8080003f8080003f80,0x3f6dbec23f36bf343ec5bf6c3b49bf80,0xbf34bf36bf80bbc9bf363f34bbc93f80,0xbec83f6c3f333f373f6dbec03c17bf80
.octa 0x3f803c493c49bf80bf80bc49bc493f80,0xbebdbf6ebf383f323f6b3ecb3c7bbf80,0xbf383f323f803c97bf32bf38bc973f80,0x3f6a3ecebf31bf393eba3f6f3cb0bf80
.octa 0x3cc9bf80bcc93f803cc9bf80bcc93f80,0xbf6f3eb73f3abf30bed13f6a3ce2bf80,0x3f2f3f3abf80bcfb3f3abf2fbcfb3f80,0x3ed4bf693f2f3f3bbf703eb43d0abf80
.octa 0xbf80bd173d17bf803f803d17bd173f80,0x3eb13f70bf3c3f2ebf68bed73d23bf80,0x3f3dbf2d3f803d303f2d3f3dbd303f80,0xbf68bed9bf2dbf3dbeaebf713d3cbf80
.octa 0x80003f8080003f8080003f8080003f80,0x3ec23f6d3f343f363f6c3ec53f803b49,0x3f343f363f803bc93f36bf343bc9bf80,0x3f6c3ec83f37bf33bec0bf6dbf80bc17
.octa 0x3f803c493c49bf80bf80bc49bc493f80,0x3f6ebebdbf32bf38becb3f6b3f803c7b,0x3f38bf32bf80bc973f323f383c97bf80,0x3ecebf6abf393f313f6fbebabf80bcb0
.octa 0x3cc9bf80bcc93f803cc9bf80bcc93f80,0xbeb7bf6f3f303f3abf6abed13f803ce2,0xbf2fbf3a3f803cfbbf3a3f2f3cfbbf80,0xbf69bed43f3bbf2f3eb43f70bf80bd0a
.octa 0xbf80bd173d17bf803f803d17bd173f80,0xbf703eb1bf2ebf3c3ed7bf683f803d23,0xbf3d3f2dbf80bd30bf2dbf3d3d30bf80,0xbed93f68bf3d3f2dbf713eaebf80bd3c
.octa 0x80003f8080003f8080003f8080003f80,0xbf713eabbf3e3f2bbedc3f67bd563f80,0xbf21bf47bf7fbdd5bf473f21bdd53f7f,0x3f06bf5abf17bf4fbf793e70be203f7d
.octa 0x3f7a3e543e54bf7abf7abe54be543f7a,0x3e073f7e3f5ebf00bf4bbf1cbe843f77,0xbf643ee93f743e9ebee9bf64be9e3f74,0xbf3abf303ed13f6abce2bf80beb73f6f
.octa 0x3ecfbf6abecf3f6a3ecfbf6abecf3f6a,0x3f7f3d9dbf733e9f3f42bf27bee83f64,0x3e863f77bf5ebeff3f77be86beff3f5e,0xbf533f11be57bf7a3f7c3e38bf0b3f57
.octa 0xbf4fbf163f16bf4f3f4f3f16bf163f4f,0x3e90bf763f7fbddb3ef63f61bf213f47,0x3f80bd623f3f3f2b3d623f80bf2b3f3f,0x3ec53f6c3b493f80bec23f6dbf343f36
.octa 0x80003f8080003f8080003f8080003f80,0xbeabbf71bf2bbf3ebf67bedcbf80bd56,0x3f213f473f7f3dd53f47bf213dd5bf7f,0xbf5abf06bf4f3f173e703f793f7d3e20
.octa 0x3f7a3e543e54bf7abf7abe54be543f7a,0xbf7e3e073f003f5e3f1cbf4bbf77be84,0x3f64bee9bf74be9e3ee93f643e9ebf74,0xbf303f3a3f6abed1bf803ce23f6f3eb7
.octa 0x3ecfbf6abecf3f6a3ecfbf6abecf3f6a,0xbd9d3f7fbe9fbf733f273f42bf64bee8,0xbe86bf773f5e3effbf773e863effbf5e,0x3f113f53bf7a3e573e38bf7c3f573f0b
.octa 0xbf4fbf163f16bf4f3f4f3f16bf163f4f,0x3f763e903ddb3f7fbf613ef6bf47bf21,0xbf803d62bf3fbf2bbd62bf803f2bbf3f,0x3f6cbec53f80bb493f6d3ec23f363f34
.octa 0x80003f8080003f8080003f8080003f80,0x3f71beab3f3ebf2b3edcbf673d56bf80,0xbf21bf47bf7fbdd5bf473f21bdd53f7f,0xbf063f5a3f173f4f3f79be703e20bf7d
.octa 0x3f7a3e543e54bf7abf7abe54be543f7a,0xbe07bf7ebf5e3f003f4b3f1c3e84bf77,0xbf643ee93f743e9ebee9bf64be9e3f74,0x3f3a3f30bed1bf6a3ce23f803eb7bf6f
.octa 0x3ecfbf6abecf3f6a3ecfbf6abecf3f6a,0xbf7fbd9d3f73be9fbf423f273ee8bf64,0x3e863f77bf5ebeff3f77be86beff3f5e,0x3f53bf113e573f7abf7cbe383f0bbf57
.octa 0xbf4fbf163f16bf4f3f4f3f16bf163f4f,0xbe903f76bf7f3ddbbef6bf613f21bf47,0x3f80bd623f3f3f2b3d623f80bf2b3f3f,0xbec5bf6cbb49bf803ec2bf6d3f34bf36
.octa 0x80003f8080003f8080003f8080003f80,0x3eab3f713f2b3f3e3f673edc3f803d56,0x3f213f473f7f3dd53f47bf213dd5bf7f,0x3f5a3f063f4fbf17be70bf79bf7dbe20
.octa 0x3f7a3e543e54bf7abf7abe54be543f7a,0x3f7ebe07bf00bf5ebf1c3f4b3f773e84,0x3f64bee9bf74be9e3ee93f643e9ebf74,0x3f30bf3abf6a3ed13f80bce2bf6fbeb7
.octa 0x3ecfbf6abecf3f6a3ecfbf6abecf3f6a,0x3d9dbf7f3e9f3f73bf27bf423f643ee8,0xbe86bf773f5e3effbf773e863effbf5e,0xbf11bf533f7abe57be383f7cbf57bf0b
.octa 0xbf4fbf163f16bf4f3f4f3f16bf163f4f,0xbf76be90bddbbf7f3f61bef63f473f21,0xbf803d62bf3fbf2bbd62bf803f2bbf3f,0xbf6c3ec5bf803b49bf6dbec2bf36bf34
.octa 0x80003f8080003f8080003f8080003f80,0xbf753e93bf463f22bef33f61bdcf3f7f,0xbf0dbf56bf7bbe4ebf563f0dbe4e3f7b,0x3f24bf44beedbf63bf7f3db6be993f74
.octa 0x3f6b3eca3ecabf6bbf6bbecabeca3f6b,0xbde83f7e3f76be8dbf1fbf48bef83f60,0xbf7c3e353f523f12be35bf7cbf123f52,0xbee8bf643d9d3f7f3e9fbf73bf273f42
.octa 0x3f39bf31bf393f313f39bf31bf393f31,0x3f5e3efebf7ebe003f77be87bf4a3f1d,0xbe663f79bf08bf593f793e66bf593f08,0xbf7f3d843ea5bf723f403f29bf663ee2
.octa 0xbeb2bf703f70beb23eb23f70bf703eb2,0x3f4cbf1a3f5d3f02be0d3f7ebf783e81,0x3f4f3f173e1c3f7dbf173f4fbf7d3e1c,0xbeab3f71bf2b3f3ebf673edcbf803d56
.octa 0x80003f8080003f8080003f8080003f80,0xbe93bf75bf22bf46bf61bef3bf7fbdcf,0x3f0d3f563f7b3e4e3f56bf0d3e4ebf7b,0xbf44bf24bf633eed3db63f7f3f743e99
.octa 0x3f6b3eca3ecabf6bbf6bbecabeca3f6b,0xbf7ebde83e8d3f763f48bf1fbf60bef8,0x3f7cbe35bf52bf123e353f7c3f12bf52,0xbf643ee83f7fbd9dbf73be9f3f423f27
.octa 0x3f39bf31bf393f313f39bf31bf393f31,0xbefe3f5e3e00bf7e3e873f77bf1dbf4a,0x3e66bf793f083f59bf79be663f59bf08,0x3d843f7fbf72bea53f29bf403ee23f66
.octa 0xbeb2bf703f70beb23eb23f70bf703eb2,0x3f1a3f4cbf023f5dbf7ebe0dbe81bf78,0xbf4fbf17be1cbf7d3f17bf4f3f7dbe1c,0x3f713eab3f3e3f2b3edc3f673d563f80
.octa 0x80003f8080003f8080003f8080003f80,0x3f75be933f46bf223ef3bf613dcfbf7f,0xbf0dbf56bf7bbe4ebf563f0dbe4e3f7b,0xbf243f443eed3f633f7fbdb63e99bf74
.octa 0x3f6b3eca3ecabf6bbf6bbecabeca3f6b,0x3de8bf7ebf763e8d3f1f3f483ef8bf60,0xbf7c3e353f523f12be35bf7cbf123f52,0x3ee83f64bd9dbf7fbe9f3f733f27bf42
.octa 0x3f39bf31bf393f313f39bf31bf393f31,0xbf5ebefe3f7e3e00bf773e873f4abf1d,0xbe663f79bf08bf593f793e66bf593f08,0x3f7fbd84bea53f72bf40bf293f66bee2
.octa 0xbeb2bf703f70beb23eb23f70bf703eb2,0xbf4c3f1abf5dbf023e0dbf7e3f78be81,0x3f4f3f173e1c3f7dbf173f4fbf7d3e1c,0x3eabbf713f2bbf3e3f67bedc3f80bd56
.octa 0x80003f8080003f8080003f8080003f80,0x3e933f753f223f463f613ef33f7f3dcf,0x3f0d3f563f7b3e4e3f56bf0d3e4ebf7b,0x3f443f243f63beedbdb6bf7fbf74be99
.octa 0x3f6b3eca3ecabf6bbf6bbecabeca3f6b,0x3f7e3de8be8dbf76bf483f1f3f603ef8,0x3f7cbe35bf52bf123e353f7c3f12bf52,0x3f64bee8bf7f3d9d3f733e9fbf42bf27
.octa 0x3f39bf31bf393f313f39bf31bf393f31,0x3efebf5ebe003f7ebe87bf773f1d3f4a,0x3e66bf793f083f59bf79be663f59bf08,0xbd84bf7f3f723ea5bf293f40bee2bf66
.octa 0xbeb2bf703f70beb23eb23f70bf703eb2,0xbf1abf4c3f02bf5d3f7e3e0d3e813f78,0xbf4fbf17be1cbf7d3f17bf4f3f7dbe1c,0xbf71beabbf3ebf2bbedcbf67bd56bf80
.octa 0x80003f8080003f8080003f8080003f80,0xbf793e76bf4e3f18bf043f5bbe193f7d,0xbeefbf63bf75be98bf633eefbe983f75,0x3f3fbf2abea8bf72bf80bd6fbedf3f66
.octa 0x3f533f113f11bf53bf53bf11bf113f53,0xbeb43f703f80bd0abed4bf69bf2f3f3b,0xbf7ebdee3f1f3f493deebf7ebf493f1f,0xbe00bf7ebe873f773f1dbf4abf5e3efe
.octa 0x3f6fbeb8bf6f3eb83f6fbeb8bf6f3eb8,0x3f133f52bf58bf0a3f7c3e32bf7a3e5d,0xbf283f41bd8abf7f3f413f28bf7f3d8a,0xbf64beea3f43bf253e9c3f74bf7fbda9
.octa 0x3e6dbf793f793e6dbe6d3f79bf79be6d,0x3f80bc173ec83f6cbf333f37bf6dbec0,0x3e7f3f78bf023f5cbf783e7fbf5cbf02,0xbf613ef3bf7f3dcfbf75be93bf46bf22
.octa 0x80003f8080003f8080003f8080003f80,0xbe76bf79bf18bf4ebf5bbf04bf7dbe19,0x3eef3f633f753e983f63beef3e98bf75,0xbf2abf3fbf723ea8bd6f3f803f663edf
.octa 0x3f533f113f11bf53bf53bf11bf113f53,0xbf70beb43d0a3f803f69bed4bf3bbf2f,0x3f7e3deebf1fbf49bdee3f7e3f49bf1f,0xbf7e3e003f773e87bf4abf1d3efe3f5e
.octa 0x3f6fbeb8bf6f3eb83f6fbeb8bf6f3eb8,0xbf523f133f0abf58be323f7cbe5dbf7a,0x3f28bf413d8a3f7fbf41bf283f7fbd8a,0xbeea3f64bf25bf433f74be9cbda93f7f
.octa 0x3e6dbf793f793e6dbe6d3f79bf79be6d,0x3c173f80bf6c3ec8bf37bf333ec0bf6d,0xbe7fbf783f02bf5c3f78be7f3f5c3f02,0x3ef33f613dcf3f7fbe933f75bf223f46
.octa 0x80003f8080003f8080003f8080003f80,0x3f79be763f4ebf183f04bf5b3e19bf7d,0xbeefbf63bf75be98bf633eefbe983f75,0xbf3f3f2a3ea83f723f803d6f3edfbf66
.octa 0x3f533f113f11bf53bf53bf11bf113f53,0x3eb4bf70bf803d0a3ed43f693f2fbf3b,0xbf7ebdee3f1f3f493deebf7ebf493f1f,0x3e003f7e3e87bf77bf1d3f4a3f5ebefe
.octa 0x3f6fbeb8bf6f3eb83f6fbeb8bf6f3eb8,0xbf13bf523f583f0abf7cbe323f7abe5d,0xbf283f41bd8abf7f3f413f28bf7f3d8a,0x3f643eeabf433f25be9cbf743f7f3da9
.octa 0x3e6dbf793f793e6dbe6d3f79bf79be6d,0xbf803c17bec8bf6c3f33bf373f6d3ec0,0x3e7f3f78bf023f5cbf783e7fbf5cbf02,0x3f61bef33f7fbdcf3f753e933f463f22
.octa 0x80003f8080003f8080003f8080003f80,0x3e763f793f183f4e3f5b3f043f7d3e19,0x3eef3f633f753e983f63beef3e98bf75,0x3f2a3f3f3f72bea83d6fbf80bf66bedf
.octa 0x3f533f113f11bf53bf53bf11bf113f53,0x3f703eb4bd0abf80bf693ed43f3b3f2f,0x3f7e3deebf1fbf49bdee3f7e3f49bf1f,0x3f7ebe00bf77be873f4a3f1dbefebf5e
.octa 0x3f6fbeb8bf6f3eb83f6fbeb8bf6f3eb8,0x3f52bf13bf0a3f583e32bf7c3e5d3f7a,0x3f28bf413d8a3f7fbf41bf283f7fbd8a,0x3eeabf643f253f43bf743e9c3da9bf7f
.octa 0x3e6dbf793f793e6dbe6d3f79bf79be6d,0xbc17bf803f6cbec83f373f33bec03f6d,0xbe7fbf783f02bf5c3f78be7f3f5c3f02,0xbef3bf61bdcfbf7f3e93bf753f22bf46
.octa 0x80003f8080003f8080003f8080003f80,0xbf7b3e45bf553f0ebf0f3f54be4b3f7b,0xbec1bf6dbf6cbec7bf6d3ec1bec73f6c,0x3f56bf0cbe3fbf7cbf7bbe51bf103f54
.octa 0x3f333f373f37bf33bf33bf37bf373f33,0xbf113f533f7a3e57be38bf7cbf573f0b,0xbf6bbecd3ebb3f6e3ecdbf6bbf6e3ebb,0x3e5dbf7abf133f523f58bf0abf7c3e32
.octa 0x3f803cc9bf80bcc93f803cc9bf80bcc9,0x3e2c3f7cbf08bf593f513f14bf7abe63,0xbf6f3eb53ed2bf693eb53f6fbf69bed2,0xbf07bf5a3f7dbe26be6a3f79bf50bf15
.octa 0x3f3cbf2e3f2e3f3cbf3c3f2ebf2ebf3c,0x3f4f3f17be703f79bf7d3e20bf06bf5a,0xbed83f68bf713eafbf68bed8beafbf71,0xbf79be76bf4ebf18bf04bf5bbe19bf7d
.octa 0x80003f8080003f8080003f8080003f80,0xbe45bf7bbf0ebf55bf54bf0fbf7bbe4b,0x3ec13f6d3f6c3ec73f6dbec13ec7bf6c,0xbf0cbf56bf7c3e3fbe513f7b3f543f10
.octa 0x3f333f373f37bf33bf33bf37bf373f33,0xbf53bf11be573f7a3f7cbe38bf0bbf57,0x3f6b3ecdbebbbf6ebecd3f6b3f6ebebb,0xbf7abe5d3f523f13bf0abf583e323f7c
.octa 0x3f803cc9bf80bcc93f803cc9bf80bcc9,0xbf7c3e2c3f59bf08bf143f513e63bf7a,0x3f6fbeb5bed23f69beb5bf6f3f693ed2,0xbf5a3f07be26bf7d3f793e6abf153f50
.octa 0x3f3cbf2e3f2e3f3cbf3c3f2ebf2ebf3c,0xbf173f4fbf79be70be20bf7d3f5abf06,0x3ed8bf683f71beaf3f683ed83eaf3f71,0xbe763f79bf183f4ebf5b3f04bf7d3e19
.octa 0x80003f8080003f8080003f8080003f80,0x3f7bbe453f55bf0e3f0fbf543e4bbf7b,0xbec1bf6dbf6cbec7bf6d3ec1bec73f6c,0xbf563f0c3e3f3f7c3f7b3e513f10bf54
.octa 0x3f333f373f37bf33bf33bf37bf373f33,0x3f11bf53bf7abe573e383f7c3f57bf0b,0xbf6bbecd3ebb3f6e3ecdbf6bbf6e3ebb,0xbe5d3f7a3f13bf52bf583f0a3f7cbe32
.octa 0x3f803cc9bf80bcc93f803cc9bf80bcc9,0xbe2cbf7c3f083f59bf51bf143f7a3e63,0xbf6f3eb53ed2bf693eb53f6fbf69bed2,0x3f073f5abf7d3e263e6abf793f503f15
.octa 0x3f3cbf2e3f2e3f3cbf3c3f2ebf2ebf3c,0xbf4fbf173e70bf793f7dbe203f063f5a,0xbed83f68bf713eafbf68bed8beafbf71,0x3f793e763f4e3f183f043f5b3e193f7d
.octa 0x80003f8080003f8080003f8080003f80,0x3e453f7b3f0e3f553f543f0f3f7b3e4b,0x3ec13f6d3f6c3ec73f6dbec13ec7bf6c,0x3f0c3f563f7cbe3f3e51bf7bbf54bf10
.octa 0x3f333f373f37bf33bf33bf37bf373f33,0x3f533f113e57bf7abf7c3e383f0b3f57,0x3f6b3ecdbebbbf6ebecd3f6b3f6ebebb,0x3f7a3e5dbf52bf133f0a3f58be32bf7c
.octa 0x3f803cc9bf80bcc93f803cc9bf80bcc9,0x3f7cbe2cbf593f083f14bf51be633f7a,0x3f6fbeb5bed23f69beb5bf6f3f693ed2,0x3f5abf073e263f7dbf79be6a3f15bf50
.octa 0x3f3cbf2e3f2e3f3cbf3c3f2ebf2ebf3c,0x3f17bf4f3f793e703e203f7dbf5a3f06,0x3ed8bf683f71beaf3f683ed83eaf3f71,0x3e76bf793f18bf4e3f5bbf043f7dbe19
.octa 0x80003f8080003f8080003f8080003f80,0xbf7d3e13bf5c3f03bf193f4dbe7c3f78,0xbe92bf75bf61bef4bf753e92bef43f61,0x3f68bed7bd23bf80bf70beb1bf2e3f3c
.octa 0x3f0c3f573f57bf0cbf0cbf57bf573f0c,0xbf403f293f663ee23d84bf7fbf723ea5,0xbf43bf263da33f7f3f26bf43bf7f3da3,0x3f08bf59bf513f143f7abe63bf7cbe2c
.octa 0x3f6a3ecfbf6abecf3f6a3ecfbf6abecf,0xbe8a3f77bdf4bf7e3efb3f5fbf49bf1e,0xbf7ebe043f4bbf1cbe043f7ebf1cbf4b,0xbc7bbf803f6e3ebdbf323f38becbbf6b
.octa 0x3f7dbe233e233f7dbf7d3e23be23bf7d,0x3e993f74bf443f24bf63beed3db6bf7f,0xbf673edebf72beaabedebf673eaabf72,0xbf0fbf54be4bbf7b3e45bf7b3f0ebf55
.octa 0x80003f8080003f8080003f8080003f80,0xbe13bf7dbf03bf5cbf4dbf19bf78be7c,0x3e923f753f613ef43f75be923ef4bf61,0xbed7bf68bf803d23beb13f703f3c3f2e
.octa 0x3f0c3f573f57bf0cbf0cbf57bf573f0c,0xbf29bf40bee23f663f7f3d84bea5bf72,0x3f433f26bda3bf7fbf263f433f7fbda3,0xbf59bf083f143f51be63bf7abe2c3f7c
.octa 0x3f6a3ecfbf6abecf3f6a3ecfbf6abecf,0xbf77be8a3f7ebdf4bf5f3efb3f1ebf49,0x3f7e3e04bf4b3f1c3e04bf7e3f1c3f4b,0xbf803c7b3ebdbf6e3f383f32bf6b3ecb
.octa 0x3f7dbe233e233f7dbf7d3e23be23bf7d,0xbf743e99bf24bf443eedbf633f7f3db6,0x3f67bede3f723eaa3ede3f67beaa3f72,0xbf543f0fbf7b3e4bbf7bbe45bf55bf0e
.octa 0x80003f8080003f8080003f8080003f80,0x3f7dbe133f5cbf033f19bf4d3e7cbf78,0xbe92bf75bf61bef4bf753e92bef43f61,0xbf683ed73d233f803f703eb13f2ebf3c
.octa 0x3f0c3f573f57bf0cbf0cbf57bf573f0c,0x3f40bf29bf66bee2bd843f7f3f72bea5,0xbf43bf263da33f7f3f26bf43bf7f3da3,0xbf083f593f51bf14bf7a3e633f7c3e2c
.octa 0x3f6a3ecfbf6abecf3f6a3ecfbf6abecf,0x3e8abf773df43f7ebefbbf5f3f493f1e,0xbf7ebe043f4bbf1cbe043f7ebf1cbf4b,0x3c7b3f80bf6ebebd3f32bf383ecb3f6b
.octa 0x3f7dbe233e233f7dbf7d3e23be23bf7d,0xbe99bf743f44bf243f633eedbdb63f7f,0xbf673edebf72beaabedebf673eaabf72,0x3f0f3f543e4b3f7bbe453f7bbf0e3f55
.octa 0x80003f8080003f8080003f8080003f80,0x3e133f7d3f033f5c3f4d3f193f783e7c,0x3e923f753f613ef43f75be923ef4bf61,0x3ed73f683f80bd233eb1bf70bf3cbf2e
.octa 0x3f0c3f573f57bf0cbf0cbf57bf573f0c,0x3f293f403ee2bf66bf7fbd843ea53f72,0x3f433f26bda3bf7fbf263f433f7fbda3,0x3f593f08bf14bf513e633f7a3e2cbf7c
.octa 0x3f6a3ecfbf6abecf3f6a3ecfbf6abecf,0x3f773e8abf7e3df43f5fbefbbf1e3f49,0x3f7e3e04bf4b3f1c3e04bf7e3f1c3f4b,0x3f80bc7bbebd3f6ebf38bf323f6bbecb
.octa 0x3f7dbe233e233f7dbf7d3e23be23bf7d,0x3f74be993f243f44beed3f63bf7fbdb6,0x3f67bede3f723eaa3ede3f67beaa3f72,0x3f54bf0f3f7bbe4b3f7b3e453f553f0e
.octa 0x80003f8080003f8080003f8080003f80,0xbf7f3dc2bf623ef0bf233f45be963f75,0xbe42bf7bbf54bf10bf7b3e42bf103f54,0x3f76be903ddbbf7fbf61bef6bf473f21
.octa 0x3ebe3f6e3f6ebebebebebf6ebf6e3ebe,0xbf643eea3f433f253e9cbf74bf7f3da9,0xbf0abf57be5a3f7a3f57bf0abf7abe5a,0x3f49bf1ebf773e8a3f7e3df4bf5fbefb
.octa 0x3f313f39bf31bf393f313f39bf31bf39,0xbf283f413ea2bf733d903f7fbee5bf65,0xbf50bf153f7cbe29bf153f50be29bf7c,0x3f00bf5e3f1c3f4bbf773e843e07bf7e
.octa 0x3f693ed5bed53f69bf69bed53ed5bf69,0xbea83f72bf803d6fbedfbf663f2abf3f,0xbf79be73bf05bf5b3e73bf793f5bbf05,0x3e13bf7d3f03bf5c3f4dbf193f78be7c
.octa 0x80003f8080003f8080003f8080003f80,0xbdc2bf7fbef0bf62bf45bf23bf75be96,0x3e423f7b3f543f103f7bbe423f10bf54,0xbe90bf76bf7fbddbbef63f613f213f47
.octa 0x3ebe3f6e3f6ebebebebebf6ebf6e3ebe,0xbeeabf64bf253f433f743e9cbda9bf7f,0x3f0a3f573e5abf7abf573f0a3f7a3e5a,0xbf1ebf493e8a3f773df4bf7ebefb3f5f
.octa 0x3f313f39bf31bf393f313f39bf31bf39,0xbf41bf283f733ea2bf7f3d903f65bee5,0x3f503f15bf7c3e293f15bf503e293f7c,0xbf5ebf003f4bbf1c3e843f77bf7ebe07
.octa 0x3f693ed5bed53f69bf69bed53ed5bf69,0xbf72bea8bd6fbf803f66bedf3f3f3f2a,0x3f793e733f053f5bbe733f79bf5b3f05,0xbf7dbe13bf5cbf03bf19bf4dbe7cbf78
.octa 0x80003f8080003f8080003f8080003f80,0x3f7fbdc23f62bef03f23bf453e96bf75,0xbe42bf7bbf54bf10bf7b3e42bf103f54,0xbf763e90bddb3f7f3f613ef63f47bf21
.octa 0x3ebe3f6e3f6ebebebebebf6ebf6e3ebe,0x3f64beeabf43bf25be9c3f743f7fbda9,0xbf0abf57be5a3f7a3f57bf0abf7abe5a,0xbf493f1e3f77be8abf7ebdf43f5f3efb
.octa 0x3f313f39bf31bf393f313f39bf31bf39,0x3f28bf41bea23f73bd90bf7f3ee53f65,0xbf50bf153f7cbe29bf153f50be29bf7c,0xbf003f5ebf1cbf4b3f77be84be073f7e
.octa 0x3f693ed5bed53f69bf69bed53ed5bf69,0x3ea8bf723f80bd6f3edf3f66bf2a3f3f,0xbf79be73bf05bf5b3e73bf793f5bbf05,0xbe133f7dbf033f5cbf4d3f19bf783e7c
.octa 0x80003f8080003f8080003f8080003f80,0x3dc23f7f3ef03f623f453f233f753e96,0x3e423f7b3f543f103f7bbe423f10bf54,0x3e903f763f7f3ddb3ef6bf61bf21bf47
.octa 0x3ebe3f6e3f6ebebebebebf6ebf6e3ebe,0x3eea3f643f25bf43bf74be9c3da93f7f,0x3f0a3f573e5abf7abf573f0a3f7a3e5a,0x3f1e3f49be8abf77bdf43f7e3efbbf5f
.octa 0x3f313f39bf31bf393f313f39bf31bf39,0x3f413f28bf73bea23f7fbd90bf653ee5,0x3f503f15bf7c3e293f15bf503e293f7c,0x3f5e3f00bf4b3f1cbe84bf773f7e3e07
.octa 0x3f693ed5bed53f69bf69bed53ed5bf69,0x3f723ea83d6f3f80bf663edfbf3fbf2a,0x3f793e733f053f5bbe733f79bf5b3f05,0x3f7d3e133f5c3f033f193f4d3e7c3f78
.octa 0x80003f8080003f8080003f8080003f80,0xbf803d3cbf683ed9bf2d3f3dbeae3f71,0xbdbcbf7fbf45bf24bf7f3dbcbf243f45,0x3f7ebe0d3e81bf78bf4cbf1abf5d3f02
.octa 0x3e3b3f7c3f7cbe3bbe3bbf7cbf7c3e3b,0xbf793e6a3f153f503f07bf5abf7dbe26,0xbe8cbf76befa3f603f76be8cbf60befa,0x3f73bea2bf7fbd903f653ee5bf28bf41
.octa 0x3eb83f6fbeb8bf6f3eb83f6fbeb8bf6f,0xbf6a3ece3f31bf39beba3f6fbcb0bf80,0xbee3bf653f733ea4bf653ee33ea4bf73,0x3f60bef83de83f7ebf76be8d3f1fbf48
.octa 0x3f063f5abf5a3f06bf06bf5a3f5abf06,0xbf543f10bf56bf0c3e3fbf7c3f7bbe51,0xbf1abf4d3e10bf7d3f4dbf1a3f7d3e10,0x3f45bf233f75be963f7f3dc23f623ef0
.octa 0x80003f8080003f8080003f8080003f80,0xbd3cbf80bed9bf68bf3dbf2dbf71beae,0x3dbc3f7f3f453f243f7fbdbc3f24bf45,0xbe0dbf7ebf78be81bf1a3f4c3f023f5d
.octa 0x3e3b3f7c3f7cbe3bbe3bbf7cbf7c3e3b,0xbe6abf79bf503f153f5a3f073e26bf7d,0x3e8c3f763efabf60bf763e8c3f603efa,0xbea2bf73bd903f7f3ee5bf65bf413f28
.octa 0x3eb83f6fbeb8bf6f3eb83f6fbeb8bf6f,0xbecebf6a3f393f31bf6fbeba3f80bcb0,0x3ee33f65bf73bea43f65bee3bea43f73,0xbef8bf603f7ebde8be8d3f76bf48bf1f
.octa 0x3f063f5abf5a3f06bf06bf5a3f5abf06,0xbf10bf543f0cbf563f7c3e3f3e513f7b,0x3f1a3f4dbe103f7dbf4d3f1abf7dbe10,0xbf23bf45be96bf753dc2bf7f3ef0bf62
.octa 0x80003f8080003f8080003f8080003f80,0x3f80bd3c3f68bed93f2dbf3d3eaebf71,0xbdbcbf7fbf45bf24bf7f3dbcbf243f45,0xbf7e3e0dbe813f783f4c3f1a3f5dbf02
.octa 0x3e3b3f7c3f7cbe3bbe3bbf7cbf7c3e3b,0x3f79be6abf15bf50bf073f5a3f7d3e26,0xbe8cbf76befa3f603f76be8cbf60befa,0xbf733ea23f7f3d90bf65bee53f283f41
.octa 0x3eb83f6fbeb8bf6f3eb83f6fbeb8bf6f,0x3f6abecebf313f393ebabf6f3cb03f80,0xbee3bf653f733ea4bf653ee33ea4bf73,0xbf603ef8bde8bf7e3f763e8dbf1f3f48
.octa 0x3f063f5abf5a3f06bf06bf5a3f5abf06,0x3f54bf103f563f0cbe3f3f7cbf7b3e51,0xbf1abf4d3e10bf7d3f4dbf1a3f7d3e10,0xbf453f23bf753e96bf7fbdc2bf62bef0
.octa 0x80003f8080003f8080003f8080003f80,0x3d3c3f803ed93f683f3d3f2d3f713eae,0x3dbc3f7f3f453f243f7fbdbc3f24bf45,0x3e0d3f7e3f783e813f1abf4cbf02bf5d
.octa 0x3e3b3f7c3f7cbe3bbe3bbf7cbf7c3e3b,0x3e6a3f793f50bf15bf5abf07be263f7d,0x3e8c3f763efabf60bf763e8c3f603efa,0x3ea23f733d90bf7fbee53f653f41bf28
.octa 0x3eb83f6fbeb8bf6f3eb83f6fbeb8bf6f,0x3ece3f6abf39bf313f6f3ebabf803cb0,0x3ee33f65bf73bea43f65bee3bea43f73,0x3ef83f60bf7e3de83e8dbf763f483f1f
.octa 0x3f063f5abf5a3f06bf06bf5a3f5abf06,0x3f103f54bf0c3f56bf7cbe3fbe51bf7b,0x3f1a3f4dbe103f7dbf4d3f1abf7dbe10,0x3f233f453e963f75bdc23f7fbef03f62
.octa 0x3f8000003f8000003f8000003f80,0x3f8080003f8080003f8080003f808000,0x3f6d3ec43f353f353ec43f6d00003f80,0x3ec4bf6d3f35bf353f6dbec43f808000
.octa 0x3f35bf353f80248d3f353f3500003f80,0xbf35bf35248dbf803f35bf353f808000,0xbec4bf6d3f35bf353f6d3ec400003f80,0xbf6d3ec4bf35bf353ec4bf6d3f808000
.octa 0xbf80a554250dbf803f80248d00003f80,0xa5543f80bf80a50d248dbf803f808000,0xbec43f6dbf35bf353f6dbec400003f80,0x3f6d3ec4bf353f35bec4bf6d3f808000
.octa 0x3f353f35bf80a5543f35bf3500003f80,0x3f35bf35a5543f80bf35bf353f808000,0x3f6dbec4bf353f353ec4bf6d00003f80,0xbec4bf6d3f353f35bf6dbec43f808000
.octa 0x3f8000003f8000003f8000003f80,0x3f8080003f8080003f8080003f808000,0x3ec4bf6d3f35bf353f6dbec43f80248d,0xbf6dbec4bf35bf35bec4bf6d248dbf80
.octa 0xbf353f35bf80a554bf35bf35250dbf80,0x3f353f35a5543f80bf353f35bf80a50d,0x3f6dbec43f353f35bec43f6dbf80a554,0xbec4bf6d3f35bf353f6d3ec4a5543f80
.octa 0xbf80a5f725d4bf803f8025b0a58d3f80,0xa5f73f80bf80a5d425b0bf803f80258d,0x3f6d3ec4bf353f35bec4bf6d3f8025b0,0x3ec4bf6d3f353f35bf6d3ec425b0bf80
.octa 0xbf35bf353f80261fbf353f3525d4bf80,0xbf353f35261fbf803f353f35bf80a5d4,0x3ec43f6dbf35bf353f6d3ec4bf80a5f7,0x3f6dbec4bf353f353ec4bf6da5f73f80
.octa 0x3f8000003f8000003f8000003f80,0x3f8080003f8080003f8080003f808000,0xbf6dbec4bf35bf35bec4bf6d250dbf80,0xbec43f6dbf353f35bf6d3ec4bf80a50d
.octa 0x3f35bf353f8025b03f353f35a58d3f80,0xbf35bf3525b0bf803f35bf353f80258d,0x3ec43f6dbf353f35bf6dbec425d4bf80,0x3f6dbec43f353f35bec43f6dbf80a5d4
.octa 0xbf80a7312630bf803f80261fa60d3f80,0xa7313f80bf80a630261fbf803f80260d,0x3ec4bf6d3f353f35bf6d3ec42630bf80,0xbf6dbec43f35bf353ec43f6dbf80a630
.octa 0x3f353f35bf80a7423f35bf35a6543f80,0x3f35bf35a7423f80bf35bf353f802654,0xbf6d3ec43f35bf35bec43f6d2677bf80,0x3ec43f6dbf35bf353f6d3ec4bf80a677
.octa 0x3f8000003f8000003f8000003f80,0x3f8080003f8080003f8080003f808000,0xbec43f6dbf353f35bf6d3ec4bf80a554,0x3f6d3ec43f353f353ec43f6da5543f80
.octa 0xbf353f35bf80a5f7bf35bf3525d4bf80,0x3f353f35a5f73f80bf353f35bf80a5d4,0xbf6d3ec4bf35bf353ec4bf6d3f80261f,0x3ec43f6dbf353f35bf6dbec4261fbf80
.octa 0xbf80a7422677bf803f80a68da6543f80,0xa7423f80bf80a677a68dbf803f802654,0xbf6dbec43f35bf353ec43f6dbf80a742,0xbec43f6dbf35bf353f6dbec4a7423f80
.octa 0xbf35bf353f80a60dbf353f35269fbf80,0xbf353f35a60dbf803f353f35bf80a69f,0xbec4bf6d3f353f35bf6dbec43f80a60d,0xbf6d3ec43f35bf35bec43f6da60dbf80
.octa 0x25d4bf80a58d3f80250dbf8000003f80,0xbf80a5d43f80258dbf80a50d3f808000,0xbf6dbec43f353f35bec4bf6d00003f80,0xbec43f6d3f35bf35bf6d3ec43f808000
.octa 0xbf353f353f8025b0bf35bf3500003f80,0x3f353f3525b0bf80bf353f353f808000,0x3ec43f6d3f35bf35bf6dbec400003f80,0x3f6dbec4bf35bf35bec43f6d3f808000
.octa 0x3f80261f25d4bf80bf80a55400003f80,0x261fbf80bf80a5d4a5543f803f808000,0x3ec4bf6dbf35bf35bf6d3ec400003f80,0xbf6dbec4bf353f353ec43f6d3f808000
.octa 0xbf35bf35bf80a5f7bf353f3500003f80,0xbf353f35a5f73f803f353f353f808000,0xbf6d3ec4bf353f35bec43f6d00003f80,0x3ec43f6d3f353f353f6d3ec43f808000
.octa 0x2677bf80a6543f802630bf80a60d3f80,0xbf80a6773f802654bf80a6303f80260d,0xbec43f6d3f35bf35bf6d3ec43f80261f,0x3f6d3ec4bf35bf353ec43f6d261fbf80
.octa 0x3f35bf35bf80a7423f353f352630bf80,0xbf35bf35a7423f803f35bf35bf80a630,0xbf6d3ec43f353f353ec4bf6dbf80a731,0x3ec43f6d3f35bf35bf6dbec4a7313f80
.octa 0x3f80a60d269fbf80bf80a742a6543f80,0xa60dbf80bf80a69fa7423f803f802654,0xbf6dbec4bf353f353ec43f6d3f80a68d,0xbec43f6d3f353f353f6dbec4a68dbf80
.octa 0x3f353f353f80a60d3f35bf352677bf80,0x3f35bf35a60dbf80bf35bf35bf80a677,0xbec4bf6dbf35bf35bf6dbec4bf80a742,0xbf6d3ec4bf353f35bec43f6da7423f80
.octa 0x27b1bf80a6b03f80269fbf80a68d3f80,0xbf80a7b13f8026b0bf80a69f3f80268d,0x3f6d3ec4bf35bf353ec43f6d269fbf80,0x3ec4bf6dbf353f353f6dbec4bf80a69f
.octa 0xbf353f353f80a58ebf35bf35a6b03f80,0x3f353f35a58ebf80bf353f353f8026b0,0xbec4bf6dbf353f353f6d3ec427b1bf80,0xbf6d3ec43f353f353ec4bf6dbf80a7b1
.octa 0x3f80258d27c2bf80bf80a777a6d43f80,0x258dbf80bf80a7c2a7773f803f8026d4,0xbec43f6d3f353f353f6dbec4a70dbf80,0x3f6d3ec43f35bf35bec4bf6dbf80270d
.octa 0xbf35bf35bf80a78dbf353f35a6f73f80,0xbf353f35a78d3f803f353f353f8026f7,0x3f6dbec43f35bf353ec4bf6d27c2bf80,0xbec4bf6dbf35bf35bf6dbec4bf80a7c2
.octa 0x27c2bf80a6f73f80a70dbf80a6d43f80,0xbf80a7c23f8026f7bf80270d3f8026d4,0x3ec4bf6dbf353f353f6dbec4bf80a777,0xbf6dbec43f353f35bec4bf6da7773f80
.octa 0x3f35bf35bf80a78d3f353f3527c2bf80,0xbf35bf35a78d3f803f35bf35bf80a7c2,0x3f6dbec4bf35bf35bec43f6d3f80258d,0xbec4bf6dbf353f353f6d3ec4258dbf80
.octa 0x3f80268da68dbf80bf80a796a71f3f80,0x268dbf80bf80268da7963f803f80271f,0x3f6d3ec43f35bf35bec4bf6dbf80a796,0x3ec4bf6dbf35bf35bf6d3ec4a7963f80
.octa 0x3f353f353f8028163f35bf35a68dbf80,0x3f35bf352816bf80bf35bf35bf80268d,0x3ec43f6d3f353f353f6d3ec43f80268d,0x3f6dbec43f35bf353ec4bf6d268dbf80
.octa 0x3f8000003f8000003f8000003f80,0x3f8080003f8080003f8080003f808000,0x3f6d3ec23f363f343ec53f6c3b493f80,0x3ec2bf6d3f34bf363f6cbec53f80bb49
.octa 0x3f34bf363f80bbc93f363f343bc93f80,0xbf36bf34bbc9bf803f34bf363f80bbc9,0xbec8bf6c3f33bf373f6d3ec03c173f80,0xbf6c3ec8bf37bf333ec0bf6d3f80bc17
.octa 0xbf803c49bc49bf803f80bc493c493f80,0x3c493f80bf803c49bc49bf803f80bc49,0xbebd3f6ebf38bf323f6bbecb3c7b3f80,0x3f6e3ebdbf323f38becbbf6b3f80bc7b
.octa 0x3f383f32bf803c973f32bf383c973f80,0x3f32bf383c973f80bf38bf323f80bc97,0x3f6abecebf313f393ebabf6f3cb03f80,0xbecebf6a3f393f31bf6fbeba3f80bcb0
.octa 0x3f8000003f8000003f8000003f80,0x3f8080003f8080003f8080003f808000,0x3ec2bf6d3f34bf363f6cbec53f80bb49,0xbf6dbec2bf36bf34bec5bf6cbb49bf80
.octa 0xbf343f36bf803bc9bf36bf34bbc9bf80,0x3f363f343bc93f80bf343f36bf803bc9,0x3f6cbec83f373f33bec03f6dbf803c17,0xbec8bf6c3f33bf373f6d3ec03c173f80
.octa 0xbf803c49bc49bf803f80bc493c493f80,0x3c493f80bf803c49bc49bf803f80bc49,0x3f6e3ebdbf323f38becbbf6b3f80bc7b,0x3ebdbf6e3f383f32bf6b3ecbbc7bbf80
.octa 0xbf38bf323f80bc97bf323f38bc97bf80,0xbf323f38bc97bf803f383f32bf803c97,0x3ece3f6abf39bf313f6f3ebabf803cb0,0x3f6abecebf313f393ebabf6f3cb03f80
.octa 0x3f8000003f8000003f8000003f80,0x3f8080003f8080003f8080003f808000,0xbf6dbec2bf36bf34bec5bf6cbb49bf80,0xbec23f6dbf343f36bf6c3ec5bf803b49
.octa 0x3f34bf363f80bbc93f363f343bc93f80,0xbf36bf34bbc9bf803f34bf363f80bbc9,0x3ec83f6cbf333f37bf6dbec0bc17bf80,0x3f6cbec83f373f33bec03f6dbf803c17
.octa 0xbf803c49bc49bf803f80bc493c493f80,0x3c493f80bf803c49bc49bf803f80bc49,0x3ebdbf6e3f383f32bf6b3ecbbc7bbf80,0xbf6ebebd3f32bf383ecb3f6bbf803c7b
.octa 0x3f383f32bf803c973f32bf383c973f80,0x3f32bf383c973f80bf38bf323f80bc97,0xbf6a3ece3f31bf39beba3f6fbcb0bf80,0x3ece3f6abf39bf313f6f3ebabf803cb0
.octa 0x3f8000003f8000003f8000003f80,0x3f8080003f8080003f8080003f808000,0xbec23f6dbf343f36bf6c3ec5bf803b49,0x3f6d3ec23f363f343ec53f6c3b493f80
.octa 0xbf343f36bf803bc9bf36bf34bbc9bf80,0x3f363f343bc93f80bf343f36bf803bc9,0xbf6c3ec8bf37bf333ec0bf6d3f80bc17,0x3ec83f6cbf333f37bf6dbec0bc17bf80
.octa 0xbf803c49bc49bf803f80bc493c493f80,0x3c493f80bf803c49bc49bf803f80bc49,0xbf6ebebd3f32bf383ecb3f6bbf803c7b,0xbebd3f6ebf38bf323f6bbecb3c7b3f80
.octa 0xbf38bf323f80bc97bf323f38bc97bf80,0xbf323f38bc97bf803f383f32bf803c97,0xbecebf6a3f393f31bf6fbeba3f80bcb0,0xbf6a3ece3f31bf39beba3f6fbcb0bf80
.octa 0xbcc9bf803cc93f80bcc9bf803cc93f80,0xbf803cc93f80bcc9bf803cc93f80bcc9,0xbf6fbeb73f3a3f30bed1bf6a3ce23f80,0xbeb73f6f3f30bf3abf6a3ed13f80bce2
.octa 0xbf2f3f3a3f80bcfbbf3abf2f3cfb3f80,0x3f3a3f2fbcfbbf80bf2f3f3a3f80bcfb,0x3ed43f693f2fbf3bbf70beb43d0a3f80,0x3f69bed4bf3bbf2fbeb43f703f80bd0a
.octa 0x3f80bd17bd17bf80bf803d173d173f80,0xbd17bf80bf803d173d173f803f80bd17,0x3eb1bf70bf3cbf2ebf683ed73d233f80,0xbf70beb1bf2e3f3c3ed73f683f80bd23
.octa 0xbf3dbf2dbf803d30bf2d3f3d3d303f80,0xbf2d3f3d3d303f803f3d3f2d3f80bd30,0xbf683ed9bf2d3f3dbeae3f713d3c3f80,0x3ed93f683f3d3f2d3f713eae3f80bd3c
.octa 0xbcc9bf803cc93f80bcc9bf803cc93f80,0xbf803cc93f80bcc9bf803cc93f80bcc9,0xbeb73f6f3f30bf3abf6a3ed13f80bce2,0x3f6f3eb7bf3abf303ed13f6abce2bf80
.octa 0x3f2fbf3abf803cfb3f3a3f2fbcfbbf80,0xbf3abf2f3cfb3f803f2fbf3abf803cfb,0xbf693ed43f3b3f2f3eb4bf70bf803d0a,0x3ed43f693f2fbf3bbf70beb43d0a3f80
.octa 0x3f80bd17bd17bf80bf803d173d173f80,0xbd17bf80bf803d173d173f803f80bd17,0xbf70beb1bf2e3f3c3ed73f683f80bd23,0xbeb13f703f3c3f2e3f68bed7bd23bf80
.octa 0x3f3d3f2d3f80bd303f2dbf3dbd30bf80,0x3f2dbf3dbd30bf80bf3dbf2dbf803d30,0xbed9bf68bf3dbf2dbf71beaebf803d3c,0xbf683ed9bf2d3f3dbeae3f713d3c3f80
.octa 0xbcc9bf803cc93f80bcc9bf803cc93f80,0xbf803cc93f80bcc9bf803cc93f80bcc9,0x3f6f3eb7bf3abf303ed13f6abce2bf80,0x3eb7bf6fbf303f3a3f6abed1bf803ce2
.octa 0xbf2f3f3a3f80bcfbbf3abf2f3cfb3f80,0x3f3a3f2fbcfbbf80bf2f3f3a3f80bcfb,0xbed4bf69bf2f3f3b3f703eb4bd0abf80,0xbf693ed43f3b3f2f3eb4bf70bf803d0a
.octa 0x3f80bd17bd17bf80bf803d173d173f80,0xbd17bf80bf803d173d173f803f80bd17,0xbeb13f703f3c3f2e3f68bed7bd23bf80,0x3f703eb13f2ebf3cbed7bf68bf803d23
.octa 0xbf3dbf2dbf803d30bf2d3f3d3d303f80,0xbf2d3f3d3d303f803f3d3f2d3f80bd30,0x3f68bed93f2dbf3d3eaebf71bd3cbf80,0xbed9bf68bf3dbf2dbf71beaebf803d3c
.octa 0xbcc9bf803cc93f80bcc9bf803cc93f80,0xbf803cc93f80bcc9bf803cc93f80bcc9,0x3eb7bf6fbf303f3a3f6abed1bf803ce2,0xbf6fbeb73f3a3f30bed1bf6a3ce23f80
.octa 0x3f2fbf3abf803cfb3f3a3f2fbcfbbf80,0xbf3abf2f3cfb3f803f2fbf3abf803cfb,0x3f69bed4bf3bbf2fbeb43f703f80bd0a,0xbed4bf69bf2f3f3b3f703eb4bd0abf80
.octa 0x3f80bd17bd17bf80bf803d173d173f80,0xbd17bf80bf803d173d173f803f80bd17,0x3f703eb13f2ebf3cbed7bf68bf803d23,0x3eb1bf70bf3cbf2ebf683ed73d233f80
.octa 0x3f3d3f2d3f80bd303f2dbf3dbd30bf80,0x3f2dbf3dbd30bf80bf3dbf2dbf803d30,0x3ed93f683f3d3f2d3f713eae3f80bd3c,0x3f68bed93f2dbf3d3eaebf71bd3cbf80
.octa 0x3f8000003f8000003f8000003f80,0x3f8080003f8080003f8080003f808000,0x3f6d3ec13f363f343ec73f6c3bc93f80,0x3ec1bf6d3f34bf363f6cbec73f80bbc9
.octa 0x3f33bf373f80bc493f373f333c493f80,0xbf37bf33bc49bf803f33bf373f80bc49,0xbecdbf6b3f32bf383f6e3ebb3c973f80,0xbf6b3ecdbf38bf323ebbbf6e3f80bc97
.octa 0xbf803cc9bcc9bf803f80bcc93cc93f80,0x3cc93f80bf803cc9bcc9bf803f80bcc9,0xbeb53f6fbf3abf2f3f69bed23cfb3f80,0x3f6f3eb5bf2f3f3abed2bf693f80bcfb
.octa 0x3f3c3f2ebf803d173f2ebf3c3d173f80,0x3f2ebf3c3d173f80bf3cbf2e3f80bd17,0x3f68bed8bf2d3f3d3eafbf713d303f80,0xbed8bf683f3d3f2dbf71beaf3f80bd30
.octa 0x3f8000003f8000003f8000003f80,0x3f8080003f8080003f8080003f808000,0x3ec1bf6d3f34bf363f6cbec73f80bbc9,0xbf6dbec1bf36bf34bec7bf6cbbc9bf80
.octa 0xbf333f37bf803c49bf37bf33bc49bf80,0x3f373f333c493f80bf333f37bf803c49,0x3f6bbecd3f383f32bebb3f6ebf803c97,0xbecdbf6b3f32bf383f6e3ebb3c973f80
.octa 0xbf803cc9bcc9bf803f80bcc93cc93f80,0x3cc93f80bf803cc9bcc9bf803f80bcc9,0x3f6f3eb5bf2f3f3abed2bf693f80bcfb,0x3eb5bf6f3f3a3f2fbf693ed2bcfbbf80
.octa 0xbf3cbf2e3f80bd17bf2e3f3cbd17bf80,0xbf2e3f3cbd17bf803f3c3f2ebf803d17,0x3ed83f68bf3dbf2d3f713eafbf803d30,0x3f68bed8bf2d3f3d3eafbf713d303f80
.octa 0x3f8000003f8000003f8000003f80,0x3f8080003f8080003f8080003f808000,0xbf6dbec1bf36bf34bec7bf6cbbc9bf80,0xbec13f6dbf343f36bf6c3ec7bf803bc9
.octa 0x3f33bf373f80bc493f373f333c493f80,0xbf37bf33bc49bf803f33bf373f80bc49,0x3ecd3f6bbf323f38bf6ebebbbc97bf80,0x3f6bbecd3f383f32bebb3f6ebf803c97
.octa 0xbf803cc9bcc9bf803f80bcc93cc93f80,0x3cc93f80bf803cc9bcc9bf803f80bcc9,0x3eb5bf6f3f3a3f2fbf693ed2bcfbbf80,0xbf6fbeb53f2fbf3a3ed23f69bf803cfb
.octa 0x3f3c3f2ebf803d173f2ebf3c3d173f80,0x3f2ebf3c3d173f80bf3cbf2e3f80bd17,0xbf683ed83f2dbf3dbeaf3f71bd30bf80,0x3ed83f68bf3dbf2d3f713eafbf803d30
.octa 0x3f8000003f8000003f8000003f80,0x3f8080003f8080003f8080003f808000,0xbec13f6dbf343f36bf6c3ec7bf803bc9,0x3f6d3ec13f363f343ec73f6c3bc93f80
.octa 0xbf333f37bf803c49bf37bf33bc49bf80,0x3f373f333c493f80bf333f37bf803c49,0xbf6b3ecdbf38bf323ebbbf6e3f80bc97,0x3ecd3f6bbf323f38bf6ebebbbc97bf80
.octa 0xbf803cc9bcc9bf803f80bcc93cc93f80,0x3cc93f80bf803cc9bcc9bf803f80bcc9,0xbf6fbeb53f2fbf3a3ed23f69bf803cfb,0xbeb53f6fbf3abf2f3f69bed23cfb3f80
.octa 0xbf3cbf2e3f80bd17bf2e3f3cbd17bf80,0xbf2e3f3cbd17bf803f3c3f2ebf803d17,0xbed8bf683f3d3f2dbf71beaf3f80bd30,0xbf683ed83f2dbf3dbeaf3f71bd30bf80
.octa 0xbd49bf803d493f80bd49bf803d493f80,0xbf803d493f80bd49bf803d493f80bd49,0xbf72beaa3f3f3f2bbedebf673d623f80,0xbeaa3f723f2bbf3fbf673ede3f80bd62
.octa 0xbf2a3f403f80bd7bbf40bf2a3d7b3f80,0x3f403f2abd7bbf80bf2a3f403f80bd7b,0x3ee33f653f28bf41bf73bea43d8a3f7f,0x3f65bee3bf41bf28bea43f733f7fbd8a
.octa 0x3f7fbd97bd97bf7fbf7f3d973d973f7f,0xbd97bf7fbf7f3d973d973f7f3f7fbd97,0x3e9ebf74bf43bf26bf643ee93da33f7f,0xbf74be9ebf263f433ee93f643f7fbda3
.octa 0xbf44bf25bf7f3db0bf253f443db03f7f,0xbf253f443db03f7f3f443f253f7fbdb0,0xbf633eefbf243f45be983f753dbc3f7f,0x3eef3f633f453f243f753e983f7fbdbc
.octa 0xbd49bf803d493f80bd49bf803d493f80,0xbf803d493f80bd49bf803d493f80bd49,0xbeaa3f723f2bbf3fbf673ede3f80bd62,0x3f723eaabf3fbf2b3ede3f67bd62bf80
.octa 0x3f2abf40bf803d7b3f403f2abd7bbf80,0xbf40bf2a3d7b3f803f2abf40bf803d7b,0xbf653ee33f413f283ea4bf73bf7f3d8a,0x3ee33f653f28bf41bf73bea43d8a3f7f
.octa 0x3f7fbd97bd97bf7fbf7f3d973d973f7f,0xbd97bf7fbf7f3d973d973f7f3f7fbd97,0xbf74be9ebf263f433ee93f643f7fbda3,0xbe9e3f743f433f263f64bee9bda3bf7f
.octa 0x3f443f253f7fbdb03f25bf44bdb0bf7f,0x3f25bf44bdb0bf7fbf44bf25bf7f3db0,0xbeefbf63bf45bf24bf75be98bf7f3dbc,0xbf633eefbf243f45be983f753dbc3f7f
.octa 0xbd49bf803d493f80bd49bf803d493f80,0xbf803d493f80bd49bf803d493f80bd49,0x3f723eaabf3fbf2b3ede3f67bd62bf80,0x3eaabf72bf2b3f3f3f67bedebf803d62
.octa 0xbf2a3f403f80bd7bbf40bf2a3d7b3f80,0x3f403f2abd7bbf80bf2a3f403f80bd7b,0xbee3bf65bf283f413f733ea4bd8abf7f,0xbf653ee33f413f283ea4bf73bf7f3d8a
.octa 0x3f7fbd97bd97bf7fbf7f3d973d973f7f,0xbd97bf7fbf7f3d973d973f7f3f7fbd97,0xbe9e3f743f433f263f64bee9bda3bf7f,0x3f743e9e3f26bf43bee9bf64bf7f3da3
.octa 0xbf44bf25bf7f3db0bf253f443db03f7f,0xbf253f443db03f7f3f443f253f7fbdb0,0x3f63beef3f24bf453e98bf75bdbcbf7f,0xbeefbf63bf45bf24bf75be98bf7f3dbc
.octa 0xbd49bf803d493f80bd49bf803d493f80,0xbf803d493f80bd49bf803d493f80bd49,0x3eaabf72bf2b3f3f3f67bedebf803d62,0xbf72beaa3f3f3f2bbedebf673d623f80
.octa 0x3f2abf40bf803d7b3f403f2abd7bbf80,0xbf40bf2a3d7b3f803f2abf40bf803d7b,0x3f65bee3bf41bf28bea43f733f7fbd8a,0xbee3bf65bf283f413f733ea4bd8abf7f
.octa 0x3f7fbd97bd97bf7fbf7f3d973d973f7f,0xbd97bf7fbf7f3d973d973f7f3f7fbd97,0x3f743e9e3f26bf43bee9bf64bf7f3da3,0x3e9ebf74bf43bf26bf643ee93da33f7f
.octa 0x3f443f253f7fbdb03f25bf44bdb0bf7f,0x3f25bf44bdb0bf7fbf44bf25bf7f3db0,0x3eef3f633f453f243f753e983f7fbdbc,0x3f63beef3f24bf453e98bf75bdbcbf7f
.octa 0x3f8000003f8000003f8000003f80,0x3f8080003f8080003f8080003f808000,0x3f6d3ec03f373f333ec83f6c3c173f80,0x3ec0bf6d3f33bf373f6cbec83f80bc17
.octa 0x3f32bf383f80bc973f383f323c973f80,0xbf38bf32bc97bf803f32bf383f80bc97,0xbed1bf6a3f30bf3a3f6f3eb73ce23f80,0xbf6a3ed1bf3abf303eb7bf6f3f80bce2
.octa 0xbf803d17bd17bf803f80bd173d173f80,0x3d173f80bf803d17bd17bf803f80bd17,0xbeae3f71bf3dbf2d3f68bed93d3c3f80,0x3f713eaebf2d3f3dbed9bf683f80bd3c
.octa 0x3f3f3f2bbf803d623f2bbf3f3d623f80,0x3f2bbf3f3d623f80bf3fbf2b3f80bd62,0x3f66bee2bf293f403ea5bf723d843f7f,0xbee2bf663f403f29bf72bea53f7fbd84
.octa 0x3f8000003f8000003f8000003f80,0x3f8080003f8080003f8080003f808000,0x3ec0bf6d3f33bf373f6cbec83f80bc17,0xbf6dbec0bf37bf33bec8bf6cbc17bf80
.octa 0xbf323f38bf803c97bf38bf32bc97bf80,0x3f383f323c973f80bf323f38bf803c97,0x3f6abed13f3a3f30beb73f6fbf803ce2,0xbed1bf6a3f30bf3a3f6f3eb73ce23f80
.octa 0xbf803d17bd17bf803f80bd173d173f80,0x3d173f80bf803d17bd17bf803f80bd17,0x3f713eaebf2d3f3dbed9bf683f80bd3c,0x3eaebf713f3d3f2dbf683ed9bd3cbf80
.octa 0xbf3fbf2b3f80bd62bf2b3f3fbd62bf80,0xbf2b3f3fbd62bf803f3f3f2bbf803d62,0x3ee23f66bf40bf293f723ea5bf7f3d84,0x3f66bee2bf293f403ea5bf723d843f7f
.octa 0x3f8000003f8000003f8000003f80,0x3f8080003f8080003f8080003f808000,0xbf6dbec0bf37bf33bec8bf6cbc17bf80,0xbec03f6dbf333f37bf6c3ec8bf803c17
.octa 0x3f32bf383f80bc973f383f323c973f80,0xbf38bf32bc97bf803f32bf383f80bc97,0x3ed13f6abf303f3abf6fbeb7bce2bf80,0x3f6abed13f3a3f30beb73f6fbf803ce2
.octa 0xbf803d17bd17bf803f80bd173d173f80,0x3d173f80bf803d17bd17bf803f80bd17,0x3eaebf713f3d3f2dbf683ed9bd3cbf80,0xbf71beae3f2dbf3d3ed93f68bf803d3c
.octa 0x3f3f3f2bbf803d623f2bbf3f3d623f80,0x3f2bbf3f3d623f80bf3fbf2b3f80bd62,0xbf663ee23f29bf40bea53f72bd84bf7f,0x3ee23f66bf40bf293f723ea5bf7f3d84
.octa 0x3f8000003f8000003f8000003f80,0x3f8080003f8080003f8080003f808000,0xbec03f6dbf333f37bf6c3ec8bf803c17,0x3f6d3ec03f373f333ec83f6c3c173f80
.octa 0xbf323f38bf803c97bf38bf32bc97bf80,0x3f383f323c973f80bf323f38bf803c97,0xbf6a3ed1bf3abf303eb7bf6f3f80bce2,0x3ed13f6abf303f3abf6fbeb7bce2bf80
.octa 0xbf803d17bd17bf803f80bd173d173f80,0x3d173f80bf803d17bd17bf803f80bd17,0xbf71beae3f2dbf3d3ed93f68bf803d3c,0xbeae3f71bf3dbf2d3f68bed93d3c3f80
.octa 0xbf3fbf2b3f80bd62bf2b3f3fbd62bf80,0xbf2b3f3fbd62bf803f3f3f2bbf803d62,0xbee2bf663f403f29bf72bea53f7fbd84,0xbf663ee23f29bf40bea53f72bd84bf7f
.octa 0xbd97bf7f3d973f7fbd97bf7f3d973f7f,0xbf7f3d973f7fbd97bf7f3d973f7fbd97,0xbf74be9c3f433f25beeabf643da93f7f,0xbe9c3f743f25bf43bf643eea3f7fbda9
.octa 0xbf243f453f7fbdbcbf45bf243dbc3f7f,0x3f453f24bdbcbf7fbf243f453f7fbdbc,0x3ef33f613f22bf46bf75be933dcf3f7f,0x3f61bef3bf46bf22be933f753f7fbdcf
.octa 0x3f7ebde2bde2bf7ebf7e3de23de23f7e,0xbde2bf7ebf7e3de23de23f7e3f7ebde2,0x3e8abf77bf49bf1ebf5f3efb3df43f7e,0xbf77be8abf1e3f493efb3f5f3f7ebdf4
.octa 0xbf4bbf1cbf7e3e04bf1c3f4b3e043f7e,0xbf1c3f4b3e043f7e3f4b3f1c3f7ebe04,0xbf5d3f02bf1a3f4cbe813f783e0d3f7e,0x3f023f5d3f4c3f1a3f783e813f7ebe0d
.octa 0xbd97bf7f3d973f7fbd97bf7f3d973f7f,0xbf7f3d973f7fbd97bf7f3d973f7fbd97,0xbe9c3f743f25bf43bf643eea3f7fbda9,0x3f743e9cbf43bf253eea3f64bda9bf7f
.octa 0x3f24bf45bf7f3dbc3f453f24bdbcbf7f,0xbf45bf243dbc3f7f3f24bf45bf7f3dbc,0xbf613ef33f463f223e93bf75bf7f3dcf,0x3ef33f613f22bf46bf75be933dcf3f7f
.octa 0x3f7ebde2bde2bf7ebf7e3de23de23f7e,0xbde2bf7ebf7e3de23de23f7e3f7ebde2,0xbf77be8abf1e3f493efb3f5f3f7ebdf4,0xbe8a3f773f493f1e3f5fbefbbdf4bf7e
.octa 0x3f4b3f1c3f7ebe043f1cbf4bbe04bf7e,0x3f1cbf4bbe04bf7ebf4bbf1cbf7e3e04,0xbf02bf5dbf4cbf1abf78be81bf7e3e0d,0xbf5d3f02bf1a3f4cbe813f783e0d3f7e
.octa 0xbd97bf7f3d973f7fbd97bf7f3d973f7f,0xbf7f3d973f7fbd97bf7f3d973f7fbd97,0x3f743e9cbf43bf253eea3f64bda9bf7f,0x3e9cbf74bf253f433f64beeabf7f3da9
.octa 0xbf243f453f7fbdbcbf45bf243dbc3f7f,0x3f453f24bdbcbf7fbf243f453f7fbdbc,0xbef3bf61bf223f463f753e93bdcfbf7f,0xbf613ef33f463f223e93bf75bf7f3dcf
.octa 0x3f7ebde2bde2bf7ebf7e3de23de23f7e,0xbde2bf7ebf7e3de23de23f7e3f7ebde2,0xbe8a3f773f493f1e3f5fbefbbdf4bf7e,0x3f773e8a3f1ebf49befbbf5fbf7e3df4
.octa 0xbf4bbf1cbf7e3e04bf1c3f4b3e043f7e,0xbf1c3f4b3e043f7e3f4b3f1c3f7ebe04,0x3f5dbf023f1abf4c3e81bf78be0dbf7e,0xbf02bf5dbf4cbf1abf78be81bf7e3e0d
.octa 0xbd97bf7f3d973f7fbd97bf7f3d973f7f,0xbf7f3d973f7fbd97bf7f3d973f7fbd97,0x3e9cbf74bf253f433f64beeabf7f3da9,0xbf74be9c3f433f25beeabf643da93f7f
.octa 0x3f24bf45bf7f3dbc3f453f24bdbcbf7f,0xbf45bf243dbc3f7f3f24bf45bf7f3dbc,0x3f61bef3bf46bf22be933f753f7fbdcf,0xbef3bf61bf223f463f753e93bdcfbf7f
.octa 0x3f7ebde2bde2bf7ebf7e3de23de23f7e,0xbde2bf7ebf7e3de23de23f7e3f7ebde2,0x3f773e8a3f1ebf49befbbf5fbf7e3df4,0x3e8abf77bf49bf1ebf5f3efb3df43f7e
.octa 0x3f4b3f1c3f7ebe043f1cbf4bbe04bf7e,0x3f1cbf4bbe04bf7ebf4bbf1cbf7e3e04,0x3f023f5d3f4c3f1a3f783e813f7ebe0d,0x3f5dbf023f1abf4c3e81bf78be0dbf7e
.octa 0x3f8000003f8000003f8000003f80,0x3f8080003f8080003f8080003f808000,0x3f6e3ebe3f373f333eca3f6b3c493f80,0x3ebebf6e3f33bf373f6bbeca3f80bc49
.octa 0x3f31bf393f80bcc93f393f313cc93f80,0xbf39bf31bcc9bf803f31bf393f80bcc9,0xbed5bf693f2ebf3c3f703eb23d173f80,0xbf693ed5bf3cbf2e3eb2bf703f80bd17
.octa 0xbf803d49bd49bf803f80bd493d493f80,0x3d493f80bf803d49bd49bf803f80bd49,0xbea73f72bf40bf2a3f66bee13d7b3f80,0x3f723ea7bf2a3f40bee1bf663f80bd7b
.octa 0x3f423f27bf7f3d973f27bf423d973f7f,0x3f27bf423d973f7fbf42bf273f7fbd97,0x3f63beecbf253f443e9bbf743db03f7f,0xbeecbf633f443f25bf74be9b3f7fbdb0
.octa 0x3f8000003f8000003f8000003f80,0x3f8080003f8080003f8080003f808000,0x3ebebf6e3f33bf373f6bbeca3f80bc49,0xbf6ebebebf37bf33becabf6bbc49bf80
.octa 0xbf313f39bf803cc9bf39bf31bcc9bf80,0x3f393f313cc93f80bf313f39bf803cc9,0x3f69bed53f3c3f2ebeb23f70bf803d17,0xbed5bf693f2ebf3c3f703eb23d173f80
.octa 0xbf803d49bd49bf803f80bd493d493f80,0x3d493f80bf803d49bd49bf803f80bd49,0x3f723ea7bf2a3f40bee1bf663f80bd7b,0x3ea7bf723f403f2abf663ee1bd7bbf80
.octa 0xbf42bf273f7fbd97bf273f42bd97bf7f,0xbf273f42bd97bf7f3f423f27bf7f3d97,0x3eec3f63bf44bf253f743e9bbf7f3db0,0x3f63beecbf253f443e9bbf743db03f7f
.octa 0x3f8000003f8000003f8000003f80,0x3f8080003f8080003f8080003f808000,0xbf6ebebebf37bf33becabf6bbc49bf80,0xbebe3f6ebf333f37bf6b3ecabf803c49
.octa 0x3f31bf393f80bcc93f393f313cc93f80,0xbf39bf31bcc9bf803f31bf393f80bcc9,0x3ed53f69bf2e3f3cbf70beb2bd17bf80,0x3f69bed53f3c3f2ebeb23f70bf803d17
.octa 0xbf803d49bd49bf803f80bd493d493f80,0x3d493f80bf803d49bd49bf803f80bd49,0x3ea7bf723f403f2abf663ee1bd7bbf80,0xbf72bea73f2abf403ee13f66bf803d7b
.octa 0x3f423f27bf7f3d973f27bf423d973f7f,0x3f27bf423d973f7fbf42bf273f7fbd97,0xbf633eec3f25bf44be9b3f74bdb0bf7f,0x3eec3f63bf44bf253f743e9bbf7f3db0
.octa 0x3f8000003f8000003f8000003f80,0x3f8080003f8080003f8080003f808000,0xbebe3f6ebf333f37bf6b3ecabf803c49,0x3f6e3ebe3f373f333eca3f6b3c493f80
.octa 0xbf313f39bf803cc9bf39bf31bcc9bf80,0x3f393f313cc93f80bf313f39bf803cc9,0xbf693ed5bf3cbf2e3eb2bf703f80bd17,0x3ed53f69bf2e3f3cbf70beb2bd17bf80
.octa 0xbf803d49bd49bf803f80bd493d493f80,0x3d493f80bf803d49bd49bf803f80bd49,0xbf72bea73f2abf403ee13f66bf803d7b,0xbea73f72bf40bf2a3f66bee13d7b3f80
.octa 0xbf42bf273f7fbd97bf273f42bd97bf7f,0xbf273f42bd97bf7f3f423f27bf7f3d97,0xbeecbf633f443f25bf74be9b3f7fbdb0,0xbf633eec3f25bf44be9b3f74bdb0bf7f
.octa 0xbdc9bf7f3dc93f7fbdc9bf7f3dc93f7f,0xbf7f3dc93f7fbdc9bf7f3dc93f7fbdc9,0xbf76be8f3f483f20bef7bf603de23f7e,0xbe8f3f763f20bf48bf603ef73f7ebde2
.octa 0xbf1d3f4a3f7ebdfbbf4abf1d3dfb3f7e,0x3f4a3f1dbdfbbf7ebf1d3f4a3f7ebdfb,0x3f013f5d3f1bbf4cbf78be823e0a3f7e,0x3f5dbf01bf4cbf1bbe823f783f7ebe0a
.octa 0x3f7dbe16be16bf7dbf7d3e163e163f7d,0xbe16bf7dbf7d3e163e163f7d3f7dbe16,0x3e6dbf79bf4fbf16bf5a3f063e233f7d,0xbf79be6dbf163f4f3f063f5a3f7dbe23
.octa 0xbf51bf13bf7c3e2fbf133f513e2f3f7c,0xbf133f513e2f3f7c3f513f133f7cbe2f,0xbf573f0cbf113f53be543f7a3e3b3f7c,0x3f0c3f573f533f113f7a3e543f7cbe3b
.octa 0xbdc9bf7f3dc93f7fbdc9bf7f3dc93f7f,0xbf7f3dc93f7fbdc9bf7f3dc93f7fbdc9,0xbe8f3f763f20bf48bf603ef73f7ebde2,0x3f763e8fbf48bf203ef73f60bde2bf7e
.octa 0x3f1dbf4abf7e3dfb3f4a3f1dbdfbbf7e,0xbf4abf1d3dfb3f7e3f1dbf4abf7e3dfb,0xbf5d3f013f4c3f1b3e82bf78bf7e3e0a,0x3f013f5d3f1bbf4cbf78be823e0a3f7e
.octa 0x3f7dbe16be16bf7dbf7d3e163e163f7d,0xbe16bf7dbf7d3e163e163f7d3f7dbe16,0xbf79be6dbf163f4f3f063f5a3f7dbe23,0xbe6d3f793f4f3f163f5abf06be23bf7d
.octa 0x3f513f133f7cbe2f3f13bf51be2fbf7c,0x3f13bf51be2fbf7cbf51bf13bf7c3e2f,0xbf0cbf57bf53bf11bf7abe54bf7c3e3b,0xbf573f0cbf113f53be543f7a3e3b3f7c
.octa 0xbdc9bf7f3dc93f7fbdc9bf7f3dc93f7f,0xbf7f3dc93f7fbdc9bf7f3dc93f7fbdc9,0x3f763e8fbf48bf203ef73f60bde2bf7e,0x3e8fbf76bf203f483f60bef7bf7e3de2
.octa 0xbf1d3f4a3f7ebdfbbf4abf1d3dfb3f7e,0x3f4a3f1dbdfbbf7ebf1d3f4a3f7ebdfb,0xbf01bf5dbf1b3f4c3f783e82be0abf7e,0xbf5d3f013f4c3f1b3e82bf78bf7e3e0a
.octa 0x3f7dbe16be16bf7dbf7d3e163e163f7d,0xbe16bf7dbf7d3e163e163f7d3f7dbe16,0xbe6d3f793f4f3f163f5abf06be23bf7d,0x3f793e6d3f16bf4fbf06bf5abf7d3e23
.octa 0xbf51bf13bf7c3e2fbf133f513e2f3f7c,0xbf133f513e2f3f7c3f513f133f7cbe2f,0x3f57bf0c3f11bf533e54bf7abe3bbf7c,0xbf0cbf57bf53bf11bf7abe54bf7c3e3b
.octa 0xbdc9bf7f3dc93f7fbdc9bf7f3dc93f7f,0xbf7f3dc93f7fbdc9bf7f3dc93f7fbdc9,0x3e8fbf76bf203f483f60bef7bf7e3de2,0xbf76be8f3f483f20bef7bf603de23f7e
.octa 0x3f1dbf4abf7e3dfb3f4a3f1dbdfbbf7e,0xbf4abf1d3dfb3f7e3f1dbf4abf7e3dfb,0x3f5dbf01bf4cbf1bbe823f783f7ebe0a,0xbf01bf5dbf1b3f4c3f783e82be0abf7e
.octa 0x3f7dbe16be16bf7dbf7d3e163e163f7d,0xbe16bf7dbf7d3e163e163f7d3f7dbe16,0x3f793e6d3f16bf4fbf06bf5abf7d3e23,0x3e6dbf79bf4fbf16bf5a3f063e233f7d
.octa 0x3f513f133f7cbe2f3f13bf51be2fbf7c,0x3f13bf51be2fbf7cbf51bf13bf7c3e2f,0x3f0c3f573f533f113f7a3e543f7cbe3b,0x3f57bf0c3f11bf533e54bf7abe3bbf7c
.octa 0x3f8000003f8000003f8000003f80,0x3f8080003f8080003f8080003f808000,0x3f6e3ebd3f383f323ecb3f6b3c7b3f80,0x3ebdbf6e3f32bf383f6bbecb3f80bc7b
.octa 0x3f2fbf3a3f80bcfb3f3a3f2f3cfb3f80,0xbf3abf2fbcfbbf803f2fbf3a3f80bcfb,0xbed9bf683f2dbf3d3f713eae3d3c3f80,0xbf683ed9bf3dbf2d3eaebf713f80bd3c
.octa 0xbf803d7bbd7bbf803f80bd7b3d7b3f80,0x3d7b3f80bf803d7bbd7bbf803f80bd7b,0xbe9f3f73bf42bf273f64bee83d9d3f7f,0x3f733e9fbf273f42bee8bf643f7fbd9d
.octa 0x3f453f24bf7f3dbc3f24bf453dbc3f7f,0x3f24bf453dbc3f7fbf45bf243f7fbdbc,0x3f61bef6bf213f473e90bf763ddb3f7f,0xbef6bf613f473f21bf76be903f7fbddb
.octa 0x3f8000003f8000003f8000003f80,0x3f8080003f8080003f8080003f808000,0x3ebdbf6e3f32bf383f6bbecb3f80bc7b,0xbf6ebebdbf38bf32becbbf6bbc7bbf80
.octa 0xbf2f3f3abf803cfbbf3abf2fbcfbbf80,0x3f3a3f2f3cfb3f80bf2f3f3abf803cfb,0x3f68bed93f3d3f2dbeae3f71bf803d3c,0xbed9bf683f2dbf3d3f713eae3d3c3f80
.octa 0xbf803d7bbd7bbf803f80bd7b3d7b3f80,0x3d7b3f80bf803d7bbd7bbf803f80bd7b,0x3f733e9fbf273f42bee8bf643f7fbd9d,0x3e9fbf733f423f27bf643ee8bd9dbf7f
.octa 0xbf45bf243f7fbdbcbf243f45bdbcbf7f,0xbf243f45bdbcbf7f3f453f24bf7f3dbc,0x3ef63f61bf47bf213f763e90bf7f3ddb,0x3f61bef6bf213f473e90bf763ddb3f7f
.octa 0x3f8000003f8000003f8000003f80,0x3f8080003f8080003f8080003f808000,0xbf6ebebdbf38bf32becbbf6bbc7bbf80,0xbebd3f6ebf323f38bf6b3ecbbf803c7b
.octa 0x3f2fbf3a3f80bcfb3f3a3f2f3cfb3f80,0xbf3abf2fbcfbbf803f2fbf3a3f80bcfb,0x3ed93f68bf2d3f3dbf71beaebd3cbf80,0x3f68bed93f3d3f2dbeae3f71bf803d3c
.octa 0xbf803d7bbd7bbf803f80bd7b3d7b3f80,0x3d7b3f80bf803d7bbd7bbf803f80bd7b,0x3e9fbf733f423f27bf643ee8bd9dbf7f,0xbf73be9f3f27bf423ee83f64bf7f3d9d
.octa 0x3f453f24bf7f3dbc3f24bf453dbc3f7f,0x3f24bf453dbc3f7fbf45bf243f7fbdbc,0xbf613ef63f21bf47be903f76bddbbf7f,0x3ef63f61bf47bf213f763e90bf7f3ddb
.octa 0x3f8000003f8000003f8000003f80,0x3f8080003f8080003f8080003f808000,0xbebd3f6ebf323f38bf6b3ecbbf803c7b,0x3f6e3ebd3f383f323ecb3f6b3c7b3f80
.octa 0xbf2f3f3abf803cfbbf3abf2fbcfbbf80,0x3f3a3f2f3cfb3f80bf2f3f3abf803cfb,0xbf683ed9bf3dbf2d3eaebf713f80bd3c,0x3ed93f68bf2d3f3dbf71beaebd3cbf80
.octa 0xbf803d7bbd7bbf803f80bd7b3d7b3f80,0x3d7b3f80bf803d7bbd7bbf803f80bd7b,0xbf73be9f3f27bf423ee83f64bf7f3d9d,0xbe9f3f73bf42bf273f64bee83d9d3f7f
.octa 0xbf45bf243f7fbdbcbf243f45bdbcbf7f,0xbf243f45bdbcbf7f3f453f24bf7f3dbc,0xbef6bf613f473f21bf76be903f7fbddb,0xbf613ef63f21bf47be903f76bddbbf7f
.octa 0xbdfbbf7e3dfb3f7ebdfbbf7e3dfb3f7e,0xbf7e3dfb3f7ebdfbbf7e3dfb3f7ebdfb,0xbf78be813f4c3f1abf02bf5d3e0d3f7e,0xbe813f783f1abf4cbf5d3f023f7ebe0d
.octa 0xbf173f4f3f7dbe1cbf4fbf173e1c3f7d,0x3f4f3f17be1cbf7dbf173f4f3f7dbe1c,0x3f083f593f14bf51bf7abe633e2c3f7c,0x3f59bf08bf51bf14be633f7a3f7cbe2c
.octa 0x3f7cbe3bbe3bbf7cbf7c3e3b3e3b3f7c,0xbe3bbf7cbf7c3e3b3e3b3f7c3f7cbe3b,0x3e45bf7bbf55bf0ebf543f0f3e4b3f7b,0xbf7bbe45bf0e3f553f0f3f543f7bbe4b
.octa 0xbf57bf0abf7a3e5abf0a3f573e5a3f7a,0xbf0a3f573e5a3f7a3f573f0a3f7abe5a,0xbf503f15bf073f5abe263f7d3e6a3f79,0x3f153f503f5a3f073f7d3e263f79be6a
.octa 0xbdfbbf7e3dfb3f7ebdfbbf7e3dfb3f7e,0xbf7e3dfb3f7ebdfbbf7e3dfb3f7ebdfb,0xbe813f783f1abf4cbf5d3f023f7ebe0d,0x3f783e81bf4cbf1a3f023f5dbe0dbf7e
.octa 0x3f17bf4fbf7d3e1c3f4f3f17be1cbf7d,0xbf4fbf173e1c3f7d3f17bf4fbf7d3e1c,0xbf593f083f513f143e63bf7abf7c3e2c,0x3f083f593f14bf51bf7abe633e2c3f7c
.octa 0x3f7cbe3bbe3bbf7cbf7c3e3b3e3b3f7c,0xbe3bbf7cbf7c3e3b3e3b3f7c3f7cbe3b,0xbf7bbe45bf0e3f553f0f3f543f7bbe4b,0xbe453f7b3f553f0e3f54bf0fbe4bbf7b
.octa 0x3f573f0a3f7abe5a3f0abf57be5abf7a,0x3f0abf57be5abf7abf57bf0abf7a3e5a,0xbf15bf50bf5abf07bf7dbe26bf793e6a,0xbf503f15bf073f5abe263f7d3e6a3f79
.octa 0xbdfbbf7e3dfb3f7ebdfbbf7e3dfb3f7e,0xbf7e3dfb3f7ebdfbbf7e3dfb3f7ebdfb,0x3f783e81bf4cbf1a3f023f5dbe0dbf7e,0x3e81bf78bf1a3f4c3f5dbf02bf7e3e0d
.octa 0xbf173f4f3f7dbe1cbf4fbf173e1c3f7d,0x3f4f3f17be1cbf7dbf173f4f3f7dbe1c,0xbf08bf59bf143f513f7a3e63be2cbf7c,0xbf593f083f513f143e63bf7abf7c3e2c
.octa 0x3f7cbe3bbe3bbf7cbf7c3e3b3e3b3f7c,0xbe3bbf7cbf7c3e3b3e3b3f7c3f7cbe3b,0xbe453f7b3f553f0e3f54bf0fbe4bbf7b,0x3f7b3e453f0ebf55bf0fbf54bf7b3e4b
.octa 0xbf57bf0abf7a3e5abf0a3f573e5a3f7a,0xbf0a3f573e5a3f7a3f573f0a3f7abe5a,0x3f50bf153f07bf5a3e26bf7dbe6abf79,0xbf15bf50bf5abf07bf7dbe26bf793e6a
.octa 0xbdfbbf7e3dfb3f7ebdfbbf7e3dfb3f7e,0xbf7e3dfb3f7ebdfbbf7e3dfb3f7ebdfb,0x3e81bf78bf1a3f4c3f5dbf02bf7e3e0d,0xbf78be813f4c3f1abf02bf5d3e0d3f7e
.octa 0x3f17bf4fbf7d3e1c3f4f3f17be1cbf7d,0xbf4fbf173e1c3f7d3f17bf4fbf7d3e1c,0x3f59bf08bf51bf14be633f7a3f7cbe2c,0xbf08bf59bf143f513f7a3e63be2cbf7c
.octa 0x3f7cbe3bbe3bbf7cbf7c3e3b3e3b3f7c,0xbe3bbf7cbf7c3e3b3e3b3f7c3f7cbe3b,0x3f7b3e453f0ebf55bf0fbf54bf7b3e4b,0x3e45bf7bbf55bf0ebf543f0f3e4b3f7b
.octa 0x3f573f0a3f7abe5a3f0abf57be5abf7a,0x3f0abf57be5abf7abf57bf0abf7a3e5a,0x3f153f503f5a3f073f7d3e263f79be6a,0x3f50bf153f07bf5a3e26bf7dbe6abf79
.octa 0x3f8000003f8000003f8000003f80,0x3f8080003f8080003f8080003f808000,0x3f6e3ebb3f383f323ecd3f6b3c973f80,0x3ebbbf6e3f32bf383f6bbecd3f80bc97
.octa 0x3f2ebf3c3f80bd173f3c3f2e3d173f80,0xbf3cbf2ebd17bf803f2ebf3c3f80bd17,0xbedebf673f2bbf3f3f723eaa3d623f80,0xbf673edebf3fbf2b3eaabf723f80bd62
.octa 0xbf7f3d97bd97bf7f3f7fbd973d973f7f,0x3d973f7fbf7f3d97bd97bf7f3f7fbd97,0xbe983f75bf45bf243f63beef3dbc3f7f,0x3f753e98bf243f45beefbf633f7fbdbc
.octa 0x3f483f20bf7e3de23f20bf483de23f7e,0x3f20bf483de23f7ebf48bf203f7ebde2,0x3f5ebeffbf1c3f4b3e86bf773e043f7e,0xbeffbf5e3f4b3f1cbf77be863f7ebe04
.octa 0x3f8000003f8000003f8000003f80,0x3f8080003f8080003f8080003f808000,0x3ebbbf6e3f32bf383f6bbecd3f80bc97,0xbf6ebebbbf38bf32becdbf6bbc97bf80
.octa 0xbf2e3f3cbf803d17bf3cbf2ebd17bf80,0x3f3c3f2e3d173f80bf2e3f3cbf803d17,0x3f67bede3f3f3f2bbeaa3f72bf803d62,0xbedebf673f2bbf3f3f723eaa3d623f80
.octa 0xbf7f3d97bd97bf7f3f7fbd973d973f7f,0x3d973f7fbf7f3d97bd97bf7f3f7fbd97,0x3f753e98bf243f45beefbf633f7fbdbc,0x3e98bf753f453f24bf633eefbdbcbf7f
.octa 0xbf48bf203f7ebde2bf203f48bde2bf7e,0xbf203f48bde2bf7e3f483f20bf7e3de2,0x3eff3f5ebf4bbf1c3f773e86bf7e3e04,0x3f5ebeffbf1c3f4b3e86bf773e043f7e
.octa 0x3f8000003f8000003f8000003f80,0x3f8080003f8080003f8080003f808000,0xbf6ebebbbf38bf32becdbf6bbc97bf80,0xbebb3f6ebf323f38bf6b3ecdbf803c97
.octa 0x3f2ebf3c3f80bd173f3c3f2e3d173f80,0xbf3cbf2ebd17bf803f2ebf3c3f80bd17,0x3ede3f67bf2b3f3fbf72beaabd62bf80,0x3f67bede3f3f3f2bbeaa3f72bf803d62
.octa 0xbf7f3d97bd97bf7f3f7fbd973d973f7f,0x3d973f7fbf7f3d97bd97bf7f3f7fbd97,0x3e98bf753f453f24bf633eefbdbcbf7f,0xbf75be983f24bf453eef3f63bf7f3dbc
.octa 0x3f483f20bf7e3de23f20bf483de23f7e,0x3f20bf483de23f7ebf48bf203f7ebde2,0xbf5e3eff3f1cbf4bbe863f77be04bf7e,0x3eff3f5ebf4bbf1c3f773e86bf7e3e04
.octa 0x3f8000003f8000003f8000003f80,0x3f8080003f8080003f8080003f808000,0xbebb3f6ebf323f38bf6b3ecdbf803c97,0x3f6e3ebb3f383f323ecd3f6b3c973f80
.octa 0xbf2e3f3cbf803d17bf3cbf2ebd17bf80,0x3f3c3f2e3d173f80bf2e3f3cbf803d17,0xbf673edebf3fbf2b3eaabf723f80bd62,0x3ede3f67bf2b3f3fbf72beaabd62bf80
.octa 0xbf7f3d97bd97bf7f3f7fbd973d973f7f,0x3d973f7fbf7f3d97bd97bf7f3f7fbd97,0xbf75be983f24bf453eef3f63bf7f3dbc,0xbe983f75bf45bf243f63beef3dbc3f7f
.octa 0xbf48bf203f7ebde2bf203f48bde2bf7e,0xbf203f48bde2bf7e3f483f20bf7e3de2,0xbeffbf5e3f4b3f1cbf77be863f7ebe04,0xbf5e3eff3f1cbf4bbe863f77be04bf7e
.octa 0xbe16bf7d3e163f7dbe16bf7d3e163f7d,0xbf7d3e163f7dbe16bf7d3e163f7dbe16,0xbf79be663f503f15bf08bf593e293f7c,0xbe663f793f15bf50bf593f083f7cbe29
.octa 0xbf113f533f7cbe3bbf53bf113e3b3f7c,0x3f533f11be3bbf7cbf113f533f7cbe3b,0x3f103f543f0dbf56bf7bbe423e4e3f7b,0x3f54bf10bf56bf0dbe423f7b3f7bbe4e
.octa 0x3f7abe60be60bf7abf7a3e603e603f7a,0xbe60bf7abf7a3e603e603f7a3f7abe60,0x3e1cbf7dbf5bbf05bf4f3f173e733f79,0xbf7dbe1cbf053f5b3f173f4f3f79be73
.octa 0xbf5dbf01bf783e82bf013f5d3e823f78,0xbf013f5d3e823f783f5d3f013f78be82,0xbf493f1fbefa3f60bdee3f7e3e8c3f76,0x3f1f3f493f603efa3f7e3dee3f76be8c
.octa 0xbe16bf7d3e163f7dbe16bf7d3e163f7d,0xbf7d3e163f7dbe16bf7d3e163f7dbe16,0xbe663f793f15bf50bf593f083f7cbe29,0x3f793e66bf50bf153f083f59be29bf7c
.octa 0x3f11bf53bf7c3e3b3f533f11be3bbf7c,0xbf53bf113e3b3f7c3f11bf53bf7c3e3b,0xbf543f103f563f0d3e42bf7bbf7b3e4e,0x3f103f543f0dbf56bf7bbe423e4e3f7b
.octa 0x3f7abe60be60bf7abf7a3e603e603f7a,0xbe60bf7abf7a3e603e603f7a3f7abe60,0xbf7dbe1cbf053f5b3f173f4f3f79be73,0xbe1c3f7d3f5b3f053f4fbf17be73bf79
.octa 0x3f5d3f013f78be823f01bf5dbe82bf78,0x3f01bf5dbe82bf78bf5dbf01bf783e82,0xbf1fbf49bf60befabf7ebdeebf763e8c,0xbf493f1fbefa3f60bdee3f7e3e8c3f76
.octa 0xbe16bf7d3e163f7dbe16bf7d3e163f7d,0xbf7d3e163f7dbe16bf7d3e163f7dbe16,0x3f793e66bf50bf153f083f59be29bf7c,0x3e66bf79bf153f503f59bf08bf7c3e29
.octa 0xbf113f533f7cbe3bbf53bf113e3b3f7c,0x3f533f11be3bbf7cbf113f533f7cbe3b,0xbf10bf54bf0d3f563f7b3e42be4ebf7b,0xbf543f103f563f0d3e42bf7bbf7b3e4e
.octa 0x3f7abe60be60bf7abf7a3e603e603f7a,0xbe60bf7abf7a3e603e603f7a3f7abe60,0xbe1c3f7d3f5b3f053f4fbf17be73bf79,0x3f7d3e1c3f05bf5bbf17bf4fbf793e73
.octa 0xbf5dbf01bf783e82bf013f5d3e823f78,0xbf013f5d3e823f783f5d3f013f78be82,0x3f49bf1f3efabf603deebf7ebe8cbf76,0xbf1fbf49bf60befabf7ebdeebf763e8c
.octa 0xbe16bf7d3e163f7dbe16bf7d3e163f7d,0xbf7d3e163f7dbe16bf7d3e163f7dbe16,0x3e66bf79bf153f503f59bf08bf7c3e29,0xbf79be663f503f15bf08bf593e293f7c
.octa 0x3f11bf53bf7c3e3b3f533f11be3bbf7c,0xbf53bf113e3b3f7c3f11bf53bf7c3e3b,0x3f54bf10bf56bf0dbe423f7b3f7bbe4e,0xbf10bf54bf0d3f563f7b3e42be4ebf7b
.octa 0x3f7abe60be60bf7abf7a3e603e603f7a,0xbe60bf7abf7a3e603e603f7a3f7abe60,0x3f7d3e1c3f05bf5bbf17bf4fbf793e73,0x3e1cbf7dbf5bbf05bf4f3f173e733f79
.octa 0x3f5d3f013f78be823f01bf5dbe82bf78,0x3f01bf5dbe82bf78bf5dbf01bf783e82,0x3f1f3f493f603efa3f7e3dee3f76be8c,0x3f49bf1f3efabf603deebf7ebe8cbf76
.octa 0x3f8000003f8000003f8000003f80,0x3f8080003f8080003f8080003f808000,0x3f6f3eba3f393f313ece3f6a3cb03f80,0x3ebabf6f3f31bf393f6abece3f80bcb0
.octa 0x3f2dbf3d3f80bd303f3d3f2d3d303f80,0xbf3dbf2dbd30bf803f2dbf3d3f80bd30,0xbee2bf663f29bf403f723ea53d843f7f,0xbf663ee2bf40bf293ea5bf723f7fbd84
.octa 0xbf7f3db0bdb0bf7f3f7fbdb03db03f7f,0x3db03f7fbf7f3db0bdb0bf7f3f7fbdb0,0xbe903f76bf47bf213f61bef63ddb3f7f,0x3f763e90bf213f47bef6bf613f7fbddb
.octa 0x3f4b3f1cbf7e3e043f1cbf4b3e043f7e,0x3f1cbf4b3e043f7ebf4bbf1c3f7ebe04,0x3f5bbf04bf183f4e3e76bf793e193f7d,0xbf04bf5b3f4e3f18bf79be763f7dbe19
.octa 0x3f8000003f8000003f8000003f80,0x3f8080003f8080003f8080003f808000,0x3ebabf6f3f31bf393f6abece3f80bcb0,0xbf6fbebabf39bf31becebf6abcb0bf80
.octa 0xbf2d3f3dbf803d30bf3dbf2dbd30bf80,0x3f3d3f2d3d303f80bf2d3f3dbf803d30,0x3f66bee23f403f29bea53f72bf7f3d84,0xbee2bf663f29bf403f723ea53d843f7f
.octa 0xbf7f3db0bdb0bf7f3f7fbdb03db03f7f,0x3db03f7fbf7f3db0bdb0bf7f3f7fbdb0,0x3f763e90bf213f47bef6bf613f7fbddb,0x3e90bf763f473f21bf613ef6bddbbf7f
.octa 0xbf4bbf1c3f7ebe04bf1c3f4bbe04bf7e,0xbf1c3f4bbe04bf7e3f4b3f1cbf7e3e04,0x3f043f5bbf4ebf183f793e76bf7d3e19,0x3f5bbf04bf183f4e3e76bf793e193f7d
.octa 0x3f8000003f8000003f8000003f80,0x3f8080003f8080003f8080003f808000,0xbf6fbebabf39bf31becebf6abcb0bf80,0xbeba3f6fbf313f39bf6a3ecebf803cb0
.octa 0x3f2dbf3d3f80bd303f3d3f2d3d303f80,0xbf3dbf2dbd30bf803f2dbf3d3f80bd30,0x3ee23f66bf293f40bf72bea5bd84bf7f,0x3f66bee23f403f29bea53f72bf7f3d84
.octa 0xbf7f3db0bdb0bf7f3f7fbdb03db03f7f,0x3db03f7fbf7f3db0bdb0bf7f3f7fbdb0,0x3e90bf763f473f21bf613ef6bddbbf7f,0xbf76be903f21bf473ef63f61bf7f3ddb
.octa 0x3f4b3f1cbf7e3e043f1cbf4b3e043f7e,0x3f1cbf4b3e043f7ebf4bbf1c3f7ebe04,0xbf5b3f043f18bf4ebe763f79be19bf7d,0x3f043f5bbf4ebf183f793e76bf7d3e19
.octa 0x3f8000003f8000003f8000003f80,0x3f8080003f8080003f8080003f808000,0xbeba3f6fbf313f39bf6a3ecebf803cb0,0x3f6f3eba3f393f313ece3f6a3cb03f80
.octa 0xbf2d3f3dbf803d30bf3dbf2dbd30bf80,0x3f3d3f2d3d303f80bf2d3f3dbf803d30,0xbf663ee2bf40bf293ea5bf723f7fbd84,0x3ee23f66bf293f40bf72bea5bd84bf7f
.octa 0xbf7f3db0bdb0bf7f3f7fbdb03db03f7f,0x3db03f7fbf7f3db0bdb0bf7f3f7fbdb0,0xbf76be903f21bf473ef63f61bf7f3ddb,0xbe903f76bf47bf213f61bef63ddb3f7f
.octa 0xbf4bbf1c3f7ebe04bf1c3f4bbe04bf7e,0xbf1c3f4bbe04bf7e3f4b3f1cbf7e3e04,0xbf04bf5b3f4e3f18bf79be763f7dbe19,0xbf5b3f043f18bf4ebe763f79be19bf7d
.octa 0xbe2fbf7c3e2f3f7cbe2fbf7c3e2f3f7c,0xbf7c3e2f3f7cbe2fbf7c3e2f3f7cbe2f,0xbf7bbe4b3f543f0fbf0ebf553e453f7b,0xbe4b3f7b3f0fbf54bf553f0e3f7bbe45
.octa 0xbf0a3f573f7abe5abf57bf0a3e5a3f7a,0x3f573f0abe5abf7abf0a3f573f7abe5a,0x3f173f4f3f06bf5abf7dbe203e703f79,0x3f4fbf17bf5abf06be203f7d3f79be70
.octa 0x3f78be82be82bf78bf783e823e823f78,0xbe82bf78bf783e823e823f783f78be82,0x3de8bf7ebf60bef8bf483f1f3e8d3f76,0xbf7ebde8bef83f603f1f3f483f76be8d
.octa 0xbf63beefbf753e98beef3f633e983f75,0xbeef3f633e983f753f633eef3f75be98,0xbf413f28bee53f65bd903f7f3ea23f73,0x3f283f413f653ee53f7f3d903f73bea2
.octa 0xbe2fbf7c3e2f3f7cbe2fbf7c3e2f3f7c,0xbf7c3e2f3f7cbe2fbf7c3e2f3f7cbe2f,0xbe4b3f7b3f0fbf54bf553f0e3f7bbe45,0x3f7b3e4bbf54bf0f3f0e3f55be45bf7b
.octa 0x3f0abf57bf7a3e5a3f573f0abe5abf7a,0xbf57bf0a3e5a3f7a3f0abf57bf7a3e5a,0xbf4f3f173f5a3f063e20bf7dbf793e70,0x3f173f4f3f06bf5abf7dbe203e703f79
.octa 0x3f78be82be82bf78bf783e823e823f78,0xbe82bf78bf783e823e823f783f78be82,0xbf7ebde8bef83f603f1f3f483f76be8d,0xbde83f7e3f603ef83f48bf1fbe8dbf76
.octa 0x3f633eef3f75be983eefbf63be98bf75,0x3eefbf63be98bf75bf63beefbf753e98,0xbf28bf41bf65bee5bf7fbd90bf733ea2,0xbf413f28bee53f65bd903f7f3ea23f73
.octa 0xbe2fbf7c3e2f3f7cbe2fbf7c3e2f3f7c,0xbf7c3e2f3f7cbe2fbf7c3e2f3f7cbe2f,0x3f7b3e4bbf54bf0f3f0e3f55be45bf7b,0x3e4bbf7bbf0f3f543f55bf0ebf7b3e45
.octa 0xbf0a3f573f7abe5abf57bf0a3e5a3f7a,0x3f573f0abe5abf7abf0a3f573f7abe5a,0xbf17bf4fbf063f5a3f7d3e20be70bf79,0xbf4f3f173f5a3f063e20bf7dbf793e70
.octa 0x3f78be82be82bf78bf783e823e823f78,0xbe82bf78bf783e823e823f783f78be82,0xbde83f7e3f603ef83f48bf1fbe8dbf76,0x3f7e3de83ef8bf60bf1fbf48bf763e8d
.octa 0xbf63beefbf753e98beef3f633e983f75,0xbeef3f633e983f753f633eef3f75be98,0x3f41bf283ee5bf653d90bf7fbea2bf73,0xbf28bf41bf65bee5bf7fbd90bf733ea2
.octa 0xbe2fbf7c3e2f3f7cbe2fbf7c3e2f3f7c,0xbf7c3e2f3f7cbe2fbf7c3e2f3f7cbe2f,0x3e4bbf7bbf0f3f543f55bf0ebf7b3e45,0xbf7bbe4b3f543f0fbf0ebf553e453f7b
.octa 0x3f0abf57bf7a3e5a3f573f0abe5abf7a,0xbf57bf0a3e5a3f7a3f0abf57bf7a3e5a,0x3f4fbf17bf5abf06be203f7d3f79be70,0xbf17bf4fbf063f5a3f7d3e20be70bf79
.octa 0x3f78be82be82bf78bf783e823e823f78,0xbe82bf78bf783e823e823f783f78be82,0x3f7e3de83ef8bf60bf1fbf48bf763e8d,0x3de8bf7ebf60bef8bf483f1f3e8d3f76
.octa 0x3f633eef3f75be983eefbf63be98bf75,0x3eefbf63be98bf75bf63beefbf753e98,0x3f283f413f653ee53f7f3d903f73bea2,0x3f41bf283ee5bf653d90bf7fbea2bf73
.octa 0x3f8000003f8000003f8000003f80,0x3f8080003f8080003f8080003f808000,0x3f6f3eb83f393f313ecf3f6a3cc93f80,0x3eb8bf6f3f31bf393f6abecf3f80bcc9
.octa 0x3f2cbf3e3f80bd493f3e3f2c3d493f80,0xbf3ebf2cbd49bf803f2cbf3e3f80bd49,0xbee6bf653f27bf423f733ea13d973f7f,0xbf653ee6bf42bf273ea1bf733f7fbd97
.octa 0xbf7f3dc9bdc9bf7f3f7fbdc93dc93f7f,0x3dc93f7fbf7f3dc9bdc9bf7f3f7fbdc9,0xbe893f77bf4abf1d3f5fbefc3dfb3f7e,0x3f773e89bf1d3f4abefcbf5f3f7ebdfb
.octa 0x3f4e3f18bf7d3e163f18bf4e3e163f7d,0x3f18bf4e3e163f7dbf4ebf183f7dbe16,0x3f58bf09bf133f513e60bf7a3e2f3f7c,0xbf09bf583f513f13bf7abe603f7cbe2f
.octa 0x3f8000003f8000003f8000003f80,0x3f8080003f8080003f8080003f808000,0x3eb8bf6f3f31bf393f6abecf3f80bcc9,0xbf6fbeb8bf39bf31becfbf6abcc9bf80
.octa 0xbf2c3f3ebf803d49bf3ebf2cbd49bf80,0x3f3e3f2c3d493f80bf2c3f3ebf803d49,0x3f65bee63f423f27bea13f73bf7f3d97,0xbee6bf653f27bf423f733ea13d973f7f
.octa 0xbf7f3dc9bdc9bf7f3f7fbdc93dc93f7f,0x3dc93f7fbf7f3dc9bdc9bf7f3f7fbdc9,0x3f773e89bf1d3f4abefcbf5f3f7ebdfb,0x3e89bf773f4a3f1dbf5f3efcbdfbbf7e
.octa 0xbf4ebf183f7dbe16bf183f4ebe16bf7d,0xbf183f4ebe16bf7d3f4e3f18bf7d3e16,0x3f093f58bf51bf133f7a3e60bf7c3e2f,0x3f58bf09bf133f513e60bf7a3e2f3f7c
.octa 0x3f8000003f8000003f8000003f80,0x3f8080003f8080003f8080003f808000,0xbf6fbeb8bf39bf31becfbf6abcc9bf80,0xbeb83f6fbf313f39bf6a3ecfbf803cc9
.octa 0x3f2cbf3e3f80bd493f3e3f2c3d493f80,0xbf3ebf2cbd49bf803f2cbf3e3f80bd49,0x3ee63f65bf273f42bf73bea1bd97bf7f,0x3f65bee63f423f27bea13f73bf7f3d97
.octa 0xbf7f3dc9bdc9bf7f3f7fbdc93dc93f7f,0x3dc93f7fbf7f3dc9bdc9bf7f3f7fbdc9,0x3e89bf773f4a3f1dbf5f3efcbdfbbf7e,0xbf77be893f1dbf4a3efc3f5fbf7e3dfb
.octa 0x3f4e3f18bf7d3e163f18bf4e3e163f7d,0x3f18bf4e3e163f7dbf4ebf183f7dbe16,0xbf583f093f13bf51be603f7abe2fbf7c,0x3f093f58bf51bf133f7a3e60bf7c3e2f
.octa 0x3f8000003f8000003f8000003f80,0x3f8080003f8080003f8080003f808000,0xbeb83f6fbf313f39bf6a3ecfbf803cc9,0x3f6f3eb83f393f313ecf3f6a3cc93f80
.octa 0xbf2c3f3ebf803d49bf3ebf2cbd49bf80,0x3f3e3f2c3d493f80bf2c3f3ebf803d49,0xbf653ee6bf42bf273ea1bf733f7fbd97,0x3ee63f65bf273f42bf73bea1bd97bf7f
.octa 0xbf7f3dc9bdc9bf7f3f7fbdc93dc93f7f,0x3dc93f7fbf7f3dc9bdc9bf7f3f7fbdc9,0xbf77be893f1dbf4a3efc3f5fbf7e3dfb,0xbe893f77bf4abf1d3f5fbefc3dfb3f7e
.octa 0xbf4ebf183f7dbe16bf183f4ebe16bf7d,0xbf183f4ebe16bf7d3f4e3f18bf7d3e16,0xbf09bf583f513f13bf7abe603f7cbe2f,0xbf583f093f13bf51be603f7abe2fbf7c
.octa 0xbe48bf7b3e483f7bbe48bf7b3e483f7b,0xbf7b3e483f7bbe48bf7b3e483f7bbe48,0xbf7cbe2f3f583f09bf13bf513e603f7a,0xbe2f3f7c3f09bf58bf513f133f7abe60
.octa 0xbf043f5c3f78be79bf5cbf043e793f78,0x3f5c3f04be79bf78bf043f5c3f78be79,0x3f1d3f4a3efcbf5fbf7ebdfb3e893f77,0x3f4abf1dbf5fbefcbdfb3f7e3f77be89
.octa 0x3f75be95be95bf75bf753e953e953f75,0xbe95bf75bf753e953e953f753f75be95,0x3d97bf7fbf65bee6bf423f273ea13f73,0xbf7fbd97bee63f653f273f423f73bea1
.octa 0xbf67bedbbf713eacbedb3f673eac3f71,0xbedb3f673eac3f713f673edb3f71beac,0xbf393f31becf3f6abcc93f803eb83f6f,0x3f313f393f6a3ecf3f803cc93f6fbeb8
.octa 0xbe48bf7b3e483f7bbe48bf7b3e483f7b,0xbf7b3e483f7bbe48bf7b3e483f7bbe48,0xbe2f3f7c3f09bf58bf513f133f7abe60,0x3f7c3e2fbf58bf093f133f51be60bf7a
.octa 0x3f04bf5cbf783e793f5c3f04be79bf78,0xbf5cbf043e793f783f04bf5cbf783e79,0xbf4a3f1d3f5f3efc3dfbbf7ebf773e89,0x3f1d3f4a3efcbf5fbf7ebdfb3e893f77
.octa 0x3f75be95be95bf75bf753e953e953f75,0xbe95bf75bf753e953e953f753f75be95,0xbf7fbd97bee63f653f273f423f73bea1,0xbd973f7f3f653ee63f42bf27bea1bf73
.octa 0x3f673edb3f71beac3edbbf67beacbf71,0x3edbbf67beacbf71bf67bedbbf713eac,0xbf31bf39bf6abecfbf80bcc9bf6f3eb8,0xbf393f31becf3f6abcc93f803eb83f6f
.octa 0xbe48bf7b3e483f7bbe48bf7b3e483f7b,0xbf7b3e483f7bbe48bf7b3e483f7bbe48,0x3f7c3e2fbf58bf093f133f51be60bf7a,0x3e2fbf7cbf093f583f51bf13bf7a3e60
.octa 0xbf043f5c3f78be79bf5cbf043e793f78,0x3f5c3f04be79bf78bf043f5c3f78be79,0xbf1dbf4abefc3f5f3f7e3dfbbe89bf77,0xbf4a3f1d3f5f3efc3dfbbf7ebf773e89
.octa 0x3f75be95be95bf75bf753e953e953f75,0xbe95bf75bf753e953e953f753f75be95,0xbd973f7f3f653ee63f42bf27bea1bf73,0x3f7f3d973ee6bf65bf27bf42bf733ea1
.octa 0xbf67bedbbf713eacbedb3f673eac3f71,0xbedb3f673eac3f713f673edb3f71beac,0x3f39bf313ecfbf6a3cc9bf80beb8bf6f,0xbf31bf39bf6abecfbf80bcc9bf6f3eb8
.octa 0xbe48bf7b3e483f7bbe48bf7b3e483f7b,0xbf7b3e483f7bbe48bf7b3e483f7bbe48,0x3e2fbf7cbf093f583f51bf13bf7a3e60,0xbf7cbe2f3f583f09bf13bf513e603f7a
.octa 0x3f04bf5cbf783e793f5c3f04be79bf78,0xbf5cbf043e793f783f04bf5cbf783e79,0x3f4abf1dbf5fbefcbdfb3f7e3f77be89,0xbf1dbf4abefc3f5f3f7e3dfbbe89bf77
.octa 0x3f75be95be95bf75bf753e953e953f75,0xbe95bf75bf753e953e953f753f75be95,0x3f7f3d973ee6bf65bf27bf42bf733ea1,0x3d97bf7fbf65bee6bf423f273ea13f73
.octa 0x3f673edb3f71beac3edbbf67beacbf71,0x3edbbf67beacbf71bf67bedbbf713eac,0x3f313f393f6a3ecf3f803cc93f6fbeb8,0x3f39bf313ecfbf6a3cc9bf80beb8bf6f
.octa 0x3f8000003f8000003f8000003f80,0x3f8080003f8080003f8080003f808000,0x3f6f3eb73f3a3f303ed13f6a3ce23f80,0x3eb7bf6f3f30bf3a3f6abed13f80bce2
.octa 0x3f2bbf3f3f80bd623f3f3f2b3d623f80,0xbf3fbf2bbd62bf803f2bbf3f3f80bd62,0xbeeabf643f25bf433f743e9c3da93f7f,0xbf643eeabf43bf253e9cbf743f7fbda9
.octa 0xbf7e3de2bde2bf7e3f7ebde23de23f7e,0x3de23f7ebf7e3de2bde2bf7e3f7ebde2,0xbe813f78bf4cbf1a3f5dbf023e0d3f7e,0x3f783e81bf1a3f4cbf02bf5d3f7ebe0d
.octa 0x3f503f15bf7c3e293f15bf503e293f7c,0x3f15bf503e293f7cbf50bf153f7cbe29,0x3f55bf0ebf0f3f543e4bbf7b3e453f7b,0xbf0ebf553f543f0fbf7bbe4b3f7bbe45
.octa 0x3f8000003f8000003f8000003f80,0x3f8080003f8080003f8080003f808000,0x3eb7bf6f3f30bf3a3f6abed13f80bce2,0xbf6fbeb7bf3abf30bed1bf6abce2bf80
.octa 0xbf2b3f3fbf803d62bf3fbf2bbd62bf80,0x3f3f3f2b3d623f80bf2b3f3fbf803d62,0x3f64beea3f433f25be9c3f74bf7f3da9,0xbeeabf643f25bf433f743e9c3da93f7f
.octa 0xbf7e3de2bde2bf7e3f7ebde23de23f7e,0x3de23f7ebf7e3de2bde2bf7e3f7ebde2,0x3f783e81bf1a3f4cbf02bf5d3f7ebe0d,0x3e81bf783f4c3f1abf5d3f02be0dbf7e
.octa 0xbf50bf153f7cbe29bf153f50be29bf7c,0xbf153f50be29bf7c3f503f15bf7c3e29,0x3f0e3f55bf54bf0f3f7b3e4bbf7b3e45,0x3f55bf0ebf0f3f543e4bbf7b3e453f7b
.octa 0x3f8000003f8000003f8000003f80,0x3f8080003f8080003f8080003f808000,0xbf6fbeb7bf3abf30bed1bf6abce2bf80,0xbeb73f6fbf303f3abf6a3ed1bf803ce2
.octa 0x3f2bbf3f3f80bd623f3f3f2b3d623f80,0xbf3fbf2bbd62bf803f2bbf3f3f80bd62,0x3eea3f64bf253f43bf74be9cbda9bf7f,0x3f64beea3f433f25be9c3f74bf7f3da9
.octa 0xbf7e3de2bde2bf7e3f7ebde23de23f7e,0x3de23f7ebf7e3de2bde2bf7e3f7ebde2,0x3e81bf783f4c3f1abf5d3f02be0dbf7e,0xbf78be813f1abf4c3f023f5dbf7e3e0d
.octa 0x3f503f15bf7c3e293f15bf503e293f7c,0x3f15bf503e293f7cbf50bf153f7cbe29,0xbf553f0e3f0fbf54be4b3f7bbe45bf7b,0x3f0e3f55bf54bf0f3f7b3e4bbf7b3e45
.octa 0x3f8000003f8000003f8000003f80,0x3f8080003f8080003f8080003f808000,0xbeb73f6fbf303f3abf6a3ed1bf803ce2,0x3f6f3eb73f3a3f303ed13f6a3ce23f80
.octa 0xbf2b3f3fbf803d62bf3fbf2bbd62bf80,0x3f3f3f2b3d623f80bf2b3f3fbf803d62,0xbf643eeabf43bf253e9cbf743f7fbda9,0x3eea3f64bf253f43bf74be9cbda9bf7f
.octa 0xbf7e3de2bde2bf7e3f7ebde23de23f7e,0x3de23f7ebf7e3de2bde2bf7e3f7ebde2,0xbf78be813f1abf4c3f023f5dbf7e3e0d,0xbe813f78bf4cbf1a3f5dbf023e0d3f7e
.octa 0xbf50bf153f7cbe29bf153f50be29bf7c,0xbf153f50be29bf7c3f503f15bf7c3e29,0xbf0ebf553f543f0fbf7bbe4b3f7bbe45,0xbf553f0e3f0fbf54be4b3f7bbe45bf7b
.octa 0xbe60bf7a3e603f7abe60bf7a3e603f7a,0xbf7a3e603f7abe60bf7a3e603f7abe60,0xbf7dbe133f5c3f03bf19bf4d3e7c3f78,0xbe133f7d3f03bf5cbf4d3f193f78be7c
.octa 0xbefa3f603f76be8cbf60befa3e8c3f76,0x3f603efabe8cbf76befa3f603f76be8c,0x3f243f443eedbf63bf7fbdb63e993f74,0x3f44bf24bf63beedbdb63f7f3f74be99
.octa 0x3f72bea7bea7bf72bf723ea73ea73f72,0xbea7bf72bf723ea73ea73f723f72bea7,0x3d0abf80bf69bed4bf3b3f2f3eb43f70,0xbf80bd0abed43f693f2f3f3b3f70beb4
.octa 0xbf6cbec7bf6d3ec1bec73f6c3ec13f6d,0xbec73f6c3ec13f6d3f6c3ec73f6dbec1,0xbf313f39beba3f6f3cb03f803ece3f6a,0x3f393f313f6f3eba3f80bcb03f6abece
.octa 0xbe60bf7a3e603f7abe60bf7a3e603f7a,0xbf7a3e603f7abe60bf7a3e603f7abe60,0xbe133f7d3f03bf5cbf4d3f193f78be7c,0x3f7d3e13bf5cbf033f193f4dbe7cbf78
.octa 0x3efabf60bf763e8c3f603efabe8cbf76,0xbf60befa3e8c3f763efabf60bf763e8c,0xbf443f243f633eed3db6bf7fbf743e99,0x3f243f443eedbf63bf7fbdb63e993f74
.octa 0x3f72bea7bea7bf72bf723ea73ea73f72,0xbea7bf72bf723ea73ea73f723f72bea7,0xbf80bd0abed43f693f2f3f3b3f70beb4,0xbd0a3f803f693ed43f3bbf2fbeb4bf70
.octa 0x3f6c3ec73f6dbec13ec7bf6cbec1bf6d,0x3ec7bf6cbec1bf6dbf6cbec7bf6d3ec1,0xbf39bf31bf6fbebabf803cb0bf6a3ece,0xbf313f39beba3f6f3cb03f803ece3f6a
.octa 0xbe60bf7a3e603f7abe60bf7a3e603f7a,0xbf7a3e603f7abe60bf7a3e603f7abe60,0x3f7d3e13bf5cbf033f193f4dbe7cbf78,0x3e13bf7dbf033f5c3f4dbf19bf783e7c
.octa 0xbefa3f603f76be8cbf60befa3e8c3f76,0x3f603efabe8cbf76befa3f603f76be8c,0xbf24bf44beed3f633f7f3db6be99bf74,0xbf443f243f633eed3db6bf7fbf743e99
.octa 0x3f72bea7bea7bf72bf723ea73ea73f72,0xbea7bf72bf723ea73ea73f723f72bea7,0xbd0a3f803f693ed43f3bbf2fbeb4bf70,0x3f803d0a3ed4bf69bf2fbf3bbf703eb4
.octa 0xbf6cbec7bf6d3ec1bec73f6c3ec13f6d,0xbec73f6c3ec13f6d3f6c3ec73f6dbec1,0x3f31bf393ebabf6fbcb0bf80becebf6a,0xbf39bf31bf6fbebabf803cb0bf6a3ece
.octa 0xbe60bf7a3e603f7abe60bf7a3e603f7a,0xbf7a3e603f7abe60bf7a3e603f7abe60,0x3e13bf7dbf033f5c3f4dbf19bf783e7c,0xbf7dbe133f5c3f03bf19bf4d3e7c3f78
.octa 0x3efabf60bf763e8c3f603efabe8cbf76,0xbf60befa3e8c3f763efabf60bf763e8c,0x3f44bf24bf63beedbdb63f7f3f74be99,0xbf24bf44beed3f633f7f3db6be99bf74
.octa 0x3f72bea7bea7bf72bf723ea73ea73f72,0xbea7bf72bf723ea73ea73f723f72bea7,0x3f803d0a3ed4bf69bf2fbf3bbf703eb4,0x3d0abf80bf69bed4bf3b3f2f3eb43f70
.octa 0x3f6c3ec73f6dbec13ec7bf6cbec1bf6d,0x3ec7bf6cbec1bf6dbf6cbec7bf6d3ec1,0x3f393f313f6f3eba3f80bcb03f6abece,0x3f31bf393ebabf6fbcb0bf80becebf6a
.octa 0x3f8000003f8000003f8000003f80,0x3f8080003f8080003f8080003f808000,0x3f6f3eb53f3a3f2f3ed23f693cfb3f80,0x3eb5bf6f3f2fbf3a3f69bed23f80bcfb
.octa 0x3f2abf403f80bd7b3f403f2a3d7b3f80,0xbf40bf2abd7bbf803f2abf403f80bd7b,0xbeefbf633f24bf453f753e983dbc3f7f,0xbf633eefbf45bf243e98bf753f7fbdbc
.octa 0xbf7e3dfbbdfbbf7e3f7ebdfb3dfb3f7e,0x3dfb3f7ebf7e3dfbbdfbbf7e3f7ebdfb,0xbe733f79bf4fbf173f5bbf053e1c3f7d,0x3f793e73bf173f4fbf05bf5b3f7dbe1c
.octa 0x3f533f11bf7c3e3b3f11bf533e3b3f7c,0x3f11bf533e3b3f7cbf53bf113f7cbe3b,0x3f52bf12bf0a3f573e35bf7c3e5a3f7a,0xbf12bf523f573f0abf7cbe353f7abe5a
.octa 0x3f8000003f8000003f8000003f80,0x3f8080003f8080003f8080003f808000,0x3eb5bf6f3f2fbf3a3f69bed23f80bcfb,0xbf6fbeb5bf3abf2fbed2bf69bcfbbf80
.octa 0xbf2a3f40bf803d7bbf40bf2abd7bbf80,0x3f403f2a3d7b3f80bf2a3f40bf803d7b,0x3f63beef3f453f24be983f75bf7f3dbc,0xbeefbf633f24bf453f753e983dbc3f7f
.octa 0xbf7e3dfbbdfbbf7e3f7ebdfb3dfb3f7e,0x3dfb3f7ebf7e3dfbbdfbbf7e3f7ebdfb,0x3f793e73bf173f4fbf05bf5b3f7dbe1c,0x3e73bf793f4f3f17bf5b3f05be1cbf7d
.octa 0xbf53bf113f7cbe3bbf113f53be3bbf7c,0xbf113f53be3bbf7c3f533f11bf7c3e3b,0x3f123f52bf57bf0a3f7c3e35bf7a3e5a,0x3f52bf12bf0a3f573e35bf7c3e5a3f7a
.octa 0x3f8000003f8000003f8000003f80,0x3f8080003f8080003f8080003f808000,0xbf6fbeb5bf3abf2fbed2bf69bcfbbf80,0xbeb53f6fbf2f3f3abf693ed2bf803cfb
.octa 0x3f2abf403f80bd7b3f403f2a3d7b3f80,0xbf40bf2abd7bbf803f2abf403f80bd7b,0x3eef3f63bf243f45bf75be98bdbcbf7f,0x3f63beef3f453f24be983f75bf7f3dbc
.octa 0xbf7e3dfbbdfbbf7e3f7ebdfb3dfb3f7e,0x3dfb3f7ebf7e3dfbbdfbbf7e3f7ebdfb,0x3e73bf793f4f3f17bf5b3f05be1cbf7d,0xbf79be733f17bf4f3f053f5bbf7d3e1c
.octa 0x3f533f11bf7c3e3b3f11bf533e3b3f7c,0x3f11bf533e3b3f7cbf53bf113f7cbe3b,0xbf523f123f0abf57be353f7cbe5abf7a,0x3f123f52bf57bf0a3f7c3e35bf7a3e5a
.octa 0x3f8000003f8000003f8000003f80,0x3f8080003f8080003f8080003f808000,0xbeb53f6fbf2f3f3abf693ed2bf803cfb,0x3f6f3eb53f3a3f2f3ed23f693cfb3f80
.octa 0xbf2a3f40bf803d7bbf40bf2abd7bbf80,0x3f403f2a3d7b3f80bf2a3f40bf803d7b,0xbf633eefbf45bf243e98bf753f7fbdbc,0x3eef3f63bf243f45bf75be98bdbcbf7f
.octa 0xbf7e3dfbbdfbbf7e3f7ebdfb3dfb3f7e,0x3dfb3f7ebf7e3dfbbdfbbf7e3f7ebdfb,0xbf79be733f17bf4f3f053f5bbf7d3e1c,0xbe733f79bf4fbf173f5bbf053e1c3f7d
.octa 0xbf53bf113f7cbe3bbf113f53be3bbf7c,0xbf113f53be3bbf7c3f533f11bf7c3e3b,0xbf12bf523f573f0abf7cbe353f7abe5a,0xbf523f123f0abf57be353f7cbe5abf7a
.octa 0xbe79bf783e793f78be79bf783e793f78,0xbf783e793f78be79bf783e793f78be79,0xbf7ebdee3f603efabf1fbf493e8c3f76,0xbdee3f7e3efabf60bf493f1f3f76be8c
.octa 0xbeec3f633f74be9bbf63beec3e9b3f74,0x3f633eecbe9bbf74beec3f633f74be9b,0x3f2b3f3f3edebf67bf80bd623eaa3f72,0x3f3fbf2bbf67bedebd623f803f72beaa
.octa 0x3f6fbeb8beb8bf6fbf6f3eb83eb83f6f,0xbeb8bf6fbf6f3eb83eb83f6f3f6fbeb8,0xbbc9bf80bf6dbec1bf343f363ec73f6c,0xbf803bc9bec13f6d3f363f343f6cbec7
.octa 0xbf70beb2bf693ed5beb23f703ed53f69,0xbeb23f703ed53f693f703eb23f69bed5,0xbf283f41bea43f733d8a3f7f3ee33f65,0x3f413f283f733ea43f7fbd8a3f65bee3
.octa 0xbe79bf783e793f78be79bf783e793f78,0xbf783e793f78be79bf783e793f78be79,0xbdee3f7e3efabf60bf493f1f3f76be8c,0x3f7e3deebf60befa3f1f3f49be8cbf76
.octa 0x3eecbf63bf743e9b3f633eecbe9bbf74,0xbf63beec3e9b3f743eecbf63bf743e9b,0xbf3f3f2b3f673ede3d62bf80bf723eaa,0x3f2b3f3f3edebf67bf80bd623eaa3f72
.octa 0x3f6fbeb8beb8bf6fbf6f3eb83eb83f6f,0xbeb8bf6fbf6f3eb83eb83f6f3f6fbeb8,0xbf803bc9bec13f6d3f363f343f6cbec7,0x3bc93f803f6d3ec13f34bf36bec7bf6c
.octa 0x3f703eb23f69bed53eb2bf70bed5bf69,0x3eb2bf70bed5bf69bf70beb2bf693ed5,0xbf41bf28bf73bea4bf7f3d8abf653ee3,0xbf283f41bea43f733d8a3f7f3ee33f65
.octa 0xbe79bf783e793f78be79bf783e793f78,0xbf783e793f78be79bf783e793f78be79,0x3f7e3deebf60befa3f1f3f49be8cbf76,0x3deebf7ebefa3f603f49bf1fbf763e8c
.octa 0xbeec3f633f74be9bbf63beec3e9b3f74,0x3f633eecbe9bbf74beec3f633f74be9b,0xbf2bbf3fbede3f673f803d62beaabf72,0xbf3f3f2b3f673ede3d62bf80bf723eaa
.octa 0x3f6fbeb8beb8bf6fbf6f3eb83eb83f6f,0xbeb8bf6fbf6f3eb83eb83f6f3f6fbeb8,0x3bc93f803f6d3ec13f34bf36bec7bf6c,0x3f80bbc93ec1bf6dbf36bf34bf6c3ec7
.octa 0xbf70beb2bf693ed5beb23f703ed53f69,0xbeb23f703ed53f693f703eb23f69bed5,0x3f28bf413ea4bf73bd8abf7fbee3bf65,0xbf41bf28bf73bea4bf7f3d8abf653ee3
.octa 0xbe79bf783e793f78be79bf783e793f78,0xbf783e793f78be79bf783e793f78be79,0x3deebf7ebefa3f603f49bf1fbf763e8c,0xbf7ebdee3f603efabf1fbf493e8c3f76
.octa 0x3eecbf63bf743e9b3f633eecbe9bbf74,0xbf63beec3e9b3f743eecbf63bf743e9b,0x3f3fbf2bbf67bedebd623f803f72beaa,0xbf2bbf3fbede3f673f803d62beaabf72
.octa 0x3f6fbeb8beb8bf6fbf6f3eb83eb83f6f,0xbeb8bf6fbf6f3eb83eb83f6f3f6fbeb8,0x3f80bbc93ec1bf6dbf36bf34bf6c3ec7,0xbbc9bf80bf6dbec1bf343f363ec73f6c
.octa 0x3f703eb23f69bed53eb2bf70bed5bf69,0x3eb2bf70bed5bf69bf70beb2bf693ed5,0x3f413f283f733ea43f7fbd8a3f65bee3,0x3f28bf413ea4bf73bd8abf7fbee3bf65
.octa 0x3f8000003f8000003f8000003f80,0x3f8080003f8080003f8080003f808000,0x3f703eb43f3b3f2f3ed43f693d0a3f80,0x3eb4bf703f2fbf3b3f69bed43f80bd0a
.octa 0x3f28bf413f7fbd8a3f413f283d8a3f7f,0xbf41bf28bd8abf7f3f28bf413f7fbd8a,0xbef3bf613f22bf463f753e933dcf3f7f,0xbf613ef3bf46bf223e93bf753f7fbdcf
.octa 0xbf7e3e0abe0abf7e3f7ebe0a3e0a3f7e,0x3e0a3f7ebf7e3e0abe0abf7e3f7ebe0a,0xbe633f7abf51bf143f59bf083e2c3f7c,0x3f7a3e63bf143f51bf08bf593f7cbe2c
.octa 0x3f563f0dbf7b3e4e3f0dbf563e4e3f7b,0x3f0dbf563e4e3f7bbf56bf0d3f7bbe4e,0x3f4fbf17bf063f5a3e20bf7d3e703f79,0xbf17bf4f3f5a3f06bf7dbe203f79be70
.octa 0x3f8000003f8000003f8000003f80,0x3f8080003f8080003f8080003f808000,0x3eb4bf703f2fbf3b3f69bed43f80bd0a,0xbf70beb4bf3bbf2fbed4bf69bd0abf80
.octa 0xbf283f41bf7f3d8abf41bf28bd8abf7f,0x3f413f283d8a3f7fbf283f41bf7f3d8a,0x3f61bef33f463f22be933f75bf7f3dcf,0xbef3bf613f22bf463f753e933dcf3f7f
.octa 0xbf7e3e0abe0abf7e3f7ebe0a3e0a3f7e,0x3e0a3f7ebf7e3e0abe0abf7e3f7ebe0a,0x3f7a3e63bf143f51bf08bf593f7cbe2c,0x3e63bf7a3f513f14bf593f08be2cbf7c
.octa 0xbf56bf0d3f7bbe4ebf0d3f56be4ebf7b,0xbf0d3f56be4ebf7b3f563f0dbf7b3e4e,0x3f173f4fbf5abf063f7d3e20bf793e70,0x3f4fbf17bf063f5a3e20bf7d3e703f79
.octa 0x3f8000003f8000003f8000003f80,0x3f8080003f8080003f8080003f808000,0xbf70beb4bf3bbf2fbed4bf69bd0abf80,0xbeb43f70bf2f3f3bbf693ed4bf803d0a
.octa 0x3f28bf413f7fbd8a3f413f283d8a3f7f,0xbf41bf28bd8abf7f3f28bf413f7fbd8a,0x3ef33f61bf223f46bf75be93bdcfbf7f,0x3f61bef33f463f22be933f75bf7f3dcf
.octa 0xbf7e3e0abe0abf7e3f7ebe0a3e0a3f7e,0x3e0a3f7ebf7e3e0abe0abf7e3f7ebe0a,0x3e63bf7a3f513f14bf593f08be2cbf7c,0xbf7abe633f14bf513f083f59bf7c3e2c
.octa 0x3f563f0dbf7b3e4e3f0dbf563e4e3f7b,0x3f0dbf563e4e3f7bbf56bf0d3f7bbe4e,0xbf4f3f173f06bf5abe203f7dbe70bf79,0x3f173f4fbf5abf063f7d3e20bf793e70
.octa 0x3f8000003f8000003f8000003f80,0x3f8080003f8080003f8080003f808000,0xbeb43f70bf2f3f3bbf693ed4bf803d0a,0x3f703eb43f3b3f2f3ed43f693d0a3f80
.octa 0xbf283f41bf7f3d8abf41bf28bd8abf7f,0x3f413f283d8a3f7fbf283f41bf7f3d8a,0xbf613ef3bf46bf223e93bf753f7fbdcf,0x3ef33f61bf223f46bf75be93bdcfbf7f
.octa 0xbf7e3e0abe0abf7e3f7ebe0a3e0a3f7e,0x3e0a3f7ebf7e3e0abe0abf7e3f7ebe0a,0xbf7abe633f14bf513f083f59bf7c3e2c,0xbe633f7abf51bf143f59bf083e2c3f7c
.octa 0xbf56bf0d3f7bbe4ebf0d3f56be4ebf7b,0xbf0d3f56be4ebf7b3f563f0dbf7b3e4e,0xbf17bf4f3f5a3f06bf7dbe203f79be70,0xbf4f3f173f06bf5abe203f7dbe70bf79
.octa 0xbe89bf773e893f77be89bf773e893f77,0xbf773e893f77be89bf773e893f77be89,0xbf7fbdb63f633eedbf24bf443e993f74,0xbdb63f7f3eedbf63bf443f243f74be99
.octa 0xbede3f673f72beaabf67bede3eaa3f72,0x3f673edebeaabf72bede3f673f72beaa,0x3f313f393ecebf6abf80bcb03eba3f6f,0x3f39bf31bf6abecebcb03f803f6fbeba
.octa 0x3f6bbecabecabf6bbf6b3eca3eca3f6b,0xbecabf6bbf6b3eca3eca3f6b3f6bbeca,0xbd3cbf80bf71beaebf2d3f3d3ed93f68,0xbf803d3cbeae3f713f3d3f2d3f68bed9
.octa 0xbf74be9ebf643ee9be9e3f743ee93f64,0xbe9e3f743ee93f643f743e9e3f64bee9,0xbf1f3f48be8d3f763de83f7e3ef83f60,0x3f483f1f3f763e8d3f7ebde83f60bef8
.octa 0xbe89bf773e893f77be89bf773e893f77,0xbf773e893f77be89bf773e893f77be89,0xbdb63f7f3eedbf63bf443f243f74be99,0x3f7f3db6bf63beed3f243f44be99bf74
.octa 0x3edebf67bf723eaa3f673edebeaabf72,0xbf67bede3eaa3f723edebf67bf723eaa,0xbf393f313f6a3ece3cb0bf80bf6f3eba,0x3f313f393ecebf6abf80bcb03eba3f6f
.octa 0x3f6bbecabecabf6bbf6b3eca3eca3f6b,0xbecabf6bbf6b3eca3eca3f6b3f6bbeca,0xbf803d3cbeae3f713f3d3f2d3f68bed9,0x3d3c3f803f713eae3f2dbf3dbed9bf68
.octa 0x3f743e9e3f64bee93e9ebf74bee9bf64,0x3e9ebf74bee9bf64bf74be9ebf643ee9,0xbf48bf1fbf76be8dbf7e3de8bf603ef8,0xbf1f3f48be8d3f763de83f7e3ef83f60
.octa 0xbe89bf773e893f77be89bf773e893f77,0xbf773e893f77be89bf773e893f77be89,0x3f7f3db6bf63beed3f243f44be99bf74,0x3db6bf7fbeed3f633f44bf24bf743e99
.octa 0xbede3f673f72beaabf67bede3eaa3f72,0x3f673edebeaabf72bede3f673f72beaa,0xbf31bf39bece3f6a3f803cb0bebabf6f,0xbf393f313f6a3ece3cb0bf80bf6f3eba
.octa 0x3f6bbecabecabf6bbf6b3eca3eca3f6b,0xbecabf6bbf6b3eca3eca3f6b3f6bbeca,0x3d3c3f803f713eae3f2dbf3dbed9bf68,0x3f80bd3c3eaebf71bf3dbf2dbf683ed9
.octa 0xbf74be9ebf643ee9be9e3f743ee93f64,0xbe9e3f743ee93f643f743e9e3f64bee9,0x3f1fbf483e8dbf76bde8bf7ebef8bf60,0xbf48bf1fbf76be8dbf7e3de8bf603ef8
.octa 0xbe89bf773e893f77be89bf773e893f77,0xbf773e893f77be89bf773e893f77be89,0x3db6bf7fbeed3f633f44bf24bf743e99,0xbf7fbdb63f633eedbf24bf443e993f74
.octa 0x3edebf67bf723eaa3f673edebeaabf72,0xbf67bede3eaa3f723edebf67bf723eaa,0x3f39bf31bf6abecebcb03f803f6fbeba,0xbf31bf39bece3f6a3f803cb0bebabf6f
.octa 0x3f6bbecabecabf6bbf6b3eca3eca3f6b,0xbecabf6bbf6b3eca3eca3f6b3f6bbeca,0x3f80bd3c3eaebf71bf3dbf2dbf683ed9,0xbd3cbf80bf71beaebf2d3f3d3ed93f68
.octa 0x3f743e9e3f64bee93e9ebf74bee9bf64,0x3e9ebf74bee9bf64bf74be9ebf643ee9,0x3f483f1f3f763e8d3f7ebde83f60bef8,0x3f1fbf483e8dbf76bde8bf7ebef8bf60
.octa 0x3f8000003f8000003f8000003f80,0x3f8080003f8080003f8080003f808000,0x3f703eb23f3c3f2e3ed53f693d173f80,0x3eb2bf703f2ebf3c3f69bed53f80bd17
.octa 0x3f27bf423f7fbd973f423f273d973f7f,0xbf42bf27bd97bf7f3f27bf423f7fbd97,0xbef7bf603f20bf483f763e8f3de23f7e,0xbf603ef7bf48bf203e8fbf763f7ebde2
.octa 0xbf7d3e16be16bf7d3f7dbe163e163f7d,0x3e163f7dbf7d3e16be16bf7d3f7dbe16,0xbe543f7abf53bf113f57bf0c3e3b3f7c,0x3f7a3e54bf113f53bf0cbf573f7cbe3b
.octa 0x3f583f09bf7a3e603f09bf583e603f7a,0x3f09bf583e603f7abf58bf093f7abe60,0x3f4cbf1bbf013f5d3e0abf7e3e823f78,0xbf1bbf4c3f5d3f01bf7ebe0a3f78be82
.octa 0x3f8000003f8000003f8000003f80,0x3f8080003f8080003f8080003f808000,0x3eb2bf703f2ebf3c3f69bed53f80bd17,0xbf70beb2bf3cbf2ebed5bf69bd17bf80
.octa 0xbf273f42bf7f3d97bf42bf27bd97bf7f,0x3f423f273d973f7fbf273f42bf7f3d97,0x3f60bef73f483f20be8f3f76bf7e3de2,0xbef7bf603f20bf483f763e8f3de23f7e
.octa 0xbf7d3e16be16bf7d3f7dbe163e163f7d,0x3e163f7dbf7d3e16be16bf7d3f7dbe16,0x3f7a3e54bf113f53bf0cbf573f7cbe3b,0x3e54bf7a3f533f11bf573f0cbe3bbf7c
.octa 0xbf58bf093f7abe60bf093f58be60bf7a,0xbf093f58be60bf7a3f583f09bf7a3e60,0x3f1b3f4cbf5dbf013f7e3e0abf783e82,0x3f4cbf1bbf013f5d3e0abf7e3e823f78
.octa 0x3f8000003f8000003f8000003f80,0x3f8080003f8080003f8080003f808000,0xbf70beb2bf3cbf2ebed5bf69bd17bf80,0xbeb23f70bf2e3f3cbf693ed5bf803d17
.octa 0x3f27bf423f7fbd973f423f273d973f7f,0xbf42bf27bd97bf7f3f27bf423f7fbd97,0x3ef73f60bf203f48bf76be8fbde2bf7e,0x3f60bef73f483f20be8f3f76bf7e3de2
.octa 0xbf7d3e16be16bf7d3f7dbe163e163f7d,0x3e163f7dbf7d3e16be16bf7d3f7dbe16,0x3e54bf7a3f533f11bf573f0cbe3bbf7c,0xbf7abe543f11bf533f0c3f57bf7c3e3b
.octa 0x3f583f09bf7a3e603f09bf583e603f7a,0x3f09bf583e603f7abf58bf093f7abe60,0xbf4c3f1b3f01bf5dbe0a3f7ebe82bf78,0x3f1b3f4cbf5dbf013f7e3e0abf783e82
.octa 0x3f8000003f8000003f8000003f80,0x3f8080003f8080003f8080003f808000,0xbeb23f70bf2e3f3cbf693ed5bf803d17,0x3f703eb23f3c3f2e3ed53f693d173f80
.octa 0xbf273f42bf7f3d97bf42bf27bd97bf7f,0x3f423f273d973f7fbf273f42bf7f3d97,0xbf603ef7bf48bf203e8fbf763f7ebde2,0x3ef73f60bf203f48bf76be8fbde2bf7e
.octa 0xbf7d3e16be16bf7d3f7dbe163e163f7d,0x3e163f7dbf7d3e16be16bf7d3f7dbe16,0xbf7abe543f11bf533f0c3f57bf7c3e3b,0xbe543f7abf53bf113f57bf0c3e3b3f7c
.octa 0xbf58bf093f7abe60bf093f58be60bf7a,0xbf093f58be60bf7a3f583f09bf7a3e60,0xbf1bbf4c3f5d3f01bf7ebe0a3f78be82,0xbf4c3f1b3f01bf5dbe0a3f7ebe82bf78
.octa 0xbe95bf753e953f75be95bf753e953f75,0xbf753e953f75be95bf753e953f75be95,0xbf80bd7b3f663ee1bf2abf403ea73f72,0xbd7b3f803ee1bf66bf403f2a3f72bea7
.octa 0xbecf3f6a3f6fbeb8bf6abecf3eb83f6f,0x3f6a3ecfbeb8bf6fbecf3f6a3f6fbeb8,0x3f373f333ebebf6ebf803c493eca3f6b,0x3f33bf37bf6ebebe3c493f803f6bbeca
.octa 0x3f67bedbbedbbf67bf673edb3edb3f67,0xbedbbf67bf673edb3edb3f673f67bedb,0xbdb0bf7fbf74be9bbf253f443eec3f63,0xbf7f3db0be9b3f743f443f253f63beec
.octa 0xbf77be89bf5f3efcbe893f773efc3f5f,0xbe893f773efc3f5f3f773e893f5fbefc,0xbf163f4fbe6d3f793e233f7d3f063f5a,0x3f4f3f163f793e6d3f7dbe233f5abf06
.octa 0xbe95bf753e953f75be95bf753e953f75,0xbf753e953f75be95bf753e953f75be95,0xbd7b3f803ee1bf66bf403f2a3f72bea7,0x3f803d7bbf66bee13f2a3f40bea7bf72
.octa 0x3ecfbf6abf6f3eb83f6a3ecfbeb8bf6f,0xbf6abecf3eb83f6f3ecfbf6abf6f3eb8,0xbf333f373f6e3ebebc49bf80bf6b3eca,0x3f373f333ebebf6ebf803c493eca3f6b
.octa 0x3f67bedbbedbbf67bf673edb3edb3f67,0xbedbbf67bf673edb3edb3f673f67bedb,0xbf7f3db0be9b3f743f443f253f63beec,0x3db03f7f3f743e9b3f25bf44beecbf63
.octa 0x3f773e893f5fbefc3e89bf77befcbf5f,0x3e89bf77befcbf5fbf77be89bf5f3efc,0xbf4fbf16bf79be6dbf7d3e23bf5a3f06,0xbf163f4fbe6d3f793e233f7d3f063f5a
.octa 0xbe95bf753e953f75be95bf753e953f75,0xbf753e953f75be95bf753e953f75be95,0x3f803d7bbf66bee13f2a3f40bea7bf72,0x3d7bbf80bee13f663f40bf2abf723ea7
.octa 0xbecf3f6a3f6fbeb8bf6abecf3eb83f6f,0x3f6a3ecfbeb8bf6fbecf3f6a3f6fbeb8,0xbf37bf33bebe3f6e3f80bc49becabf6b,0xbf333f373f6e3ebebc49bf80bf6b3eca
.octa 0x3f67bedbbedbbf67bf673edb3edb3f67,0xbedbbf67bf673edb3edb3f673f67bedb,0x3db03f7f3f743e9b3f25bf44beecbf63,0x3f7fbdb03e9bbf74bf44bf25bf633eec
.octa 0xbf77be89bf5f3efcbe893f773efc3f5f,0xbe893f773efc3f5f3f773e893f5fbefc,0x3f16bf4f3e6dbf79be23bf7dbf06bf5a,0xbf4fbf16bf79be6dbf7d3e23bf5a3f06
.octa 0xbe95bf753e953f75be95bf753e953f75,0xbf753e953f75be95bf753e953f75be95,0x3d7bbf80bee13f663f40bf2abf723ea7,0xbf80bd7b3f663ee1bf2abf403ea73f72
.octa 0x3ecfbf6abf6f3eb83f6a3ecfbeb8bf6f,0xbf6abecf3eb83f6f3ecfbf6abf6f3eb8,0x3f33bf37bf6ebebe3c493f803f6bbeca,0xbf37bf33bebe3f6e3f80bc49becabf6b
.octa 0x3f67bedbbedbbf67bf673edb3edb3f67,0xbedbbf67bf673edb3edb3f673f67bedb,0x3f7fbdb03e9bbf74bf44bf25bf633eec,0xbdb0bf7fbf74be9bbf253f443eec3f63
.octa 0x3f773e893f5fbefc3e89bf77befcbf5f,0x3e89bf77befcbf5fbf77be89bf5f3efc,0x3f4f3f163f793e6d3f7dbe233f5abf06,0x3f16bf4f3e6dbf79be23bf7dbf06bf5a
.octa 0x3f8000003f8000003f8000003f80,0x3f8080003f8080003f8080003f808000,0x3f703eb13f3c3f2e3ed73f683d233f80,0x3eb1bf703f2ebf3c3f68bed73f80bd23
.octa 0x3f26bf433f7fbda33f433f263da33f7f,0xbf43bf26bda3bf7f3f26bf433f7fbda3,0xbefbbf5f3f1ebf493f773e8a3df43f7e,0xbf5f3efbbf49bf1e3e8abf773f7ebdf4
.octa 0xbf7d3e23be23bf7d3f7dbe233e233f7d,0x3e233f7dbf7d3e23be23bf7d3f7dbe23,0xbe453f7bbf55bf0e3f54bf0f3e4b3f7b,0x3f7b3e45bf0e3f55bf0fbf543f7bbe4b
.octa 0x3f5b3f05bf793e733f05bf5b3e733f79,0x3f05bf5b3e733f79bf5bbf053f79be73,0x3f48bf1fbef83f603de8bf7e3e8d3f76,0xbf1fbf483f603ef8bf7ebde83f76be8d
.octa 0x3f8000003f8000003f8000003f80,0x3f8080003f8080003f8080003f808000,0x3eb1bf703f2ebf3c3f68bed73f80bd23,0xbf70beb1bf3cbf2ebed7bf68bd23bf80
.octa 0xbf263f43bf7f3da3bf43bf26bda3bf7f,0x3f433f263da33f7fbf263f43bf7f3da3,0x3f5fbefb3f493f1ebe8a3f77bf7e3df4,0xbefbbf5f3f1ebf493f773e8a3df43f7e
.octa 0xbf7d3e23be23bf7d3f7dbe233e233f7d,0x3e233f7dbf7d3e23be23bf7d3f7dbe23,0x3f7b3e45bf0e3f55bf0fbf543f7bbe4b,0x3e45bf7b3f553f0ebf543f0fbe4bbf7b
.octa 0xbf5bbf053f79be73bf053f5bbe73bf79,0xbf053f5bbe73bf793f5b3f05bf793e73,0x3f1f3f48bf60bef83f7e3de8bf763e8d,0x3f48bf1fbef83f603de8bf7e3e8d3f76
.octa 0x3f8000003f8000003f8000003f80,0x3f8080003f8080003f8080003f808000,0xbf70beb1bf3cbf2ebed7bf68bd23bf80,0xbeb13f70bf2e3f3cbf683ed7bf803d23
.octa 0x3f26bf433f7fbda33f433f263da33f7f,0xbf43bf26bda3bf7f3f26bf433f7fbda3,0x3efb3f5fbf1e3f49bf77be8abdf4bf7e,0x3f5fbefb3f493f1ebe8a3f77bf7e3df4
.octa 0xbf7d3e23be23bf7d3f7dbe233e233f7d,0x3e233f7dbf7d3e23be23bf7d3f7dbe23,0x3e45bf7b3f553f0ebf543f0fbe4bbf7b,0xbf7bbe453f0ebf553f0f3f54bf7b3e4b
.octa 0x3f5b3f05bf793e733f05bf5b3e733f79,0x3f05bf5b3e733f79bf5bbf053f79be73,0xbf483f1f3ef8bf60bde83f7ebe8dbf76,0x3f1f3f48bf60bef83f7e3de8bf763e8d
.octa 0x3f8000003f8000003f8000003f80,0x3f8080003f8080003f8080003f808000,0xbeb13f70bf2e3f3cbf683ed7bf803d23,0x3f703eb13f3c3f2e3ed73f683d233f80
.octa 0xbf263f43bf7f3da3bf43bf26bda3bf7f,0x3f433f263da33f7fbf263f43bf7f3da3,0xbf5f3efbbf49bf1e3e8abf773f7ebdf4,0x3efb3f5fbf1e3f49bf77be8abdf4bf7e
.octa 0xbf7d3e23be23bf7d3f7dbe233e233f7d,0x3e233f7dbf7d3e23be23bf7d3f7dbe23,0xbf7bbe453f0ebf553f0f3f54bf7b3e4b,0xbe453f7bbf55bf0e3f54bf0f3e4b3f7b
.octa 0xbf5bbf053f79be73bf053f5bbe73bf79,0xbf053f5bbe73bf793f5b3f05bf793e73,0xbf1fbf483f603ef8bf7ebde83f76be8d,0xbf483f1f3ef8bf60bde83f7ebe8dbf76
.octa 0xbea1bf733ea13f73bea1bf733ea13f73,0xbf733ea13f73bea1bf733ea13f73bea1,0xbf80bd0a3f693ed4bf2fbf3b3eb43f70,0xbd0a3f803ed4bf69bf3b3f2f3f70beb4
.octa 0xbec13f6d3f6cbec7bf6dbec13ec73f6c,0x3f6d3ec1bec7bf6cbec13f6d3f6cbec7,0x3f3d3f2d3eaebf71bf803d3c3ed93f68,0x3f2dbf3dbf71beae3d3c3f803f68bed9
.octa 0x3f63beecbeecbf63bf633eec3eec3f63,0xbeecbf63bf633eec3eec3f633f63beec,0xbe00bf7ebf77be87bf1d3f4a3efe3f5e,0xbf7e3e00be873f773f4a3f1d3f5ebefe
.octa 0xbf79be66bf593f08be663f793f083f59,0xbe663f793f083f593f793e663f59bf08,0xbf0c3f56be3f3f7c3e513f7b3f103f54,0x3f563f0c3f7c3e3f3f7bbe513f54bf10
.octa 0xbea1bf733ea13f73bea1bf733ea13f73,0xbf733ea13f73bea1bf733ea13f73bea1,0xbd0a3f803ed4bf69bf3b3f2f3f70beb4,0x3f803d0abf69bed43f2f3f3bbeb4bf70
.octa 0x3ec1bf6dbf6c3ec73f6d3ec1bec7bf6c,0xbf6dbec13ec73f6c3ec1bf6dbf6c3ec7,0xbf2d3f3d3f713eaebd3cbf80bf683ed9,0x3f3d3f2d3eaebf71bf803d3c3ed93f68
.octa 0x3f63beecbeecbf63bf633eec3eec3f63,0xbeecbf63bf633eec3eec3f633f63beec,0xbf7e3e00be873f773f4a3f1d3f5ebefe,0x3e003f7e3f773e873f1dbf4abefebf5e
.octa 0x3f793e663f59bf083e66bf79bf08bf59,0x3e66bf79bf08bf59bf79be66bf593f08,0xbf56bf0cbf7cbe3fbf7b3e51bf543f10,0xbf0c3f56be3f3f7c3e513f7b3f103f54
.octa 0xbea1bf733ea13f73bea1bf733ea13f73,0xbf733ea13f73bea1bf733ea13f73bea1,0x3f803d0abf69bed43f2f3f3bbeb4bf70,0x3d0abf80bed43f693f3bbf2fbf703eb4
.octa 0xbec13f6d3f6cbec7bf6dbec13ec73f6c,0x3f6d3ec1bec7bf6cbec13f6d3f6cbec7,0xbf3dbf2dbeae3f713f80bd3cbed9bf68,0xbf2d3f3d3f713eaebd3cbf80bf683ed9
.octa 0x3f63beecbeecbf63bf633eec3eec3f63,0xbeecbf63bf633eec3eec3f633f63beec,0x3e003f7e3f773e873f1dbf4abefebf5e,0x3f7ebe003e87bf77bf4abf1dbf5e3efe
.octa 0xbf79be66bf593f08be663f793f083f59,0xbe663f793f083f593f793e663f59bf08,0x3f0cbf563e3fbf7cbe51bf7bbf10bf54,0xbf56bf0cbf7cbe3fbf7b3e51bf543f10
.octa 0xbea1bf733ea13f73bea1bf733ea13f73,0xbf733ea13f73bea1bf733ea13f73bea1,0x3d0abf80bed43f693f3bbf2fbf703eb4,0xbf80bd0a3f693ed4bf2fbf3b3eb43f70
.octa 0x3ec1bf6dbf6c3ec73f6d3ec1bec7bf6c,0xbf6dbec13ec73f6c3ec1bf6dbf6c3ec7,0x3f2dbf3dbf71beae3d3c3f803f68bed9,0xbf3dbf2dbeae3f713f80bd3cbed9bf68
.octa 0x3f63beecbeecbf63bf633eec3eec3f63,0xbeecbf63bf633eec3eec3f633f63beec,0x3f7ebe003e87bf77bf4abf1dbf5e3efe,0xbe00bf7ebf77be87bf1d3f4a3efe3f5e
.octa 0x3f793e663f59bf083e66bf79bf08bf59,0x3e66bf79bf08bf59bf79be66bf593f08,0x3f563f0c3f7c3e3f3f7bbe513f54bf10,0x3f0cbf563e3fbf7cbe51bf7bbf10bf54
.octa 0x3f8000003f8000003f8000003f80,0x3f8080003f8080003f8080003f808000,0x3f713eaf3f3d3f2d3ed83f683d303f80,0x3eafbf713f2dbf3d3f68bed83f80bd30
.octa 0x3f25bf443f7fbdb03f443f253db03f7f,0xbf44bf25bdb0bf7f3f25bf443f7fbdb0,0xbeffbf5e3f1cbf4b3f773e863e043f7e,0xbf5e3effbf4bbf1c3e86bf773f7ebe04
.octa 0xbf7c3e2fbe2fbf7c3f7cbe2f3e2f3f7c,0x3e2f3f7cbf7c3e2fbe2fbf7c3f7cbe2f,0xbe353f7cbf57bf0a3f52bf123e5a3f7a,0x3f7c3e35bf0a3f57bf12bf523f7abe5a
.octa 0x3f5d3f01bf783e823f01bf5d3e823f78,0x3f01bf5d3e823f78bf5dbf013f78be82,0x3f45bf24beef3f633dbcbf7f3e983f75,0xbf24bf453f633eefbf7fbdbc3f75be98
.octa 0x3f8000003f8000003f8000003f80,0x3f8080003f8080003f8080003f808000,0x3eafbf713f2dbf3d3f68bed83f80bd30,0xbf71beafbf3dbf2dbed8bf68bd30bf80
.octa 0xbf253f44bf7f3db0bf44bf25bdb0bf7f,0x3f443f253db03f7fbf253f44bf7f3db0,0x3f5ebeff3f4b3f1cbe863f77bf7e3e04,0xbeffbf5e3f1cbf4b3f773e863e043f7e
.octa 0xbf7c3e2fbe2fbf7c3f7cbe2f3e2f3f7c,0x3e2f3f7cbf7c3e2fbe2fbf7c3f7cbe2f,0x3f7c3e35bf0a3f57bf12bf523f7abe5a,0x3e35bf7c3f573f0abf523f12be5abf7a
.octa 0xbf5dbf013f78be82bf013f5dbe82bf78,0xbf013f5dbe82bf783f5d3f01bf783e82,0x3f243f45bf63beef3f7f3dbcbf753e98,0x3f45bf24beef3f633dbcbf7f3e983f75
.octa 0x3f8000003f8000003f8000003f80,0x3f8080003f8080003f8080003f808000,0xbf71beafbf3dbf2dbed8bf68bd30bf80,0xbeaf3f71bf2d3f3dbf683ed8bf803d30
.octa 0x3f25bf443f7fbdb03f443f253db03f7f,0xbf44bf25bdb0bf7f3f25bf443f7fbdb0,0x3eff3f5ebf1c3f4bbf77be86be04bf7e,0x3f5ebeff3f4b3f1cbe863f77bf7e3e04
.octa 0xbf7c3e2fbe2fbf7c3f7cbe2f3e2f3f7c,0x3e2f3f7cbf7c3e2fbe2fbf7c3f7cbe2f,0x3e35bf7c3f573f0abf523f12be5abf7a,0xbf7cbe353f0abf573f123f52bf7a3e5a
.octa 0x3f5d3f01bf783e823f01bf5d3e823f78,0x3f01bf5d3e823f78bf5dbf013f78be82,0xbf453f243eefbf63bdbc3f7fbe98bf75,0x3f243f45bf63beef3f7f3dbcbf753e98
.octa 0x3f8000003f8000003f8000003f80,0x3f8080003f8080003f8080003f808000,0xbeaf3f71bf2d3f3dbf683ed8bf803d30,0x3f713eaf3f3d3f2d3ed83f683d303f80
.octa 0xbf253f44bf7f3db0bf44bf25bdb0bf7f,0x3f443f253db03f7fbf253f44bf7f3db0,0xbf5e3effbf4bbf1c3e86bf773f7ebe04,0x3eff3f5ebf1c3f4bbf77be86be04bf7e
.octa 0xbf7c3e2fbe2fbf7c3f7cbe2f3e2f3f7c,0x3e2f3f7cbf7c3e2fbe2fbf7c3f7cbe2f,0xbf7cbe353f0abf573f123f52bf7a3e5a,0xbe353f7cbf57bf0a3f52bf123e5a3f7a
.octa 0xbf5dbf013f78be82bf013f5dbe82bf78,0xbf013f5dbe82bf783f5d3f01bf783e82,0xbf24bf453f633eefbf7fbdbc3f75be98,0xbf453f243eefbf63bdbc3f7fbe98bf75
.octa 0xbeacbf713eac3f71beacbf713eac3f71,0xbf713eac3f71beacbf713eac3f71beac,0xbf80bbc93f6c3ec7bf34bf363ec13f6d,0xbbc93f803ec7bf6cbf363f343f6dbec1
.octa 0xbeb23f703f69bed5bf70beb23ed53f69,0x3f703eb2bed5bf69beb23f703f69bed5,0x3f433f263e9ebf74bf7f3da33ee93f64,0x3f26bf43bf74be9e3da33f7f3f64bee9
.octa 0x3f5fbefcbefcbf5fbf5f3efc3efc3f5f,0xbefcbf5fbf5f3efc3efc3f5f3f5fbefc,0xbe29bf7cbf79be66bf153f503f083f59,0xbf7c3e29be663f793f503f153f59bf08
.octa 0xbf7cbe3bbf533f11be3b3f7c3f113f53,0xbe3b3f7c3f113f533f7c3e3b3f53bf11,0xbf023f5cbe103f7d3e7f3f783f1a3f4d,0x3f5c3f023f7d3e103f78be7f3f4dbf1a
.octa 0xbeacbf713eac3f71beacbf713eac3f71,0xbf713eac3f71beacbf713eac3f71beac,0xbbc93f803ec7bf6cbf363f343f6dbec1,0x3f803bc9bf6cbec73f343f36bec1bf6d
.octa 0x3eb2bf70bf693ed53f703eb2bed5bf69,0xbf70beb23ed53f693eb2bf70bf693ed5,0xbf263f433f743e9ebda3bf7fbf643ee9,0x3f433f263e9ebf74bf7f3da33ee93f64
.octa 0x3f5fbefcbefcbf5fbf5f3efc3efc3f5f,0xbefcbf5fbf5f3efc3efc3f5f3f5fbefc,0xbf7c3e29be663f793f503f153f59bf08,0x3e293f7c3f793e663f15bf50bf08bf59
.octa 0x3f7c3e3b3f53bf113e3bbf7cbf11bf53,0x3e3bbf7cbf11bf53bf7cbe3bbf533f11,0xbf5cbf02bf7dbe10bf783e7fbf4d3f1a,0xbf023f5cbe103f7d3e7f3f783f1a3f4d
.octa 0xbeacbf713eac3f71beacbf713eac3f71,0xbf713eac3f71beacbf713eac3f71beac,0x3f803bc9bf6cbec73f343f36bec1bf6d,0x3bc9bf80bec73f6c3f36bf34bf6d3ec1
.octa 0xbeb23f703f69bed5bf70beb23ed53f69,0x3f703eb2bed5bf69beb23f703f69bed5,0xbf43bf26be9e3f743f7fbda3bee9bf64,0xbf263f433f743e9ebda3bf7fbf643ee9
.octa 0x3f5fbefcbefcbf5fbf5f3efc3efc3f5f,0xbefcbf5fbf5f3efc3efc3f5f3f5fbefc,0x3e293f7c3f793e663f15bf50bf08bf59,0x3f7cbe293e66bf79bf50bf15bf593f08
.octa 0xbf7cbe3bbf533f11be3b3f7c3f113f53,0xbe3b3f7c3f113f533f7c3e3b3f53bf11,0x3f02bf5c3e10bf7dbe7fbf78bf1abf4d,0xbf5cbf02bf7dbe10bf783e7fbf4d3f1a
.octa 0xbeacbf713eac3f71beacbf713eac3f71,0xbf713eac3f71beacbf713eac3f71beac,0x3bc9bf80bec73f6c3f36bf34bf6d3ec1,0xbf80bbc93f6c3ec7bf34bf363ec13f6d
.octa 0x3eb2bf70bf693ed53f703eb2bed5bf69,0xbf70beb23ed53f693eb2bf70bf693ed5,0x3f26bf43bf74be9e3da33f7f3f64bee9,0xbf43bf26be9e3f743f7fbda3bee9bf64
.octa 0x3f5fbefcbefcbf5fbf5f3efc3efc3f5f,0xbefcbf5fbf5f3efc3efc3f5f3f5fbefc,0x3f7cbe293e66bf79bf50bf15bf593f08,0xbe29bf7cbf79be66bf153f503f083f59
.octa 0x3f7c3e3b3f53bf113e3bbf7cbf11bf53,0x3e3bbf7cbf11bf53bf7cbe3bbf533f11,0x3f5c3f023f7d3e103f78be7f3f4dbf1a,0x3f02bf5c3e10bf7dbe7fbf78bf1abf4d
.octa 0x3f8000003f8000003f8000003f80,0x3f8080003f8080003f8080003f808000,0x3f713eae3f3d3f2d3ed93f683d3c3f80,0x3eaebf713f2dbf3d3f68bed93f80bd3c
.octa 0x3f24bf453f7fbdbc3f453f243dbc3f7f,0xbf45bf24bdbcbf7f3f24bf453f7fbdbc,0xbf02bf5d3f1abf4c3f783e813e0d3f7e,0xbf5d3f02bf4cbf1a3e81bf783f7ebe0d
.octa 0xbf7c3e3bbe3bbf7c3f7cbe3b3e3b3f7c,0x3e3b3f7cbf7c3e3bbe3bbf7c3f7cbe3b,0xbe263f7dbf5abf073f50bf153e6a3f79,0x3f7d3e26bf073f5abf15bf503f79be6a
.octa 0x3f603efabf763e8c3efabf603e8c3f76,0x3efabf603e8c3f76bf60befa3f76be8c,0x3f41bf28bee53f653d90bf7f3ea23f73,0xbf28bf413f653ee5bf7fbd903f73bea2
.octa 0x3f8000003f8000003f8000003f80,0x3f8080003f8080003f8080003f808000,0x3eaebf713f2dbf3d3f68bed93f80bd3c,0xbf71beaebf3dbf2dbed9bf68bd3cbf80
.octa 0xbf243f45bf7f3dbcbf45bf24bdbcbf7f,0x3f453f243dbc3f7fbf243f45bf7f3dbc,0x3f5dbf023f4c3f1abe813f78bf7e3e0d,0xbf02bf5d3f1abf4c3f783e813e0d3f7e
.octa 0xbf7c3e3bbe3bbf7c3f7cbe3b3e3b3f7c,0x3e3b3f7cbf7c3e3bbe3bbf7c3f7cbe3b,0x3f7d3e26bf073f5abf15bf503f79be6a,0x3e26bf7d3f5a3f07bf503f15be6abf79
.octa 0xbf60befa3f76be8cbefa3f60be8cbf76,0xbefa3f60be8cbf763f603efabf763e8c,0x3f283f41bf65bee53f7f3d90bf733ea2,0x3f41bf28bee53f653d90bf7f3ea23f73
.octa 0x3f8000003f8000003f8000003f80,0x3f8080003f8080003f8080003f808000,0xbf71beaebf3dbf2dbed9bf68bd3cbf80,0xbeae3f71bf2d3f3dbf683ed9bf803d3c
.octa 0x3f24bf453f7fbdbc3f453f243dbc3f7f,0xbf45bf24bdbcbf7f3f24bf453f7fbdbc,0x3f023f5dbf1a3f4cbf78be81be0dbf7e,0x3f5dbf023f4c3f1abe813f78bf7e3e0d
.octa 0xbf7c3e3bbe3bbf7c3f7cbe3b3e3b3f7c,0x3e3b3f7cbf7c3e3bbe3bbf7c3f7cbe3b,0x3e26bf7d3f5a3f07bf503f15be6abf79,0xbf7dbe263f07bf5a3f153f50bf793e6a
.octa 0x3f603efabf763e8c3efabf603e8c3f76,0x3efabf603e8c3f76bf60befa3f76be8c,0xbf413f283ee5bf65bd903f7fbea2bf73,0x3f283f41bf65bee53f7f3d90bf733ea2
.octa 0x3f8000003f8000003f8000003f80,0x3f8080003f8080003f8080003f808000,0xbeae3f71bf2d3f3dbf683ed9bf803d3c,0x3f713eae3f3d3f2d3ed93f683d3c3f80
.octa 0xbf243f45bf7f3dbcbf45bf24bdbcbf7f,0x3f453f243dbc3f7fbf243f45bf7f3dbc,0xbf5d3f02bf4cbf1a3e81bf783f7ebe0d,0x3f023f5dbf1a3f4cbf78be81be0dbf7e
.octa 0xbf7c3e3bbe3bbf7c3f7cbe3b3e3b3f7c,0x3e3b3f7cbf7c3e3bbe3bbf7c3f7cbe3b,0xbf7dbe263f07bf5a3f153f50bf793e6a,0xbe263f7dbf5abf073f50bf153e6a3f79
.octa 0xbf60befa3f76be8cbefa3f60be8cbf76,0xbefa3f60be8cbf763f603efabf763e8c,0xbf28bf413f653ee5bf7fbd903f73bea2,0xbf413f283ee5bf65bd903f7fbea2bf73
.octa 0xbeb8bf6f3eb83f6fbeb8bf6f3eb83f6f,0xbf6f3eb83f6fbeb8bf6f3eb83f6fbeb8,0xbf803cb03f6f3ebabf39bf313ece3f6a,0x3cb03f803ebabf6fbf313f393f6abece
.octa 0xbea43f733f65bee3bf73bea43ee33f65,0x3f733ea4bee3bf65bea43f733f65bee3,0x3f483f1f3e8dbf76bf7e3de83ef83f60,0x3f1fbf48bf76be8d3de83f7e3f60bef8
.octa 0x3f5abf06bf06bf5abf5a3f063f063f5a,0xbf06bf5abf5a3f063f063f5a3f5abf06,0xbe51bf7bbf7cbe3fbf0c3f563f103f54,0xbf7b3e51be3f3f7c3f563f0c3f54bf10
.octa 0xbf7dbe10bf4d3f1abe103f7d3f1a3f4d,0xbe103f7d3f1a3f4d3f7d3e103f4dbf1a,0xbef03f62bdc23f7f3e963f753f233f45,0x3f623ef03f7f3dc23f75be963f45bf23
.octa 0xbeb8bf6f3eb83f6fbeb8bf6f3eb83f6f,0xbf6f3eb83f6fbeb8bf6f3eb83f6fbeb8,0x3cb03f803ebabf6fbf313f393f6abece,0x3f80bcb0bf6fbeba3f393f31becebf6a
.octa 0x3ea4bf73bf653ee33f733ea4bee3bf65,0xbf73bea43ee33f653ea4bf73bf653ee3,0xbf1f3f483f763e8dbde8bf7ebf603ef8,0x3f483f1f3e8dbf76bf7e3de83ef83f60
.octa 0x3f5abf06bf06bf5abf5a3f063f063f5a,0xbf06bf5abf5a3f063f063f5a3f5abf06,0xbf7b3e51be3f3f7c3f563f0c3f54bf10,0x3e513f7b3f7c3e3f3f0cbf56bf10bf54
.octa 0x3f7d3e103f4dbf1a3e10bf7dbf1abf4d,0x3e10bf7dbf1abf4dbf7dbe10bf4d3f1a,0xbf62bef0bf7fbdc2bf753e96bf453f23,0xbef03f62bdc23f7f3e963f753f233f45
.octa 0xbeb8bf6f3eb83f6fbeb8bf6f3eb83f6f,0xbf6f3eb83f6fbeb8bf6f3eb83f6fbeb8,0x3f80bcb0bf6fbeba3f393f31becebf6a,0xbcb0bf80beba3f6f3f31bf39bf6a3ece
.octa 0xbea43f733f65bee3bf73bea43ee33f65,0x3f733ea4bee3bf65bea43f733f65bee3,0xbf48bf1fbe8d3f763f7ebde8bef8bf60,0xbf1f3f483f763e8dbde8bf7ebf603ef8
.octa 0x3f5abf06bf06bf5abf5a3f063f063f5a,0xbf06bf5abf5a3f063f063f5a3f5abf06,0x3e513f7b3f7c3e3f3f0cbf56bf10bf54,0x3f7bbe513e3fbf7cbf56bf0cbf543f10
.octa 0xbf7dbe10bf4d3f1abe103f7d3f1a3f4d,0xbe103f7d3f1a3f4d3f7d3e103f4dbf1a,0x3ef0bf623dc2bf7fbe96bf75bf23bf45,0xbf62bef0bf7fbdc2bf753e96bf453f23
.octa 0xbeb8bf6f3eb83f6fbeb8bf6f3eb83f6f,0xbf6f3eb83f6fbeb8bf6f3eb83f6fbeb8,0xbcb0bf80beba3f6f3f31bf39bf6a3ece,0xbf803cb03f6f3ebabf39bf313ece3f6a
.octa 0x3ea4bf73bf653ee33f733ea4bee3bf65,0xbf73bea43ee33f653ea4bf73bf653ee3,0x3f1fbf48bf76be8d3de83f7e3f60bef8,0xbf48bf1fbe8d3f763f7ebde8bef8bf60
.octa 0x3f5abf06bf06bf5abf5a3f063f063f5a,0xbf06bf5abf5a3f063f063f5a3f5abf06,0x3f7bbe513e3fbf7cbf56bf0cbf543f10,0xbe51bf7bbf7cbe3fbf0c3f563f103f54
.octa 0x3f7d3e103f4dbf1a3e10bf7dbf1abf4d,0x3e10bf7dbf1abf4dbf7dbe10bf4d3f1a,0x3f623ef03f7f3dc23f75be963f45bf23,0x3ef0bf623dc2bf7fbe96bf75bf23bf45
.octa 0x3f800000000000003f80,0x3f353f350000000000003f80,0x3f800000000000003f8000000000,0x3f353f350000000000003f8000000000
.octa 0x3f80248d0000000000003f80,0x3f35bf350000000000003f80,0x3f80248d0000000000003f8000000000,0x3f35bf350000000000003f8000000000
.octa 0x250dbf800000000000003f80,0xbf35bf350000000000003f80,0x250dbf800000000000003f8000000000,0xbf35bf350000000000003f8000000000
.octa 0xbf80a5540000000000003f80,0xbf353f350000000000003f80,0xbf80a5540000000000003f8000000000,0xbf353f350000000000003f8000000000
.octa 0x3f800000000000003f80,0x3f35bf35000000003f80248d,0x3f800000000000003f8000000000,0x3f35bf35000000003f80248d00000000
.octa 0xbf80a55400000000250dbf80,0x3f353f3500000000bf80a554,0xbf80a55400000000250dbf8000000000,0x3f353f3500000000bf80a55400000000
.octa 0x25d4bf8000000000a58d3f80,0xbf353f35000000003f8025b0,0x25d4bf8000000000a58d3f8000000000,0xbf353f35000000003f8025b000000000
.octa 0x3f80261f0000000025d4bf80,0xbf35bf3500000000bf80a5f7,0x3f80261f0000000025d4bf8000000000,0xbf35bf3500000000bf80a5f700000000
.octa 0x3f800000000000003f80,0xbf35bf3500000000250dbf80,0x3f800000000000003f8000000000,0xbf35bf3500000000250dbf8000000000
.octa 0x3f8025b000000000a58d3f80,0xbf353f350000000025d4bf80,0x3f8025b000000000a58d3f8000000000,0xbf353f350000000025d4bf8000000000
.octa 0x2630bf8000000000a60d3f80,0x3f353f35000000002630bf80,0x2630bf8000000000a60d3f8000000000,0x3f353f35000000002630bf8000000000
.octa 0xbf80a74200000000a6543f80,0x3f35bf35000000002677bf80,0xbf80a74200000000a6543f8000000000,0x3f35bf35000000002677bf8000000000
.octa 0x3f800000000000003f80,0xbf353f3500000000bf80a554,0x3f800000000000003f8000000000,0xbf353f3500000000bf80a55400000000
.octa 0xbf80a5f70000000025d4bf80,0xbf35bf35000000003f80261f,0xbf80a5f70000000025d4bf8000000000,0xbf35bf35000000003f80261f00000000
.octa 0x2677bf8000000000a6543f80,0x3f35bf3500000000bf80a742,0x2677bf8000000000a6543f8000000000,0x3f35bf3500000000bf80a74200000000
.octa 0x3f80a60d00000000269fbf80,0x3f353f35000000003f80a60d,0x3f80a60d00000000269fbf8000000000,0x3f353f35000000003f80a60d00000000
.octa 0x3f808000000000003f808000,0x3f35bf35000000003f808000,0x3f808000000000003f80800000000000,0x3f35bf35000000003f80800000000000
.octa 0x248dbf80000000003f808000,0xbf35bf35000000003f808000,0x248dbf80000000003f80800000000000,0xbf35bf35000000003f80800000000000
.octa 0xbf80a50d000000003f808000,0xbf353f35000000003f808000,0xbf80a50d000000003f80800000000000,0xbf353f35000000003f80800000000000
.octa 0xa5543f80000000003f808000,0x3f353f35000000003f808000,0xa5543f80000000003f80800000000000,0x3f353f35000000003f80800000000000
.octa 0x3f808000000000003f808000,0xbf35bf3500000000248dbf80,0x3f808000000000003f80800000000000,0xbf35bf3500000000248dbf8000000000
.octa 0xa5543f8000000000bf80a50d,0x3f35bf3500000000a5543f80,0xa5543f8000000000bf80a50d00000000,0x3f35bf3500000000a5543f8000000000
.octa 0xbf80a5d4000000003f80258d,0x3f353f350000000025b0bf80,0xbf80a5d4000000003f80258d00000000,0x3f353f350000000025b0bf8000000000
.octa 0x261fbf8000000000bf80a5d4,0xbf353f3500000000a5f73f80,0x261fbf8000000000bf80a5d400000000,0xbf353f3500000000a5f73f8000000000
.octa 0x3f808000000000003f808000,0xbf353f3500000000bf80a50d,0x3f808000000000003f80800000000000,0xbf353f3500000000bf80a50d00000000
.octa 0x25b0bf80000000003f80258d,0x3f353f3500000000bf80a5d4,0x25b0bf80000000003f80258d00000000,0x3f353f3500000000bf80a5d400000000
.octa 0xbf80a630000000003f80260d,0x3f35bf3500000000bf80a630,0xbf80a630000000003f80260d00000000,0x3f35bf3500000000bf80a63000000000
.octa 0xa7423f80000000003f802654,0xbf35bf3500000000bf80a677,0xa7423f80000000003f80265400000000,0xbf35bf3500000000bf80a67700000000
.octa 0x3f808000000000003f808000,0x3f353f3500000000a5543f80,0x3f808000000000003f80800000000000,0x3f353f3500000000a5543f8000000000
.octa 0xa5f73f8000000000bf80a5d4,0xbf353f3500000000261fbf80,0xa5f73f8000000000bf80a5d400000000,0xbf353f3500000000261fbf8000000000
.octa 0xbf80a677000000003f802654,0xbf35bf3500000000a7423f80,0xbf80a677000000003f80265400000000,0xbf35bf3500000000a7423f8000000000
.octa 0xa60dbf8000000000bf80a69f,0x3f35bf3500000000a60dbf80,0xa60dbf8000000000bf80a69f00000000,0x3f35bf3500000000a60dbf8000000000
.octa 0x80003f800000000080003f80,0x80003f800000000080003f8000000000,0xbf353f350000000080003f80,0xbf353f350000000080003f8000000000
.octa 0xbf80248d0000000080003f80,0xbf80248d0000000080003f8000000000,0xbf35bf350000000080003f80,0xbf35bf350000000080003f8000000000
.octa 0xa50dbf800000000080003f80,0xa50dbf800000000080003f8000000000,0x3f35bf350000000080003f80,0x3f35bf350000000080003f8000000000
.octa 0x3f80a5540000000080003f80,0x3f80a5540000000080003f8000000000,0x3f353f350000000080003f80,0x3f353f350000000080003f8000000000
.octa 0x80003f800000000080003f80,0x80003f800000000080003f8000000000,0xbf35bf3500000000bf80248d,0xbf35bf3500000000bf80248d00000000
.octa 0x3f80a55400000000a50dbf80,0x3f80a55400000000a50dbf8000000000,0xbf353f35000000003f80a554,0xbf353f35000000003f80a55400000000
.octa 0xa5d4bf8000000000258d3f80,0xa5d4bf8000000000258d3f8000000000,0x3f353f3500000000bf8025b0,0x3f353f3500000000bf8025b000000000
.octa 0xbf80261f00000000a5d4bf80,0xbf80261f00000000a5d4bf8000000000,0x3f35bf35000000003f80a5f7,0x3f35bf35000000003f80a5f700000000
.octa 0x80003f800000000080003f80,0x80003f800000000080003f8000000000,0x3f35bf3500000000a50dbf80,0x3f35bf3500000000a50dbf8000000000
.octa 0xbf8025b000000000258d3f80,0xbf8025b000000000258d3f8000000000,0x3f353f3500000000a5d4bf80,0x3f353f3500000000a5d4bf8000000000
.octa 0xa630bf8000000000260d3f80,0xa630bf8000000000260d3f8000000000,0xbf353f3500000000a630bf80,0xbf353f3500000000a630bf8000000000
.octa 0x3f80a7420000000026543f80,0x3f80a7420000000026543f8000000000,0xbf35bf3500000000a677bf80,0xbf35bf3500000000a677bf8000000000
.octa 0x80003f800000000080003f80,0x80003f800000000080003f8000000000,0x3f353f35000000003f80a554,0x3f353f35000000003f80a55400000000
.octa 0x3f80a5f700000000a5d4bf80,0x3f80a5f700000000a5d4bf8000000000,0x3f35bf3500000000bf80261f,0x3f35bf3500000000bf80261f00000000
.octa 0xa677bf800000000026543f80,0xa677bf800000000026543f8000000000,0xbf35bf35000000003f80a742,0xbf35bf35000000003f80a74200000000
.octa 0xbf80a60d00000000a69fbf80,0xbf80a60d00000000a69fbf8000000000,0xbf353f3500000000bf80a60d,0xbf353f3500000000bf80a60d00000000
.octa 0x3f800000000000003f800000,0x3f800000000000003f80000000000000,0x3f353f35000000003f800000,0x3f353f35000000003f80000000000000
.octa 0x248d3f80000000003f800000,0x248d3f80000000003f80000000000000,0xbf353f35000000003f800000,0xbf353f35000000003f80000000000000
.octa 0xbf80250d000000003f800000,0xbf80250d000000003f80000000000000,0xbf35bf35000000003f800000,0xbf35bf35000000003f80000000000000
.octa 0xa554bf80000000003f800000,0xa554bf80000000003f80000000000000,0x3f35bf35000000003f800000,0x3f35bf35000000003f80000000000000
.octa 0x3f800000000000003f800000,0x3f800000000000003f80000000000000,0xbf353f3500000000248d3f80,0xbf353f3500000000248d3f8000000000
.octa 0xa554bf8000000000bf80250d,0xa554bf8000000000bf80250d00000000,0x3f353f3500000000a554bf80,0x3f353f3500000000a554bf8000000000
.octa 0xbf8025d4000000003f80a58d,0xbf8025d4000000003f80a58d00000000,0x3f35bf350000000025b03f80,0x3f35bf350000000025b03f8000000000
.octa 0x261f3f8000000000bf8025d4,0x261f3f8000000000bf8025d400000000,0xbf35bf3500000000a5f7bf80,0xbf35bf3500000000a5f7bf8000000000
.octa 0x3f800000000000003f800000,0x3f800000000000003f80000000000000,0xbf35bf3500000000bf80250d,0xbf35bf3500000000bf80250d00000000
.octa 0x25b03f80000000003f80a58d,0x25b03f80000000003f80a58d00000000,0x3f35bf3500000000bf8025d4,0x3f35bf3500000000bf8025d400000000
.octa 0xbf802630000000003f80a60d,0xbf802630000000003f80a60d00000000,0x3f353f3500000000bf802630,0x3f353f3500000000bf80263000000000
.octa 0xa742bf80000000003f80a654,0xa742bf80000000003f80a65400000000,0xbf353f3500000000bf802677,0xbf353f3500000000bf80267700000000
.octa 0x3f800000000000003f800000,0x3f800000000000003f80000000000000,0x3f35bf3500000000a554bf80,0x3f35bf3500000000a554bf8000000000
.octa 0xa5f7bf8000000000bf8025d4,0xa5f7bf8000000000bf8025d400000000,0xbf35bf3500000000261f3f80,0xbf35bf3500000000261f3f8000000000
.octa 0xbf802677000000003f80a654,0xbf802677000000003f80a65400000000,0xbf353f3500000000a742bf80,0xbf353f3500000000a742bf8000000000
.octa 0xa60d3f8000000000bf80269f,0xa60d3f8000000000bf80269f00000000,0x3f353f3500000000a60d3f80,0x3f353f3500000000a60d3f8000000000
.octa 0x3d493f800000000000003f80,0x3f3e3f2c0000000000003f80,0x3d493f800000000000003f8000000000,0x3f3e3f2c0000000000003f8000000000
.octa 0x3f80bd490000000000003f80,0x3f2cbf3e0000000000003f80,0x3f80bd490000000000003f8000000000,0x3f2cbf3e0000000000003f8000000000
.octa 0xbd49bf800000000000003f80,0xbf3ebf2c0000000000003f80,0xbd49bf800000000000003f8000000000,0xbf3ebf2c0000000000003f8000000000
.octa 0xbf803d490000000000003f80,0xbf2c3f3e0000000000003f80,0xbf803d490000000000003f8000000000,0xbf2c3f3e0000000000003f8000000000
.octa 0x3e163f7d000000003dc93f7f,0x3f18bf4e000000003f7fbdc9,0x3e163f7d000000003dc93f7f00000000,0x3f18bf4e000000003f7fbdc900000000
.octa 0xbf7d3e1600000000bdc9bf7f,0x3f4e3f1800000000bf7f3dc9,0xbf7d3e1600000000bdc9bf7f00000000,0x3f4e3f1800000000bf7f3dc900000000
.octa 0xbe16bf7d000000003dc93f7f,0xbf183f4e000000003f7fbdc9,0xbe16bf7d000000003dc93f7f00000000,0xbf183f4e000000003f7fbdc900000000
.octa 0x3f7dbe1600000000bdc9bf7f,0xbf4ebf1800000000bf7f3dc9,0x3f7dbe1600000000bdc9bf7f00000000,0xbf4ebf1800000000bf7f3dc900000000
.octa 0x3e793f78000000003e483f7b,0xbf5cbf0400000000be48bf7b,0x3e793f78000000003e483f7b00000000,0xbf5cbf0400000000be48bf7b00000000
.octa 0x3f78be79000000003e483f7b,0xbf043f5c00000000be48bf7b,0x3f78be79000000003e483f7b00000000,0xbf043f5c00000000be48bf7b00000000
.octa 0xbe79bf78000000003e483f7b,0x3f5c3f0400000000be48bf7b,0xbe79bf78000000003e483f7b00000000,0x3f5c3f0400000000be48bf7b00000000
.octa 0xbf783e79000000003e483f7b,0x3f04bf5c00000000be48bf7b,0xbf783e79000000003e483f7b00000000,0x3f04bf5c00000000be48bf7b00000000
.octa 0x3eac3f71000000003e953f75,0xbedb3f6700000000bf753e95,0x3eac3f71000000003e953f7500000000,0xbedb3f6700000000bf753e9500000000
.octa 0xbf713eac00000000be95bf75,0xbf67bedb000000003f75be95,0xbf713eac00000000be95bf7500000000,0xbf67bedb000000003f75be9500000000
.octa 0xbeacbf71000000003e953f75,0x3edbbf6700000000bf753e95,0xbeacbf71000000003e953f7500000000,0x3edbbf6700000000bf753e9500000000
.octa 0x3f71beac00000000be95bf75,0x3f673edb000000003f75be95,0x3f71beac00000000be95bf7500000000,0x3f673edb000000003f75be9500000000
.octa 0x3f80bd49000000003f808000,0x3f2cbf3e000000003f808000,0x3f80bd49000000003f80800000000000,0x3f2cbf3e000000003f80800000000000
.octa 0xbd49bf80000000003f808000,0xbf3ebf2c000000003f808000,0xbd49bf80000000003f80800000000000,0xbf3ebf2c000000003f80800000000000
.octa 0xbf803d49000000003f808000,0xbf2c3f3e000000003f808000,0xbf803d49000000003f80800000000000,0xbf2c3f3e000000003f80800000000000
.octa 0x3d493f80000000003f808000,0x3f3e3f2c000000003f808000,0x3d493f80000000003f80800000000000,0x3f3e3f2c000000003f80800000000000
.octa 0x3f7dbe16000000003f7fbdc9,0xbf4ebf1800000000bdc9bf7f,0x3f7dbe16000000003f7fbdc900000000,0xbf4ebf1800000000bdc9bf7f00000000
.octa 0x3e163f7d00000000bf7f3dc9,0x3f18bf4e000000003dc93f7f,0x3e163f7d00000000bf7f3dc900000000,0x3f18bf4e000000003dc93f7f00000000
.octa 0xbf7d3e16000000003f7fbdc9,0x3f4e3f1800000000bdc9bf7f,0xbf7d3e16000000003f7fbdc900000000,0x3f4e3f1800000000bdc9bf7f00000000
.octa 0xbe16bf7d00000000bf7f3dc9,0xbf183f4e000000003dc93f7f,0xbe16bf7d00000000bf7f3dc900000000,0xbf183f4e000000003dc93f7f00000000
.octa 0x3f78be79000000003f7bbe48,0xbf043f5c00000000bf7b3e48,0x3f78be79000000003f7bbe4800000000,0xbf043f5c00000000bf7b3e4800000000
.octa 0xbe79bf78000000003f7bbe48,0x3f5c3f0400000000bf7b3e48,0xbe79bf78000000003f7bbe4800000000,0x3f5c3f0400000000bf7b3e4800000000
.octa 0xbf783e79000000003f7bbe48,0x3f04bf5c00000000bf7b3e48,0xbf783e79000000003f7bbe4800000000,0x3f04bf5c00000000bf7b3e4800000000
.octa 0x3e793f78000000003f7bbe48,0xbf5cbf0400000000bf7b3e48,0x3e793f78000000003f7bbe4800000000,0xbf5cbf0400000000bf7b3e4800000000
.octa 0x3f71beac000000003f75be95,0x3f673edb000000003e953f75,0x3f71beac000000003f75be9500000000,0x3f673edb000000003e953f7500000000
.octa 0x3eac3f7100000000bf753e95,0xbedb3f6700000000be95bf75,0x3eac3f7100000000bf753e9500000000,0xbedb3f6700000000be95bf7500000000
.octa 0xbf713eac000000003f75be95,0xbf67bedb000000003e953f75,0xbf713eac000000003f75be9500000000,0xbf67bedb000000003e953f7500000000
.octa 0xbeacbf7100000000bf753e95,0x3edbbf6700000000be95bf75,0xbeacbf7100000000bf753e9500000000,0x3edbbf6700000000be95bf7500000000
.octa 0x80003f800000000080003f80,0x80003f800000000080003f8000000000,0xbf3e3f2c00000000bd493f80,0xbf3e3f2c00000000bd493f8000000000
.octa 0xbf7fbdc900000000bdc93f7f,0xbf7fbdc900000000bdc93f7f00000000,0xbf18bf4e00000000be163f7d,0xbf18bf4e00000000be163f7d00000000
.octa 0x3e48bf7b00000000be483f7b,0x3e48bf7b00000000be483f7b00000000,0x3f5cbf0400000000be793f78,0x3f5cbf0400000000be793f7800000000
.octa 0x3f753e9500000000be953f75,0x3f753e9500000000be953f7500000000,0x3edb3f6700000000beac3f71,0x3edb3f6700000000beac3f7100000000
.octa 0x80003f800000000080003f80,0x80003f800000000080003f8000000000,0xbf2cbf3e00000000bf80bd49,0xbf2cbf3e00000000bf80bd4900000000
.octa 0x3f7f3dc9000000003dc9bf7f,0x3f7f3dc9000000003dc9bf7f00000000,0xbf4e3f18000000003f7d3e16,0xbf4e3f18000000003f7d3e1600000000
.octa 0x3e48bf7b00000000be483f7b,0x3e48bf7b00000000be483f7b00000000,0x3f043f5c00000000bf78be79,0x3f043f5c00000000bf78be7900000000
.octa 0xbf75be95000000003e95bf75,0xbf75be95000000003e95bf7500000000,0x3f67bedb000000003f713eac,0x3f67bedb000000003f713eac00000000
.octa 0x80003f800000000080003f80,0x80003f800000000080003f8000000000,0x3f3ebf2c000000003d49bf80,0x3f3ebf2c000000003d49bf8000000000
.octa 0xbf7fbdc900000000bdc93f7f,0xbf7fbdc900000000bdc93f7f00000000,0x3f183f4e000000003e16bf7d,0x3f183f4e000000003e16bf7d00000000
.octa 0x3e48bf7b00000000be483f7b,0x3e48bf7b00000000be483f7b00000000,0xbf5c3f04000000003e79bf78,0xbf5c3f04000000003e79bf7800000000
.octa 0x3f753e9500000000be953f75,0x3f753e9500000000be953f7500000000,0xbedbbf67000000003eacbf71,0xbedbbf67000000003eacbf7100000000
.octa 0x80003f800000000080003f80,0x80003f800000000080003f8000000000,0x3f2c3f3e000000003f803d49,0x3f2c3f3e000000003f803d4900000000
.octa 0x3f7f3dc9000000003dc9bf7f,0x3f7f3dc9000000003dc9bf7f00000000,0x3f4ebf1800000000bf7dbe16,0x3f4ebf1800000000bf7dbe1600000000
.octa 0x3e48bf7b00000000be483f7b,0x3e48bf7b00000000be483f7b00000000,0xbf04bf5c000000003f783e79,0xbf04bf5c000000003f783e7900000000
.octa 0xbf75be95000000003e95bf75,0xbf75be95000000003e95bf7500000000,0xbf673edb00000000bf71beac,0xbf673edb00000000bf71beac00000000
.octa 0x3f800000000000003f800000,0x3f800000000000003f80000000000000,0x3f2c3f3e000000003f803d49,0x3f2c3f3e000000003f803d4900000000
.octa 0xbdc93f7f000000003f7f3dc9,0xbdc93f7f000000003f7f3dc900000000,0xbf4e3f18000000003f7d3e16,0xbf4e3f18000000003f7d3e1600000000
.octa 0xbf7bbe48000000003f7b3e48,0xbf7bbe48000000003f7b3e4800000000,0xbf04bf5c000000003f783e79,0xbf04bf5c000000003f783e7900000000
.octa 0x3e95bf75000000003f753e95,0x3e95bf75000000003f753e9500000000,0x3f67bedb000000003f713eac,0x3f67bedb000000003f713eac00000000
.octa 0x3f800000000000003f800000,0x3f800000000000003f80000000000000,0xbf3e3f2c00000000bd493f80,0xbf3e3f2c00000000bd493f8000000000
.octa 0x3dc9bf7f00000000bf7fbdc9,0x3dc9bf7f00000000bf7fbdc900000000,0x3f183f4e000000003e16bf7d,0x3f183f4e000000003e16bf7d00000000
.octa 0xbf7bbe48000000003f7b3e48,0xbf7bbe48000000003f7b3e4800000000,0x3f5cbf0400000000be793f78,0x3f5cbf0400000000be793f7800000000
.octa 0xbe953f7500000000bf75be95,0xbe953f7500000000bf75be9500000000,0xbedbbf67000000003eacbf71,0xbedbbf67000000003eacbf7100000000
.octa 0x3f800000000000003f800000,0x3f800000000000003f80000000000000,0xbf2cbf3e00000000bf80bd49,0xbf2cbf3e00000000bf80bd4900000000
.octa 0xbdc93f7f000000003f7f3dc9,0xbdc93f7f000000003f7f3dc900000000,0x3f4ebf1800000000bf7dbe16,0x3f4ebf1800000000bf7dbe1600000000
.octa 0xbf7bbe48000000003f7b3e48,0xbf7bbe48000000003f7b3e4800000000,0x3f043f5c00000000bf78be79,0x3f043f5c00000000bf78be7900000000
.octa 0x3e95bf75000000003f753e95,0x3e95bf75000000003f753e9500000000,0xbf673edb00000000bf71beac,0xbf673edb00000000bf71beac00000000
.octa 0x3f800000000000003f800000,0x3f800000000000003f80000000000000,0x3f3ebf2c000000003d49bf80,0x3f3ebf2c000000003d49bf8000000000
.octa 0x3dc9bf7f00000000bf7fbdc9,0x3dc9bf7f00000000bf7fbdc900000000,0xbf18bf4e00000000be163f7d,0xbf18bf4e00000000be163f7d00000000
.octa 0xbf7bbe48000000003f7b3e48,0xbf7bbe48000000003f7b3e4800000000,0xbf5c3f04000000003e79bf78,0xbf5c3f04000000003e79bf7800000000
.octa 0xbe953f7500000000bf75be95,0xbe953f7500000000bf75be9500000000,0x3edb3f6700000000beac3f71,0x3edb3f6700000000beac3f7100000000
.octa 0x3dc93f7f0000000000003f80,0x3f463f220000000000003f80,0x3dc93f7f0000000000003f8000000000,0x3f463f220000000000003f8000000000
.octa 0x3f7fbdc90000000000003f80,0x3f22bf460000000000003f80,0x3f7fbdc90000000000003f8000000000,0x3f22bf460000000000003f8000000000
.octa 0xbdc9bf7f0000000000003f80,0xbf46bf220000000000003f80,0xbdc9bf7f0000000000003f8000000000,0xbf46bf220000000000003f8000000000
.octa 0xbf7f3dc90000000000003f80,0xbf223f460000000000003f80,0xbf7f3dc90000000000003f8000000000,0xbf223f460000000000003f8000000000
.octa 0x3e953f75000000003e483f7b,0x3ef1bf62000000003f7bbe48,0x3e953f75000000003e483f7b00000000,0x3ef1bf62000000003f7bbe4800000000
.octa 0xbf753e9500000000be48bf7b,0x3f623ef100000000bf7b3e48,0xbf753e9500000000be48bf7b00000000,0x3f623ef100000000bf7b3e4800000000
.octa 0xbe95bf75000000003e483f7b,0xbef13f62000000003f7bbe48,0xbe95bf75000000003e483f7b00000000,0xbef13f62000000003f7bbe4800000000
.octa 0x3f75be9500000000be48bf7b,0xbf62bef100000000bf7b3e48,0x3f75be9500000000be48bf7b00000000,0xbf62bef100000000bf7b3e4800000000
.octa 0x3ef13f62000000003ec43f6d,0xbf75be9500000000bec4bf6d,0x3ef13f62000000003ec43f6d00000000,0xbf75be9500000000bec4bf6d00000000
.octa 0x3f62bef1000000003ec43f6d,0xbe953f7500000000bec4bf6d,0x3f62bef1000000003ec43f6d00000000,0xbe953f7500000000bec4bf6d00000000
.octa 0xbef1bf62000000003ec43f6d,0x3f753e9500000000bec4bf6d,0xbef1bf62000000003ec43f6d00000000,0x3f753e9500000000bec4bf6d00000000
.octa 0xbf623ef1000000003ec43f6d,0x3e95bf7500000000bec4bf6d,0xbf623ef1000000003ec43f6d00000000,0x3e95bf7500000000bec4bf6d00000000
.octa 0x3f223f46000000003f0e3f55,0xbdc93f7f00000000bf553f0e,0x3f223f46000000003f0e3f5500000000,0xbdc93f7f00000000bf553f0e00000000
.octa 0xbf463f2200000000bf0ebf55,0xbf7fbdc9000000003f55bf0e,0xbf463f2200000000bf0ebf5500000000,0xbf7fbdc9000000003f55bf0e00000000
.octa 0xbf22bf46000000003f0e3f55,0x3dc9bf7f00000000bf553f0e,0xbf22bf46000000003f0e3f5500000000,0x3dc9bf7f00000000bf553f0e00000000
.octa 0x3f46bf2200000000bf0ebf55,0x3f7f3dc9000000003f55bf0e,0x3f46bf2200000000bf0ebf5500000000,0x3f7f3dc9000000003f55bf0e00000000
.octa 0x3f7fbdc9000000003f808000,0x3f22bf46000000003f808000,0x3f7fbdc9000000003f80800000000000,0x3f22bf46000000003f80800000000000
.octa 0xbdc9bf7f000000003f808000,0xbf46bf22000000003f808000,0xbdc9bf7f000000003f80800000000000,0xbf46bf22000000003f80800000000000
.octa 0xbf7f3dc9000000003f808000,0xbf223f46000000003f808000,0xbf7f3dc9000000003f80800000000000,0xbf223f46000000003f80800000000000
.octa 0x3dc93f7f000000003f808000,0x3f463f22000000003f808000,0x3dc93f7f000000003f80800000000000,0x3f463f22000000003f80800000000000
.octa 0x3f75be95000000003f7bbe48,0xbf62bef100000000be48bf7b,0x3f75be95000000003f7bbe4800000000,0xbf62bef100000000be48bf7b00000000
.octa 0x3e953f7500000000bf7b3e48,0x3ef1bf62000000003e483f7b,0x3e953f7500000000bf7b3e4800000000,0x3ef1bf62000000003e483f7b00000000
.octa 0xbf753e95000000003f7bbe48,0x3f623ef100000000be48bf7b,0xbf753e95000000003f7bbe4800000000,0x3f623ef100000000be48bf7b00000000
.octa 0xbe95bf7500000000bf7b3e48,0xbef13f62000000003e483f7b,0xbe95bf7500000000bf7b3e4800000000,0xbef13f62000000003e483f7b00000000
.octa 0x3f62bef1000000003f6dbec4,0xbe953f7500000000bf6d3ec4,0x3f62bef1000000003f6dbec400000000,0xbe953f7500000000bf6d3ec400000000
.octa 0xbef1bf62000000003f6dbec4,0x3f753e9500000000bf6d3ec4,0xbef1bf62000000003f6dbec400000000,0x3f753e9500000000bf6d3ec400000000
.octa 0xbf623ef1000000003f6dbec4,0x3e95bf7500000000bf6d3ec4,0xbf623ef1000000003f6dbec400000000,0x3e95bf7500000000bf6d3ec400000000
.octa 0x3ef13f62000000003f6dbec4,0xbf75be9500000000bf6d3ec4,0x3ef13f62000000003f6dbec400000000,0xbf75be9500000000bf6d3ec400000000
.octa 0x3f46bf22000000003f55bf0e,0x3f7f3dc9000000003f0e3f55,0x3f46bf22000000003f55bf0e00000000,0x3f7f3dc9000000003f0e3f5500000000
.octa 0x3f223f4600000000bf553f0e,0xbdc93f7f00000000bf0ebf55,0x3f223f4600000000bf553f0e00000000,0xbdc93f7f00000000bf0ebf5500000000
.octa 0xbf463f22000000003f55bf0e,0xbf7fbdc9000000003f0e3f55,0xbf463f22000000003f55bf0e00000000,0xbf7fbdc9000000003f0e3f5500000000
.octa 0xbf22bf4600000000bf553f0e,0x3dc9bf7f00000000bf0ebf55,0xbf22bf4600000000bf553f0e00000000,0x3dc9bf7f00000000bf0ebf5500000000
.octa 0x80003f800000000080003f80,0x80003f800000000080003f8000000000,0xbf463f2200000000bdc93f7f,0xbf463f2200000000bdc93f7f00000000
.octa 0xbf7bbe4800000000be483f7b,0xbf7bbe4800000000be483f7b00000000,0xbef1bf6200000000be953f75,0xbef1bf6200000000be953f7500000000
.octa 0x3ec4bf6d00000000bec43f6d,0x3ec4bf6d00000000bec43f6d00000000,0x3f75be9500000000bef13f62,0x3f75be9500000000bef13f6200000000
.octa 0x3f553f0e00000000bf0e3f55,0x3f553f0e00000000bf0e3f5500000000,0x3dc93f7f00000000bf223f46,0x3dc93f7f00000000bf223f4600000000
.octa 0x80003f800000000080003f80,0x80003f800000000080003f8000000000,0xbf22bf4600000000bf7fbdc9,0xbf22bf4600000000bf7fbdc900000000
.octa 0x3f7b3e48000000003e48bf7b,0x3f7b3e48000000003e48bf7b00000000,0xbf623ef1000000003f753e95,0xbf623ef1000000003f753e9500000000
.octa 0x3ec4bf6d00000000bec43f6d,0x3ec4bf6d00000000bec43f6d00000000,0x3e953f7500000000bf62bef1,0x3e953f7500000000bf62bef100000000
.octa 0xbf55bf0e000000003f0ebf55,0xbf55bf0e000000003f0ebf5500000000,0x3f7fbdc9000000003f463f22,0x3f7fbdc9000000003f463f2200000000
.octa 0x80003f800000000080003f80,0x80003f800000000080003f8000000000,0x3f46bf22000000003dc9bf7f,0x3f46bf22000000003dc9bf7f00000000
.octa 0xbf7bbe4800000000be483f7b,0xbf7bbe4800000000be483f7b00000000,0x3ef13f62000000003e95bf75,0x3ef13f62000000003e95bf7500000000
.octa 0x3ec4bf6d00000000bec43f6d,0x3ec4bf6d00000000bec43f6d00000000,0xbf753e95000000003ef1bf62,0xbf753e95000000003ef1bf6200000000
.octa 0x3f553f0e00000000bf0e3f55,0x3f553f0e00000000bf0e3f5500000000,0xbdc9bf7f000000003f22bf46,0xbdc9bf7f000000003f22bf4600000000
.octa 0x80003f800000000080003f80,0x80003f800000000080003f8000000000,0x3f223f46000000003f7f3dc9,0x3f223f46000000003f7f3dc900000000
.octa 0x3f7b3e48000000003e48bf7b,0x3f7b3e48000000003e48bf7b00000000,0x3f62bef100000000bf75be95,0x3f62bef100000000bf75be9500000000
.octa 0x3ec4bf6d00000000bec43f6d,0x3ec4bf6d00000000bec43f6d00000000,0xbe95bf75000000003f623ef1,0xbe95bf75000000003f623ef100000000
.octa 0xbf55bf0e000000003f0ebf55,0xbf55bf0e000000003f0ebf5500000000,0xbf7f3dc900000000bf46bf22,0xbf7f3dc900000000bf46bf2200000000
.octa 0x3f800000000000003f800000,0x3f800000000000003f80000000000000,0x3f223f46000000003f7f3dc9,0x3f223f46000000003f7f3dc900000000
.octa 0xbe483f7b000000003f7b3e48,0xbe483f7b000000003f7b3e4800000000,0xbf623ef1000000003f753e95,0xbf623ef1000000003f753e9500000000
.octa 0xbf6dbec4000000003f6d3ec4,0xbf6dbec4000000003f6d3ec400000000,0xbe95bf75000000003f623ef1,0xbe95bf75000000003f623ef100000000
.octa 0x3f0ebf55000000003f553f0e,0x3f0ebf55000000003f553f0e00000000,0x3f7fbdc9000000003f463f22,0x3f7fbdc9000000003f463f2200000000
.octa 0x3f800000000000003f800000,0x3f800000000000003f80000000000000,0xbf463f2200000000bdc93f7f,0xbf463f2200000000bdc93f7f00000000
.octa 0x3e48bf7b00000000bf7bbe48,0x3e48bf7b00000000bf7bbe4800000000,0x3ef13f62000000003e95bf75,0x3ef13f62000000003e95bf7500000000
.octa 0xbf6dbec4000000003f6d3ec4,0xbf6dbec4000000003f6d3ec400000000,0x3f75be9500000000bef13f62,0x3f75be9500000000bef13f6200000000
.octa 0xbf0e3f5500000000bf55bf0e,0xbf0e3f5500000000bf55bf0e00000000,0xbdc9bf7f000000003f22bf46,0xbdc9bf7f000000003f22bf4600000000
.octa 0x3f800000000000003f800000,0x3f800000000000003f80000000000000,0xbf22bf4600000000bf7fbdc9,0xbf22bf4600000000bf7fbdc900000000
.octa 0xbe483f7b000000003f7b3e48,0xbe483f7b000000003f7b3e4800000000,0x3f62bef100000000bf75be95,0x3f62bef100000000bf75be9500000000
.octa 0xbf6dbec4000000003f6d3ec4,0xbf6dbec4000000003f6d3ec400000000,0x3e953f7500000000bf62bef1,0x3e953f7500000000bf62bef100000000
.octa 0x3f0ebf55000000003f553f0e,0x3f0ebf55000000003f553f0e00000000,0xbf7f3dc900000000bf46bf22,0xbf7f3dc900000000bf46bf2200000000
.octa 0x3f800000000000003f800000,0x3f800000000000003f80000000000000,0x3f46bf22000000003dc9bf7f,0x3f46bf22000000003dc9bf7f00000000
.octa 0x3e48bf7b00000000bf7bbe48,0x3e48bf7b00000000bf7bbe4800000000,0xbef1bf6200000000be953f75,0xbef1bf6200000000be953f7500000000
.octa 0xbf6dbec4000000003f6d3ec4,0xbf6dbec4000000003f6d3ec400000000,0xbf753e95000000003ef1bf62,0xbf753e95000000003ef1bf6200000000
.octa 0xbf0e3f5500000000bf55bf0e,0xbf0e3f5500000000bf55bf0e00000000,0x3dc93f7f00000000bf223f46,0x3dc93f7f00000000bf223f4600000000
.octa 0x3e163f7d0000000000003f80,0x3f4e3f180000000000003f80,0x3e163f7d0000000000003f8000000000,0x3f4e3f180000000000003f8000000000
.octa 0x3f7dbe160000000000003f80,0x3f18bf4e0000000000003f80,0x3f7dbe160000000000003f8000000000,0x3f18bf4e0000000000003f8000000000
.octa 0xbe16bf7d0000000000003f80,0xbf4ebf180000000000003f80,0xbe16bf7d0000000000003f8000000000,0xbf4ebf180000000000003f8000000000
.octa 0xbf7d3e160000000000003f80,0xbf183f4e0000000000003f80,0xbf7d3e160000000000003f8000000000,0xbf183f4e0000000000003f8000000000
.octa 0x3edb3f67000000003e953f75,0x3eacbf71000000003f75be95,0x3edb3f67000000003e953f7500000000,0x3eacbf71000000003f75be9500000000
.octa 0xbf673edb00000000be95bf75,0x3f713eac00000000bf753e95,0xbf673edb00000000be95bf7500000000,0x3f713eac00000000bf753e9500000000
.octa 0xbedbbf67000000003e953f75,0xbeac3f71000000003f75be95,0xbedbbf67000000003e953f7500000000,0xbeac3f71000000003f75be9500000000
.octa 0x3f67bedb00000000be95bf75,0xbf71beac00000000bf753e95,0x3f67bedb00000000be95bf7500000000,0xbf71beac00000000bf753e9500000000
.octa 0x3f2c3f3e000000003f0e3f55,0xbf80bd4900000000bf0ebf55,0x3f2c3f3e000000003f0e3f5500000000,0xbf80bd4900000000bf0ebf5500000000
.octa 0x3f3ebf2c000000003f0e3f55,0xbd493f8000000000bf0ebf55,0x3f3ebf2c000000003f0e3f5500000000,0xbd493f8000000000bf0ebf5500000000
.octa 0xbf2cbf3e000000003f0e3f55,0x3f803d4900000000bf0ebf55,0xbf2cbf3e000000003f0e3f5500000000,0x3f803d4900000000bf0ebf5500000000
.octa 0xbf3e3f2c000000003f0e3f55,0x3d49bf8000000000bf0ebf55,0xbf3e3f2c000000003f0e3f5500000000,0x3d49bf8000000000bf0ebf5500000000
.octa 0x3f5c3f04000000003f463f22,0x3e793f7800000000bf223f46,0x3f5c3f04000000003f463f2200000000,0x3e793f7800000000bf223f4600000000
.octa 0xbf043f5c00000000bf46bf22,0xbf783e79000000003f22bf46,0xbf043f5c00000000bf46bf2200000000,0xbf783e79000000003f22bf4600000000
.octa 0xbf5cbf04000000003f463f22,0xbe79bf7800000000bf223f46,0xbf5cbf04000000003f463f2200000000,0xbe79bf7800000000bf223f4600000000
.octa 0x3f04bf5c00000000bf46bf22,0x3f78be79000000003f22bf46,0x3f04bf5c00000000bf46bf2200000000,0x3f78be79000000003f22bf4600000000
.octa 0x3f7dbe16000000003f808000,0x3f18bf4e000000003f808000,0x3f7dbe16000000003f80800000000000,0x3f18bf4e000000003f80800000000000
.octa 0xbe16bf7d000000003f808000,0xbf4ebf18000000003f808000,0xbe16bf7d000000003f80800000000000,0xbf4ebf18000000003f80800000000000
.octa 0xbf7d3e16000000003f808000,0xbf183f4e000000003f808000,0xbf7d3e16000000003f80800000000000,0xbf183f4e000000003f80800000000000
.octa 0x3e163f7d000000003f808000,0x3f4e3f18000000003f808000,0x3e163f7d000000003f80800000000000,0x3f4e3f18000000003f80800000000000
.octa 0x3f67bedb000000003f75be95,0xbf71beac00000000be95bf75,0x3f67bedb000000003f75be9500000000,0xbf71beac00000000be95bf7500000000
.octa 0x3edb3f6700000000bf753e95,0x3eacbf71000000003e953f75,0x3edb3f6700000000bf753e9500000000,0x3eacbf71000000003e953f7500000000
.octa 0xbf673edb000000003f75be95,0x3f713eac00000000be95bf75,0xbf673edb000000003f75be9500000000,0x3f713eac00000000be95bf7500000000
.octa 0xbedbbf6700000000bf753e95,0xbeac3f71000000003e953f75,0xbedbbf6700000000bf753e9500000000,0xbeac3f71000000003e953f7500000000
.octa 0x3f3ebf2c000000003f55bf0e,0xbd493f8000000000bf553f0e,0x3f3ebf2c000000003f55bf0e00000000,0xbd493f8000000000bf553f0e00000000
.octa 0xbf2cbf3e000000003f55bf0e,0x3f803d4900000000bf553f0e,0xbf2cbf3e000000003f55bf0e00000000,0x3f803d4900000000bf553f0e00000000
.octa 0xbf3e3f2c000000003f55bf0e,0x3d49bf8000000000bf553f0e,0xbf3e3f2c000000003f55bf0e00000000,0x3d49bf8000000000bf553f0e00000000
.octa 0x3f2c3f3e000000003f55bf0e,0xbf80bd4900000000bf553f0e,0x3f2c3f3e000000003f55bf0e00000000,0xbf80bd4900000000bf553f0e00000000
.octa 0x3f04bf5c000000003f22bf46,0x3f78be79000000003f463f22,0x3f04bf5c000000003f22bf4600000000,0x3f78be79000000003f463f2200000000
.octa 0x3f5c3f0400000000bf223f46,0x3e793f7800000000bf46bf22,0x3f5c3f0400000000bf223f4600000000,0x3e793f7800000000bf46bf2200000000
.octa 0xbf043f5c000000003f22bf46,0xbf783e79000000003f463f22,0xbf043f5c000000003f22bf4600000000,0xbf783e79000000003f463f2200000000
.octa 0xbf5cbf0400000000bf223f46,0xbe79bf7800000000bf46bf22,0xbf5cbf0400000000bf223f4600000000,0xbe79bf7800000000bf46bf2200000000
.octa 0x80003f800000000080003f80,0x80003f800000000080003f8000000000,0xbf4e3f1800000000be163f7d,0xbf4e3f1800000000be163f7d00000000
.octa 0xbf75be9500000000be953f75,0xbf75be9500000000be953f7500000000,0xbeacbf7100000000bedb3f67,0xbeacbf7100000000bedb3f6700000000
.octa 0x3f0ebf5500000000bf0e3f55,0x3f0ebf5500000000bf0e3f5500000000,0x3f80bd4900000000bf2c3f3e,0x3f80bd4900000000bf2c3f3e00000000
.octa 0x3f223f4600000000bf463f22,0x3f223f4600000000bf463f2200000000,0xbe793f7800000000bf5c3f04,0xbe793f7800000000bf5c3f0400000000
.octa 0x80003f800000000080003f80,0x80003f800000000080003f8000000000,0xbf18bf4e00000000bf7dbe16,0xbf18bf4e00000000bf7dbe1600000000
.octa 0x3f753e95000000003e95bf75,0x3f753e95000000003e95bf7500000000,0xbf713eac000000003f673edb,0xbf713eac000000003f673edb00000000
.octa 0x3f0ebf5500000000bf0e3f55,0x3f0ebf5500000000bf0e3f5500000000,0x3d493f8000000000bf3ebf2c,0x3d493f8000000000bf3ebf2c00000000
.octa 0xbf22bf46000000003f46bf22,0xbf22bf46000000003f46bf2200000000,0x3f783e79000000003f043f5c,0x3f783e79000000003f043f5c00000000
.octa 0x80003f800000000080003f80,0x80003f800000000080003f8000000000,0x3f4ebf18000000003e16bf7d,0x3f4ebf18000000003e16bf7d00000000
.octa 0xbf75be9500000000be953f75,0xbf75be9500000000be953f7500000000,0x3eac3f71000000003edbbf67,0x3eac3f71000000003edbbf6700000000
.octa 0x3f0ebf5500000000bf0e3f55,0x3f0ebf5500000000bf0e3f5500000000,0xbf803d49000000003f2cbf3e,0xbf803d49000000003f2cbf3e00000000
.octa 0x3f223f4600000000bf463f22,0x3f223f4600000000bf463f2200000000,0x3e79bf78000000003f5cbf04,0x3e79bf78000000003f5cbf0400000000
.octa 0x80003f800000000080003f80,0x80003f800000000080003f8000000000,0x3f183f4e000000003f7d3e16,0x3f183f4e000000003f7d3e1600000000
.octa 0x3f753e95000000003e95bf75,0x3f753e95000000003e95bf7500000000,0x3f71beac00000000bf67bedb,0x3f71beac00000000bf67bedb00000000
.octa 0x3f0ebf5500000000bf0e3f55,0x3f0ebf5500000000bf0e3f5500000000,0xbd49bf80000000003f3e3f2c,0xbd49bf80000000003f3e3f2c00000000
.octa 0xbf22bf46000000003f46bf22,0xbf22bf46000000003f46bf2200000000,0xbf78be7900000000bf04bf5c,0xbf78be7900000000bf04bf5c00000000
.octa 0x3f800000000000003f800000,0x3f800000000000003f80000000000000,0x3f183f4e000000003f7d3e16,0x3f183f4e000000003f7d3e1600000000
.octa 0xbe953f75000000003f753e95,0xbe953f75000000003f753e9500000000,0xbf713eac000000003f673edb,0xbf713eac000000003f673edb00000000
.octa 0xbf55bf0e000000003f553f0e,0xbf55bf0e000000003f553f0e00000000,0xbd49bf80000000003f3e3f2c,0xbd49bf80000000003f3e3f2c00000000
.octa 0x3f46bf22000000003f223f46,0x3f46bf22000000003f223f4600000000,0x3f783e79000000003f043f5c,0x3f783e79000000003f043f5c00000000
.octa 0x3f800000000000003f800000,0x3f800000000000003f80000000000000,0xbf4e3f1800000000be163f7d,0xbf4e3f1800000000be163f7d00000000
.octa 0x3e95bf7500000000bf75be95,0x3e95bf7500000000bf75be9500000000,0x3eac3f71000000003edbbf67,0x3eac3f71000000003edbbf6700000000
.octa 0xbf55bf0e000000003f553f0e,0xbf55bf0e000000003f553f0e00000000,0x3f80bd4900000000bf2c3f3e,0x3f80bd4900000000bf2c3f3e00000000
.octa 0xbf463f2200000000bf22bf46,0xbf463f2200000000bf22bf4600000000,0x3e79bf78000000003f5cbf04,0x3e79bf78000000003f5cbf0400000000
.octa 0x3f800000000000003f800000,0x3f800000000000003f80000000000000,0xbf18bf4e00000000bf7dbe16,0xbf18bf4e00000000bf7dbe1600000000
.octa 0xbe953f75000000003f753e95,0xbe953f75000000003f753e9500000000,0x3f71beac00000000bf67bedb,0x3f71beac00000000bf67bedb00000000
.octa 0xbf55bf0e000000003f553f0e,0xbf55bf0e000000003f553f0e00000000,0x3d493f8000000000bf3ebf2c,0x3d493f8000000000bf3ebf2c00000000
.octa 0x3f46bf22000000003f223f46,0x3f46bf22000000003f223f4600000000,0xbf78be7900000000bf04bf5c,0xbf78be7900000000bf04bf5c00000000
.octa 0x3f800000000000003f800000,0x3f800000000000003f80000000000000,0x3f4ebf18000000003e16bf7d,0x3f4ebf18000000003e16bf7d00000000
.octa 0x3e95bf7500000000bf75be95,0x3e95bf7500000000bf75be9500000000,0xbeacbf7100000000bedb3f67,0xbeacbf7100000000bedb3f6700000000
.octa 0xbf55bf0e000000003f553f0e,0xbf55bf0e000000003f553f0e00000000,0xbf803d49000000003f2cbf3e,0xbf803d49000000003f2cbf3e00000000
.octa 0xbf463f2200000000bf22bf46,0xbf463f2200000000bf22bf4600000000,0xbe793f7800000000bf5c3f04,0xbe793f7800000000bf5c3f0400000000
.octa 0x3e483f7b0000000000003f80,0x3f553f0e0000000000003f80,0x3e483f7b0000000000003f8000000000,0x3f553f0e0000000000003f8000000000
.octa 0x3f7bbe480000000000003f80,0x3f0ebf550000000000003f80,0x3f7bbe480000000000003f8000000000,0x3f0ebf550000000000003f8000000000
.octa 0xbe48bf7b0000000000003f80,0xbf55bf0e0000000000003f80,0xbe48bf7b0000000000003f8000000000,0xbf55bf0e0000000000003f8000000000
.octa 0xbf7b3e480000000000003f80,0xbf0e3f550000000000003f80,0xbf7b3e480000000000003f8000000000,0xbf0e3f550000000000003f8000000000
.octa 0x3f0e3f55000000003ec43f6d,0x3e48bf7b000000003f6dbec4,0x3f0e3f55000000003ec43f6d00000000,0x3e48bf7b000000003f6dbec400000000
.octa 0xbf553f0e00000000bec4bf6d,0x3f7b3e4800000000bf6d3ec4,0xbf553f0e00000000bec4bf6d00000000,0x3f7b3e4800000000bf6d3ec400000000
.octa 0xbf0ebf55000000003ec43f6d,0xbe483f7b000000003f6dbec4,0xbf0ebf55000000003ec43f6d00000000,0xbe483f7b000000003f6dbec400000000
.octa 0x3f55bf0e00000000bec4bf6d,0xbf7bbe4800000000bf6d3ec4,0x3f55bf0e00000000bec4bf6d00000000,0xbf7bbe4800000000bf6d3ec400000000
.octa 0x3f553f0e000000003f353f35,0xbf7b3e4800000000bf35bf35,0x3f553f0e000000003f353f3500000000,0xbf7b3e4800000000bf35bf3500000000
.octa 0x3f0ebf55000000003f353f35,0x3e483f7b00000000bf35bf35,0x3f0ebf55000000003f353f3500000000,0x3e483f7b00000000bf35bf3500000000
.octa 0xbf55bf0e000000003f353f35,0x3f7bbe4800000000bf35bf35,0xbf55bf0e000000003f353f3500000000,0x3f7bbe4800000000bf35bf3500000000
.octa 0xbf0e3f55000000003f353f35,0xbe48bf7b00000000bf35bf35,0xbf0e3f55000000003f353f3500000000,0xbe48bf7b00000000bf35bf3500000000
.octa 0x3f7b3e48000000003f6d3ec4,0x3f0e3f5500000000bec43f6d,0x3f7b3e48000000003f6d3ec400000000,0x3f0e3f5500000000bec43f6d00000000
.octa 0xbe483f7b00000000bf6dbec4,0xbf553f0e000000003ec4bf6d,0xbe483f7b00000000bf6dbec400000000,0xbf553f0e000000003ec4bf6d00000000
.octa 0xbf7bbe48000000003f6d3ec4,0xbf0ebf5500000000bec43f6d,0xbf7bbe48000000003f6d3ec400000000,0xbf0ebf5500000000bec43f6d00000000
.octa 0x3e48bf7b00000000bf6dbec4,0x3f55bf0e000000003ec4bf6d,0x3e48bf7b00000000bf6dbec400000000,0x3f55bf0e000000003ec4bf6d00000000
.octa 0x3f7bbe48000000003f808000,0x3f0ebf55000000003f808000,0x3f7bbe48000000003f80800000000000,0x3f0ebf55000000003f80800000000000
.octa 0xbe48bf7b000000003f808000,0xbf55bf0e000000003f808000,0xbe48bf7b000000003f80800000000000,0xbf55bf0e000000003f80800000000000
.octa 0xbf7b3e48000000003f808000,0xbf0e3f55000000003f808000,0xbf7b3e48000000003f80800000000000,0xbf0e3f55000000003f80800000000000
.octa 0x3e483f7b000000003f808000,0x3f553f0e000000003f808000,0x3e483f7b000000003f80800000000000,0x3f553f0e000000003f80800000000000
.octa 0x3f55bf0e000000003f6dbec4,0xbf7bbe4800000000bec4bf6d,0x3f55bf0e000000003f6dbec400000000,0xbf7bbe4800000000bec4bf6d00000000
.octa 0x3f0e3f5500000000bf6d3ec4,0x3e48bf7b000000003ec43f6d,0x3f0e3f5500000000bf6d3ec400000000,0x3e48bf7b000000003ec43f6d00000000
.octa 0xbf553f0e000000003f6dbec4,0x3f7b3e4800000000bec4bf6d,0xbf553f0e000000003f6dbec400000000,0x3f7b3e4800000000bec4bf6d00000000
.octa 0xbf0ebf5500000000bf6d3ec4,0xbe483f7b000000003ec43f6d,0xbf0ebf5500000000bf6d3ec400000000,0xbe483f7b000000003ec43f6d00000000
.octa 0x3f0ebf55000000003f35bf35,0x3e483f7b00000000bf353f35,0x3f0ebf55000000003f35bf3500000000,0x3e483f7b00000000bf353f3500000000
.octa 0xbf55bf0e000000003f35bf35,0x3f7bbe4800000000bf353f35,0xbf55bf0e000000003f35bf3500000000,0x3f7bbe4800000000bf353f3500000000
.octa 0xbf0e3f55000000003f35bf35,0xbe48bf7b00000000bf353f35,0xbf0e3f55000000003f35bf3500000000,0xbe48bf7b00000000bf353f3500000000
.octa 0x3f553f0e000000003f35bf35,0xbf7b3e4800000000bf353f35,0x3f553f0e000000003f35bf3500000000,0xbf7b3e4800000000bf353f3500000000
.octa 0x3e48bf7b000000003ec4bf6d,0x3f55bf0e000000003f6d3ec4,0x3e48bf7b000000003ec4bf6d00000000,0x3f55bf0e000000003f6d3ec400000000
.octa 0x3f7b3e4800000000bec43f6d,0x3f0e3f5500000000bf6dbec4,0x3f7b3e4800000000bec43f6d00000000,0x3f0e3f5500000000bf6dbec400000000
.octa 0xbe483f7b000000003ec4bf6d,0xbf553f0e000000003f6d3ec4,0xbe483f7b000000003ec4bf6d00000000,0xbf553f0e000000003f6d3ec400000000
.octa 0xbf7bbe4800000000bec43f6d,0xbf0ebf5500000000bf6dbec4,0xbf7bbe4800000000bec43f6d00000000,0xbf0ebf5500000000bf6dbec400000000
.octa 0x80003f800000000080003f80,0x80003f800000000080003f8000000000,0xbf553f0e00000000be483f7b,0xbf553f0e00000000be483f7b00000000
.octa 0xbf6dbec400000000bec43f6d,0xbf6dbec400000000bec43f6d00000000,0xbe48bf7b00000000bf0e3f55,0xbe48bf7b00000000bf0e3f5500000000
.octa 0x3f35bf3500000000bf353f35,0x3f35bf3500000000bf353f3500000000,0x3f7b3e4800000000bf553f0e,0x3f7b3e4800000000bf553f0e00000000
.octa 0x3ec43f6d00000000bf6d3ec4,0x3ec43f6d00000000bf6d3ec400000000,0xbf0e3f5500000000bf7b3e48,0xbf0e3f5500000000bf7b3e4800000000
.octa 0x80003f800000000080003f80,0x80003f800000000080003f8000000000,0xbf0ebf5500000000bf7bbe48,0xbf0ebf5500000000bf7bbe4800000000
.octa 0x3f6d3ec4000000003ec4bf6d,0x3f6d3ec4000000003ec4bf6d00000000,0xbf7b3e48000000003f553f0e,0xbf7b3e48000000003f553f0e00000000
.octa 0x3f35bf3500000000bf353f35,0x3f35bf3500000000bf353f3500000000,0xbe483f7b00000000bf0ebf55,0xbe483f7b00000000bf0ebf5500000000
.octa 0xbec4bf6d000000003f6dbec4,0xbec4bf6d000000003f6dbec400000000,0x3f553f0e000000003e483f7b,0x3f553f0e000000003e483f7b00000000
.octa 0x80003f800000000080003f80,0x80003f800000000080003f8000000000,0x3f55bf0e000000003e48bf7b,0x3f55bf0e000000003e48bf7b00000000
.octa 0xbf6dbec400000000bec43f6d,0xbf6dbec400000000bec43f6d00000000,0x3e483f7b000000003f0ebf55,0x3e483f7b000000003f0ebf5500000000
.octa 0x3f35bf3500000000bf353f35,0x3f35bf3500000000bf353f3500000000,0xbf7bbe48000000003f55bf0e,0xbf7bbe48000000003f55bf0e00000000
.octa 0x3ec43f6d00000000bf6d3ec4,0x3ec43f6d00000000bf6d3ec400000000,0x3f0ebf55000000003f7bbe48,0x3f0ebf55000000003f7bbe4800000000
.octa 0x80003f800000000080003f80,0x80003f800000000080003f8000000000,0x3f0e3f55000000003f7b3e48,0x3f0e3f55000000003f7b3e4800000000
.octa 0x3f6d3ec4000000003ec4bf6d,0x3f6d3ec4000000003ec4bf6d00000000,0x3f7bbe4800000000bf55bf0e,0x3f7bbe4800000000bf55bf0e00000000
.octa 0x3f35bf3500000000bf353f35,0x3f35bf3500000000bf353f3500000000,0x3e48bf7b000000003f0e3f55,0x3e48bf7b000000003f0e3f5500000000
.octa 0xbec4bf6d000000003f6dbec4,0xbec4bf6d000000003f6dbec400000000,0xbf55bf0e00000000be48bf7b,0xbf55bf0e00000000be48bf7b00000000
.octa 0x3f800000000000003f800000,0x3f800000000000003f80000000000000,0x3f0e3f55000000003f7b3e48,0x3f0e3f55000000003f7b3e4800000000
.octa 0xbec43f6d000000003f6d3ec4,0xbec43f6d000000003f6d3ec400000000,0xbf7b3e48000000003f553f0e,0xbf7b3e48000000003f553f0e00000000
.octa 0xbf35bf35000000003f353f35,0xbf35bf35000000003f353f3500000000,0x3e48bf7b000000003f0e3f55,0x3e48bf7b000000003f0e3f5500000000
.octa 0x3f6dbec4000000003ec43f6d,0x3f6dbec4000000003ec43f6d00000000,0x3f553f0e000000003e483f7b,0x3f553f0e000000003e483f7b00000000
.octa 0x3f800000000000003f800000,0x3f800000000000003f80000000000000,0xbf553f0e00000000be483f7b,0xbf553f0e00000000be483f7b00000000
.octa 0x3ec4bf6d00000000bf6dbec4,0x3ec4bf6d00000000bf6dbec400000000,0x3e483f7b000000003f0ebf55,0x3e483f7b000000003f0ebf5500000000
.octa 0xbf35bf35000000003f353f35,0xbf35bf35000000003f353f3500000000,0x3f7b3e4800000000bf553f0e,0x3f7b3e4800000000bf553f0e00000000
.octa 0xbf6d3ec400000000bec4bf6d,0xbf6d3ec400000000bec4bf6d00000000,0x3f0ebf55000000003f7bbe48,0x3f0ebf55000000003f7bbe4800000000
.octa 0x3f800000000000003f800000,0x3f800000000000003f80000000000000,0xbf0ebf5500000000bf7bbe48,0xbf0ebf5500000000bf7bbe4800000000
.octa 0xbec43f6d000000003f6d3ec4,0xbec43f6d000000003f6d3ec400000000,0x3f7bbe4800000000bf55bf0e,0x3f7bbe4800000000bf55bf0e00000000
.octa 0xbf35bf35000000003f353f35,0xbf35bf35000000003f353f3500000000,0xbe483f7b00000000bf0ebf55,0xbe483f7b00000000bf0ebf5500000000
.octa 0x3f6dbec4000000003ec43f6d,0x3f6dbec4000000003ec43f6d00000000,0xbf55bf0e00000000be48bf7b,0xbf55bf0e00000000be48bf7b00000000
.octa 0x3f800000000000003f800000,0x3f800000000000003f80000000000000,0x3f55bf0e000000003e48bf7b,0x3f55bf0e000000003e48bf7b00000000
.octa 0x3ec4bf6d00000000bf6dbec4,0x3ec4bf6d00000000bf6dbec400000000,0xbe48bf7b00000000bf0e3f55,0xbe48bf7b00000000bf0e3f5500000000
.octa 0xbf35bf35000000003f353f35,0xbf35bf35000000003f353f3500000000,0xbf7bbe48000000003f55bf0e,0xbf7bbe48000000003f55bf0e00000000
.octa 0xbf6d3ec400000000bec4bf6d,0xbf6d3ec400000000bec4bf6d00000000,0xbf0e3f5500000000bf7b3e48,0xbf0e3f5500000000bf7b3e4800000000
.octa 0x3e793f780000000000003f80,0x3f5c3f040000000000003f80,0x3e793f780000000000003f8000000000,0x3f5c3f040000000000003f8000000000
.octa 0x3f78be790000000000003f80,0x3f04bf5c0000000000003f80,0x3f78be790000000000003f8000000000,0x3f04bf5c0000000000003f8000000000
.octa 0xbe79bf780000000000003f80,0xbf5cbf040000000000003f80,0xbe79bf780000000000003f8000000000,0xbf5cbf040000000000003f8000000000
.octa 0xbf783e790000000000003f80,0xbf043f5c0000000000003f80,0xbf783e790000000000003f8000000000,0xbf043f5c0000000000003f8000000000
.octa 0x3f2c3f3e000000003ef13f62,0x3d49bf80000000003f62bef1,0x3f2c3f3e000000003ef13f6200000000,0x3d49bf80000000003f62bef100000000
.octa 0xbf3e3f2c00000000bef1bf62,0x3f803d4900000000bf623ef1,0xbf3e3f2c00000000bef1bf6200000000,0x3f803d4900000000bf623ef100000000
.octa 0xbf2cbf3e000000003ef13f62,0xbd493f80000000003f62bef1,0xbf2cbf3e000000003ef13f6200000000,0xbd493f80000000003f62bef100000000
.octa 0x3f3ebf2c00000000bef1bf62,0xbf80bd4900000000bf623ef1,0x3f3ebf2c00000000bef1bf6200000000,0xbf80bd4900000000bf623ef100000000
.octa 0x3f713eac000000003f553f0e,0xbf673edb00000000bf55bf0e,0x3f713eac000000003f553f0e00000000,0xbf673edb00000000bf55bf0e00000000
.octa 0x3eacbf71000000003f553f0e,0x3edb3f6700000000bf55bf0e,0x3eacbf71000000003f553f0e00000000,0x3edb3f6700000000bf55bf0e00000000
.octa 0xbf71beac000000003f553f0e,0x3f67bedb00000000bf55bf0e,0xbf71beac000000003f553f0e00000000,0x3f67bedb00000000bf55bf0e00000000
.octa 0xbeac3f71000000003f553f0e,0xbedbbf6700000000bf55bf0e,0xbeac3f71000000003f553f0e00000000,0xbedbbf6700000000bf55bf0e00000000
.octa 0x3f7dbe16000000003f7f3dc9,0x3f4e3f1800000000bdc93f7f,0x3f7dbe16000000003f7f3dc900000000,0x3f4e3f1800000000bdc93f7f00000000
.octa 0x3e163f7d00000000bf7fbdc9,0xbf183f4e000000003dc9bf7f,0x3e163f7d00000000bf7fbdc900000000,0xbf183f4e000000003dc9bf7f00000000
.octa 0xbf7d3e16000000003f7f3dc9,0xbf4ebf1800000000bdc93f7f,0xbf7d3e16000000003f7f3dc900000000,0xbf4ebf1800000000bdc93f7f00000000
.octa 0xbe16bf7d00000000bf7fbdc9,0x3f18bf4e000000003dc9bf7f,0xbe16bf7d00000000bf7fbdc900000000,0x3f18bf4e000000003dc9bf7f00000000
.octa 0x3f78be79000000003f808000,0x3f04bf5c000000003f808000,0x3f78be79000000003f80800000000000,0x3f04bf5c000000003f80800000000000
.octa 0xbe79bf78000000003f808000,0xbf5cbf04000000003f808000,0xbe79bf78000000003f80800000000000,0xbf5cbf04000000003f80800000000000
.octa 0xbf783e79000000003f808000,0xbf043f5c000000003f808000,0xbf783e79000000003f80800000000000,0xbf043f5c000000003f80800000000000
.octa 0x3e793f78000000003f808000,0x3f5c3f04000000003f808000,0x3e793f78000000003f80800000000000,0x3f5c3f04000000003f80800000000000
.octa 0x3f3ebf2c000000003f62bef1,0xbf80bd4900000000bef1bf62,0x3f3ebf2c000000003f62bef100000000,0xbf80bd4900000000bef1bf6200000000
.octa 0x3f2c3f3e00000000bf623ef1,0x3d49bf80000000003ef13f62,0x3f2c3f3e00000000bf623ef100000000,0x3d49bf80000000003ef13f6200000000
.octa 0xbf3e3f2c000000003f62bef1,0x3f803d4900000000bef1bf62,0xbf3e3f2c000000003f62bef100000000,0x3f803d4900000000bef1bf6200000000
.octa 0xbf2cbf3e00000000bf623ef1,0xbd493f80000000003ef13f62,0xbf2cbf3e00000000bf623ef100000000,0xbd493f80000000003ef13f6200000000
.octa 0x3eacbf71000000003f0ebf55,0x3edb3f6700000000bf0e3f55,0x3eacbf71000000003f0ebf5500000000,0x3edb3f6700000000bf0e3f5500000000
.octa 0xbf71beac000000003f0ebf55,0x3f67bedb00000000bf0e3f55,0xbf71beac000000003f0ebf5500000000,0x3f67bedb00000000bf0e3f5500000000
.octa 0xbeac3f71000000003f0ebf55,0xbedbbf6700000000bf0e3f55,0xbeac3f71000000003f0ebf5500000000,0xbedbbf6700000000bf0e3f5500000000
.octa 0x3f713eac000000003f0ebf55,0xbf673edb00000000bf0e3f55,0x3f713eac000000003f0ebf5500000000,0xbf673edb00000000bf0e3f5500000000
.octa 0xbe16bf7d000000003dc9bf7f,0x3f18bf4e000000003f7f3dc9,0xbe16bf7d000000003dc9bf7f00000000,0x3f18bf4e000000003f7f3dc900000000
.octa 0x3f7dbe1600000000bdc93f7f,0x3f4e3f1800000000bf7fbdc9,0x3f7dbe1600000000bdc93f7f00000000,0x3f4e3f1800000000bf7fbdc900000000
.octa 0x3e163f7d000000003dc9bf7f,0xbf183f4e000000003f7f3dc9,0x3e163f7d000000003dc9bf7f00000000,0xbf183f4e000000003f7f3dc900000000
.octa 0xbf7d3e1600000000bdc93f7f,0xbf4ebf1800000000bf7fbdc9,0xbf7d3e1600000000bdc93f7f00000000,0xbf4ebf1800000000bf7fbdc900000000
.octa 0x80003f800000000080003f80,0x80003f800000000080003f8000000000,0xbf5c3f0400000000be793f78,0xbf5c3f0400000000be793f7800000000
.octa 0xbf62bef100000000bef13f62,0xbf62bef100000000bef13f6200000000,0xbd49bf8000000000bf2c3f3e,0xbd49bf8000000000bf2c3f3e00000000
.octa 0x3f55bf0e00000000bf553f0e,0x3f55bf0e00000000bf553f0e00000000,0x3f673edb00000000bf713eac,0x3f673edb00000000bf713eac00000000
.octa 0x3dc93f7f00000000bf7f3dc9,0x3dc93f7f00000000bf7f3dc900000000,0xbf4e3f1800000000bf7dbe16,0xbf4e3f1800000000bf7dbe1600000000
.octa 0x80003f800000000080003f80,0x80003f800000000080003f8000000000,0xbf04bf5c00000000bf78be79,0xbf04bf5c00000000bf78be7900000000
.octa 0x3f623ef1000000003ef1bf62,0x3f623ef1000000003ef1bf6200000000,0xbf803d49000000003f3e3f2c,0xbf803d49000000003f3e3f2c00000000
.octa 0x3f55bf0e00000000bf553f0e,0x3f55bf0e00000000bf553f0e00000000,0xbedb3f6700000000beacbf71,0xbedb3f6700000000beacbf7100000000
.octa 0xbdc9bf7f000000003f7fbdc9,0xbdc9bf7f000000003f7fbdc900000000,0x3f183f4e00000000be163f7d,0x3f183f4e00000000be163f7d00000000
.octa 0x80003f800000000080003f80,0x80003f800000000080003f8000000000,0x3f5cbf04000000003e79bf78,0x3f5cbf04000000003e79bf7800000000
.octa 0xbf62bef100000000bef13f62,0xbf62bef100000000bef13f6200000000,0x3d493f80000000003f2cbf3e,0x3d493f80000000003f2cbf3e00000000
.octa 0x3f55bf0e00000000bf553f0e,0x3f55bf0e00000000bf553f0e00000000,0xbf67bedb000000003f71beac,0xbf67bedb000000003f71beac00000000
.octa 0x3dc93f7f00000000bf7f3dc9,0x3dc93f7f00000000bf7f3dc900000000,0x3f4ebf18000000003f7d3e16,0x3f4ebf18000000003f7d3e1600000000
.octa 0x80003f800000000080003f80,0x80003f800000000080003f8000000000,0x3f043f5c000000003f783e79,0x3f043f5c000000003f783e7900000000
.octa 0x3f623ef1000000003ef1bf62,0x3f623ef1000000003ef1bf6200000000,0x3f80bd4900000000bf3ebf2c,0x3f80bd4900000000bf3ebf2c00000000
.octa 0x3f55bf0e00000000bf553f0e,0x3f55bf0e00000000bf553f0e00000000,0x3edbbf67000000003eac3f71,0x3edbbf67000000003eac3f7100000000
.octa 0xbdc9bf7f000000003f7fbdc9,0xbdc9bf7f000000003f7fbdc900000000,0xbf18bf4e000000003e16bf7d,0xbf18bf4e000000003e16bf7d00000000
.octa 0x3f800000000000003f800000,0x3f800000000000003f80000000000000,0x3f043f5c000000003f783e79,0x3f043f5c000000003f783e7900000000
.octa 0xbef13f62000000003f623ef1,0xbef13f62000000003f623ef100000000,0xbf803d49000000003f3e3f2c,0xbf803d49000000003f3e3f2c00000000
.octa 0xbf0ebf55000000003f0e3f55,0xbf0ebf55000000003f0e3f5500000000,0x3edbbf67000000003eac3f71,0x3edbbf67000000003eac3f7100000000
.octa 0x3f7fbdc9000000003dc93f7f,0x3f7fbdc9000000003dc93f7f00000000,0x3f183f4e00000000be163f7d,0x3f183f4e00000000be163f7d00000000
.octa 0x3f800000000000003f800000,0x3f800000000000003f80000000000000,0xbf5c3f0400000000be793f78,0xbf5c3f0400000000be793f7800000000
.octa 0x3ef1bf6200000000bf62bef1,0x3ef1bf6200000000bf62bef100000000,0x3d493f80000000003f2cbf3e,0x3d493f80000000003f2cbf3e00000000
.octa 0xbf0ebf55000000003f0e3f55,0xbf0ebf55000000003f0e3f5500000000,0x3f673edb00000000bf713eac,0x3f673edb00000000bf713eac00000000
.octa 0xbf7f3dc900000000bdc9bf7f,0xbf7f3dc900000000bdc9bf7f00000000,0x3f4ebf18000000003f7d3e16,0x3f4ebf18000000003f7d3e1600000000
.octa 0x3f800000000000003f800000,0x3f800000000000003f80000000000000,0xbf04bf5c00000000bf78be79,0xbf04bf5c00000000bf78be7900000000
.octa 0xbef13f62000000003f623ef1,0xbef13f62000000003f623ef100000000,0x3f80bd4900000000bf3ebf2c,0x3f80bd4900000000bf3ebf2c00000000
.octa 0xbf0ebf55000000003f0e3f55,0xbf0ebf55000000003f0e3f5500000000,0xbedb3f6700000000beacbf71,0xbedb3f6700000000beacbf7100000000
.octa 0x3f7fbdc9000000003dc93f7f,0x3f7fbdc9000000003dc93f7f00000000,0xbf18bf4e000000003e16bf7d,0xbf18bf4e000000003e16bf7d00000000
.octa 0x3f800000000000003f800000,0x3f800000000000003f80000000000000,0x3f5cbf04000000003e79bf78,0x3f5cbf04000000003e79bf7800000000
.octa 0x3ef1bf6200000000bf62bef1,0x3ef1bf6200000000bf62bef100000000,0xbd49bf8000000000bf2c3f3e,0xbd49bf8000000000bf2c3f3e00000000
.octa 0xbf0ebf55000000003f0e3f55,0xbf0ebf55000000003f0e3f5500000000,0xbf67bedb000000003f71beac,0xbf67bedb000000003f71beac00000000
.octa 0xbf7f3dc900000000bdc9bf7f,0xbf7f3dc900000000bdc9bf7f00000000,0xbf4e3f1800000000bf7dbe16,0xbf4e3f1800000000bf7dbe1600000000
.octa 0x3e953f750000000000003f80,0x3f623ef10000000000003f80,0x3e953f750000000000003f8000000000,0x3f623ef10000000000003f8000000000
.octa 0x3f75be950000000000003f80,0x3ef1bf620000000000003f80,0x3f75be950000000000003f8000000000,0x3ef1bf620000000000003f8000000000
.octa 0xbe95bf750000000000003f80,0xbf62bef10000000000003f80,0xbe95bf750000000000003f8000000000,0xbf62bef10000000000003f8000000000
.octa 0xbf753e950000000000003f80,0xbef13f620000000000003f80,0xbf753e950000000000003f8000000000,0xbef13f620000000000003f8000000000
.octa 0x3f463f22000000003f0e3f55,0xbdc9bf7f000000003f55bf0e,0x3f463f22000000003f0e3f5500000000,0xbdc9bf7f000000003f55bf0e00000000
.octa 0xbf223f4600000000bf0ebf55,0x3f7fbdc900000000bf553f0e,0xbf223f4600000000bf0ebf5500000000,0x3f7fbdc900000000bf553f0e00000000
.octa 0xbf46bf22000000003f0e3f55,0x3dc93f7f000000003f55bf0e,0xbf46bf22000000003f0e3f5500000000,0x3dc93f7f000000003f55bf0e00000000
.octa 0x3f22bf4600000000bf0ebf55,0xbf7f3dc900000000bf553f0e,0x3f22bf4600000000bf0ebf5500000000,0xbf7f3dc900000000bf553f0e00000000
.octa 0x3f7f3dc9000000003f6d3ec4,0xbf463f2200000000bf6dbec4,0x3f7f3dc9000000003f6d3ec400000000,0xbf463f2200000000bf6dbec400000000
.octa 0x3dc9bf7f000000003f6d3ec4,0x3f223f4600000000bf6dbec4,0x3dc9bf7f000000003f6d3ec400000000,0x3f223f4600000000bf6dbec400000000
.octa 0xbf7fbdc9000000003f6d3ec4,0x3f46bf2200000000bf6dbec4,0xbf7fbdc9000000003f6d3ec400000000,0x3f46bf2200000000bf6dbec400000000
.octa 0xbdc93f7f000000003f6d3ec4,0xbf22bf4600000000bf6dbec4,0xbdc93f7f000000003f6d3ec400000000,0xbf22bf4600000000bf6dbec400000000
.octa 0x3f62bef1000000003f7bbe48,0x3f753e95000000003e483f7b,0x3f62bef1000000003f7bbe4800000000,0x3f753e95000000003e483f7b00000000
.octa 0x3ef13f6200000000bf7b3e48,0xbe953f7500000000be48bf7b,0x3ef13f6200000000bf7b3e4800000000,0xbe953f7500000000be48bf7b00000000
.octa 0xbf623ef1000000003f7bbe48,0xbf75be95000000003e483f7b,0xbf623ef1000000003f7bbe4800000000,0xbf75be95000000003e483f7b00000000
.octa 0xbef1bf6200000000bf7b3e48,0x3e95bf7500000000be48bf7b,0xbef1bf6200000000bf7b3e4800000000,0x3e95bf7500000000be48bf7b00000000
.octa 0x3f75be95000000003f808000,0x3ef1bf62000000003f808000,0x3f75be95000000003f80800000000000,0x3ef1bf62000000003f80800000000000
.octa 0xbe95bf75000000003f808000,0xbf62bef1000000003f808000,0xbe95bf75000000003f80800000000000,0xbf62bef1000000003f80800000000000
.octa 0xbf753e95000000003f808000,0xbef13f62000000003f808000,0xbf753e95000000003f80800000000000,0xbef13f62000000003f80800000000000
.octa 0x3e953f75000000003f808000,0x3f623ef1000000003f808000,0x3e953f75000000003f80800000000000,0x3f623ef1000000003f80800000000000
.octa 0x3f22bf46000000003f55bf0e,0xbf7f3dc900000000bf0ebf55,0x3f22bf46000000003f55bf0e00000000,0xbf7f3dc900000000bf0ebf5500000000
.octa 0x3f463f2200000000bf553f0e,0xbdc9bf7f000000003f0e3f55,0x3f463f2200000000bf553f0e00000000,0xbdc9bf7f000000003f0e3f5500000000
.octa 0xbf223f46000000003f55bf0e,0x3f7fbdc900000000bf0ebf55,0xbf223f46000000003f55bf0e00000000,0x3f7fbdc900000000bf0ebf5500000000
.octa 0xbf46bf2200000000bf553f0e,0x3dc93f7f000000003f0e3f55,0xbf46bf2200000000bf553f0e00000000,0x3dc93f7f000000003f0e3f5500000000
.octa 0x3dc9bf7f000000003ec4bf6d,0x3f223f4600000000bec43f6d,0x3dc9bf7f000000003ec4bf6d00000000,0x3f223f4600000000bec43f6d00000000
.octa 0xbf7fbdc9000000003ec4bf6d,0x3f46bf2200000000bec43f6d,0xbf7fbdc9000000003ec4bf6d00000000,0x3f46bf2200000000bec43f6d00000000
.octa 0xbdc93f7f000000003ec4bf6d,0xbf22bf4600000000bec43f6d,0xbdc93f7f000000003ec4bf6d00000000,0xbf22bf4600000000bec43f6d00000000
.octa 0x3f7f3dc9000000003ec4bf6d,0xbf463f2200000000bec43f6d,0x3f7f3dc9000000003ec4bf6d00000000,0xbf463f2200000000bec43f6d00000000
.octa 0xbef1bf6200000000be48bf7b,0x3e95bf75000000003f7bbe48,0xbef1bf6200000000be48bf7b00000000,0x3e95bf75000000003f7bbe4800000000
.octa 0x3f62bef1000000003e483f7b,0x3f753e9500000000bf7b3e48,0x3f62bef1000000003e483f7b00000000,0x3f753e9500000000bf7b3e4800000000
.octa 0x3ef13f6200000000be48bf7b,0xbe953f75000000003f7bbe48,0x3ef13f6200000000be48bf7b00000000,0xbe953f75000000003f7bbe4800000000
.octa 0xbf623ef1000000003e483f7b,0xbf75be9500000000bf7b3e48,0xbf623ef1000000003e483f7b00000000,0xbf75be9500000000bf7b3e4800000000
.octa 0x80003f800000000080003f80,0x80003f800000000080003f8000000000,0xbf623ef100000000be953f75,0xbf623ef100000000be953f7500000000
.octa 0xbf55bf0e00000000bf0e3f55,0xbf55bf0e00000000bf0e3f5500000000,0x3dc9bf7f00000000bf463f22,0x3dc9bf7f00000000bf463f2200000000
.octa 0x3f6dbec400000000bf6d3ec4,0x3f6dbec400000000bf6d3ec400000000,0x3f463f2200000000bf7f3dc9,0x3f463f2200000000bf7f3dc900000000
.octa 0xbe483f7b00000000bf7bbe48,0xbe483f7b00000000bf7bbe4800000000,0xbf753e9500000000bf62bef1,0xbf753e9500000000bf62bef100000000
.octa 0x80003f800000000080003f80,0x80003f800000000080003f8000000000,0xbef1bf6200000000bf75be95,0xbef1bf6200000000bf75be9500000000
.octa 0x3f553f0e000000003f0ebf55,0x3f553f0e000000003f0ebf5500000000,0xbf7fbdc9000000003f223f46,0xbf7fbdc9000000003f223f4600000000
.octa 0x3f6dbec400000000bf6d3ec4,0x3f6dbec400000000bf6d3ec400000000,0xbf223f4600000000bdc9bf7f,0xbf223f4600000000bdc9bf7f00000000
.octa 0x3e48bf7b000000003f7b3e48,0x3e48bf7b000000003f7b3e4800000000,0x3e953f7500000000bef13f62,0x3e953f7500000000bef13f6200000000
.octa 0x80003f800000000080003f80,0x80003f800000000080003f8000000000,0x3f62bef1000000003e95bf75,0x3f62bef1000000003e95bf7500000000
.octa 0xbf55bf0e00000000bf0e3f55,0xbf55bf0e00000000bf0e3f5500000000,0xbdc93f7f000000003f46bf22,0xbdc93f7f000000003f46bf2200000000
.octa 0x3f6dbec400000000bf6d3ec4,0x3f6dbec400000000bf6d3ec400000000,0xbf46bf22000000003f7fbdc9,0xbf46bf22000000003f7fbdc900000000
.octa 0xbe483f7b00000000bf7bbe48,0xbe483f7b00000000bf7bbe4800000000,0x3f75be95000000003f623ef1,0x3f75be95000000003f623ef100000000
.octa 0x80003f800000000080003f80,0x80003f800000000080003f8000000000,0x3ef13f62000000003f753e95,0x3ef13f62000000003f753e9500000000
.octa 0x3f553f0e000000003f0ebf55,0x3f553f0e000000003f0ebf5500000000,0x3f7f3dc900000000bf22bf46,0x3f7f3dc900000000bf22bf4600000000
.octa 0x3f6dbec400000000bf6d3ec4,0x3f6dbec400000000bf6d3ec400000000,0x3f22bf46000000003dc93f7f,0x3f22bf46000000003dc93f7f00000000
.octa 0x3e48bf7b000000003f7b3e48,0x3e48bf7b000000003f7b3e4800000000,0xbe95bf75000000003ef1bf62,0xbe95bf75000000003ef1bf6200000000
.octa 0x3f800000000000003f800000,0x3f800000000000003f80000000000000,0x3ef13f62000000003f753e95,0x3ef13f62000000003f753e9500000000
.octa 0xbf0e3f55000000003f553f0e,0xbf0e3f55000000003f553f0e00000000,0xbf7fbdc9000000003f223f46,0xbf7fbdc9000000003f223f4600000000
.octa 0xbec4bf6d000000003ec43f6d,0xbec4bf6d000000003ec43f6d00000000,0x3f22bf46000000003dc93f7f,0x3f22bf46000000003dc93f7f00000000
.octa 0x3f7b3e4800000000be483f7b,0x3f7b3e4800000000be483f7b00000000,0x3e953f7500000000bef13f62,0x3e953f7500000000bef13f6200000000
.octa 0x3f800000000000003f800000,0x3f800000000000003f80000000000000,0xbf623ef100000000be953f75,0xbf623ef100000000be953f7500000000
.octa 0x3f0ebf5500000000bf55bf0e,0x3f0ebf5500000000bf55bf0e00000000,0xbdc93f7f000000003f46bf22,0xbdc93f7f000000003f46bf2200000000
.octa 0xbec4bf6d000000003ec43f6d,0xbec4bf6d000000003ec43f6d00000000,0x3f463f2200000000bf7f3dc9,0x3f463f2200000000bf7f3dc900000000
.octa 0xbf7bbe48000000003e48bf7b,0xbf7bbe48000000003e48bf7b00000000,0x3f75be95000000003f623ef1,0x3f75be95000000003f623ef100000000
.octa 0x3f800000000000003f800000,0x3f800000000000003f80000000000000,0xbef1bf6200000000bf75be95,0xbef1bf6200000000bf75be9500000000
.octa 0xbf0e3f55000000003f553f0e,0xbf0e3f55000000003f553f0e00000000,0x3f7f3dc900000000bf22bf46,0x3f7f3dc900000000bf22bf4600000000
.octa 0xbec4bf6d000000003ec43f6d,0xbec4bf6d000000003ec43f6d00000000,0xbf223f4600000000bdc9bf7f,0xbf223f4600000000bdc9bf7f00000000
.octa 0x3f7b3e4800000000be483f7b,0x3f7b3e4800000000be483f7b00000000,0xbe95bf75000000003ef1bf62,0xbe95bf75000000003ef1bf6200000000
.octa 0x3f800000000000003f800000,0x3f800000000000003f80000000000000,0x3f62bef1000000003e95bf75,0x3f62bef1000000003e95bf7500000000
.octa 0x3f0ebf5500000000bf55bf0e,0x3f0ebf5500000000bf55bf0e00000000,0x3dc9bf7f00000000bf463f22,0x3dc9bf7f00000000bf463f2200000000
.octa 0xbec4bf6d000000003ec43f6d,0xbec4bf6d000000003ec43f6d00000000,0xbf46bf22000000003f7fbdc9,0xbf46bf22000000003f7fbdc900000000
.octa 0xbf7bbe48000000003e48bf7b,0xbf7bbe48000000003e48bf7b00000000,0xbf753e9500000000bf62bef1,0xbf753e9500000000bf62bef100000000
.octa 0x3eac3f710000000000003f80,0x3f673edb0000000000003f80,0x3eac3f710000000000003f8000000000,0x3f673edb0000000000003f8000000000
.octa 0x3f71beac0000000000003f80,0x3edbbf670000000000003f80,0x3f71beac0000000000003f8000000000,0x3edbbf670000000000003f8000000000
.octa 0xbeacbf710000000000003f80,0xbf67bedb0000000000003f80,0xbeacbf710000000000003f8000000000,0xbf67bedb0000000000003f8000000000
.octa 0xbf713eac0000000000003f80,0xbedb3f670000000000003f80,0xbf713eac0000000000003f8000000000,0xbedb3f670000000000003f8000000000
.octa 0x3f5c3f04000000003f223f46,0xbe79bf78000000003f46bf22,0x3f5c3f04000000003f223f4600000000,0xbe79bf78000000003f46bf2200000000
.octa 0xbf043f5c00000000bf22bf46,0x3f78be7900000000bf463f22,0xbf043f5c00000000bf22bf4600000000,0x3f78be7900000000bf463f2200000000
.octa 0xbf5cbf04000000003f223f46,0x3e793f78000000003f46bf22,0xbf5cbf04000000003f223f4600000000,0x3e793f78000000003f46bf2200000000
.octa 0x3f04bf5c00000000bf22bf46,0xbf783e7900000000bf463f22,0x3f04bf5c00000000bf22bf4600000000,0xbf783e7900000000bf463f2200000000
.octa 0x3f7dbe16000000003f7b3e48,0xbf183f4e00000000bf7bbe48,0x3f7dbe16000000003f7b3e4800000000,0xbf183f4e00000000bf7bbe4800000000
.octa 0xbe16bf7d000000003f7b3e48,0x3f4e3f1800000000bf7bbe48,0xbe16bf7d000000003f7b3e4800000000,0x3f4e3f1800000000bf7bbe4800000000
.octa 0xbf7d3e16000000003f7b3e48,0x3f18bf4e00000000bf7bbe48,0xbf7d3e16000000003f7b3e4800000000,0x3f18bf4e00000000bf7bbe4800000000
.octa 0x3e163f7d000000003f7b3e48,0xbf4ebf1800000000bf7bbe48,0x3e163f7d000000003f7b3e4800000000,0xbf4ebf1800000000bf7bbe4800000000
.octa 0x3f2cbf3e000000003f62bef1,0x3f80bd49000000003ef13f62,0x3f2cbf3e000000003f62bef100000000,0x3f80bd49000000003ef13f6200000000
.octa 0x3f3e3f2c00000000bf623ef1,0x3d493f8000000000bef1bf62,0x3f3e3f2c00000000bf623ef100000000,0x3d493f8000000000bef1bf6200000000
.octa 0xbf2c3f3e000000003f62bef1,0xbf803d49000000003ef13f62,0xbf2c3f3e000000003f62bef100000000,0xbf803d49000000003ef13f6200000000
.octa 0xbf3ebf2c00000000bf623ef1,0xbd49bf8000000000bef1bf62,0xbf3ebf2c00000000bf623ef100000000,0xbd49bf8000000000bef1bf6200000000
.octa 0x3f71beac000000003f808000,0x3edbbf67000000003f808000,0x3f71beac000000003f80800000000000,0x3edbbf67000000003f80800000000000
.octa 0xbeacbf71000000003f808000,0xbf67bedb000000003f808000,0xbeacbf71000000003f80800000000000,0xbf67bedb000000003f80800000000000
.octa 0xbf713eac000000003f808000,0xbedb3f67000000003f808000,0xbf713eac000000003f80800000000000,0xbedb3f67000000003f80800000000000
.octa 0x3eac3f71000000003f808000,0x3f673edb000000003f808000,0x3eac3f71000000003f80800000000000,0x3f673edb000000003f80800000000000
.octa 0x3f04bf5c000000003f46bf22,0xbf783e7900000000bf22bf46,0x3f04bf5c000000003f46bf2200000000,0xbf783e7900000000bf22bf4600000000
.octa 0x3f5c3f0400000000bf463f22,0xbe79bf78000000003f223f46,0x3f5c3f0400000000bf463f2200000000,0xbe79bf78000000003f223f4600000000
.octa 0xbf043f5c000000003f46bf22,0x3f78be7900000000bf22bf46,0xbf043f5c000000003f46bf2200000000,0x3f78be7900000000bf22bf4600000000
.octa 0xbf5cbf0400000000bf463f22,0x3e793f78000000003f223f46,0xbf5cbf0400000000bf463f2200000000,0x3e793f78000000003f223f4600000000
.octa 0xbe16bf7d000000003e48bf7b,0x3f4e3f1800000000be483f7b,0xbe16bf7d000000003e48bf7b00000000,0x3f4e3f1800000000be483f7b00000000
.octa 0xbf7d3e16000000003e48bf7b,0x3f18bf4e00000000be483f7b,0xbf7d3e16000000003e48bf7b00000000,0x3f18bf4e00000000be483f7b00000000
.octa 0x3e163f7d000000003e48bf7b,0xbf4ebf1800000000be483f7b,0x3e163f7d000000003e48bf7b00000000,0xbf4ebf1800000000be483f7b00000000
.octa 0x3f7dbe16000000003e48bf7b,0xbf183f4e00000000be483f7b,0x3f7dbe16000000003e48bf7b00000000,0xbf183f4e00000000be483f7b00000000
.octa 0xbf3ebf2c00000000bef1bf62,0xbd49bf80000000003f62bef1,0xbf3ebf2c00000000bef1bf6200000000,0xbd49bf80000000003f62bef100000000
.octa 0x3f2cbf3e000000003ef13f62,0x3f80bd4900000000bf623ef1,0x3f2cbf3e000000003ef13f6200000000,0x3f80bd4900000000bf623ef100000000
.octa 0x3f3e3f2c00000000bef1bf62,0x3d493f80000000003f62bef1,0x3f3e3f2c00000000bef1bf6200000000,0x3d493f80000000003f62bef100000000
.octa 0xbf2c3f3e000000003ef13f62,0xbf803d4900000000bf623ef1,0xbf2c3f3e000000003ef13f6200000000,0xbf803d4900000000bf623ef100000000
.octa 0x80003f800000000080003f80,0x80003f800000000080003f8000000000,0xbf673edb00000000beac3f71,0xbf673edb00000000beac3f7100000000
.octa 0xbf46bf2200000000bf223f46,0xbf46bf2200000000bf223f4600000000,0x3e79bf7800000000bf5c3f04,0x3e79bf7800000000bf5c3f0400000000
.octa 0x3f7bbe4800000000bf7b3e48,0x3f7bbe4800000000bf7b3e4800000000,0x3f183f4e00000000bf7dbe16,0x3f183f4e00000000bf7dbe1600000000
.octa 0xbef13f6200000000bf62bef1,0xbef13f6200000000bf62bef100000000,0xbf80bd4900000000bf2cbf3e,0xbf80bd4900000000bf2cbf3e00000000
.octa 0x80003f800000000080003f80,0x80003f800000000080003f8000000000,0xbedbbf6700000000bf71beac,0xbedbbf6700000000bf71beac00000000
.octa 0x3f463f22000000003f22bf46,0x3f463f22000000003f22bf4600000000,0xbf78be79000000003f043f5c,0xbf78be79000000003f043f5c00000000
.octa 0x3f7bbe4800000000bf7b3e48,0x3f7bbe4800000000bf7b3e4800000000,0xbf4e3f18000000003e16bf7d,0xbf4e3f18000000003e16bf7d00000000
.octa 0x3ef1bf62000000003f623ef1,0x3ef1bf62000000003f623ef100000000,0xbd493f8000000000bf3e3f2c,0xbd493f8000000000bf3e3f2c00000000
.octa 0x80003f800000000080003f80,0x80003f800000000080003f8000000000,0x3f67bedb000000003eacbf71,0x3f67bedb000000003eacbf7100000000
.octa 0xbf46bf2200000000bf223f46,0xbf46bf2200000000bf223f4600000000,0xbe793f78000000003f5cbf04,0xbe793f78000000003f5cbf0400000000
.octa 0x3f7bbe4800000000bf7b3e48,0x3f7bbe4800000000bf7b3e4800000000,0xbf18bf4e000000003f7d3e16,0xbf18bf4e000000003f7d3e1600000000
.octa 0xbef13f6200000000bf62bef1,0xbef13f6200000000bf62bef100000000,0x3f803d49000000003f2c3f3e,0x3f803d49000000003f2c3f3e00000000
.octa 0x80003f800000000080003f80,0x80003f800000000080003f8000000000,0x3edb3f67000000003f713eac,0x3edb3f67000000003f713eac00000000
.octa 0x3f463f22000000003f22bf46,0x3f463f22000000003f22bf4600000000,0x3f783e7900000000bf04bf5c,0x3f783e7900000000bf04bf5c00000000
.octa 0x3f7bbe4800000000bf7b3e48,0x3f7bbe4800000000bf7b3e4800000000,0x3f4ebf1800000000be163f7d,0x3f4ebf1800000000be163f7d00000000
.octa 0x3ef1bf62000000003f623ef1,0x3ef1bf62000000003f623ef100000000,0x3d49bf80000000003f3ebf2c,0x3d49bf80000000003f3ebf2c00000000
.octa 0x3f800000000000003f800000,0x3f800000000000003f80000000000000,0x3edb3f67000000003f713eac,0x3edb3f67000000003f713eac00000000
.octa 0xbf223f46000000003f463f22,0xbf223f46000000003f463f2200000000,0xbf78be79000000003f043f5c,0xbf78be79000000003f043f5c00000000
.octa 0xbe48bf7b000000003e483f7b,0xbe48bf7b000000003e483f7b00000000,0x3f4ebf1800000000be163f7d,0x3f4ebf1800000000be163f7d00000000
.octa 0x3f623ef100000000bef13f62,0x3f623ef100000000bef13f6200000000,0xbd493f8000000000bf3e3f2c,0xbd493f8000000000bf3e3f2c00000000
.octa 0x3f800000000000003f800000,0x3f800000000000003f80000000000000,0xbf673edb00000000beac3f71,0xbf673edb00000000beac3f7100000000
.octa 0x3f22bf4600000000bf46bf22,0x3f22bf4600000000bf46bf2200000000,0xbe793f78000000003f5cbf04,0xbe793f78000000003f5cbf0400000000
.octa 0xbe48bf7b000000003e483f7b,0xbe48bf7b000000003e483f7b00000000,0x3f183f4e00000000bf7dbe16,0x3f183f4e00000000bf7dbe1600000000
.octa 0xbf62bef1000000003ef1bf62,0xbf62bef1000000003ef1bf6200000000,0x3f803d49000000003f2c3f3e,0x3f803d49000000003f2c3f3e00000000
.octa 0x3f800000000000003f800000,0x3f800000000000003f80000000000000,0xbedbbf6700000000bf71beac,0xbedbbf6700000000bf71beac00000000
.octa 0xbf223f46000000003f463f22,0xbf223f46000000003f463f2200000000,0x3f783e7900000000bf04bf5c,0x3f783e7900000000bf04bf5c00000000
.octa 0xbe48bf7b000000003e483f7b,0xbe48bf7b000000003e483f7b00000000,0xbf4e3f18000000003e16bf7d,0xbf4e3f18000000003e16bf7d00000000
.octa 0x3f623ef100000000bef13f62,0x3f623ef100000000bef13f6200000000,0x3d49bf80000000003f3ebf2c,0x3d49bf80000000003f3ebf2c00000000
.octa 0x3f800000000000003f800000,0x3f800000000000003f80000000000000,0x3f67bedb000000003eacbf71,0x3f67bedb000000003eacbf7100000000
.octa 0x3f22bf4600000000bf46bf22,0x3f22bf4600000000bf46bf2200000000,0x3e79bf7800000000bf5c3f04,0x3e79bf7800000000bf5c3f0400000000
.octa 0xbe48bf7b000000003e483f7b,0xbe48bf7b000000003e483f7b00000000,0xbf18bf4e000000003f7d3e16,0xbf18bf4e000000003f7d3e1600000000
.octa 0xbf62bef1000000003ef1bf62,0xbf62bef1000000003ef1bf6200000000,0xbf80bd4900000000bf2cbf3e,0xbf80bd4900000000bf2cbf3e00000000
.octa 0x3ec43f6d0000000000003f80,0x3f6d3ec40000000000003f80,0x3ec43f6d0000000000003f8000000000,0x3f6d3ec40000000000003f8000000000
.octa 0x3f6dbec40000000000003f80,0x3ec4bf6d0000000000003f80,0x3f6dbec40000000000003f8000000000,0x3ec4bf6d0000000000003f8000000000
.octa 0xbec4bf6d0000000000003f80,0xbf6dbec40000000000003f80,0xbec4bf6d0000000000003f8000000000,0xbf6dbec40000000000003f8000000000
.octa 0xbf6d3ec40000000000003f80,0xbec43f6d0000000000003f80,0xbf6d3ec40000000000003f8000000000,0xbec43f6d0000000000003f8000000000
.octa 0x3f6d3ec4000000003f353f35,0xbec4bf6d000000003f35bf35,0x3f6d3ec4000000003f353f3500000000,0xbec4bf6d000000003f35bf3500000000
.octa 0xbec43f6d00000000bf35bf35,0x3f6dbec400000000bf353f35,0xbec43f6d00000000bf35bf3500000000,0x3f6dbec400000000bf353f3500000000
.octa 0xbf6dbec4000000003f353f35,0x3ec43f6d000000003f35bf35,0xbf6dbec4000000003f353f3500000000,0x3ec43f6d000000003f35bf3500000000
.octa 0x3ec4bf6d00000000bf35bf35,0xbf6d3ec400000000bf353f35,0x3ec4bf6d00000000bf35bf3500000000,0xbf6d3ec400000000bf353f3500000000
.octa 0x3f6dbec4000000003f80248d,0xbec43f6d00000000bf80a554,0x3f6dbec4000000003f80248d00000000,0xbec43f6d00000000bf80a55400000000
.octa 0xbec4bf6d000000003f8025b0,0x3f6d3ec400000000bf80a5f7,0xbec4bf6d000000003f8025b000000000,0x3f6d3ec400000000bf80a5f700000000
.octa 0xbf6d3ec4000000003f80261f,0x3ec4bf6d00000000bf80a731,0xbf6d3ec4000000003f80261f00000000,0x3ec4bf6d00000000bf80a73100000000
.octa 0x3ec43f6d000000003f80a68d,0xbf6dbec400000000bf80a742,0x3ec43f6d000000003f80a68d00000000,0xbf6dbec400000000bf80a74200000000
.octa 0x3ec4bf6d000000003f35bf35,0x3f6dbec4000000003f353f35,0x3ec4bf6d000000003f35bf3500000000,0x3f6dbec4000000003f353f3500000000
.octa 0x3f6d3ec400000000bf353f35,0x3ec43f6d00000000bf35bf35,0x3f6d3ec400000000bf353f3500000000,0x3ec43f6d00000000bf35bf3500000000
.octa 0xbec43f6d000000003f35bf35,0xbf6d3ec4000000003f353f35,0xbec43f6d000000003f35bf3500000000,0xbf6d3ec4000000003f353f3500000000
.octa 0xbf6dbec400000000bf353f35,0xbec4bf6d00000000bf35bf35,0xbf6dbec400000000bf353f3500000000,0xbec4bf6d00000000bf35bf3500000000
.octa 0x3f6dbec4000000003f808000,0x3ec4bf6d000000003f808000,0x3f6dbec4000000003f80800000000000,0x3ec4bf6d000000003f80800000000000
.octa 0xbec4bf6d000000003f808000,0xbf6dbec4000000003f808000,0xbec4bf6d000000003f80800000000000,0xbf6dbec4000000003f80800000000000
.octa 0xbf6d3ec4000000003f808000,0xbec43f6d000000003f808000,0xbf6d3ec4000000003f80800000000000,0xbec43f6d000000003f80800000000000
.octa 0x3ec43f6d000000003f808000,0x3f6d3ec4000000003f808000,0x3ec43f6d000000003f80800000000000,0x3f6d3ec4000000003f80800000000000
.octa 0x3ec4bf6d000000003f35bf35,0xbf6d3ec400000000bf35bf35,0x3ec4bf6d000000003f35bf3500000000,0xbf6d3ec400000000bf35bf3500000000
.octa 0x3f6d3ec400000000bf353f35,0xbec4bf6d000000003f353f35,0x3f6d3ec400000000bf353f3500000000,0xbec4bf6d000000003f353f3500000000
.octa 0xbec43f6d000000003f35bf35,0x3f6dbec400000000bf35bf35,0xbec43f6d000000003f35bf3500000000,0x3f6dbec400000000bf35bf3500000000
.octa 0xbf6dbec400000000bf353f35,0x3ec43f6d000000003f353f35,0xbf6dbec400000000bf353f3500000000,0x3ec43f6d000000003f353f3500000000
.octa 0xbec4bf6d00000000248dbf80,0x3f6d3ec400000000a5543f80,0xbec4bf6d00000000248dbf8000000000,0x3f6d3ec400000000a5543f8000000000
.octa 0xbf6d3ec40000000025b0bf80,0x3ec4bf6d00000000a5f73f80,0xbf6d3ec40000000025b0bf8000000000,0x3ec4bf6d00000000a5f73f8000000000
.octa 0x3ec43f6d00000000261fbf80,0xbf6dbec400000000a7313f80,0x3ec43f6d00000000261fbf8000000000,0xbf6dbec400000000a7313f8000000000
.octa 0x3f6dbec400000000a68dbf80,0xbec43f6d00000000a7423f80,0x3f6dbec400000000a68dbf8000000000,0xbec43f6d00000000a7423f8000000000
.octa 0xbf6dbec400000000bf35bf35,0xbec4bf6d000000003f35bf35,0xbf6dbec400000000bf35bf3500000000,0xbec4bf6d000000003f35bf3500000000
.octa 0x3ec4bf6d000000003f353f35,0x3f6dbec400000000bf353f35,0x3ec4bf6d000000003f353f3500000000,0x3f6dbec400000000bf353f3500000000
.octa 0x3f6d3ec400000000bf35bf35,0x3ec43f6d000000003f35bf35,0x3f6d3ec400000000bf35bf3500000000,0x3ec43f6d000000003f35bf3500000000
.octa 0xbec43f6d000000003f353f35,0xbf6d3ec400000000bf353f35,0xbec43f6d000000003f353f3500000000,0xbf6d3ec400000000bf353f3500000000
.octa 0x80003f800000000080003f80,0x80003f800000000080003f8000000000,0xbf6d3ec400000000bec43f6d,0xbf6d3ec400000000bec43f6d00000000
.octa 0xbf35bf3500000000bf353f35,0xbf35bf3500000000bf353f3500000000,0x3ec4bf6d00000000bf6d3ec4,0x3ec4bf6d00000000bf6d3ec400000000
.octa 0x3f80a55400000000bf80248d,0x3f80a55400000000bf80248d00000000,0x3ec43f6d00000000bf6dbec4,0x3ec43f6d00000000bf6dbec400000000
.octa 0xbf353f3500000000bf35bf35,0xbf353f3500000000bf35bf3500000000,0xbf6dbec400000000bec4bf6d,0xbf6dbec400000000bec4bf6d00000000
.octa 0x80003f800000000080003f80,0x80003f800000000080003f8000000000,0xbec4bf6d00000000bf6dbec4,0xbec4bf6d00000000bf6dbec400000000
.octa 0x3f353f35000000003f35bf35,0x3f353f35000000003f35bf3500000000,0xbf6dbec4000000003ec43f6d,0xbf6dbec4000000003ec43f6d00000000
.octa 0x3f80a5f700000000bf8025b0,0x3f80a5f700000000bf8025b000000000,0xbf6d3ec4000000003ec4bf6d,0xbf6d3ec4000000003ec4bf6d00000000
.octa 0x3f35bf35000000003f353f35,0x3f35bf35000000003f353f3500000000,0xbec43f6d00000000bf6d3ec4,0xbec43f6d00000000bf6d3ec400000000
.octa 0x80003f800000000080003f80,0x80003f800000000080003f8000000000,0x3f6dbec4000000003ec4bf6d,0x3f6dbec4000000003ec4bf6d00000000
.octa 0xbf35bf3500000000bf353f35,0xbf35bf3500000000bf353f3500000000,0xbec43f6d000000003f6dbec4,0xbec43f6d000000003f6dbec400000000
.octa 0x3f80a73100000000bf80261f,0x3f80a73100000000bf80261f00000000,0xbec4bf6d000000003f6d3ec4,0xbec4bf6d000000003f6d3ec400000000
.octa 0xbf353f3500000000bf35bf35,0xbf353f3500000000bf35bf3500000000,0x3f6d3ec4000000003ec43f6d,0x3f6d3ec4000000003ec43f6d00000000
.octa 0x80003f800000000080003f80,0x80003f800000000080003f8000000000,0x3ec43f6d000000003f6d3ec4,0x3ec43f6d000000003f6d3ec400000000
.octa 0x3f353f35000000003f35bf35,0x3f353f35000000003f35bf3500000000,0x3f6d3ec400000000bec4bf6d,0x3f6d3ec400000000bec4bf6d00000000
.octa 0x3f80a74200000000bf80a68d,0x3f80a74200000000bf80a68d00000000,0x3f6dbec400000000bec43f6d,0x3f6dbec400000000bec43f6d00000000
.octa 0x3f35bf35000000003f353f35,0x3f35bf35000000003f353f3500000000,0x3ec4bf6d000000003f6dbec4,0x3ec4bf6d000000003f6dbec400000000
.octa 0x3f800000000000003f800000,0x3f800000000000003f80000000000000,0x3ec43f6d000000003f6d3ec4,0x3ec43f6d000000003f6d3ec400000000
.octa 0xbf353f35000000003f353f35,0xbf353f35000000003f353f3500000000,0xbf6dbec4000000003ec43f6d,0xbf6dbec4000000003ec43f6d00000000
.octa 0xa554bf8000000000248d3f80,0xa554bf8000000000248d3f8000000000,0x3f6dbec400000000bec43f6d,0x3f6dbec400000000bec43f6d00000000
.octa 0x3f353f3500000000bf353f35,0x3f353f3500000000bf353f3500000000,0xbec43f6d00000000bf6d3ec4,0xbec43f6d00000000bf6d3ec400000000
.octa 0x3f800000000000003f800000,0x3f800000000000003f80000000000000,0xbf6d3ec400000000bec43f6d,0xbf6d3ec400000000bec43f6d00000000
.octa 0x3f35bf3500000000bf35bf35,0x3f35bf3500000000bf35bf3500000000,0xbec43f6d000000003f6dbec4,0xbec43f6d000000003f6dbec400000000
.octa 0xa5f7bf800000000025b03f80,0xa5f7bf800000000025b03f8000000000,0x3ec43f6d00000000bf6dbec4,0x3ec43f6d00000000bf6dbec400000000
.octa 0xbf35bf35000000003f35bf35,0xbf35bf35000000003f35bf3500000000,0x3f6d3ec4000000003ec43f6d,0x3f6d3ec4000000003ec43f6d00000000
.octa 0x3f800000000000003f800000,0x3f800000000000003f80000000000000,0xbec4bf6d00000000bf6dbec4,0xbec4bf6d00000000bf6dbec400000000
.octa 0xbf353f35000000003f353f35,0xbf353f35000000003f353f3500000000,0x3f6d3ec400000000bec4bf6d,0x3f6d3ec400000000bec4bf6d00000000
.octa 0xa731bf8000000000261f3f80,0xa731bf8000000000261f3f8000000000,0xbf6d3ec4000000003ec4bf6d,0xbf6d3ec4000000003ec4bf6d00000000
.octa 0x3f353f3500000000bf353f35,0x3f353f3500000000bf353f3500000000,0x3ec4bf6d000000003f6dbec4,0x3ec4bf6d000000003f6dbec400000000
.octa 0x3f800000000000003f800000,0x3f800000000000003f80000000000000,0x3f6dbec4000000003ec4bf6d,0x3f6dbec4000000003ec4bf6d00000000
.octa 0x3f35bf3500000000bf35bf35,0x3f35bf3500000000bf35bf3500000000,0x3ec4bf6d00000000bf6d3ec4,0x3ec4bf6d00000000bf6d3ec400000000
.octa 0xa742bf8000000000a68d3f80,0xa742bf8000000000a68d3f8000000000,0xbec4bf6d000000003f6d3ec4,0xbec4bf6d000000003f6d3ec400000000
.octa 0xbf35bf35000000003f35bf35,0xbf35bf35000000003f35bf3500000000,0xbf6dbec400000000bec4bf6d,0xbf6dbec400000000bec4bf6d00000000
.octa 0x3edb3f670000000000003f80,0x3f713eac0000000000003f80,0x3edb3f670000000000003f8000000000,0x3f713eac0000000000003f8000000000
.octa 0x3f67bedb0000000000003f80,0x3eacbf710000000000003f80,0x3f67bedb0000000000003f8000000000,0x3eacbf710000000000003f8000000000
.octa 0xbedbbf670000000000003f80,0xbf71beac0000000000003f80,0xbedbbf670000000000003f8000000000,0xbf71beac0000000000003f8000000000
.octa 0xbf673edb0000000000003f80,0xbeac3f710000000000003f80,0xbf673edb0000000000003f8000000000,0xbeac3f710000000000003f8000000000
.octa 0x3f783e79000000003f463f22,0xbf04bf5c000000003f22bf46,0x3f783e79000000003f463f2200000000,0xbf04bf5c000000003f22bf4600000000
.octa 0xbe793f7800000000bf46bf22,0x3f5cbf0400000000bf223f46,0xbe793f7800000000bf46bf2200000000,0x3f5cbf0400000000bf223f4600000000
.octa 0xbf78be79000000003f463f22,0x3f043f5c000000003f22bf46,0xbf78be79000000003f463f2200000000,0x3f043f5c000000003f22bf4600000000
.octa 0x3e79bf7800000000bf46bf22,0xbf5c3f0400000000bf223f46,0x3e79bf7800000000bf46bf2200000000,0xbf5c3f0400000000bf223f4600000000
.octa 0x3f4ebf18000000003f7bbe48,0xbe163f7d00000000bf7b3e48,0x3f4ebf18000000003f7bbe4800000000,0xbe163f7d00000000bf7b3e4800000000
.octa 0xbf18bf4e000000003f7bbe48,0x3f7d3e1600000000bf7b3e48,0xbf18bf4e000000003f7bbe4800000000,0x3f7d3e1600000000bf7b3e4800000000
.octa 0xbf4e3f18000000003f7bbe48,0x3e16bf7d00000000bf7b3e48,0xbf4e3f18000000003f7bbe4800000000,0x3e16bf7d00000000bf7b3e4800000000
.octa 0x3f183f4e000000003f7bbe48,0xbf7dbe1600000000bf7b3e48,0x3f183f4e000000003f7bbe4800000000,0xbf7dbe1600000000bf7b3e4800000000
.octa 0x3d49bf80000000003ef1bf62,0x3f3ebf2c000000003f623ef1,0x3d49bf80000000003ef1bf6200000000,0x3f3ebf2c000000003f623ef100000000
.octa 0x3f803d4900000000bef13f62,0x3f2c3f3e00000000bf62bef1,0x3f803d4900000000bef13f6200000000,0x3f2c3f3e00000000bf62bef100000000
.octa 0xbd493f80000000003ef1bf62,0xbf3e3f2c000000003f623ef1,0xbd493f80000000003ef1bf6200000000,0xbf3e3f2c000000003f623ef100000000
.octa 0xbf80bd4900000000bef13f62,0xbf2cbf3e00000000bf62bef1,0xbf80bd4900000000bef13f6200000000,0xbf2cbf3e00000000bf62bef100000000
.octa 0x3f67bedb000000003f808000,0x3eacbf71000000003f808000,0x3f67bedb000000003f80800000000000,0x3eacbf71000000003f80800000000000
.octa 0xbedbbf67000000003f808000,0xbf71beac000000003f808000,0xbedbbf67000000003f80800000000000,0xbf71beac000000003f80800000000000
.octa 0xbf673edb000000003f808000,0xbeac3f71000000003f808000,0xbf673edb000000003f80800000000000,0xbeac3f71000000003f80800000000000
.octa 0x3edb3f67000000003f808000,0x3f713eac000000003f808000,0x3edb3f67000000003f80800000000000,0x3f713eac000000003f80800000000000
.octa 0x3e79bf78000000003f22bf46,0xbf5c3f0400000000bf46bf22,0x3e79bf78000000003f22bf4600000000,0xbf5c3f0400000000bf46bf2200000000
.octa 0x3f783e7900000000bf223f46,0xbf04bf5c000000003f463f22,0x3f783e7900000000bf223f4600000000,0xbf04bf5c000000003f463f2200000000
.octa 0xbe793f78000000003f22bf46,0x3f5cbf0400000000bf46bf22,0xbe793f78000000003f22bf4600000000,0x3f5cbf0400000000bf46bf2200000000
.octa 0xbf78be7900000000bf223f46,0x3f043f5c000000003f463f22,0xbf78be7900000000bf223f4600000000,0x3f043f5c000000003f463f2200000000
.octa 0xbf18bf4e00000000be48bf7b,0x3f7d3e16000000003e483f7b,0xbf18bf4e00000000be48bf7b00000000,0x3f7d3e16000000003e483f7b00000000
.octa 0xbf4e3f1800000000be48bf7b,0x3e16bf7d000000003e483f7b,0xbf4e3f1800000000be48bf7b00000000,0x3e16bf7d000000003e483f7b00000000
.octa 0x3f183f4e00000000be48bf7b,0xbf7dbe16000000003e483f7b,0x3f183f4e00000000be48bf7b00000000,0xbf7dbe16000000003e483f7b00000000
.octa 0x3f4ebf1800000000be48bf7b,0xbe163f7d000000003e483f7b,0x3f4ebf1800000000be48bf7b00000000,0xbe163f7d000000003e483f7b00000000
.octa 0xbf80bd4900000000bf62bef1,0xbf2cbf3e000000003ef1bf62,0xbf80bd4900000000bf62bef100000000,0xbf2cbf3e000000003ef1bf6200000000
.octa 0x3d49bf80000000003f623ef1,0x3f3ebf2c00000000bef13f62,0x3d49bf80000000003f623ef100000000,0x3f3ebf2c00000000bef13f6200000000
.octa 0x3f803d4900000000bf62bef1,0x3f2c3f3e000000003ef1bf62,0x3f803d4900000000bf62bef100000000,0x3f2c3f3e000000003ef1bf6200000000
.octa 0xbd493f80000000003f623ef1,0xbf3e3f2c00000000bef13f62,0xbd493f80000000003f623ef100000000,0xbf3e3f2c00000000bef13f6200000000
.octa 0x80003f800000000080003f80,0x80003f800000000080003f8000000000,0xbf713eac00000000bedb3f67,0xbf713eac00000000bedb3f6700000000
.octa 0xbf22bf4600000000bf463f22,0xbf22bf4600000000bf463f2200000000,0x3f04bf5c00000000bf783e79,0x3f04bf5c00000000bf783e7900000000
.octa 0x3f7b3e4800000000bf7bbe48,0x3f7b3e4800000000bf7bbe4800000000,0x3e163f7d00000000bf4ebf18,0x3e163f7d00000000bf4ebf1800000000
.octa 0xbf623ef100000000bef1bf62,0xbf623ef100000000bef1bf6200000000,0xbf3ebf2c00000000bd49bf80,0xbf3ebf2c00000000bd49bf8000000000
.octa 0x80003f800000000080003f80,0x80003f800000000080003f8000000000,0xbeacbf7100000000bf67bedb,0xbeacbf7100000000bf67bedb00000000
.octa 0x3f223f46000000003f46bf22,0x3f223f46000000003f46bf2200000000,0xbf5cbf04000000003e793f78,0xbf5cbf04000000003e793f7800000000
.octa 0x3f7b3e4800000000bf7bbe48,0x3f7b3e4800000000bf7bbe4800000000,0xbf7d3e16000000003f18bf4e,0xbf7d3e16000000003f18bf4e00000000
.octa 0x3f62bef1000000003ef13f62,0x3f62bef1000000003ef13f6200000000,0xbf2c3f3e00000000bf803d49,0xbf2c3f3e00000000bf803d4900000000
.octa 0x80003f800000000080003f80,0x80003f800000000080003f8000000000,0x3f71beac000000003edbbf67,0x3f71beac000000003edbbf6700000000
.octa 0xbf22bf4600000000bf463f22,0xbf22bf4600000000bf463f2200000000,0xbf043f5c000000003f78be79,0xbf043f5c000000003f78be7900000000
.octa 0x3f7b3e4800000000bf7bbe48,0x3f7b3e4800000000bf7bbe4800000000,0xbe16bf7d000000003f4e3f18,0xbe16bf7d000000003f4e3f1800000000
.octa 0xbf623ef100000000bef1bf62,0xbf623ef100000000bef1bf6200000000,0x3f3e3f2c000000003d493f80,0x3f3e3f2c000000003d493f8000000000
.octa 0x80003f800000000080003f80,0x80003f800000000080003f8000000000,0x3eac3f71000000003f673edb,0x3eac3f71000000003f673edb00000000
.octa 0x3f223f46000000003f46bf22,0x3f223f46000000003f46bf2200000000,0x3f5c3f0400000000be79bf78,0x3f5c3f0400000000be79bf7800000000
.octa 0x3f7b3e4800000000bf7bbe48,0x3f7b3e4800000000bf7bbe4800000000,0x3f7dbe1600000000bf183f4e,0x3f7dbe1600000000bf183f4e00000000
.octa 0x3f62bef1000000003ef13f62,0x3f62bef1000000003ef13f6200000000,0x3f2cbf3e000000003f80bd49,0x3f2cbf3e000000003f80bd4900000000
.octa 0x3f800000000000003f800000,0x3f800000000000003f80000000000000,0x3eac3f71000000003f673edb,0x3eac3f71000000003f673edb00000000
.octa 0xbf463f22000000003f223f46,0xbf463f22000000003f223f4600000000,0xbf5cbf04000000003e793f78,0xbf5cbf04000000003e793f7800000000
.octa 0x3e48bf7b00000000be483f7b,0x3e48bf7b00000000be483f7b00000000,0x3f7dbe1600000000bf183f4e,0x3f7dbe1600000000bf183f4e00000000
.octa 0x3ef13f6200000000bf623ef1,0x3ef13f6200000000bf623ef100000000,0xbf2c3f3e00000000bf803d49,0xbf2c3f3e00000000bf803d4900000000
.octa 0x3f800000000000003f800000,0x3f800000000000003f80000000000000,0xbf713eac00000000bedb3f67,0xbf713eac00000000bedb3f6700000000
.octa 0x3f46bf2200000000bf22bf46,0x3f46bf2200000000bf22bf4600000000,0xbf043f5c000000003f78be79,0xbf043f5c000000003f78be7900000000
.octa 0x3e48bf7b00000000be483f7b,0x3e48bf7b00000000be483f7b00000000,0x3e163f7d00000000bf4ebf18,0x3e163f7d00000000bf4ebf1800000000
.octa 0xbef1bf62000000003f62bef1,0xbef1bf62000000003f62bef100000000,0x3f3e3f2c000000003d493f80,0x3f3e3f2c000000003d493f8000000000
.octa 0x3f800000000000003f800000,0x3f800000000000003f80000000000000,0xbeacbf7100000000bf67bedb,0xbeacbf7100000000bf67bedb00000000
.octa 0xbf463f22000000003f223f46,0xbf463f22000000003f223f4600000000,0x3f5c3f0400000000be79bf78,0x3f5c3f0400000000be79bf7800000000
.octa 0x3e48bf7b00000000be483f7b,0x3e48bf7b00000000be483f7b00000000,0xbf7d3e16000000003f18bf4e,0xbf7d3e16000000003f18bf4e00000000
.octa 0x3ef13f6200000000bf623ef1,0x3ef13f6200000000bf623ef100000000,0x3f2cbf3e000000003f80bd49,0x3f2cbf3e000000003f80bd4900000000
.octa 0x3f800000000000003f800000,0x3f800000000000003f80000000000000,0x3f71beac000000003edbbf67,0x3f71beac000000003edbbf6700000000
.octa 0x3f46bf2200000000bf22bf46,0x3f46bf2200000000bf22bf4600000000,0x3f04bf5c00000000bf783e79,0x3f04bf5c00000000bf783e7900000000
.octa 0x3e48bf7b00000000be483f7b,0x3e48bf7b00000000be483f7b00000000,0xbe16bf7d000000003f4e3f18,0xbe16bf7d000000003f4e3f1800000000
.octa 0xbef1bf62000000003f62bef1,0xbef1bf62000000003f62bef100000000,0xbf3ebf2c00000000bd49bf80,0xbf3ebf2c00000000bd49bf8000000000
.octa 0x3ef13f620000000000003f80,0x3f753e950000000000003f80,0x3ef13f620000000000003f8000000000,0x3f753e950000000000003f8000000000
.octa 0x3f62bef10000000000003f80,0x3e95bf750000000000003f80,0x3f62bef10000000000003f8000000000,0x3e95bf750000000000003f8000000000
.octa 0xbef1bf620000000000003f80,0xbf75be950000000000003f80,0xbef1bf620000000000003f8000000000,0xbf75be950000000000003f8000000000
.octa 0xbf623ef10000000000003f80,0xbe953f750000000000003f80,0xbf623ef10000000000003f8000000000,0xbe953f750000000000003f8000000000
.octa 0x3f7f3dc9000000003f553f0e,0xbf22bf46000000003f0ebf55,0x3f7f3dc9000000003f553f0e00000000,0xbf22bf46000000003f0ebf5500000000
.octa 0xbdc93f7f00000000bf55bf0e,0x3f46bf2200000000bf0e3f55,0xbdc93f7f00000000bf55bf0e00000000,0x3f46bf2200000000bf0e3f5500000000
.octa 0xbf7fbdc9000000003f553f0e,0x3f223f46000000003f0ebf55,0xbf7fbdc9000000003f553f0e00000000,0x3f223f46000000003f0ebf5500000000
.octa 0x3dc9bf7f00000000bf55bf0e,0xbf463f2200000000bf0e3f55,0x3dc9bf7f00000000bf55bf0e00000000,0xbf463f2200000000bf0e3f5500000000
.octa 0x3f22bf46000000003f6dbec4,0x3dc93f7f00000000bf6d3ec4,0x3f22bf46000000003f6dbec400000000,0x3dc93f7f00000000bf6d3ec400000000
.octa 0xbf46bf22000000003f6dbec4,0x3f7fbdc900000000bf6d3ec4,0xbf46bf22000000003f6dbec400000000,0x3f7fbdc900000000bf6d3ec400000000
.octa 0xbf223f46000000003f6dbec4,0xbdc9bf7f00000000bf6d3ec4,0xbf223f46000000003f6dbec400000000,0xbdc9bf7f00000000bf6d3ec400000000
.octa 0x3f463f22000000003f6dbec4,0xbf7f3dc900000000bf6d3ec4,0x3f463f22000000003f6dbec400000000,0xbf7f3dc900000000bf6d3ec400000000
.octa 0xbe95bf75000000003e48bf7b,0x3ef1bf62000000003f7b3e48,0xbe95bf75000000003e48bf7b00000000,0x3ef1bf62000000003f7b3e4800000000
.octa 0x3f75be9500000000be483f7b,0x3f623ef100000000bf7bbe48,0x3f75be9500000000be483f7b00000000,0x3f623ef100000000bf7bbe4800000000
.octa 0x3e953f75000000003e48bf7b,0xbef13f62000000003f7b3e48,0x3e953f75000000003e48bf7b00000000,0xbef13f62000000003f7b3e4800000000
.octa 0xbf753e9500000000be483f7b,0xbf62bef100000000bf7bbe48,0xbf753e9500000000be483f7b00000000,0xbf62bef100000000bf7bbe4800000000
.octa 0x3f62bef1000000003f808000,0x3e95bf75000000003f808000,0x3f62bef1000000003f80800000000000,0x3e95bf75000000003f80800000000000
.octa 0xbef1bf62000000003f808000,0xbf75be95000000003f808000,0xbef1bf62000000003f80800000000000,0xbf75be95000000003f80800000000000
.octa 0xbf623ef1000000003f808000,0xbe953f75000000003f808000,0xbf623ef1000000003f80800000000000,0xbe953f75000000003f80800000000000
.octa 0x3ef13f62000000003f808000,0x3f753e95000000003f808000,0x3ef13f62000000003f80800000000000,0x3f753e95000000003f80800000000000
.octa 0x3dc9bf7f000000003f0ebf55,0xbf463f2200000000bf55bf0e,0x3dc9bf7f000000003f0ebf5500000000,0xbf463f2200000000bf55bf0e00000000
.octa 0x3f7f3dc900000000bf0e3f55,0xbf22bf46000000003f553f0e,0x3f7f3dc900000000bf0e3f5500000000,0xbf22bf46000000003f553f0e00000000
.octa 0xbdc93f7f000000003f0ebf55,0x3f46bf2200000000bf55bf0e,0xbdc93f7f000000003f0ebf5500000000,0x3f46bf2200000000bf55bf0e00000000
.octa 0xbf7fbdc900000000bf0e3f55,0x3f223f46000000003f553f0e,0xbf7fbdc900000000bf0e3f5500000000,0x3f223f46000000003f553f0e00000000
.octa 0xbf46bf2200000000bec4bf6d,0x3f7fbdc9000000003ec43f6d,0xbf46bf2200000000bec4bf6d00000000,0x3f7fbdc9000000003ec43f6d00000000
.octa 0xbf223f4600000000bec4bf6d,0xbdc9bf7f000000003ec43f6d,0xbf223f4600000000bec4bf6d00000000,0xbdc9bf7f000000003ec43f6d00000000
.octa 0x3f463f2200000000bec4bf6d,0xbf7f3dc9000000003ec43f6d,0x3f463f2200000000bec4bf6d00000000,0xbf7f3dc9000000003ec43f6d00000000
.octa 0x3f22bf4600000000bec4bf6d,0x3dc93f7f000000003ec43f6d,0x3f22bf4600000000bec4bf6d00000000,0x3dc93f7f000000003ec43f6d00000000
.octa 0xbf753e9500000000bf7bbe48,0xbf62bef1000000003e48bf7b,0xbf753e9500000000bf7bbe4800000000,0xbf62bef1000000003e48bf7b00000000
.octa 0xbe95bf75000000003f7b3e48,0x3ef1bf6200000000be483f7b,0xbe95bf75000000003f7b3e4800000000,0x3ef1bf6200000000be483f7b00000000
.octa 0x3f75be9500000000bf7bbe48,0x3f623ef1000000003e48bf7b,0x3f75be9500000000bf7bbe4800000000,0x3f623ef1000000003e48bf7b00000000
.octa 0x3e953f75000000003f7b3e48,0xbef13f6200000000be483f7b,0x3e953f75000000003f7b3e4800000000,0xbef13f6200000000be483f7b00000000
.octa 0x80003f800000000080003f80,0x80003f800000000080003f8000000000,0xbf753e9500000000bef13f62,0xbf753e9500000000bef13f6200000000
.octa 0xbf0ebf5500000000bf553f0e,0xbf0ebf5500000000bf553f0e00000000,0x3f22bf4600000000bf7f3dc9,0x3f22bf4600000000bf7f3dc900000000
.octa 0x3f6d3ec400000000bf6dbec4,0x3f6d3ec400000000bf6dbec400000000,0xbdc93f7f00000000bf22bf46,0xbdc93f7f00000000bf22bf4600000000
.octa 0xbf7b3e4800000000be48bf7b,0xbf7b3e4800000000be48bf7b00000000,0xbef1bf62000000003e95bf75,0xbef1bf62000000003e95bf7500000000
.octa 0x80003f800000000080003f80,0x80003f800000000080003f8000000000,0xbe95bf7500000000bf62bef1,0xbe95bf7500000000bf62bef100000000
.octa 0x3f0e3f55000000003f55bf0e,0x3f0e3f55000000003f55bf0e00000000,0xbf46bf22000000003dc93f7f,0xbf46bf22000000003dc93f7f00000000
.octa 0x3f6d3ec400000000bf6dbec4,0x3f6d3ec400000000bf6dbec400000000,0xbf7fbdc9000000003f46bf22,0xbf7fbdc9000000003f46bf2200000000
.octa 0x3f7bbe48000000003e483f7b,0x3f7bbe48000000003e483f7b00000000,0xbf623ef100000000bf75be95,0xbf623ef100000000bf75be9500000000
.octa 0x80003f800000000080003f80,0x80003f800000000080003f8000000000,0x3f75be95000000003ef1bf62,0x3f75be95000000003ef1bf6200000000
.octa 0xbf0ebf5500000000bf553f0e,0xbf0ebf5500000000bf553f0e00000000,0xbf223f46000000003f7fbdc9,0xbf223f46000000003f7fbdc900000000
.octa 0x3f6d3ec400000000bf6dbec4,0x3f6d3ec400000000bf6dbec400000000,0x3dc9bf7f000000003f223f46,0x3dc9bf7f000000003f223f4600000000
.octa 0xbf7b3e4800000000be48bf7b,0xbf7b3e4800000000be48bf7b00000000,0x3ef13f6200000000be953f75,0x3ef13f6200000000be953f7500000000
.octa 0x80003f800000000080003f80,0x80003f800000000080003f8000000000,0x3e953f75000000003f623ef1,0x3e953f75000000003f623ef100000000
.octa 0x3f0e3f55000000003f55bf0e,0x3f0e3f55000000003f55bf0e00000000,0x3f463f2200000000bdc9bf7f,0x3f463f2200000000bdc9bf7f00000000
.octa 0x3f6d3ec400000000bf6dbec4,0x3f6d3ec400000000bf6dbec400000000,0x3f7f3dc900000000bf463f22,0x3f7f3dc900000000bf463f2200000000
.octa 0x3f7bbe48000000003e483f7b,0x3f7bbe48000000003e483f7b00000000,0x3f62bef1000000003f753e95,0x3f62bef1000000003f753e9500000000
.octa 0x3f800000000000003f800000,0x3f800000000000003f80000000000000,0x3e953f75000000003f623ef1,0x3e953f75000000003f623ef100000000
.octa 0xbf553f0e000000003f0e3f55,0xbf553f0e000000003f0e3f5500000000,0xbf46bf22000000003dc93f7f,0xbf46bf22000000003dc93f7f00000000
.octa 0x3ec4bf6d00000000bec43f6d,0x3ec4bf6d00000000bec43f6d00000000,0x3f7f3dc900000000bf463f22,0x3f7f3dc900000000bf463f2200000000
.octa 0x3e483f7b00000000bf7b3e48,0x3e483f7b00000000bf7b3e4800000000,0xbf623ef100000000bf75be95,0xbf623ef100000000bf75be9500000000
.octa 0x3f800000000000003f800000,0x3f800000000000003f80000000000000,0xbf753e9500000000bef13f62,0xbf753e9500000000bef13f6200000000
.octa 0x3f55bf0e00000000bf0ebf55,0x3f55bf0e00000000bf0ebf5500000000,0xbf223f46000000003f7fbdc9,0xbf223f46000000003f7fbdc900000000
.octa 0x3ec4bf6d00000000bec43f6d,0x3ec4bf6d00000000bec43f6d00000000,0xbdc93f7f00000000bf22bf46,0xbdc93f7f00000000bf22bf4600000000
.octa 0xbe48bf7b000000003f7bbe48,0xbe48bf7b000000003f7bbe4800000000,0x3ef13f6200000000be953f75,0x3ef13f6200000000be953f7500000000
.octa 0x3f800000000000003f800000,0x3f800000000000003f80000000000000,0xbe95bf7500000000bf62bef1,0xbe95bf7500000000bf62bef100000000
.octa 0xbf553f0e000000003f0e3f55,0xbf553f0e000000003f0e3f5500000000,0x3f463f2200000000bdc9bf7f,0x3f463f2200000000bdc9bf7f00000000
.octa 0x3ec4bf6d00000000bec43f6d,0x3ec4bf6d00000000bec43f6d00000000,0xbf7fbdc9000000003f46bf22,0xbf7fbdc9000000003f46bf2200000000
.octa 0x3e483f7b00000000bf7b3e48,0x3e483f7b00000000bf7b3e4800000000,0x3f62bef1000000003f753e95,0x3f62bef1000000003f753e9500000000
.octa 0x3f800000000000003f800000,0x3f800000000000003f80000000000000,0x3f75be95000000003ef1bf62,0x3f75be95000000003ef1bf6200000000
.octa 0x3f55bf0e00000000bf0ebf55,0x3f55bf0e00000000bf0ebf5500000000,0x3f22bf4600000000bf7f3dc9,0x3f22bf4600000000bf7f3dc900000000
.octa 0x3ec4bf6d00000000bec43f6d,0x3ec4bf6d00000000bec43f6d00000000,0x3dc9bf7f000000003f223f46,0x3dc9bf7f000000003f223f4600000000
.octa 0xbe48bf7b000000003f7bbe48,0xbe48bf7b000000003f7bbe4800000000,0xbef1bf62000000003e95bf75,0xbef1bf62000000003e95bf7500000000
.octa 0x3f043f5c0000000000003f80,0x3f783e790000000000003f80,0x3f043f5c0000000000003f8000000000,0x3f783e790000000000003f8000000000
.octa 0x3f5cbf040000000000003f80,0x3e79bf780000000000003f80,0x3f5cbf040000000000003f8000000000,0x3e79bf780000000000003f8000000000
.octa 0xbf04bf5c0000000000003f80,0xbf78be790000000000003f80,0xbf04bf5c0000000000003f8000000000,0xbf78be790000000000003f8000000000
.octa 0xbf5c3f040000000000003f80,0xbe793f780000000000003f80,0xbf5c3f040000000000003f8000000000,0xbe793f780000000000003f8000000000
.octa 0x3f80bd49000000003f623ef1,0xbf3ebf2c000000003ef1bf62,0x3f80bd49000000003f623ef100000000,0xbf3ebf2c000000003ef1bf6200000000
.octa 0x3d493f8000000000bf62bef1,0x3f2cbf3e00000000bef13f62,0x3d493f8000000000bf62bef100000000,0x3f2cbf3e00000000bef13f6200000000
.octa 0xbf803d49000000003f623ef1,0x3f3e3f2c000000003ef1bf62,0xbf803d49000000003f623ef100000000,0x3f3e3f2c000000003ef1bf6200000000
.octa 0xbd49bf8000000000bf62bef1,0xbf2c3f3e00000000bef13f62,0xbd49bf8000000000bf62bef100000000,0xbf2c3f3e00000000bef13f6200000000
.octa 0x3edbbf67000000003f55bf0e,0x3eac3f7100000000bf553f0e,0x3edbbf67000000003f55bf0e00000000,0x3eac3f7100000000bf553f0e00000000
.octa 0xbf67bedb000000003f55bf0e,0x3f71beac00000000bf553f0e,0xbf67bedb000000003f55bf0e00000000,0x3f71beac00000000bf553f0e00000000
.octa 0xbedb3f67000000003f55bf0e,0xbeacbf7100000000bf553f0e,0xbedb3f67000000003f55bf0e00000000,0xbeacbf7100000000bf553f0e00000000
.octa 0x3f673edb000000003f55bf0e,0xbf713eac00000000bf553f0e,0x3f673edb000000003f55bf0e00000000,0xbf713eac00000000bf553f0e00000000
.octa 0xbf18bf4e00000000bdc9bf7f,0x3e16bf7d000000003f7fbdc9,0xbf18bf4e00000000bdc9bf7f00000000,0x3e16bf7d000000003f7fbdc900000000
.octa 0x3f4ebf18000000003dc93f7f,0x3f7d3e1600000000bf7f3dc9,0x3f4ebf18000000003dc93f7f00000000,0x3f7d3e1600000000bf7f3dc900000000
.octa 0x3f183f4e00000000bdc9bf7f,0xbe163f7d000000003f7fbdc9,0x3f183f4e00000000bdc9bf7f00000000,0xbe163f7d000000003f7fbdc900000000
.octa 0xbf4e3f18000000003dc93f7f,0xbf7dbe1600000000bf7f3dc9,0xbf4e3f18000000003dc93f7f00000000,0xbf7dbe1600000000bf7f3dc900000000
.octa 0x3f5cbf04000000003f808000,0x3e79bf78000000003f808000,0x3f5cbf04000000003f80800000000000,0x3e79bf78000000003f80800000000000
.octa 0xbf04bf5c000000003f808000,0xbf78be79000000003f808000,0xbf04bf5c000000003f80800000000000,0xbf78be79000000003f80800000000000
.octa 0xbf5c3f04000000003f808000,0xbe793f78000000003f808000,0xbf5c3f04000000003f80800000000000,0xbe793f78000000003f80800000000000
.octa 0x3f043f5c000000003f808000,0x3f783e79000000003f808000,0x3f043f5c000000003f80800000000000,0x3f783e79000000003f80800000000000
.octa 0xbd49bf80000000003ef1bf62,0xbf2c3f3e00000000bf62bef1,0xbd49bf80000000003ef1bf6200000000,0xbf2c3f3e00000000bf62bef100000000
.octa 0x3f80bd4900000000bef13f62,0xbf3ebf2c000000003f623ef1,0x3f80bd4900000000bef13f6200000000,0xbf3ebf2c000000003f623ef100000000
.octa 0x3d493f80000000003ef1bf62,0x3f2cbf3e00000000bf62bef1,0x3d493f80000000003ef1bf6200000000,0x3f2cbf3e00000000bf62bef100000000
.octa 0xbf803d4900000000bef13f62,0x3f3e3f2c000000003f623ef1,0xbf803d4900000000bef13f6200000000,0x3f3e3f2c000000003f623ef100000000
.octa 0xbf67bedb00000000bf0ebf55,0x3f71beac000000003f0e3f55,0xbf67bedb00000000bf0ebf5500000000,0x3f71beac000000003f0e3f5500000000
.octa 0xbedb3f6700000000bf0ebf55,0xbeacbf71000000003f0e3f55,0xbedb3f6700000000bf0ebf5500000000,0xbeacbf71000000003f0e3f5500000000
.octa 0x3f673edb00000000bf0ebf55,0xbf713eac000000003f0e3f55,0x3f673edb00000000bf0ebf5500000000,0xbf713eac000000003f0e3f5500000000
.octa 0x3edbbf6700000000bf0ebf55,0x3eac3f71000000003f0e3f55,0x3edbbf6700000000bf0ebf5500000000,0x3eac3f71000000003f0e3f5500000000
.octa 0xbf4e3f1800000000bf7f3dc9,0xbf7dbe1600000000bdc9bf7f,0xbf4e3f1800000000bf7f3dc900000000,0xbf7dbe1600000000bdc9bf7f00000000
.octa 0xbf18bf4e000000003f7fbdc9,0x3e16bf7d000000003dc93f7f,0xbf18bf4e000000003f7fbdc900000000,0x3e16bf7d000000003dc93f7f00000000
.octa 0x3f4ebf1800000000bf7f3dc9,0x3f7d3e1600000000bdc9bf7f,0x3f4ebf1800000000bf7f3dc900000000,0x3f7d3e1600000000bdc9bf7f00000000
.octa 0x3f183f4e000000003f7fbdc9,0xbe163f7d000000003dc93f7f,0x3f183f4e000000003f7fbdc900000000,0xbe163f7d000000003dc93f7f00000000
.octa 0x80003f800000000080003f80,0x80003f800000000080003f8000000000,0xbf783e7900000000bf043f5c,0xbf783e7900000000bf043f5c00000000
.octa 0xbef1bf6200000000bf623ef1,0xbef1bf6200000000bf623ef100000000,0x3f3ebf2c00000000bf80bd49,0x3f3ebf2c00000000bf80bd4900000000
.octa 0x3f553f0e00000000bf55bf0e,0x3f553f0e00000000bf55bf0e00000000,0xbeac3f7100000000bedbbf67,0xbeac3f7100000000bedbbf6700000000
.octa 0xbf7fbdc9000000003dc9bf7f,0xbf7fbdc9000000003dc9bf7f00000000,0xbe16bf7d000000003f18bf4e,0xbe16bf7d000000003f18bf4e00000000
.octa 0x80003f800000000080003f80,0x80003f800000000080003f8000000000,0xbe79bf7800000000bf5cbf04,0xbe79bf7800000000bf5cbf0400000000
.octa 0x3ef13f62000000003f62bef1,0x3ef13f62000000003f62bef100000000,0xbf2cbf3e00000000bd493f80,0xbf2cbf3e00000000bd493f8000000000
.octa 0x3f553f0e00000000bf55bf0e,0x3f553f0e00000000bf55bf0e00000000,0xbf71beac000000003f67bedb,0xbf71beac000000003f67bedb00000000
.octa 0x3f7f3dc900000000bdc93f7f,0x3f7f3dc900000000bdc93f7f00000000,0xbf7d3e1600000000bf4ebf18,0xbf7d3e1600000000bf4ebf1800000000
.octa 0x80003f800000000080003f80,0x80003f800000000080003f8000000000,0x3f78be79000000003f04bf5c,0x3f78be79000000003f04bf5c00000000
.octa 0xbef1bf6200000000bf623ef1,0xbef1bf6200000000bf623ef100000000,0xbf3e3f2c000000003f803d49,0xbf3e3f2c000000003f803d4900000000
.octa 0x3f553f0e00000000bf55bf0e,0x3f553f0e00000000bf55bf0e00000000,0x3eacbf71000000003edb3f67,0x3eacbf71000000003edb3f6700000000
.octa 0xbf7fbdc9000000003dc9bf7f,0xbf7fbdc9000000003dc9bf7f00000000,0x3e163f7d00000000bf183f4e,0x3e163f7d00000000bf183f4e00000000
.octa 0x80003f800000000080003f80,0x80003f800000000080003f8000000000,0x3e793f78000000003f5c3f04,0x3e793f78000000003f5c3f0400000000
.octa 0x3ef13f62000000003f62bef1,0x3ef13f62000000003f62bef100000000,0x3f2c3f3e000000003d49bf80,0x3f2c3f3e000000003d49bf8000000000
.octa 0x3f553f0e00000000bf55bf0e,0x3f553f0e00000000bf55bf0e00000000,0x3f713eac00000000bf673edb,0x3f713eac00000000bf673edb00000000
.octa 0x3f7f3dc900000000bdc93f7f,0x3f7f3dc900000000bdc93f7f00000000,0x3f7dbe16000000003f4e3f18,0x3f7dbe16000000003f4e3f1800000000
.octa 0x3f800000000000003f800000,0x3f800000000000003f80000000000000,0x3e793f78000000003f5c3f04,0x3e793f78000000003f5c3f0400000000
.octa 0xbf623ef1000000003ef13f62,0xbf623ef1000000003ef13f6200000000,0xbf2cbf3e00000000bd493f80,0xbf2cbf3e00000000bd493f8000000000
.octa 0x3f0ebf5500000000bf0e3f55,0x3f0ebf5500000000bf0e3f5500000000,0x3f713eac00000000bf673edb,0x3f713eac00000000bf673edb00000000
.octa 0xbdc93f7f00000000bf7fbdc9,0xbdc93f7f00000000bf7fbdc900000000,0xbf7d3e1600000000bf4ebf18,0xbf7d3e1600000000bf4ebf1800000000
.octa 0x3f800000000000003f800000,0x3f800000000000003f80000000000000,0xbf783e7900000000bf043f5c,0xbf783e7900000000bf043f5c00000000
.octa 0x3f62bef100000000bef1bf62,0x3f62bef100000000bef1bf6200000000,0xbf3e3f2c000000003f803d49,0xbf3e3f2c000000003f803d4900000000
.octa 0x3f0ebf5500000000bf0e3f55,0x3f0ebf5500000000bf0e3f5500000000,0xbeac3f7100000000bedbbf67,0xbeac3f7100000000bedbbf6700000000
.octa 0x3dc9bf7f000000003f7f3dc9,0x3dc9bf7f000000003f7f3dc900000000,0x3e163f7d00000000bf183f4e,0x3e163f7d00000000bf183f4e00000000
.octa 0x3f800000000000003f800000,0x3f800000000000003f80000000000000,0xbe79bf7800000000bf5cbf04,0xbe79bf7800000000bf5cbf0400000000
.octa 0xbf623ef1000000003ef13f62,0xbf623ef1000000003ef13f6200000000,0x3f2c3f3e000000003d49bf80,0x3f2c3f3e000000003d49bf8000000000
.octa 0x3f0ebf5500000000bf0e3f55,0x3f0ebf5500000000bf0e3f5500000000,0xbf71beac000000003f67bedb,0xbf71beac000000003f67bedb00000000
.octa 0xbdc93f7f00000000bf7fbdc9,0xbdc93f7f00000000bf7fbdc900000000,0x3f7dbe16000000003f4e3f18,0x3f7dbe16000000003f4e3f1800000000
.octa 0x3f800000000000003f800000,0x3f800000000000003f80000000000000,0x3f78be79000000003f04bf5c,0x3f78be79000000003f04bf5c00000000
.octa 0x3f62bef100000000bef1bf62,0x3f62bef100000000bef1bf6200000000,0x3f3ebf2c00000000bf80bd49,0x3f3ebf2c00000000bf80bd4900000000
.octa 0x3f0ebf5500000000bf0e3f55,0x3f0ebf5500000000bf0e3f5500000000,0x3eacbf71000000003edb3f67,0x3eacbf71000000003edb3f6700000000
.octa 0x3dc9bf7f000000003f7f3dc9,0x3dc9bf7f000000003f7f3dc900000000,0xbe16bf7d000000003f18bf4e,0xbe16bf7d000000003f18bf4e00000000
.octa 0x3f0e3f550000000000003f80,0x3f7b3e480000000000003f80,0x3f0e3f550000000000003f8000000000,0x3f7b3e480000000000003f8000000000
.octa 0x3f55bf0e0000000000003f80,0x3e48bf7b0000000000003f80,0x3f55bf0e0000000000003f8000000000,0x3e48bf7b0000000000003f8000000000
.octa 0xbf0ebf550000000000003f80,0xbf7bbe480000000000003f80,0xbf0ebf550000000000003f8000000000,0xbf7bbe480000000000003f8000000000
.octa 0xbf553f0e0000000000003f80,0xbe483f7b0000000000003f80,0xbf553f0e0000000000003f8000000000,0xbe483f7b0000000000003f8000000000
.octa 0x3f7bbe48000000003f6d3ec4,0xbf55bf0e000000003ec4bf6d,0x3f7bbe48000000003f6d3ec400000000,0xbf55bf0e000000003ec4bf6d00000000
.octa 0x3e483f7b00000000bf6dbec4,0x3f0ebf5500000000bec43f6d,0x3e483f7b00000000bf6dbec400000000,0x3f0ebf5500000000bec43f6d00000000
.octa 0xbf7b3e48000000003f6d3ec4,0x3f553f0e000000003ec4bf6d,0xbf7b3e48000000003f6d3ec400000000,0x3f553f0e000000003ec4bf6d00000000
.octa 0xbe48bf7b00000000bf6dbec4,0xbf0e3f5500000000bec43f6d,0xbe48bf7b00000000bf6dbec400000000,0xbf0e3f5500000000bec43f6d00000000
.octa 0x3e48bf7b000000003f35bf35,0x3f0e3f5500000000bf353f35,0x3e48bf7b000000003f35bf3500000000,0x3f0e3f5500000000bf353f3500000000
.octa 0xbf7bbe48000000003f35bf35,0x3f55bf0e00000000bf353f35,0xbf7bbe48000000003f35bf3500000000,0x3f55bf0e00000000bf353f3500000000
.octa 0xbe483f7b000000003f35bf35,0xbf0ebf5500000000bf353f35,0xbe483f7b000000003f35bf3500000000,0xbf0ebf5500000000bf353f3500000000
.octa 0x3f7b3e48000000003f35bf35,0xbf553f0e00000000bf353f35,0x3f7b3e48000000003f35bf3500000000,0xbf553f0e00000000bf353f3500000000
.octa 0xbf55bf0e00000000bec4bf6d,0xbe48bf7b000000003f6dbec4,0xbf55bf0e00000000bec4bf6d00000000,0xbe48bf7b000000003f6dbec400000000
.octa 0x3f0ebf55000000003ec43f6d,0x3f7bbe4800000000bf6d3ec4,0x3f0ebf55000000003ec43f6d00000000,0x3f7bbe4800000000bf6d3ec400000000
.octa 0x3f553f0e00000000bec4bf6d,0x3e483f7b000000003f6dbec4,0x3f553f0e00000000bec4bf6d00000000,0x3e483f7b000000003f6dbec400000000
.octa 0xbf0e3f55000000003ec43f6d,0xbf7b3e4800000000bf6d3ec4,0xbf0e3f55000000003ec43f6d00000000,0xbf7b3e4800000000bf6d3ec400000000
.octa 0x3f55bf0e000000003f808000,0x3e48bf7b000000003f808000,0x3f55bf0e000000003f80800000000000,0x3e48bf7b000000003f80800000000000
.octa 0xbf0ebf55000000003f808000,0xbf7bbe48000000003f808000,0xbf0ebf55000000003f80800000000000,0xbf7bbe48000000003f80800000000000
.octa 0xbf553f0e000000003f808000,0xbe483f7b000000003f808000,0xbf553f0e000000003f80800000000000,0xbe483f7b000000003f80800000000000
.octa 0x3f0e3f55000000003f808000,0x3f7b3e48000000003f808000,0x3f0e3f55000000003f80800000000000,0x3f7b3e48000000003f80800000000000
.octa 0xbe48bf7b000000003ec4bf6d,0xbf0e3f5500000000bf6dbec4,0xbe48bf7b000000003ec4bf6d00000000,0xbf0e3f5500000000bf6dbec400000000
.octa 0x3f7bbe4800000000bec43f6d,0xbf55bf0e000000003f6d3ec4,0x3f7bbe4800000000bec43f6d00000000,0xbf55bf0e000000003f6d3ec400000000
.octa 0x3e483f7b000000003ec4bf6d,0x3f0ebf5500000000bf6dbec4,0x3e483f7b000000003ec4bf6d00000000,0x3f0ebf5500000000bf6dbec400000000
.octa 0xbf7b3e4800000000bec43f6d,0x3f553f0e000000003f6d3ec4,0xbf7b3e4800000000bec43f6d00000000,0x3f553f0e000000003f6d3ec400000000
.octa 0xbf7bbe4800000000bf35bf35,0x3f55bf0e000000003f353f35,0xbf7bbe4800000000bf35bf3500000000,0x3f55bf0e000000003f353f3500000000
.octa 0xbe483f7b00000000bf35bf35,0xbf0ebf55000000003f353f35,0xbe483f7b00000000bf35bf3500000000,0xbf0ebf55000000003f353f3500000000
.octa 0x3f7b3e4800000000bf35bf35,0xbf553f0e000000003f353f35,0x3f7b3e4800000000bf35bf3500000000,0xbf553f0e000000003f353f3500000000
.octa 0x3e48bf7b00000000bf35bf35,0x3f0e3f55000000003f353f35,0x3e48bf7b00000000bf35bf3500000000,0x3f0e3f55000000003f353f3500000000
.octa 0xbf0e3f5500000000bf6d3ec4,0xbf7b3e4800000000bec4bf6d,0xbf0e3f5500000000bf6d3ec400000000,0xbf7b3e4800000000bec4bf6d00000000
.octa 0xbf55bf0e000000003f6dbec4,0xbe48bf7b000000003ec43f6d,0xbf55bf0e000000003f6dbec400000000,0xbe48bf7b000000003ec43f6d00000000
.octa 0x3f0ebf5500000000bf6d3ec4,0x3f7bbe4800000000bec4bf6d,0x3f0ebf5500000000bf6d3ec400000000,0x3f7bbe4800000000bec4bf6d00000000
.octa 0x3f553f0e000000003f6dbec4,0x3e483f7b000000003ec43f6d,0x3f553f0e000000003f6dbec400000000,0x3e483f7b000000003ec43f6d00000000
.octa 0x80003f800000000080003f80,0x80003f800000000080003f8000000000,0xbf7b3e4800000000bf0e3f55,0xbf7b3e4800000000bf0e3f5500000000
.octa 0xbec4bf6d00000000bf6d3ec4,0xbec4bf6d00000000bf6d3ec400000000,0x3f55bf0e00000000bf7bbe48,0x3f55bf0e00000000bf7bbe4800000000
.octa 0x3f353f3500000000bf35bf35,0x3f353f3500000000bf35bf3500000000,0xbf0e3f5500000000be48bf7b,0xbf0e3f5500000000be48bf7b00000000
.octa 0xbf6dbec4000000003ec4bf6d,0xbf6dbec4000000003ec4bf6d00000000,0x3e48bf7b000000003f55bf0e,0x3e48bf7b000000003f55bf0e00000000
.octa 0x80003f800000000080003f80,0x80003f800000000080003f8000000000,0xbe48bf7b00000000bf55bf0e,0xbe48bf7b00000000bf55bf0e00000000
.octa 0x3ec43f6d000000003f6dbec4,0x3ec43f6d000000003f6dbec400000000,0xbf0ebf5500000000be483f7b,0xbf0ebf5500000000be483f7b00000000
.octa 0x3f353f3500000000bf35bf35,0x3f353f3500000000bf35bf3500000000,0xbf55bf0e000000003f7bbe48,0xbf55bf0e000000003f7bbe4800000000
.octa 0x3f6d3ec400000000bec43f6d,0x3f6d3ec400000000bec43f6d00000000,0xbf7bbe4800000000bf0ebf55,0xbf7bbe4800000000bf0ebf5500000000
.octa 0x80003f800000000080003f80,0x80003f800000000080003f8000000000,0x3f7bbe48000000003f0ebf55,0x3f7bbe48000000003f0ebf5500000000
.octa 0xbec4bf6d00000000bf6d3ec4,0xbec4bf6d00000000bf6d3ec400000000,0xbf553f0e000000003f7b3e48,0xbf553f0e000000003f7b3e4800000000
.octa 0x3f353f3500000000bf35bf35,0x3f353f3500000000bf35bf3500000000,0x3f0ebf55000000003e483f7b,0x3f0ebf55000000003e483f7b00000000
.octa 0xbf6dbec4000000003ec4bf6d,0xbf6dbec4000000003ec4bf6d00000000,0xbe483f7b00000000bf553f0e,0xbe483f7b00000000bf553f0e00000000
.octa 0x80003f800000000080003f80,0x80003f800000000080003f8000000000,0x3e483f7b000000003f553f0e,0x3e483f7b000000003f553f0e00000000
.octa 0x3ec43f6d000000003f6dbec4,0x3ec43f6d000000003f6dbec400000000,0x3f0e3f55000000003e48bf7b,0x3f0e3f55000000003e48bf7b00000000
.octa 0x3f353f3500000000bf35bf35,0x3f353f3500000000bf35bf3500000000,0x3f553f0e00000000bf7b3e48,0x3f553f0e00000000bf7b3e4800000000
.octa 0x3f6d3ec400000000bec43f6d,0x3f6d3ec400000000bec43f6d00000000,0x3f7b3e48000000003f0e3f55,0x3f7b3e48000000003f0e3f5500000000
.octa 0x3f800000000000003f800000,0x3f800000000000003f80000000000000,0x3e483f7b000000003f553f0e,0x3e483f7b000000003f553f0e00000000
.octa 0xbf6d3ec4000000003ec43f6d,0xbf6d3ec4000000003ec43f6d00000000,0xbf0ebf5500000000be483f7b,0xbf0ebf5500000000be483f7b00000000
.octa 0x3f35bf3500000000bf353f35,0x3f35bf3500000000bf353f3500000000,0x3f553f0e00000000bf7b3e48,0x3f553f0e00000000bf7b3e4800000000
.octa 0xbec43f6d00000000bf6dbec4,0xbec43f6d00000000bf6dbec400000000,0xbf7bbe4800000000bf0ebf55,0xbf7bbe4800000000bf0ebf5500000000
.octa 0x3f800000000000003f800000,0x3f800000000000003f80000000000000,0xbf7b3e4800000000bf0e3f55,0xbf7b3e4800000000bf0e3f5500000000
.octa 0x3f6dbec400000000bec4bf6d,0x3f6dbec400000000bec4bf6d00000000,0xbf553f0e000000003f7b3e48,0xbf553f0e000000003f7b3e4800000000
.octa 0x3f35bf3500000000bf353f35,0x3f35bf3500000000bf353f3500000000,0xbf0e3f5500000000be48bf7b,0xbf0e3f5500000000be48bf7b00000000
.octa 0x3ec4bf6d000000003f6d3ec4,0x3ec4bf6d000000003f6d3ec400000000,0xbe483f7b00000000bf553f0e,0xbe483f7b00000000bf553f0e00000000
.octa 0x3f800000000000003f800000,0x3f800000000000003f80000000000000,0xbe48bf7b00000000bf55bf0e,0xbe48bf7b00000000bf55bf0e00000000
.octa 0xbf6d3ec4000000003ec43f6d,0xbf6d3ec4000000003ec43f6d00000000,0x3f0e3f55000000003e48bf7b,0x3f0e3f55000000003e48bf7b00000000
.octa 0x3f35bf3500000000bf353f35,0x3f35bf3500000000bf353f3500000000,0xbf55bf0e000000003f7bbe48,0xbf55bf0e000000003f7bbe4800000000
.octa 0xbec43f6d00000000bf6dbec4,0xbec43f6d00000000bf6dbec400000000,0x3f7b3e48000000003f0e3f55,0x3f7b3e48000000003f0e3f5500000000
.octa 0x3f800000000000003f800000,0x3f800000000000003f80000000000000,0x3f7bbe48000000003f0ebf55,0x3f7bbe48000000003f0ebf5500000000
.octa 0x3f6dbec400000000bec4bf6d,0x3f6dbec400000000bec4bf6d00000000,0x3f55bf0e00000000bf7bbe48,0x3f55bf0e00000000bf7bbe4800000000
.octa 0x3f35bf3500000000bf353f35,0x3f35bf3500000000bf353f3500000000,0x3f0ebf55000000003e483f7b,0x3f0ebf55000000003e483f7b00000000
.octa 0x3ec4bf6d000000003f6d3ec4,0x3ec4bf6d000000003f6d3ec400000000,0x3e48bf7b000000003f55bf0e,0x3e48bf7b000000003f55bf0e00000000
.octa 0x3f183f4e0000000000003f80,0x3f7d3e160000000000003f80,0x3f183f4e0000000000003f8000000000,0x3f7d3e160000000000003f8000000000
.octa 0x3f4ebf180000000000003f80,0x3e16bf7d0000000000003f80,0x3f4ebf180000000000003f8000000000,0x3e16bf7d0000000000003f8000000000
.octa 0xbf18bf4e0000000000003f80,0xbf7dbe160000000000003f80,0xbf18bf4e0000000000003f8000000000,0xbf7dbe160000000000003f8000000000
.octa 0xbf4e3f180000000000003f80,0xbe163f7d0000000000003f80,0xbf4e3f180000000000003f8000000000,0xbe163f7d0000000000003f8000000000
.octa 0x3f71beac000000003f753e95,0xbf67bedb000000003e95bf75,0x3f71beac000000003f753e9500000000,0xbf67bedb000000003e95bf7500000000
.octa 0x3eac3f7100000000bf75be95,0x3edbbf6700000000be953f75,0x3eac3f7100000000bf75be9500000000,0x3edbbf6700000000be953f7500000000
.octa 0xbf713eac000000003f753e95,0x3f673edb000000003e95bf75,0xbf713eac000000003f753e9500000000,0x3f673edb000000003e95bf7500000000
.octa 0xbeacbf7100000000bf75be95,0xbedb3f6700000000be953f75,0xbeacbf7100000000bf75be9500000000,0xbedb3f6700000000be953f7500000000
.octa 0xbd49bf80000000003f0ebf55,0x3f3e3f2c00000000bf0e3f55,0xbd49bf80000000003f0ebf5500000000,0x3f3e3f2c00000000bf0e3f5500000000
.octa 0xbf803d49000000003f0ebf55,0x3f2cbf3e00000000bf0e3f55,0xbf803d49000000003f0ebf5500000000,0x3f2cbf3e00000000bf0e3f5500000000
.octa 0x3d493f80000000003f0ebf55,0xbf3ebf2c00000000bf0e3f55,0x3d493f80000000003f0ebf5500000000,0xbf3ebf2c00000000bf0e3f5500000000
.octa 0x3f80bd49000000003f0ebf55,0xbf2c3f3e00000000bf0e3f55,0x3f80bd49000000003f0ebf5500000000,0xbf2c3f3e00000000bf0e3f5500000000
.octa 0xbf78be7900000000bf22bf46,0xbf04bf5c000000003f46bf22,0xbf78be7900000000bf22bf4600000000,0xbf04bf5c000000003f46bf2200000000
.octa 0x3e79bf78000000003f223f46,0x3f5cbf0400000000bf463f22,0x3e79bf78000000003f223f4600000000,0x3f5cbf0400000000bf463f2200000000
.octa 0x3f783e7900000000bf22bf46,0x3f043f5c000000003f46bf22,0x3f783e7900000000bf22bf4600000000,0x3f043f5c000000003f46bf2200000000
.octa 0xbe793f78000000003f223f46,0xbf5c3f0400000000bf463f22,0xbe793f78000000003f223f4600000000,0xbf5c3f0400000000bf463f2200000000
.octa 0x3f4ebf18000000003f808000,0x3e16bf7d000000003f808000,0x3f4ebf18000000003f80800000000000,0x3e16bf7d000000003f80800000000000
.octa 0xbf18bf4e000000003f808000,0xbf7dbe16000000003f808000,0xbf18bf4e000000003f80800000000000,0xbf7dbe16000000003f80800000000000
.octa 0xbf4e3f18000000003f808000,0xbe163f7d000000003f808000,0xbf4e3f18000000003f80800000000000,0xbe163f7d000000003f80800000000000
.octa 0x3f183f4e000000003f808000,0x3f7d3e16000000003f808000,0x3f183f4e000000003f80800000000000,0x3f7d3e16000000003f80800000000000
.octa 0xbeacbf71000000003e95bf75,0xbedb3f6700000000bf75be95,0xbeacbf71000000003e95bf7500000000,0xbedb3f6700000000bf75be9500000000
.octa 0x3f71beac00000000be953f75,0xbf67bedb000000003f753e95,0x3f71beac00000000be953f7500000000,0xbf67bedb000000003f753e9500000000
.octa 0x3eac3f71000000003e95bf75,0x3edbbf6700000000bf75be95,0x3eac3f71000000003e95bf7500000000,0x3edbbf6700000000bf75be9500000000
.octa 0xbf713eac00000000be953f75,0x3f673edb000000003f753e95,0xbf713eac00000000be953f7500000000,0x3f673edb000000003f753e9500000000
.octa 0xbf803d4900000000bf55bf0e,0x3f2cbf3e000000003f553f0e,0xbf803d4900000000bf55bf0e00000000,0x3f2cbf3e000000003f553f0e00000000
.octa 0x3d493f8000000000bf55bf0e,0xbf3ebf2c000000003f553f0e,0x3d493f8000000000bf55bf0e00000000,0xbf3ebf2c000000003f553f0e00000000
.octa 0x3f80bd4900000000bf55bf0e,0xbf2c3f3e000000003f553f0e,0x3f80bd4900000000bf55bf0e00000000,0xbf2c3f3e000000003f553f0e00000000
.octa 0xbd49bf8000000000bf55bf0e,0x3f3e3f2c000000003f553f0e,0xbd49bf8000000000bf55bf0e00000000,0x3f3e3f2c000000003f553f0e00000000
.octa 0xbe793f7800000000bf463f22,0xbf5c3f0400000000bf22bf46,0xbe793f7800000000bf463f2200000000,0xbf5c3f0400000000bf22bf4600000000
.octa 0xbf78be79000000003f46bf22,0xbf04bf5c000000003f223f46,0xbf78be79000000003f46bf2200000000,0xbf04bf5c000000003f223f4600000000
.octa 0x3e79bf7800000000bf463f22,0x3f5cbf0400000000bf22bf46,0x3e79bf7800000000bf463f2200000000,0x3f5cbf0400000000bf22bf4600000000
.octa 0x3f783e79000000003f46bf22,0x3f043f5c000000003f223f46,0x3f783e79000000003f46bf2200000000,0x3f043f5c000000003f223f4600000000
.octa 0x80003f800000000080003f80,0x80003f800000000080003f8000000000,0xbf7d3e1600000000bf183f4e,0xbf7d3e1600000000bf183f4e00000000
.octa 0xbe95bf7500000000bf753e95,0xbe95bf7500000000bf753e9500000000,0x3f67bedb00000000bf71beac,0x3f67bedb00000000bf71beac00000000
.octa 0x3f0e3f5500000000bf0ebf55,0x3f0e3f5500000000bf0ebf5500000000,0xbf3e3f2c000000003d49bf80,0xbf3e3f2c000000003d49bf8000000000
.octa 0xbf46bf22000000003f22bf46,0xbf46bf22000000003f22bf4600000000,0x3f04bf5c000000003f78be79,0x3f04bf5c000000003f78be7900000000
.octa 0x80003f800000000080003f80,0x80003f800000000080003f8000000000,0xbe16bf7d00000000bf4ebf18,0xbe16bf7d00000000bf4ebf1800000000
.octa 0x3e953f75000000003f75be95,0x3e953f75000000003f75be9500000000,0xbedbbf6700000000beac3f71,0xbedbbf6700000000beac3f7100000000
.octa 0x3f0e3f5500000000bf0ebf55,0x3f0e3f5500000000bf0ebf5500000000,0xbf2cbf3e000000003f803d49,0xbf2cbf3e000000003f803d4900000000
.octa 0x3f463f2200000000bf223f46,0x3f463f2200000000bf223f4600000000,0xbf5cbf0400000000be79bf78,0xbf5cbf0400000000be79bf7800000000
.octa 0x80003f800000000080003f80,0x80003f800000000080003f8000000000,0x3f7dbe16000000003f18bf4e,0x3f7dbe16000000003f18bf4e00000000
.octa 0xbe95bf7500000000bf753e95,0xbe95bf7500000000bf753e9500000000,0xbf673edb000000003f713eac,0xbf673edb000000003f713eac00000000
.octa 0x3f0e3f5500000000bf0ebf55,0x3f0e3f5500000000bf0ebf5500000000,0x3f3ebf2c00000000bd493f80,0x3f3ebf2c00000000bd493f8000000000
.octa 0xbf46bf22000000003f22bf46,0xbf46bf22000000003f22bf4600000000,0xbf043f5c00000000bf783e79,0xbf043f5c00000000bf783e7900000000
.octa 0x80003f800000000080003f80,0x80003f800000000080003f8000000000,0x3e163f7d000000003f4e3f18,0x3e163f7d000000003f4e3f1800000000
.octa 0x3e953f75000000003f75be95,0x3e953f75000000003f75be9500000000,0x3edb3f67000000003eacbf71,0x3edb3f67000000003eacbf7100000000
.octa 0x3f0e3f5500000000bf0ebf55,0x3f0e3f5500000000bf0ebf5500000000,0x3f2c3f3e00000000bf80bd49,0x3f2c3f3e00000000bf80bd4900000000
.octa 0x3f463f2200000000bf223f46,0x3f463f2200000000bf223f4600000000,0x3f5c3f04000000003e793f78,0x3f5c3f04000000003e793f7800000000
.octa 0x3f800000000000003f800000,0x3f800000000000003f80000000000000,0x3e163f7d000000003f4e3f18,0x3e163f7d000000003f4e3f1800000000
.octa 0xbf753e95000000003e953f75,0xbf753e95000000003e953f7500000000,0xbedbbf6700000000beac3f71,0xbedbbf6700000000beac3f7100000000
.octa 0x3f55bf0e00000000bf553f0e,0x3f55bf0e00000000bf553f0e00000000,0x3f2c3f3e00000000bf80bd49,0x3f2c3f3e00000000bf80bd4900000000
.octa 0xbf223f4600000000bf46bf22,0xbf223f4600000000bf46bf2200000000,0xbf5cbf0400000000be79bf78,0xbf5cbf0400000000be79bf7800000000
.octa 0x3f800000000000003f800000,0x3f800000000000003f80000000000000,0xbf7d3e1600000000bf183f4e,0xbf7d3e1600000000bf183f4e00000000
.octa 0x3f75be9500000000be95bf75,0x3f75be9500000000be95bf7500000000,0xbf673edb000000003f713eac,0xbf673edb000000003f713eac00000000
.octa 0x3f55bf0e00000000bf553f0e,0x3f55bf0e00000000bf553f0e00000000,0xbf3e3f2c000000003d49bf80,0xbf3e3f2c000000003d49bf8000000000
.octa 0x3f22bf46000000003f463f22,0x3f22bf46000000003f463f2200000000,0xbf043f5c00000000bf783e79,0xbf043f5c00000000bf783e7900000000
.octa 0x3f800000000000003f800000,0x3f800000000000003f80000000000000,0xbe16bf7d00000000bf4ebf18,0xbe16bf7d00000000bf4ebf1800000000
.octa 0xbf753e95000000003e953f75,0xbf753e95000000003e953f7500000000,0x3edb3f67000000003eacbf71,0x3edb3f67000000003eacbf7100000000
.octa 0x3f55bf0e00000000bf553f0e,0x3f55bf0e00000000bf553f0e00000000,0xbf2cbf3e000000003f803d49,0xbf2cbf3e000000003f803d4900000000
.octa 0xbf223f4600000000bf46bf22,0xbf223f4600000000bf46bf2200000000,0x3f5c3f04000000003e793f78,0x3f5c3f04000000003e793f7800000000
.octa 0x3f800000000000003f800000,0x3f800000000000003f80000000000000,0x3f7dbe16000000003f18bf4e,0x3f7dbe16000000003f18bf4e00000000
.octa 0x3f75be9500000000be95bf75,0x3f75be9500000000be95bf7500000000,0x3f67bedb00000000bf71beac,0x3f67bedb00000000bf71beac00000000
.octa 0x3f55bf0e00000000bf553f0e,0x3f55bf0e00000000bf553f0e00000000,0x3f3ebf2c00000000bd493f80,0x3f3ebf2c00000000bd493f8000000000
.octa 0x3f22bf46000000003f463f22,0x3f22bf46000000003f463f2200000000,0x3f04bf5c000000003f78be79,0x3f04bf5c000000003f78be7900000000
.octa 0x3f223f460000000000003f80,0x3f7f3dc90000000000003f80,0x3f223f460000000000003f8000000000,0x3f7f3dc90000000000003f8000000000
.octa 0x3f46bf220000000000003f80,0x3dc9bf7f0000000000003f80,0x3f46bf220000000000003f8000000000,0x3dc9bf7f0000000000003f8000000000
.octa 0xbf22bf460000000000003f80,0xbf7fbdc90000000000003f80,0xbf22bf460000000000003f8000000000,0xbf7fbdc90000000000003f8000000000
.octa 0xbf463f220000000000003f80,0xbdc93f7f0000000000003f80,0xbf463f220000000000003f8000000000,0xbdc93f7f0000000000003f8000000000
.octa 0x3f62bef1000000003f7b3e48,0xbf75be95000000003e48bf7b,0x3f62bef1000000003f7b3e4800000000,0xbf75be95000000003e48bf7b00000000
.octa 0x3ef13f6200000000bf7bbe48,0x3e95bf7500000000be483f7b,0x3ef13f6200000000bf7bbe4800000000,0x3e95bf7500000000be483f7b00000000
.octa 0xbf623ef1000000003f7b3e48,0x3f753e95000000003e48bf7b,0xbf623ef1000000003f7b3e4800000000,0x3f753e95000000003e48bf7b00000000
.octa 0xbef1bf6200000000bf7bbe48,0xbe953f7500000000be483f7b,0xbef1bf6200000000bf7bbe4800000000,0xbe953f7500000000be483f7b00000000
.octa 0xbe95bf75000000003ec4bf6d,0x3f623ef100000000bec43f6d,0xbe95bf75000000003ec4bf6d00000000,0x3f623ef100000000bec43f6d00000000
.octa 0xbf753e95000000003ec4bf6d,0x3ef1bf6200000000bec43f6d,0xbf753e95000000003ec4bf6d00000000,0x3ef1bf6200000000bec43f6d00000000
.octa 0x3e953f75000000003ec4bf6d,0xbf62bef100000000bec43f6d,0x3e953f75000000003ec4bf6d00000000,0xbf62bef100000000bec43f6d00000000
.octa 0x3f75be95000000003ec4bf6d,0xbef13f6200000000bec43f6d,0x3f75be95000000003ec4bf6d00000000,0xbef13f6200000000bec43f6d00000000
.octa 0xbf7f3dc900000000bf55bf0e,0xbf46bf22000000003f0ebf55,0xbf7f3dc900000000bf55bf0e00000000,0xbf46bf22000000003f0ebf5500000000
.octa 0xbdc9bf7f000000003f553f0e,0x3f22bf4600000000bf0e3f55,0xbdc9bf7f000000003f553f0e00000000,0x3f22bf4600000000bf0e3f5500000000
.octa 0x3f7fbdc900000000bf55bf0e,0x3f463f22000000003f0ebf55,0x3f7fbdc900000000bf55bf0e00000000,0x3f463f22000000003f0ebf5500000000
.octa 0x3dc93f7f000000003f553f0e,0xbf223f4600000000bf0e3f55,0x3dc93f7f000000003f553f0e00000000,0xbf223f4600000000bf0e3f5500000000
.octa 0x3f46bf22000000003f808000,0x3dc9bf7f000000003f808000,0x3f46bf22000000003f80800000000000,0x3dc9bf7f000000003f80800000000000
.octa 0xbf22bf46000000003f808000,0xbf7fbdc9000000003f808000,0xbf22bf46000000003f80800000000000,0xbf7fbdc9000000003f80800000000000
.octa 0xbf463f22000000003f808000,0xbdc93f7f000000003f808000,0xbf463f22000000003f80800000000000,0xbdc93f7f000000003f80800000000000
.octa 0x3f223f46000000003f808000,0x3f7f3dc9000000003f808000,0x3f223f46000000003f80800000000000,0x3f7f3dc9000000003f80800000000000
.octa 0xbef1bf62000000003e48bf7b,0xbe953f7500000000bf7bbe48,0xbef1bf62000000003e48bf7b00000000,0xbe953f7500000000bf7bbe4800000000
.octa 0x3f62bef100000000be483f7b,0xbf75be95000000003f7b3e48,0x3f62bef100000000be483f7b00000000,0xbf75be95000000003f7b3e4800000000
.octa 0x3ef13f62000000003e48bf7b,0x3e95bf7500000000bf7bbe48,0x3ef13f62000000003e48bf7b00000000,0x3e95bf7500000000bf7bbe4800000000
.octa 0xbf623ef100000000be483f7b,0x3f753e95000000003f7b3e48,0xbf623ef100000000be483f7b00000000,0x3f753e95000000003f7b3e4800000000
.octa 0xbf753e9500000000bf6dbec4,0x3ef1bf62000000003f6d3ec4,0xbf753e9500000000bf6dbec400000000,0x3ef1bf62000000003f6d3ec400000000
.octa 0x3e953f7500000000bf6dbec4,0xbf62bef1000000003f6d3ec4,0x3e953f7500000000bf6dbec400000000,0xbf62bef1000000003f6d3ec400000000
.octa 0x3f75be9500000000bf6dbec4,0xbef13f62000000003f6d3ec4,0x3f75be9500000000bf6dbec400000000,0xbef13f62000000003f6d3ec400000000
.octa 0xbe95bf7500000000bf6dbec4,0x3f623ef1000000003f6d3ec4,0xbe95bf7500000000bf6dbec400000000,0x3f623ef1000000003f6d3ec400000000
.octa 0x3dc93f7f00000000bf0e3f55,0xbf223f4600000000bf55bf0e,0x3dc93f7f00000000bf0e3f5500000000,0xbf223f4600000000bf55bf0e00000000
.octa 0xbf7f3dc9000000003f0ebf55,0xbf46bf22000000003f553f0e,0xbf7f3dc9000000003f0ebf5500000000,0xbf46bf22000000003f553f0e00000000
.octa 0xbdc9bf7f00000000bf0e3f55,0x3f22bf4600000000bf55bf0e,0xbdc9bf7f00000000bf0e3f5500000000,0x3f22bf4600000000bf55bf0e00000000
.octa 0x3f7fbdc9000000003f0ebf55,0x3f463f22000000003f553f0e,0x3f7fbdc9000000003f0ebf5500000000,0x3f463f22000000003f553f0e00000000
.octa 0x80003f800000000080003f80,0x80003f800000000080003f8000000000,0xbf7f3dc900000000bf223f46,0xbf7f3dc900000000bf223f4600000000
.octa 0xbe48bf7b00000000bf7b3e48,0xbe48bf7b00000000bf7b3e4800000000,0x3f75be9500000000bf62bef1,0x3f75be9500000000bf62bef100000000
.octa 0x3ec43f6d00000000bec4bf6d,0x3ec43f6d00000000bec4bf6d00000000,0xbf623ef1000000003e95bf75,0xbf623ef1000000003e95bf7500000000
.octa 0xbf0ebf55000000003f55bf0e,0xbf0ebf55000000003f55bf0e00000000,0x3f46bf22000000003f7f3dc9,0x3f46bf22000000003f7f3dc900000000
.octa 0x80003f800000000080003f80,0x80003f800000000080003f8000000000,0xbdc9bf7f00000000bf46bf22,0xbdc9bf7f00000000bf46bf2200000000
.octa 0x3e483f7b000000003f7bbe48,0x3e483f7b000000003f7bbe4800000000,0xbe95bf7500000000bef13f62,0xbe95bf7500000000bef13f6200000000
.octa 0x3ec43f6d00000000bec4bf6d,0x3ec43f6d00000000bec4bf6d00000000,0xbef1bf62000000003f753e95,0xbef1bf62000000003f753e9500000000
.octa 0x3f0e3f5500000000bf553f0e,0x3f0e3f5500000000bf553f0e00000000,0xbf22bf46000000003dc9bf7f,0xbf22bf46000000003dc9bf7f00000000
.octa 0x80003f800000000080003f80,0x80003f800000000080003f8000000000,0x3f7fbdc9000000003f22bf46,0x3f7fbdc9000000003f22bf4600000000
.octa 0xbe48bf7b00000000bf7b3e48,0xbe48bf7b00000000bf7b3e4800000000,0xbf753e95000000003f623ef1,0xbf753e95000000003f623ef100000000
.octa 0x3ec43f6d00000000bec4bf6d,0x3ec43f6d00000000bec4bf6d00000000,0x3f62bef100000000be953f75,0x3f62bef100000000be953f7500000000
.octa 0xbf0ebf55000000003f55bf0e,0xbf0ebf55000000003f55bf0e00000000,0xbf463f2200000000bf7fbdc9,0xbf463f2200000000bf7fbdc900000000
.octa 0x80003f800000000080003f80,0x80003f800000000080003f8000000000,0x3dc93f7f000000003f463f22,0x3dc93f7f000000003f463f2200000000
.octa 0x3e483f7b000000003f7bbe48,0x3e483f7b000000003f7bbe4800000000,0x3e953f75000000003ef1bf62,0x3e953f75000000003ef1bf6200000000
.octa 0x3ec43f6d00000000bec4bf6d,0x3ec43f6d00000000bec4bf6d00000000,0x3ef13f6200000000bf75be95,0x3ef13f6200000000bf75be9500000000
.octa 0x3f0e3f5500000000bf553f0e,0x3f0e3f5500000000bf553f0e00000000,0x3f223f4600000000bdc93f7f,0x3f223f4600000000bdc93f7f00000000
.octa 0x3f800000000000003f800000,0x3f800000000000003f80000000000000,0x3dc93f7f000000003f463f22,0x3dc93f7f000000003f463f2200000000
.octa 0xbf7b3e48000000003e483f7b,0xbf7b3e48000000003e483f7b00000000,0xbe95bf7500000000bef13f62,0xbe95bf7500000000bef13f6200000000
.octa 0x3f6dbec400000000bf6d3ec4,0x3f6dbec400000000bf6d3ec400000000,0x3ef13f6200000000bf75be95,0x3ef13f6200000000bf75be9500000000
.octa 0xbf553f0e00000000bf0ebf55,0xbf553f0e00000000bf0ebf5500000000,0xbf22bf46000000003dc9bf7f,0xbf22bf46000000003dc9bf7f00000000
.octa 0x3f800000000000003f800000,0x3f800000000000003f80000000000000,0xbf7f3dc900000000bf223f46,0xbf7f3dc900000000bf223f4600000000
.octa 0x3f7bbe4800000000be48bf7b,0x3f7bbe4800000000be48bf7b00000000,0xbf753e95000000003f623ef1,0xbf753e95000000003f623ef100000000
.octa 0x3f6dbec400000000bf6d3ec4,0x3f6dbec400000000bf6d3ec400000000,0xbf623ef1000000003e95bf75,0xbf623ef1000000003e95bf7500000000
.octa 0x3f55bf0e000000003f0e3f55,0x3f55bf0e000000003f0e3f5500000000,0xbf463f2200000000bf7fbdc9,0xbf463f2200000000bf7fbdc900000000
.octa 0x3f800000000000003f800000,0x3f800000000000003f80000000000000,0xbdc9bf7f00000000bf46bf22,0xbdc9bf7f00000000bf46bf2200000000
.octa 0xbf7b3e48000000003e483f7b,0xbf7b3e48000000003e483f7b00000000,0x3e953f75000000003ef1bf62,0x3e953f75000000003ef1bf6200000000
.octa 0x3f6dbec400000000bf6d3ec4,0x3f6dbec400000000bf6d3ec400000000,0xbef1bf62000000003f753e95,0xbef1bf62000000003f753e9500000000
.octa 0xbf553f0e00000000bf0ebf55,0xbf553f0e00000000bf0ebf5500000000,0x3f223f4600000000bdc93f7f,0x3f223f4600000000bdc93f7f00000000
.octa 0x3f800000000000003f800000,0x3f800000000000003f80000000000000,0x3f7fbdc9000000003f22bf46,0x3f7fbdc9000000003f22bf4600000000
.octa 0x3f7bbe4800000000be48bf7b,0x3f7bbe4800000000be48bf7b00000000,0x3f75be9500000000bf62bef1,0x3f75be9500000000bf62bef100000000
.octa 0x3f6dbec400000000bf6d3ec4,0x3f6dbec400000000bf6d3ec400000000,0x3f62bef100000000be953f75,0x3f62bef100000000be953f7500000000
.octa 0x3f55bf0e000000003f0e3f55,0x3f55bf0e000000003f0e3f5500000000,0x3f46bf22000000003f7f3dc9,0x3f46bf22000000003f7f3dc900000000
.octa 0x3f2c3f3e0000000000003f80,0x3f803d490000000000003f80,0x3f2c3f3e0000000000003f8000000000,0x3f803d490000000000003f8000000000
.octa 0x3f3ebf2c0000000000003f80,0x3d49bf800000000000003f80,0x3f3ebf2c0000000000003f8000000000,0x3d49bf800000000000003f8000000000
.octa 0xbf2cbf3e0000000000003f80,0xbf80bd490000000000003f80,0xbf2cbf3e0000000000003f8000000000,0xbf80bd490000000000003f8000000000
.octa 0xbf3e3f2c0000000000003f80,0xbd493f800000000000003f80,0xbf3e3f2c0000000000003f8000000000,0xbd493f800000000000003f8000000000
.octa 0x3f4ebf18000000003f7f3dc9,0xbf7dbe16000000003dc9bf7f,0x3f4ebf18000000003f7f3dc900000000,0xbf7dbe16000000003dc9bf7f00000000
.octa 0x3f183f4e00000000bf7fbdc9,0x3e16bf7d00000000bdc93f7f,0x3f183f4e00000000bf7fbdc900000000,0x3e16bf7d00000000bdc93f7f00000000
.octa 0xbf4e3f18000000003f7f3dc9,0x3f7d3e16000000003dc9bf7f,0xbf4e3f18000000003f7f3dc900000000,0x3f7d3e16000000003dc9bf7f00000000
.octa 0xbf18bf4e00000000bf7fbdc9,0xbe163f7d00000000bdc93f7f,0xbf18bf4e00000000bf7fbdc900000000,0xbe163f7d00000000bdc93f7f00000000
.octa 0xbf04bf5c000000003e48bf7b,0x3f783e7900000000be483f7b,0xbf04bf5c000000003e48bf7b00000000,0x3f783e7900000000be483f7b00000000
.octa 0xbf5c3f04000000003e48bf7b,0x3e79bf7800000000be483f7b,0xbf5c3f04000000003e48bf7b00000000,0x3e79bf7800000000be483f7b00000000
.octa 0x3f043f5c000000003e48bf7b,0xbf78be7900000000be483f7b,0x3f043f5c000000003e48bf7b00000000,0xbf78be7900000000be483f7b00000000
.octa 0x3f5cbf04000000003e48bf7b,0xbe793f7800000000be483f7b,0x3f5cbf04000000003e48bf7b00000000,0xbe793f7800000000be483f7b00000000
.octa 0xbf673edb00000000bf75be95,0xbf71beac000000003e95bf75,0xbf673edb00000000bf75be9500000000,0xbf71beac000000003e95bf7500000000
.octa 0xbedbbf67000000003f753e95,0x3eacbf7100000000be953f75,0xbedbbf67000000003f753e9500000000,0x3eacbf7100000000be953f7500000000
.octa 0x3f67bedb00000000bf75be95,0x3f713eac000000003e95bf75,0x3f67bedb00000000bf75be9500000000,0x3f713eac000000003e95bf7500000000
.octa 0x3edb3f67000000003f753e95,0xbeac3f7100000000be953f75,0x3edb3f67000000003f753e9500000000,0xbeac3f7100000000be953f7500000000
.octa 0x3f3ebf2c000000003f808000,0x3d49bf80000000003f808000,0x3f3ebf2c000000003f80800000000000,0x3d49bf80000000003f80800000000000
.octa 0xbf2cbf3e000000003f808000,0xbf80bd49000000003f808000,0xbf2cbf3e000000003f80800000000000,0xbf80bd49000000003f80800000000000
.octa 0xbf3e3f2c000000003f808000,0xbd493f80000000003f808000,0xbf3e3f2c000000003f80800000000000,0xbd493f80000000003f80800000000000
.octa 0x3f2c3f3e000000003f808000,0x3f803d49000000003f808000,0x3f2c3f3e000000003f80800000000000,0x3f803d49000000003f80800000000000
.octa 0xbf18bf4e000000003dc9bf7f,0xbe163f7d00000000bf7fbdc9,0xbf18bf4e000000003dc9bf7f00000000,0xbe163f7d00000000bf7fbdc900000000
.octa 0x3f4ebf1800000000bdc93f7f,0xbf7dbe16000000003f7f3dc9,0x3f4ebf1800000000bdc93f7f00000000,0xbf7dbe16000000003f7f3dc900000000
.octa 0x3f183f4e000000003dc9bf7f,0x3e16bf7d00000000bf7fbdc9,0x3f183f4e000000003dc9bf7f00000000,0x3e16bf7d00000000bf7fbdc900000000
.octa 0xbf4e3f1800000000bdc93f7f,0x3f7d3e16000000003f7f3dc9,0xbf4e3f1800000000bdc93f7f00000000,0x3f7d3e16000000003f7f3dc900000000
.octa 0xbf5c3f0400000000bf7bbe48,0x3e79bf78000000003f7b3e48,0xbf5c3f0400000000bf7bbe4800000000,0x3e79bf78000000003f7b3e4800000000
.octa 0x3f043f5c00000000bf7bbe48,0xbf78be79000000003f7b3e48,0x3f043f5c00000000bf7bbe4800000000,0xbf78be79000000003f7b3e4800000000
.octa 0x3f5cbf0400000000bf7bbe48,0xbe793f78000000003f7b3e48,0x3f5cbf0400000000bf7bbe4800000000,0xbe793f78000000003f7b3e4800000000
.octa 0xbf04bf5c00000000bf7bbe48,0x3f783e79000000003f7b3e48,0xbf04bf5c00000000bf7bbe4800000000,0x3f783e79000000003f7b3e4800000000
.octa 0x3edb3f6700000000be953f75,0xbeac3f7100000000bf75be95,0x3edb3f6700000000be953f7500000000,0xbeac3f7100000000bf75be9500000000
.octa 0xbf673edb000000003e95bf75,0xbf71beac000000003f753e95,0xbf673edb000000003e95bf7500000000,0xbf71beac000000003f753e9500000000
.octa 0xbedbbf6700000000be953f75,0x3eacbf7100000000bf75be95,0xbedbbf6700000000be953f7500000000,0x3eacbf7100000000bf75be9500000000
.octa 0x3f67bedb000000003e95bf75,0x3f713eac000000003f753e95,0x3f67bedb000000003e95bf7500000000,0x3f713eac000000003f753e9500000000
.octa 0x80003f800000000080003f80,0x80003f800000000080003f8000000000,0xbf803d4900000000bf2c3f3e,0xbf803d4900000000bf2c3f3e00000000
.octa 0xbdc9bf7f00000000bf7f3dc9,0xbdc9bf7f00000000bf7f3dc900000000,0x3f7dbe1600000000bf4ebf18,0x3f7dbe1600000000bf4ebf1800000000
.octa 0x3e483f7b00000000be48bf7b,0x3e483f7b00000000be48bf7b00000000,0xbf783e79000000003f04bf5c,0xbf783e79000000003f04bf5c00000000
.octa 0xbe95bf75000000003f75be95,0xbe95bf75000000003f75be9500000000,0x3f71beac000000003f673edb,0x3f71beac000000003f673edb00000000
.octa 0x80003f800000000080003f80,0x80003f800000000080003f8000000000,0xbd49bf8000000000bf3ebf2c,0xbd49bf8000000000bf3ebf2c00000000
.octa 0x3dc93f7f000000003f7fbdc9,0x3dc93f7f000000003f7fbdc900000000,0xbe16bf7d00000000bf183f4e,0xbe16bf7d00000000bf183f4e00000000
.octa 0x3e483f7b00000000be48bf7b,0x3e483f7b00000000be48bf7b00000000,0xbe79bf78000000003f5c3f04,0xbe79bf78000000003f5c3f0400000000
.octa 0x3e953f7500000000bf753e95,0x3e953f7500000000bf753e9500000000,0xbeacbf71000000003edbbf67,0xbeacbf71000000003edbbf6700000000
.octa 0x80003f800000000080003f80,0x80003f800000000080003f8000000000,0x3f80bd49000000003f2cbf3e,0x3f80bd49000000003f2cbf3e00000000
.octa 0xbdc9bf7f00000000bf7f3dc9,0xbdc9bf7f00000000bf7f3dc900000000,0xbf7d3e16000000003f4e3f18,0xbf7d3e16000000003f4e3f1800000000
.octa 0x3e483f7b00000000be48bf7b,0x3e483f7b00000000be48bf7b00000000,0x3f78be7900000000bf043f5c,0x3f78be7900000000bf043f5c00000000
.octa 0xbe95bf75000000003f75be95,0xbe95bf75000000003f75be9500000000,0xbf713eac00000000bf67bedb,0xbf713eac00000000bf67bedb00000000
.octa 0x80003f800000000080003f80,0x80003f800000000080003f8000000000,0x3d493f80000000003f3e3f2c,0x3d493f80000000003f3e3f2c00000000
.octa 0x3dc93f7f000000003f7fbdc9,0x3dc93f7f000000003f7fbdc900000000,0x3e163f7d000000003f18bf4e,0x3e163f7d000000003f18bf4e00000000
.octa 0x3e483f7b00000000be48bf7b,0x3e483f7b00000000be48bf7b00000000,0x3e793f7800000000bf5cbf04,0x3e793f7800000000bf5cbf0400000000
.octa 0x3e953f7500000000bf753e95,0x3e953f7500000000bf753e9500000000,0x3eac3f7100000000bedb3f67,0x3eac3f7100000000bedb3f6700000000
.octa 0x3f800000000000003f800000,0x3f800000000000003f80000000000000,0x3d493f80000000003f3e3f2c,0x3d493f80000000003f3e3f2c00000000
.octa 0xbf7f3dc9000000003dc93f7f,0xbf7f3dc9000000003dc93f7f00000000,0xbe16bf7d00000000bf183f4e,0xbe16bf7d00000000bf183f4e00000000
.octa 0x3f7bbe4800000000bf7b3e48,0x3f7bbe4800000000bf7b3e4800000000,0x3e793f7800000000bf5cbf04,0x3e793f7800000000bf5cbf0400000000
.octa 0xbf753e9500000000be95bf75,0xbf753e9500000000be95bf7500000000,0xbeacbf71000000003edbbf67,0xbeacbf71000000003edbbf6700000000
.octa 0x3f800000000000003f800000,0x3f800000000000003f80000000000000,0xbf803d4900000000bf2c3f3e,0xbf803d4900000000bf2c3f3e00000000
.octa 0x3f7fbdc900000000bdc9bf7f,0x3f7fbdc900000000bdc9bf7f00000000,0xbf7d3e16000000003f4e3f18,0xbf7d3e16000000003f4e3f1800000000
.octa 0x3f7bbe4800000000bf7b3e48,0x3f7bbe4800000000bf7b3e4800000000,0xbf783e79000000003f04bf5c,0xbf783e79000000003f04bf5c00000000
.octa 0x3f75be95000000003e953f75,0x3f75be95000000003e953f7500000000,0xbf713eac00000000bf67bedb,0xbf713eac00000000bf67bedb00000000
.octa 0x3f800000000000003f800000,0x3f800000000000003f80000000000000,0xbd49bf8000000000bf3ebf2c,0xbd49bf8000000000bf3ebf2c00000000
.octa 0xbf7f3dc9000000003dc93f7f,0xbf7f3dc9000000003dc93f7f00000000,0x3e163f7d000000003f18bf4e,0x3e163f7d000000003f18bf4e00000000
.octa 0x3f7bbe4800000000bf7b3e48,0x3f7bbe4800000000bf7b3e4800000000,0xbe79bf78000000003f5c3f04,0xbe79bf78000000003f5c3f0400000000
.octa 0xbf753e9500000000be95bf75,0xbf753e9500000000be95bf7500000000,0x3eac3f7100000000bedb3f67,0x3eac3f7100000000bedb3f6700000000
.octa 0x3f800000000000003f800000,0x3f800000000000003f80000000000000,0x3f80bd49000000003f2cbf3e,0x3f80bd49000000003f2cbf3e00000000
.octa 0x3f7fbdc900000000bdc9bf7f,0x3f7fbdc900000000bdc9bf7f00000000,0x3f7dbe1600000000bf4ebf18,0x3f7dbe1600000000bf4ebf1800000000
.octa 0x3f7bbe4800000000bf7b3e48,0x3f7bbe4800000000bf7b3e4800000000,0x3f78be7900000000bf043f5c,0x3f78be7900000000bf043f5c00000000
.octa 0x3f75be95000000003e953f75,0x3f75be95000000003e953f7500000000,0x3f71beac000000003f673edb,0x3f71beac000000003f673edb00000000
.octa 0x80003f800000000080003f80,0xbf353f350000000080003f80,0x80003f800000000080003f8000000000,0xbf353f350000000080003f8000000000
.octa 0xbf80248d0000000080003f80,0xbf35bf350000000080003f80,0xbf80248d0000000080003f8000000000,0xbf35bf350000000080003f8000000000
.octa 0xa50dbf800000000080003f80,0x3f35bf350000000080003f80,0xa50dbf800000000080003f8000000000,0x3f35bf350000000080003f8000000000
.octa 0x3f80a5540000000080003f80,0x3f353f350000000080003f80,0x3f80a5540000000080003f8000000000,0x3f353f350000000080003f8000000000
.octa 0x80003f800000000080003f80,0xbf35bf3500000000bf80248d,0x80003f800000000080003f8000000000,0xbf35bf3500000000bf80248d00000000
.octa 0x3f80a55400000000a50dbf80,0xbf353f35000000003f80a554,0x3f80a55400000000a50dbf8000000000,0xbf353f35000000003f80a55400000000
.octa 0xa5d4bf8000000000258d3f80,0x3f353f3500000000bf8025b0,0xa5d4bf8000000000258d3f8000000000,0x3f353f3500000000bf8025b000000000
.octa 0xbf80261f00000000a5d4bf80,0x3f35bf35000000003f80a5f7,0xbf80261f00000000a5d4bf8000000000,0x3f35bf35000000003f80a5f700000000
.octa 0x80003f800000000080003f80,0x3f35bf3500000000a50dbf80,0x80003f800000000080003f8000000000,0x3f35bf3500000000a50dbf8000000000
.octa 0xbf8025b000000000258d3f80,0x3f353f3500000000a5d4bf80,0xbf8025b000000000258d3f8000000000,0x3f353f3500000000a5d4bf8000000000
.octa 0xa630bf8000000000260d3f80,0xbf353f3500000000a630bf80,0xa630bf8000000000260d3f8000000000,0xbf353f3500000000a630bf8000000000
.octa 0x3f80a7420000000026543f80,0xbf35bf3500000000a677bf80,0x3f80a7420000000026543f8000000000,0xbf35bf3500000000a677bf8000000000
.octa 0x80003f800000000080003f80,0x3f353f35000000003f80a554,0x80003f800000000080003f8000000000,0x3f353f35000000003f80a55400000000
.octa 0x3f80a5f700000000a5d4bf80,0x3f35bf3500000000bf80261f,0x3f80a5f700000000a5d4bf8000000000,0x3f35bf3500000000bf80261f00000000
.octa 0xa677bf800000000026543f80,0xbf35bf35000000003f80a742,0xa677bf800000000026543f8000000000,0xbf35bf35000000003f80a74200000000
.octa 0xbf80a60d00000000a69fbf80,0xbf353f3500000000bf80a60d,0xbf80a60d00000000a69fbf8000000000,0xbf353f3500000000bf80a60d00000000
.octa 0x3f800000000000003f800000,0x3f353f35000000003f800000,0x3f800000000000003f80000000000000,0x3f353f35000000003f80000000000000
.octa 0x248d3f80000000003f800000,0xbf353f35000000003f800000,0x248d3f80000000003f80000000000000,0xbf353f35000000003f80000000000000
.octa 0xbf80250d000000003f800000,0xbf35bf35000000003f800000,0xbf80250d000000003f80000000000000,0xbf35bf35000000003f80000000000000
.octa 0xa554bf80000000003f800000,0x3f35bf35000000003f800000,0xa554bf80000000003f80000000000000,0x3f35bf35000000003f80000000000000
.octa 0x3f800000000000003f800000,0xbf353f3500000000248d3f80,0x3f800000000000003f80000000000000,0xbf353f3500000000248d3f8000000000
.octa 0xa554bf8000000000bf80250d,0x3f353f3500000000a554bf80,0xa554bf8000000000bf80250d00000000,0x3f353f3500000000a554bf8000000000
.octa 0xbf8025d4000000003f80a58d,0x3f35bf350000000025b03f80,0xbf8025d4000000003f80a58d00000000,0x3f35bf350000000025b03f8000000000
.octa 0x261f3f8000000000bf8025d4,0xbf35bf3500000000a5f7bf80,0x261f3f8000000000bf8025d400000000,0xbf35bf3500000000a5f7bf8000000000
.octa 0x3f800000000000003f800000,0xbf35bf3500000000bf80250d,0x3f800000000000003f80000000000000,0xbf35bf3500000000bf80250d00000000
.octa 0x25b03f80000000003f80a58d,0x3f35bf3500000000bf8025d4,0x25b03f80000000003f80a58d00000000,0x3f35bf3500000000bf8025d400000000
.octa 0xbf802630000000003f80a60d,0x3f353f3500000000bf802630,0xbf802630000000003f80a60d00000000,0x3f353f3500000000bf80263000000000
.octa 0xa742bf80000000003f80a654,0xbf353f3500000000bf802677,0xa742bf80000000003f80a65400000000,0xbf353f3500000000bf80267700000000
.octa 0x3f800000000000003f800000,0x3f35bf3500000000a554bf80,0x3f800000000000003f80000000000000,0x3f35bf3500000000a554bf8000000000
.octa 0xa5f7bf8000000000bf8025d4,0xbf35bf3500000000261f3f80,0xa5f7bf8000000000bf8025d400000000,0xbf35bf3500000000261f3f8000000000
.octa 0xbf802677000000003f80a654,0xbf353f3500000000a742bf80,0xbf802677000000003f80a65400000000,0xbf353f3500000000a742bf8000000000
.octa 0xa60d3f8000000000bf80269f,0x3f353f3500000000a60d3f80,0xa60d3f8000000000bf80269f00000000,0x3f353f3500000000a60d3f8000000000
.octa 0xbbc93f800000000080003f80,0xbf363f340000000080003f80,0xbbc93f800000000080003f8000000000,0xbf363f340000000080003f8000000000
.octa 0xbf80bbc90000000080003f80,0xbf34bf360000000080003f80,0xbf80bbc90000000080003f8000000000,0xbf34bf360000000080003f8000000000
.octa 0x3bc9bf800000000080003f80,0x3f36bf340000000080003f80,0x3bc9bf800000000080003f8000000000,0x3f36bf340000000080003f8000000000
.octa 0x3f803bc90000000080003f80,0x3f343f360000000080003f80,0x3f803bc90000000080003f8000000000,0x3f343f360000000080003f8000000000
.octa 0xbc973f8000000000bc493f80,0xbf32bf3800000000bf80bc49,0xbc973f8000000000bc493f8000000000,0xbf32bf3800000000bf80bc4900000000
.octa 0x3f803c97000000003c49bf80,0xbf383f32000000003f803c49,0x3f803c97000000003c49bf8000000000,0xbf383f32000000003f803c4900000000
.octa 0x3c97bf8000000000bc493f80,0x3f323f3800000000bf80bc49,0x3c97bf8000000000bc493f8000000000,0x3f323f3800000000bf80bc4900000000
.octa 0xbf80bc97000000003c49bf80,0x3f38bf32000000003f803c49,0xbf80bc97000000003c49bf8000000000,0x3f38bf32000000003f803c4900000000
.octa 0xbcfb3f8000000000bcc93f80,0x3f3abf2f000000003cc9bf80,0xbcfb3f8000000000bcc93f8000000000,0x3f3abf2f000000003cc9bf8000000000
.octa 0xbf80bcfb00000000bcc93f80,0x3f2f3f3a000000003cc9bf80,0xbf80bcfb00000000bcc93f8000000000,0x3f2f3f3a000000003cc9bf8000000000
.octa 0x3cfbbf8000000000bcc93f80,0xbf3a3f2f000000003cc9bf80,0x3cfbbf8000000000bcc93f8000000000,0xbf3a3f2f000000003cc9bf8000000000
.octa 0x3f803cfb00000000bcc93f80,0xbf2fbf3a000000003cc9bf80,0x3f803cfb00000000bcc93f8000000000,0xbf2fbf3a000000003cc9bf8000000000
.octa 0xbd303f8000000000bd173f80,0x3f2d3f3d000000003f803d17,0xbd303f8000000000bd173f8000000000,0x3f2d3f3d000000003f803d1700000000
.octa 0x3f803d30000000003d17bf80,0x3f3dbf2d00000000bf80bd17,0x3f803d30000000003d17bf8000000000,0x3f3dbf2d00000000bf80bd1700000000
.octa 0x3d30bf8000000000bd173f80,0xbf2dbf3d000000003f803d17,0x3d30bf8000000000bd173f8000000000,0xbf2dbf3d000000003f803d1700000000
.octa 0xbf80bd30000000003d17bf80,0xbf3d3f2d00000000bf80bd17,0xbf80bd30000000003d17bf8000000000,0xbf3d3f2d00000000bf80bd1700000000
.octa 0x3f803bc9000000003f800000,0x3f343f36000000003f800000,0x3f803bc9000000003f80000000000000,0x3f343f36000000003f80000000000000
.octa 0xbbc93f80000000003f800000,0xbf363f34000000003f800000,0xbbc93f80000000003f80000000000000,0xbf363f34000000003f80000000000000
.octa 0xbf80bbc9000000003f800000,0xbf34bf36000000003f800000,0xbf80bbc9000000003f80000000000000,0xbf34bf36000000003f80000000000000
.octa 0x3bc9bf80000000003f800000,0x3f36bf34000000003f800000,0x3bc9bf80000000003f80000000000000,0x3f36bf34000000003f80000000000000
.octa 0x3f803c97000000003f803c49,0xbf383f3200000000bc493f80,0x3f803c97000000003f803c4900000000,0xbf383f3200000000bc493f8000000000
.octa 0x3c97bf8000000000bf80bc49,0x3f323f38000000003c49bf80,0x3c97bf8000000000bf80bc4900000000,0x3f323f38000000003c49bf8000000000
.octa 0xbf80bc97000000003f803c49,0x3f38bf3200000000bc493f80,0xbf80bc97000000003f803c4900000000,0x3f38bf3200000000bc493f8000000000
.octa 0xbc973f8000000000bf80bc49,0xbf32bf38000000003c49bf80,0xbc973f8000000000bf80bc4900000000,0xbf32bf38000000003c49bf8000000000
.octa 0x3f803cfb000000003f803cc9,0xbf2fbf3a00000000bf80bcc9,0x3f803cfb000000003f803cc900000000,0xbf2fbf3a00000000bf80bcc900000000
.octa 0xbcfb3f80000000003f803cc9,0x3f3abf2f00000000bf80bcc9,0xbcfb3f80000000003f803cc900000000,0x3f3abf2f00000000bf80bcc900000000
.octa 0xbf80bcfb000000003f803cc9,0x3f2f3f3a00000000bf80bcc9,0xbf80bcfb000000003f803cc900000000,0x3f2f3f3a00000000bf80bcc900000000
.octa 0x3cfbbf80000000003f803cc9,0xbf3a3f2f00000000bf80bcc9,0x3cfbbf80000000003f803cc900000000,0xbf3a3f2f00000000bf80bcc900000000
.octa 0x3f803d30000000003f803d17,0x3f3dbf2d000000003d17bf80,0x3f803d30000000003f803d1700000000,0x3f3dbf2d000000003d17bf8000000000
.octa 0x3d30bf8000000000bf80bd17,0xbf2dbf3d00000000bd173f80,0x3d30bf8000000000bf80bd1700000000,0xbf2dbf3d00000000bd173f8000000000
.octa 0xbf80bd30000000003f803d17,0xbf3d3f2d000000003d17bf80,0xbf80bd30000000003f803d1700000000,0xbf3d3f2d000000003d17bf8000000000
.octa 0xbd303f8000000000bf80bd17,0x3f2d3f3d00000000bd173f80,0xbd303f8000000000bf80bd1700000000,0x3f2d3f3d00000000bd173f8000000000
.octa 0xbc493f800000000080003f80,0xbf373f330000000080003f80,0xbc493f800000000080003f8000000000,0xbf373f330000000080003f8000000000
.octa 0xbf80bc490000000080003f80,0xbf33bf370000000080003f80,0xbf80bc490000000080003f8000000000,0xbf33bf370000000080003f8000000000
.octa 0x3c49bf800000000080003f80,0x3f37bf330000000080003f80,0x3c49bf800000000080003f8000000000,0x3f37bf330000000080003f8000000000
.octa 0x3f803c490000000080003f80,0x3f333f370000000080003f80,0x3f803c490000000080003f8000000000,0x3f333f370000000080003f8000000000
.octa 0xbd173f8000000000bcc93f80,0xbf2ebf3c00000000bf80bcc9,0xbd173f8000000000bcc93f8000000000,0xbf2ebf3c00000000bf80bcc900000000
.octa 0x3f803d17000000003cc9bf80,0xbf3c3f2e000000003f803cc9,0x3f803d17000000003cc9bf8000000000,0xbf3c3f2e000000003f803cc900000000
.octa 0x3d17bf8000000000bcc93f80,0x3f2e3f3c00000000bf80bcc9,0x3d17bf8000000000bcc93f8000000000,0x3f2e3f3c00000000bf80bcc900000000
.octa 0xbf80bd17000000003cc9bf80,0x3f3cbf2e000000003f803cc9,0xbf80bd17000000003cc9bf8000000000,0x3f3cbf2e000000003f803cc900000000
.octa 0xbd7b3f8000000000bd493f80,0x3f40bf2a000000003d49bf80,0xbd7b3f8000000000bd493f8000000000,0x3f40bf2a000000003d49bf8000000000
.octa 0xbf80bd7b00000000bd493f80,0x3f2a3f40000000003d49bf80,0xbf80bd7b00000000bd493f8000000000,0x3f2a3f40000000003d49bf8000000000
.octa 0x3d7bbf8000000000bd493f80,0xbf403f2a000000003d49bf80,0x3d7bbf8000000000bd493f8000000000,0xbf403f2a000000003d49bf8000000000
.octa 0x3f803d7b00000000bd493f80,0xbf2abf40000000003d49bf80,0x3f803d7b00000000bd493f8000000000,0xbf2abf40000000003d49bf8000000000
.octa 0xbdb03f7f00000000bd973f7f,0x3f253f44000000003f7f3d97,0xbdb03f7f00000000bd973f7f00000000,0x3f253f44000000003f7f3d9700000000
.octa 0x3f7f3db0000000003d97bf7f,0x3f44bf2500000000bf7fbd97,0x3f7f3db0000000003d97bf7f00000000,0x3f44bf2500000000bf7fbd9700000000
.octa 0x3db0bf7f00000000bd973f7f,0xbf25bf44000000003f7f3d97,0x3db0bf7f00000000bd973f7f00000000,0xbf25bf44000000003f7f3d9700000000
.octa 0xbf7fbdb0000000003d97bf7f,0xbf443f2500000000bf7fbd97,0xbf7fbdb0000000003d97bf7f00000000,0xbf443f2500000000bf7fbd9700000000
.octa 0x3f803c49000000003f800000,0x3f333f37000000003f800000,0x3f803c49000000003f80000000000000,0x3f333f37000000003f80000000000000
.octa 0xbc493f80000000003f800000,0xbf373f33000000003f800000,0xbc493f80000000003f80000000000000,0xbf373f33000000003f80000000000000
.octa 0xbf80bc49000000003f800000,0xbf33bf37000000003f800000,0xbf80bc49000000003f80000000000000,0xbf33bf37000000003f80000000000000
.octa 0x3c49bf80000000003f800000,0x3f37bf33000000003f800000,0x3c49bf80000000003f80000000000000,0x3f37bf33000000003f80000000000000
.octa 0x3f803d17000000003f803cc9,0xbf3c3f2e00000000bcc93f80,0x3f803d17000000003f803cc900000000,0xbf3c3f2e00000000bcc93f8000000000
.octa 0x3d17bf8000000000bf80bcc9,0x3f2e3f3c000000003cc9bf80,0x3d17bf8000000000bf80bcc900000000,0x3f2e3f3c000000003cc9bf8000000000
.octa 0xbf80bd17000000003f803cc9,0x3f3cbf2e00000000bcc93f80,0xbf80bd17000000003f803cc900000000,0x3f3cbf2e00000000bcc93f8000000000
.octa 0xbd173f8000000000bf80bcc9,0xbf2ebf3c000000003cc9bf80,0xbd173f8000000000bf80bcc900000000,0xbf2ebf3c000000003cc9bf8000000000
.octa 0x3f803d7b000000003f803d49,0xbf2abf4000000000bf80bd49,0x3f803d7b000000003f803d4900000000,0xbf2abf4000000000bf80bd4900000000
.octa 0xbd7b3f80000000003f803d49,0x3f40bf2a00000000bf80bd49,0xbd7b3f80000000003f803d4900000000,0x3f40bf2a00000000bf80bd4900000000
.octa 0xbf80bd7b000000003f803d49,0x3f2a3f4000000000bf80bd49,0xbf80bd7b000000003f803d4900000000,0x3f2a3f4000000000bf80bd4900000000
.octa 0x3d7bbf80000000003f803d49,0xbf403f2a00000000bf80bd49,0x3d7bbf80000000003f803d4900000000,0xbf403f2a00000000bf80bd4900000000
.octa 0x3f7f3db0000000003f7f3d97,0x3f44bf25000000003d97bf7f,0x3f7f3db0000000003f7f3d9700000000,0x3f44bf25000000003d97bf7f00000000
.octa 0x3db0bf7f00000000bf7fbd97,0xbf25bf4400000000bd973f7f,0x3db0bf7f00000000bf7fbd9700000000,0xbf25bf4400000000bd973f7f00000000
.octa 0xbf7fbdb0000000003f7f3d97,0xbf443f25000000003d97bf7f,0xbf7fbdb0000000003f7f3d9700000000,0xbf443f25000000003d97bf7f00000000
.octa 0xbdb03f7f00000000bf7fbd97,0x3f253f4400000000bd973f7f,0xbdb03f7f00000000bf7fbd9700000000,0x3f253f4400000000bd973f7f00000000
.octa 0xbc973f800000000080003f80,0xbf383f320000000080003f80,0xbc973f800000000080003f8000000000,0xbf383f320000000080003f8000000000
.octa 0xbf80bc970000000080003f80,0xbf32bf380000000080003f80,0xbf80bc970000000080003f8000000000,0xbf32bf380000000080003f8000000000
.octa 0x3c97bf800000000080003f80,0x3f38bf320000000080003f80,0x3c97bf800000000080003f8000000000,0x3f38bf320000000080003f8000000000
.octa 0x3f803c970000000080003f80,0x3f323f380000000080003f80,0x3f803c970000000080003f8000000000,0x3f323f380000000080003f8000000000
.octa 0xbd623f8000000000bd173f80,0xbf2bbf3f00000000bf80bd17,0xbd623f8000000000bd173f8000000000,0xbf2bbf3f00000000bf80bd1700000000
.octa 0x3f803d62000000003d17bf80,0xbf3f3f2b000000003f803d17,0x3f803d62000000003d17bf8000000000,0xbf3f3f2b000000003f803d1700000000
.octa 0x3d62bf8000000000bd173f80,0x3f2b3f3f00000000bf80bd17,0x3d62bf8000000000bd173f8000000000,0x3f2b3f3f00000000bf80bd1700000000
.octa 0xbf80bd62000000003d17bf80,0x3f3fbf2b000000003f803d17,0xbf80bd62000000003d17bf8000000000,0x3f3fbf2b000000003f803d1700000000
.octa 0xbdbc3f7f00000000bd973f7f,0x3f45bf24000000003d97bf7f,0xbdbc3f7f00000000bd973f7f00000000,0x3f45bf24000000003d97bf7f00000000
.octa 0xbf7fbdbc00000000bd973f7f,0x3f243f45000000003d97bf7f,0xbf7fbdbc00000000bd973f7f00000000,0x3f243f45000000003d97bf7f00000000
.octa 0x3dbcbf7f00000000bd973f7f,0xbf453f24000000003d97bf7f,0x3dbcbf7f00000000bd973f7f00000000,0xbf453f24000000003d97bf7f00000000
.octa 0x3f7f3dbc00000000bd973f7f,0xbf24bf45000000003d97bf7f,0x3f7f3dbc00000000bd973f7f00000000,0xbf24bf45000000003d97bf7f00000000
.octa 0xbe043f7e00000000bde23f7e,0x3f1c3f4b000000003f7e3de2,0xbe043f7e00000000bde23f7e00000000,0x3f1c3f4b000000003f7e3de200000000
.octa 0x3f7e3e04000000003de2bf7e,0x3f4bbf1c00000000bf7ebde2,0x3f7e3e04000000003de2bf7e00000000,0x3f4bbf1c00000000bf7ebde200000000
.octa 0x3e04bf7e00000000bde23f7e,0xbf1cbf4b000000003f7e3de2,0x3e04bf7e00000000bde23f7e00000000,0xbf1cbf4b000000003f7e3de200000000
.octa 0xbf7ebe04000000003de2bf7e,0xbf4b3f1c00000000bf7ebde2,0xbf7ebe04000000003de2bf7e00000000,0xbf4b3f1c00000000bf7ebde200000000
.octa 0x3f803c97000000003f800000,0x3f323f38000000003f800000,0x3f803c97000000003f80000000000000,0x3f323f38000000003f80000000000000
.octa 0xbc973f80000000003f800000,0xbf383f32000000003f800000,0xbc973f80000000003f80000000000000,0xbf383f32000000003f80000000000000
.octa 0xbf80bc97000000003f800000,0xbf32bf38000000003f800000,0xbf80bc97000000003f80000000000000,0xbf32bf38000000003f80000000000000
.octa 0x3c97bf80000000003f800000,0x3f38bf32000000003f800000,0x3c97bf80000000003f80000000000000,0x3f38bf32000000003f80000000000000
.octa 0x3f803d62000000003f803d17,0xbf3f3f2b00000000bd173f80,0x3f803d62000000003f803d1700000000,0xbf3f3f2b00000000bd173f8000000000
.octa 0x3d62bf8000000000bf80bd17,0x3f2b3f3f000000003d17bf80,0x3d62bf8000000000bf80bd1700000000,0x3f2b3f3f000000003d17bf8000000000
.octa 0xbf80bd62000000003f803d17,0x3f3fbf2b00000000bd173f80,0xbf80bd62000000003f803d1700000000,0x3f3fbf2b00000000bd173f8000000000
.octa 0xbd623f8000000000bf80bd17,0xbf2bbf3f000000003d17bf80,0xbd623f8000000000bf80bd1700000000,0xbf2bbf3f000000003d17bf8000000000
.octa 0x3f7f3dbc000000003f7f3d97,0xbf24bf4500000000bf7fbd97,0x3f7f3dbc000000003f7f3d9700000000,0xbf24bf4500000000bf7fbd9700000000
.octa 0xbdbc3f7f000000003f7f3d97,0x3f45bf2400000000bf7fbd97,0xbdbc3f7f000000003f7f3d9700000000,0x3f45bf2400000000bf7fbd9700000000
.octa 0xbf7fbdbc000000003f7f3d97,0x3f243f4500000000bf7fbd97,0xbf7fbdbc000000003f7f3d9700000000,0x3f243f4500000000bf7fbd9700000000
.octa 0x3dbcbf7f000000003f7f3d97,0xbf453f2400000000bf7fbd97,0x3dbcbf7f000000003f7f3d9700000000,0xbf453f2400000000bf7fbd9700000000
.octa 0x3f7e3e04000000003f7e3de2,0x3f4bbf1c000000003de2bf7e,0x3f7e3e04000000003f7e3de200000000,0x3f4bbf1c000000003de2bf7e00000000
.octa 0x3e04bf7e00000000bf7ebde2,0xbf1cbf4b00000000bde23f7e,0x3e04bf7e00000000bf7ebde200000000,0xbf1cbf4b00000000bde23f7e00000000
.octa 0xbf7ebe04000000003f7e3de2,0xbf4b3f1c000000003de2bf7e,0xbf7ebe04000000003f7e3de200000000,0xbf4b3f1c000000003de2bf7e00000000
.octa 0xbe043f7e00000000bf7ebde2,0x3f1c3f4b00000000bde23f7e,0xbe043f7e00000000bf7ebde200000000,0x3f1c3f4b00000000bde23f7e00000000
.octa 0xbcc93f800000000080003f80,0xbf393f310000000080003f80,0xbcc93f800000000080003f8000000000,0xbf393f310000000080003f8000000000
.octa 0xbf80bcc90000000080003f80,0xbf31bf390000000080003f80,0xbf80bcc90000000080003f8000000000,0xbf31bf390000000080003f8000000000
.octa 0x3cc9bf800000000080003f80,0x3f39bf310000000080003f80,0x3cc9bf800000000080003f8000000000,0x3f39bf310000000080003f8000000000
.octa 0x3f803cc90000000080003f80,0x3f313f390000000080003f80,0x3f803cc90000000080003f8000000000,0x3f313f390000000080003f8000000000
.octa 0xbd973f7f00000000bd493f80,0xbf27bf4200000000bf80bd49,0xbd973f7f00000000bd493f8000000000,0xbf27bf4200000000bf80bd4900000000
.octa 0x3f7f3d97000000003d49bf80,0xbf423f27000000003f803d49,0x3f7f3d97000000003d49bf8000000000,0xbf423f27000000003f803d4900000000
.octa 0x3d97bf7f00000000bd493f80,0x3f273f4200000000bf80bd49,0x3d97bf7f00000000bd493f8000000000,0x3f273f4200000000bf80bd4900000000
.octa 0xbf7fbd97000000003d49bf80,0x3f42bf27000000003f803d49,0xbf7fbd97000000003d49bf8000000000,0x3f42bf27000000003f803d4900000000
.octa 0xbdfb3f7e00000000bdc93f7f,0x3f4abf1d000000003dc9bf7f,0xbdfb3f7e00000000bdc93f7f00000000,0x3f4abf1d000000003dc9bf7f00000000
.octa 0xbf7ebdfb00000000bdc93f7f,0x3f1d3f4a000000003dc9bf7f,0xbf7ebdfb00000000bdc93f7f00000000,0x3f1d3f4a000000003dc9bf7f00000000
.octa 0x3dfbbf7e00000000bdc93f7f,0xbf4a3f1d000000003dc9bf7f,0x3dfbbf7e00000000bdc93f7f00000000,0xbf4a3f1d000000003dc9bf7f00000000
.octa 0x3f7e3dfb00000000bdc93f7f,0xbf1dbf4a000000003dc9bf7f,0x3f7e3dfb00000000bdc93f7f00000000,0xbf1dbf4a000000003dc9bf7f00000000
.octa 0xbe2f3f7c00000000be163f7d,0x3f133f51000000003f7d3e16,0xbe2f3f7c00000000be163f7d00000000,0x3f133f51000000003f7d3e1600000000
.octa 0x3f7c3e2f000000003e16bf7d,0x3f51bf1300000000bf7dbe16,0x3f7c3e2f000000003e16bf7d00000000,0x3f51bf1300000000bf7dbe1600000000
.octa 0x3e2fbf7c00000000be163f7d,0xbf13bf51000000003f7d3e16,0x3e2fbf7c00000000be163f7d00000000,0xbf13bf51000000003f7d3e1600000000
.octa 0xbf7cbe2f000000003e16bf7d,0xbf513f1300000000bf7dbe16,0xbf7cbe2f000000003e16bf7d00000000,0xbf513f1300000000bf7dbe1600000000
.octa 0x3f803cc9000000003f800000,0x3f313f39000000003f800000,0x3f803cc9000000003f80000000000000,0x3f313f39000000003f80000000000000
.octa 0xbcc93f80000000003f800000,0xbf393f31000000003f800000,0xbcc93f80000000003f80000000000000,0xbf393f31000000003f80000000000000
.octa 0xbf80bcc9000000003f800000,0xbf31bf39000000003f800000,0xbf80bcc9000000003f80000000000000,0xbf31bf39000000003f80000000000000
.octa 0x3cc9bf80000000003f800000,0x3f39bf31000000003f800000,0x3cc9bf80000000003f80000000000000,0x3f39bf31000000003f80000000000000
.octa 0x3f7f3d97000000003f803d49,0xbf423f2700000000bd493f80,0x3f7f3d97000000003f803d4900000000,0xbf423f2700000000bd493f8000000000
.octa 0x3d97bf7f00000000bf80bd49,0x3f273f42000000003d49bf80,0x3d97bf7f00000000bf80bd4900000000,0x3f273f42000000003d49bf8000000000
.octa 0xbf7fbd97000000003f803d49,0x3f42bf2700000000bd493f80,0xbf7fbd97000000003f803d4900000000,0x3f42bf2700000000bd493f8000000000
.octa 0xbd973f7f00000000bf80bd49,0xbf27bf42000000003d49bf80,0xbd973f7f00000000bf80bd4900000000,0xbf27bf42000000003d49bf8000000000
.octa 0x3f7e3dfb000000003f7f3dc9,0xbf1dbf4a00000000bf7fbdc9,0x3f7e3dfb000000003f7f3dc900000000,0xbf1dbf4a00000000bf7fbdc900000000
.octa 0xbdfb3f7e000000003f7f3dc9,0x3f4abf1d00000000bf7fbdc9,0xbdfb3f7e000000003f7f3dc900000000,0x3f4abf1d00000000bf7fbdc900000000
.octa 0xbf7ebdfb000000003f7f3dc9,0x3f1d3f4a00000000bf7fbdc9,0xbf7ebdfb000000003f7f3dc900000000,0x3f1d3f4a00000000bf7fbdc900000000
.octa 0x3dfbbf7e000000003f7f3dc9,0xbf4a3f1d00000000bf7fbdc9,0x3dfbbf7e000000003f7f3dc900000000,0xbf4a3f1d00000000bf7fbdc900000000
.octa 0x3f7c3e2f000000003f7d3e16,0x3f51bf13000000003e16bf7d,0x3f7c3e2f000000003f7d3e1600000000,0x3f51bf13000000003e16bf7d00000000
.octa 0x3e2fbf7c00000000bf7dbe16,0xbf13bf5100000000be163f7d,0x3e2fbf7c00000000bf7dbe1600000000,0xbf13bf5100000000be163f7d00000000
.octa 0xbf7cbe2f000000003f7d3e16,0xbf513f13000000003e16bf7d,0xbf7cbe2f000000003f7d3e1600000000,0xbf513f13000000003e16bf7d00000000
.octa 0xbe2f3f7c00000000bf7dbe16,0x3f133f5100000000be163f7d,0xbe2f3f7c00000000bf7dbe1600000000,0x3f133f5100000000be163f7d00000000
.octa 0xbcfb3f800000000080003f80,0xbf3a3f2f0000000080003f80,0xbcfb3f800000000080003f8000000000,0xbf3a3f2f0000000080003f8000000000
.octa 0xbf80bcfb0000000080003f80,0xbf2fbf3a0000000080003f80,0xbf80bcfb0000000080003f8000000000,0xbf2fbf3a0000000080003f8000000000
.octa 0x3cfbbf800000000080003f80,0x3f3abf2f0000000080003f80,0x3cfbbf800000000080003f8000000000,0x3f3abf2f0000000080003f8000000000
.octa 0x3f803cfb0000000080003f80,0x3f2f3f3a0000000080003f80,0x3f803cfb0000000080003f8000000000,0x3f2f3f3a0000000080003f8000000000
.octa 0xbdbc3f7f00000000bd7b3f80,0xbf24bf4500000000bf80bd7b,0xbdbc3f7f00000000bd7b3f8000000000,0xbf24bf4500000000bf80bd7b00000000
.octa 0x3f7f3dbc000000003d7bbf80,0xbf453f24000000003f803d7b,0x3f7f3dbc000000003d7bbf8000000000,0xbf453f24000000003f803d7b00000000
.octa 0x3dbcbf7f00000000bd7b3f80,0x3f243f4500000000bf80bd7b,0x3dbcbf7f00000000bd7b3f8000000000,0x3f243f4500000000bf80bd7b00000000
.octa 0xbf7fbdbc000000003d7bbf80,0x3f45bf24000000003f803d7b,0xbf7fbdbc000000003d7bbf8000000000,0x3f45bf24000000003f803d7b00000000
.octa 0xbe1c3f7d00000000bdfb3f7e,0x3f4fbf17000000003dfbbf7e,0xbe1c3f7d00000000bdfb3f7e00000000,0x3f4fbf17000000003dfbbf7e00000000
.octa 0xbf7dbe1c00000000bdfb3f7e,0x3f173f4f000000003dfbbf7e,0xbf7dbe1c00000000bdfb3f7e00000000,0x3f173f4f000000003dfbbf7e00000000
.octa 0x3e1cbf7d00000000bdfb3f7e,0xbf4f3f17000000003dfbbf7e,0x3e1cbf7d00000000bdfb3f7e00000000,0xbf4f3f17000000003dfbbf7e00000000
.octa 0x3f7d3e1c00000000bdfb3f7e,0xbf17bf4f000000003dfbbf7e,0x3f7d3e1c00000000bdfb3f7e00000000,0xbf17bf4f000000003dfbbf7e00000000
.octa 0xbe5a3f7a00000000be3b3f7c,0x3f0a3f57000000003f7c3e3b,0xbe5a3f7a00000000be3b3f7c00000000,0x3f0a3f57000000003f7c3e3b00000000
.octa 0x3f7a3e5a000000003e3bbf7c,0x3f57bf0a00000000bf7cbe3b,0x3f7a3e5a000000003e3bbf7c00000000,0x3f57bf0a00000000bf7cbe3b00000000
.octa 0x3e5abf7a00000000be3b3f7c,0xbf0abf57000000003f7c3e3b,0x3e5abf7a00000000be3b3f7c00000000,0xbf0abf57000000003f7c3e3b00000000
.octa 0xbf7abe5a000000003e3bbf7c,0xbf573f0a00000000bf7cbe3b,0xbf7abe5a000000003e3bbf7c00000000,0xbf573f0a00000000bf7cbe3b00000000
.octa 0x3f803cfb000000003f800000,0x3f2f3f3a000000003f800000,0x3f803cfb000000003f80000000000000,0x3f2f3f3a000000003f80000000000000
.octa 0xbcfb3f80000000003f800000,0xbf3a3f2f000000003f800000,0xbcfb3f80000000003f80000000000000,0xbf3a3f2f000000003f80000000000000
.octa 0xbf80bcfb000000003f800000,0xbf2fbf3a000000003f800000,0xbf80bcfb000000003f80000000000000,0xbf2fbf3a000000003f80000000000000
.octa 0x3cfbbf80000000003f800000,0x3f3abf2f000000003f800000,0x3cfbbf80000000003f80000000000000,0x3f3abf2f000000003f80000000000000
.octa 0x3f7f3dbc000000003f803d7b,0xbf453f2400000000bd7b3f80,0x3f7f3dbc000000003f803d7b00000000,0xbf453f2400000000bd7b3f8000000000
.octa 0x3dbcbf7f00000000bf80bd7b,0x3f243f45000000003d7bbf80,0x3dbcbf7f00000000bf80bd7b00000000,0x3f243f45000000003d7bbf8000000000
.octa 0xbf7fbdbc000000003f803d7b,0x3f45bf2400000000bd7b3f80,0xbf7fbdbc000000003f803d7b00000000,0x3f45bf2400000000bd7b3f8000000000
.octa 0xbdbc3f7f00000000bf80bd7b,0xbf24bf45000000003d7bbf80,0xbdbc3f7f00000000bf80bd7b00000000,0xbf24bf45000000003d7bbf8000000000
.octa 0x3f7d3e1c000000003f7e3dfb,0xbf17bf4f00000000bf7ebdfb,0x3f7d3e1c000000003f7e3dfb00000000,0xbf17bf4f00000000bf7ebdfb00000000
.octa 0xbe1c3f7d000000003f7e3dfb,0x3f4fbf1700000000bf7ebdfb,0xbe1c3f7d000000003f7e3dfb00000000,0x3f4fbf1700000000bf7ebdfb00000000
.octa 0xbf7dbe1c000000003f7e3dfb,0x3f173f4f00000000bf7ebdfb,0xbf7dbe1c000000003f7e3dfb00000000,0x3f173f4f00000000bf7ebdfb00000000
.octa 0x3e1cbf7d000000003f7e3dfb,0xbf4f3f1700000000bf7ebdfb,0x3e1cbf7d000000003f7e3dfb00000000,0xbf4f3f1700000000bf7ebdfb00000000
.octa 0x3f7a3e5a000000003f7c3e3b,0x3f57bf0a000000003e3bbf7c,0x3f7a3e5a000000003f7c3e3b00000000,0x3f57bf0a000000003e3bbf7c00000000
.octa 0x3e5abf7a00000000bf7cbe3b,0xbf0abf5700000000be3b3f7c,0x3e5abf7a00000000bf7cbe3b00000000,0xbf0abf5700000000be3b3f7c00000000
.octa 0xbf7abe5a000000003f7c3e3b,0xbf573f0a000000003e3bbf7c,0xbf7abe5a000000003f7c3e3b00000000,0xbf573f0a000000003e3bbf7c00000000
.octa 0xbe5a3f7a00000000bf7cbe3b,0x3f0a3f5700000000be3b3f7c,0xbe5a3f7a00000000bf7cbe3b00000000,0x3f0a3f5700000000be3b3f7c00000000
.octa 0xbd173f800000000080003f80,0xbf3c3f2e0000000080003f80,0xbd173f800000000080003f8000000000,0xbf3c3f2e0000000080003f8000000000
.octa 0xbf80bd170000000080003f80,0xbf2ebf3c0000000080003f80,0xbf80bd170000000080003f8000000000,0xbf2ebf3c0000000080003f8000000000
.octa 0x3d17bf800000000080003f80,0x3f3cbf2e0000000080003f80,0x3d17bf800000000080003f8000000000,0x3f3cbf2e0000000080003f8000000000
.octa 0x3f803d170000000080003f80,0x3f2e3f3c0000000080003f80,0x3f803d170000000080003f8000000000,0x3f2e3f3c0000000080003f8000000000
.octa 0xbde23f7e00000000bd973f7f,0xbf20bf4800000000bf7fbd97,0xbde23f7e00000000bd973f7f00000000,0xbf20bf4800000000bf7fbd9700000000
.octa 0x3f7e3de2000000003d97bf7f,0xbf483f20000000003f7f3d97,0x3f7e3de2000000003d97bf7f00000000,0xbf483f20000000003f7f3d9700000000
.octa 0x3de2bf7e00000000bd973f7f,0x3f203f4800000000bf7fbd97,0x3de2bf7e00000000bd973f7f00000000,0x3f203f4800000000bf7fbd9700000000
.octa 0xbf7ebde2000000003d97bf7f,0x3f48bf20000000003f7f3d97,0xbf7ebde2000000003d97bf7f00000000,0x3f48bf20000000003f7f3d9700000000
.octa 0xbe3b3f7c00000000be163f7d,0x3f53bf11000000003e16bf7d,0xbe3b3f7c00000000be163f7d00000000,0x3f53bf11000000003e16bf7d00000000
.octa 0xbf7cbe3b00000000be163f7d,0x3f113f53000000003e16bf7d,0xbf7cbe3b00000000be163f7d00000000,0x3f113f53000000003e16bf7d00000000
.octa 0x3e3bbf7c00000000be163f7d,0xbf533f11000000003e16bf7d,0x3e3bbf7c00000000be163f7d00000000,0xbf533f11000000003e16bf7d00000000
.octa 0x3f7c3e3b00000000be163f7d,0xbf11bf53000000003e16bf7d,0x3f7c3e3b00000000be163f7d00000000,0xbf11bf53000000003e16bf7d00000000
.octa 0xbe823f7800000000be603f7a,0x3f013f5d000000003f7a3e60,0xbe823f7800000000be603f7a00000000,0x3f013f5d000000003f7a3e6000000000
.octa 0x3f783e82000000003e60bf7a,0x3f5dbf0100000000bf7abe60,0x3f783e82000000003e60bf7a00000000,0x3f5dbf0100000000bf7abe6000000000
.octa 0x3e82bf7800000000be603f7a,0xbf01bf5d000000003f7a3e60,0x3e82bf7800000000be603f7a00000000,0xbf01bf5d000000003f7a3e6000000000
.octa 0xbf78be82000000003e60bf7a,0xbf5d3f0100000000bf7abe60,0xbf78be82000000003e60bf7a00000000,0xbf5d3f0100000000bf7abe6000000000
.octa 0x3f803d17000000003f800000,0x3f2e3f3c000000003f800000,0x3f803d17000000003f80000000000000,0x3f2e3f3c000000003f80000000000000
.octa 0xbd173f80000000003f800000,0xbf3c3f2e000000003f800000,0xbd173f80000000003f80000000000000,0xbf3c3f2e000000003f80000000000000
.octa 0xbf80bd17000000003f800000,0xbf2ebf3c000000003f800000,0xbf80bd17000000003f80000000000000,0xbf2ebf3c000000003f80000000000000
.octa 0x3d17bf80000000003f800000,0x3f3cbf2e000000003f800000,0x3d17bf80000000003f80000000000000,0x3f3cbf2e000000003f80000000000000
.octa 0x3f7e3de2000000003f7f3d97,0xbf483f2000000000bd973f7f,0x3f7e3de2000000003f7f3d9700000000,0xbf483f2000000000bd973f7f00000000
.octa 0x3de2bf7e00000000bf7fbd97,0x3f203f48000000003d97bf7f,0x3de2bf7e00000000bf7fbd9700000000,0x3f203f48000000003d97bf7f00000000
.octa 0xbf7ebde2000000003f7f3d97,0x3f48bf2000000000bd973f7f,0xbf7ebde2000000003f7f3d9700000000,0x3f48bf2000000000bd973f7f00000000
.octa 0xbde23f7e00000000bf7fbd97,0xbf20bf48000000003d97bf7f,0xbde23f7e00000000bf7fbd9700000000,0xbf20bf48000000003d97bf7f00000000
.octa 0x3f7c3e3b000000003f7d3e16,0xbf11bf5300000000bf7dbe16,0x3f7c3e3b000000003f7d3e1600000000,0xbf11bf5300000000bf7dbe1600000000
.octa 0xbe3b3f7c000000003f7d3e16,0x3f53bf1100000000bf7dbe16,0xbe3b3f7c000000003f7d3e1600000000,0x3f53bf1100000000bf7dbe1600000000
.octa 0xbf7cbe3b000000003f7d3e16,0x3f113f5300000000bf7dbe16,0xbf7cbe3b000000003f7d3e1600000000,0x3f113f5300000000bf7dbe1600000000
.octa 0x3e3bbf7c000000003f7d3e16,0xbf533f1100000000bf7dbe16,0x3e3bbf7c000000003f7d3e1600000000,0xbf533f1100000000bf7dbe1600000000
.octa 0x3f783e82000000003f7a3e60,0x3f5dbf01000000003e60bf7a,0x3f783e82000000003f7a3e6000000000,0x3f5dbf01000000003e60bf7a00000000
.octa 0x3e82bf7800000000bf7abe60,0xbf01bf5d00000000be603f7a,0x3e82bf7800000000bf7abe6000000000,0xbf01bf5d00000000be603f7a00000000
.octa 0xbf78be82000000003f7a3e60,0xbf5d3f01000000003e60bf7a,0xbf78be82000000003f7a3e6000000000,0xbf5d3f01000000003e60bf7a00000000
.octa 0xbe823f7800000000bf7abe60,0x3f013f5d00000000be603f7a,0xbe823f7800000000bf7abe6000000000,0x3f013f5d00000000be603f7a00000000
.octa 0xbd303f800000000080003f80,0xbf3d3f2d0000000080003f80,0xbd303f800000000080003f8000000000,0xbf3d3f2d0000000080003f8000000000
.octa 0xbf80bd300000000080003f80,0xbf2dbf3d0000000080003f80,0xbf80bd300000000080003f8000000000,0xbf2dbf3d0000000080003f8000000000
.octa 0x3d30bf800000000080003f80,0x3f3dbf2d0000000080003f80,0x3d30bf800000000080003f8000000000,0x3f3dbf2d0000000080003f8000000000
.octa 0x3f803d300000000080003f80,0x3f2d3f3d0000000080003f80,0x3f803d300000000080003f8000000000,0x3f2d3f3d0000000080003f8000000000
.octa 0xbe043f7e00000000bdb03f7f,0xbf1cbf4b00000000bf7fbdb0,0xbe043f7e00000000bdb03f7f00000000,0xbf1cbf4b00000000bf7fbdb000000000
.octa 0x3f7e3e04000000003db0bf7f,0xbf4b3f1c000000003f7f3db0,0x3f7e3e04000000003db0bf7f00000000,0xbf4b3f1c000000003f7f3db000000000
.octa 0x3e04bf7e00000000bdb03f7f,0x3f1c3f4b00000000bf7fbdb0,0x3e04bf7e00000000bdb03f7f00000000,0x3f1c3f4b00000000bf7fbdb000000000
.octa 0xbf7ebe04000000003db0bf7f,0x3f4bbf1c000000003f7f3db0,0xbf7ebe04000000003db0bf7f00000000,0x3f4bbf1c000000003f7f3db000000000
.octa 0xbe5a3f7a00000000be2f3f7c,0x3f57bf0a000000003e2fbf7c,0xbe5a3f7a00000000be2f3f7c00000000,0x3f57bf0a000000003e2fbf7c00000000
.octa 0xbf7abe5a00000000be2f3f7c,0x3f0a3f57000000003e2fbf7c,0xbf7abe5a00000000be2f3f7c00000000,0x3f0a3f57000000003e2fbf7c00000000
.octa 0x3e5abf7a00000000be2f3f7c,0xbf573f0a000000003e2fbf7c,0x3e5abf7a00000000be2f3f7c00000000,0xbf573f0a000000003e2fbf7c00000000
.octa 0x3f7a3e5a00000000be2f3f7c,0xbf0abf57000000003e2fbf7c,0x3f7a3e5a00000000be2f3f7c00000000,0xbf0abf57000000003e2fbf7c00000000
.octa 0xbe983f7500000000be823f78,0x3eef3f63000000003f783e82,0xbe983f7500000000be823f7800000000,0x3eef3f63000000003f783e8200000000
.octa 0x3f753e98000000003e82bf78,0x3f63beef00000000bf78be82,0x3f753e98000000003e82bf7800000000,0x3f63beef00000000bf78be8200000000
.octa 0x3e98bf7500000000be823f78,0xbeefbf63000000003f783e82,0x3e98bf7500000000be823f7800000000,0xbeefbf63000000003f783e8200000000
.octa 0xbf75be98000000003e82bf78,0xbf633eef00000000bf78be82,0xbf75be98000000003e82bf7800000000,0xbf633eef00000000bf78be8200000000
.octa 0x3f803d30000000003f800000,0x3f2d3f3d000000003f800000,0x3f803d30000000003f80000000000000,0x3f2d3f3d000000003f80000000000000
.octa 0xbd303f80000000003f800000,0xbf3d3f2d000000003f800000,0xbd303f80000000003f80000000000000,0xbf3d3f2d000000003f80000000000000
.octa 0xbf80bd30000000003f800000,0xbf2dbf3d000000003f800000,0xbf80bd30000000003f80000000000000,0xbf2dbf3d000000003f80000000000000
.octa 0x3d30bf80000000003f800000,0x3f3dbf2d000000003f800000,0x3d30bf80000000003f80000000000000,0x3f3dbf2d000000003f80000000000000
.octa 0x3f7e3e04000000003f7f3db0,0xbf4b3f1c00000000bdb03f7f,0x3f7e3e04000000003f7f3db000000000,0xbf4b3f1c00000000bdb03f7f00000000
.octa 0x3e04bf7e00000000bf7fbdb0,0x3f1c3f4b000000003db0bf7f,0x3e04bf7e00000000bf7fbdb000000000,0x3f1c3f4b000000003db0bf7f00000000
.octa 0xbf7ebe04000000003f7f3db0,0x3f4bbf1c00000000bdb03f7f,0xbf7ebe04000000003f7f3db000000000,0x3f4bbf1c00000000bdb03f7f00000000
.octa 0xbe043f7e00000000bf7fbdb0,0xbf1cbf4b000000003db0bf7f,0xbe043f7e00000000bf7fbdb000000000,0xbf1cbf4b000000003db0bf7f00000000
.octa 0x3f7a3e5a000000003f7c3e2f,0xbf0abf5700000000bf7cbe2f,0x3f7a3e5a000000003f7c3e2f00000000,0xbf0abf5700000000bf7cbe2f00000000
.octa 0xbe5a3f7a000000003f7c3e2f,0x3f57bf0a00000000bf7cbe2f,0xbe5a3f7a000000003f7c3e2f00000000,0x3f57bf0a00000000bf7cbe2f00000000
.octa 0xbf7abe5a000000003f7c3e2f,0x3f0a3f5700000000bf7cbe2f,0xbf7abe5a000000003f7c3e2f00000000,0x3f0a3f5700000000bf7cbe2f00000000
.octa 0x3e5abf7a000000003f7c3e2f,0xbf573f0a00000000bf7cbe2f,0x3e5abf7a000000003f7c3e2f00000000,0xbf573f0a00000000bf7cbe2f00000000
.octa 0x3f753e98000000003f783e82,0x3f63beef000000003e82bf78,0x3f753e98000000003f783e8200000000,0x3f63beef000000003e82bf7800000000
.octa 0x3e98bf7500000000bf78be82,0xbeefbf6300000000be823f78,0x3e98bf7500000000bf78be8200000000,0xbeefbf6300000000be823f7800000000
.octa 0xbf75be98000000003f783e82,0xbf633eef000000003e82bf78,0xbf75be98000000003f783e8200000000,0xbf633eef000000003e82bf7800000000
.octa 0xbe983f7500000000bf78be82,0x3eef3f6300000000be823f78,0xbe983f7500000000bf78be8200000000,0x3eef3f6300000000be823f7800000000
.octa 0xbd493f800000000080003f80,0xbf3e3f2c0000000080003f80,0xbd493f800000000080003f8000000000,0xbf3e3f2c0000000080003f8000000000
.octa 0xbf80bd490000000080003f80,0xbf2cbf3e0000000080003f80,0xbf80bd490000000080003f8000000000,0xbf2cbf3e0000000080003f8000000000
.octa 0x3d49bf800000000080003f80,0x3f3ebf2c0000000080003f80,0x3d49bf800000000080003f8000000000,0x3f3ebf2c0000000080003f8000000000
.octa 0x3f803d490000000080003f80,0x3f2c3f3e0000000080003f80,0x3f803d490000000080003f8000000000,0x3f2c3f3e0000000080003f8000000000
.octa 0xbe163f7d00000000bdc93f7f,0xbf18bf4e00000000bf7fbdc9,0xbe163f7d00000000bdc93f7f00000000,0xbf18bf4e00000000bf7fbdc900000000
.octa 0x3f7d3e16000000003dc9bf7f,0xbf4e3f18000000003f7f3dc9,0x3f7d3e16000000003dc9bf7f00000000,0xbf4e3f18000000003f7f3dc900000000
.octa 0x3e16bf7d00000000bdc93f7f,0x3f183f4e00000000bf7fbdc9,0x3e16bf7d00000000bdc93f7f00000000,0x3f183f4e00000000bf7fbdc900000000
.octa 0xbf7dbe16000000003dc9bf7f,0x3f4ebf18000000003f7f3dc9,0xbf7dbe16000000003dc9bf7f00000000,0x3f4ebf18000000003f7f3dc900000000
.octa 0xbe793f7800000000be483f7b,0x3f5cbf04000000003e48bf7b,0xbe793f7800000000be483f7b00000000,0x3f5cbf04000000003e48bf7b00000000
.octa 0xbf78be7900000000be483f7b,0x3f043f5c000000003e48bf7b,0xbf78be7900000000be483f7b00000000,0x3f043f5c000000003e48bf7b00000000
.octa 0x3e79bf7800000000be483f7b,0xbf5c3f04000000003e48bf7b,0x3e79bf7800000000be483f7b00000000,0xbf5c3f04000000003e48bf7b00000000
.octa 0x3f783e7900000000be483f7b,0xbf04bf5c000000003e48bf7b,0x3f783e7900000000be483f7b00000000,0xbf04bf5c000000003e48bf7b00000000
.octa 0xbeac3f7100000000be953f75,0x3edb3f67000000003f753e95,0xbeac3f7100000000be953f7500000000,0x3edb3f67000000003f753e9500000000
.octa 0x3f713eac000000003e95bf75,0x3f67bedb00000000bf75be95,0x3f713eac000000003e95bf7500000000,0x3f67bedb00000000bf75be9500000000
.octa 0x3eacbf7100000000be953f75,0xbedbbf67000000003f753e95,0x3eacbf7100000000be953f7500000000,0xbedbbf67000000003f753e9500000000
.octa 0xbf71beac000000003e95bf75,0xbf673edb00000000bf75be95,0xbf71beac000000003e95bf7500000000,0xbf673edb00000000bf75be9500000000
.octa 0x3f803d49000000003f800000,0x3f2c3f3e000000003f800000,0x3f803d49000000003f80000000000000,0x3f2c3f3e000000003f80000000000000
.octa 0xbd493f80000000003f800000,0xbf3e3f2c000000003f800000,0xbd493f80000000003f80000000000000,0xbf3e3f2c000000003f80000000000000
.octa 0xbf80bd49000000003f800000,0xbf2cbf3e000000003f800000,0xbf80bd49000000003f80000000000000,0xbf2cbf3e000000003f80000000000000
.octa 0x3d49bf80000000003f800000,0x3f3ebf2c000000003f800000,0x3d49bf80000000003f80000000000000,0x3f3ebf2c000000003f80000000000000
.octa 0x3f7d3e16000000003f7f3dc9,0xbf4e3f1800000000bdc93f7f,0x3f7d3e16000000003f7f3dc900000000,0xbf4e3f1800000000bdc93f7f00000000
.octa 0x3e16bf7d00000000bf7fbdc9,0x3f183f4e000000003dc9bf7f,0x3e16bf7d00000000bf7fbdc900000000,0x3f183f4e000000003dc9bf7f00000000
.octa 0xbf7dbe16000000003f7f3dc9,0x3f4ebf1800000000bdc93f7f,0xbf7dbe16000000003f7f3dc900000000,0x3f4ebf1800000000bdc93f7f00000000
.octa 0xbe163f7d00000000bf7fbdc9,0xbf18bf4e000000003dc9bf7f,0xbe163f7d00000000bf7fbdc900000000,0xbf18bf4e000000003dc9bf7f00000000
.octa 0x3f783e79000000003f7b3e48,0xbf04bf5c00000000bf7bbe48,0x3f783e79000000003f7b3e4800000000,0xbf04bf5c00000000bf7bbe4800000000
.octa 0xbe793f78000000003f7b3e48,0x3f5cbf0400000000bf7bbe48,0xbe793f78000000003f7b3e4800000000,0x3f5cbf0400000000bf7bbe4800000000
.octa 0xbf78be79000000003f7b3e48,0x3f043f5c00000000bf7bbe48,0xbf78be79000000003f7b3e4800000000,0x3f043f5c00000000bf7bbe4800000000
.octa 0x3e79bf78000000003f7b3e48,0xbf5c3f0400000000bf7bbe48,0x3e79bf78000000003f7b3e4800000000,0xbf5c3f0400000000bf7bbe4800000000
.octa 0x3f713eac000000003f753e95,0x3f67bedb000000003e95bf75,0x3f713eac000000003f753e9500000000,0x3f67bedb000000003e95bf7500000000
.octa 0x3eacbf7100000000bf75be95,0xbedbbf6700000000be953f75,0x3eacbf7100000000bf75be9500000000,0xbedbbf6700000000be953f7500000000
.octa 0xbf71beac000000003f753e95,0xbf673edb000000003e95bf75,0xbf71beac000000003f753e9500000000,0xbf673edb000000003e95bf7500000000
.octa 0xbeac3f7100000000bf75be95,0x3edb3f6700000000be953f75,0xbeac3f7100000000bf75be9500000000,0x3edb3f6700000000be953f7500000000
.octa 0xbd623f800000000080003f80,0xbf3f3f2b0000000080003f80,0xbd623f800000000080003f8000000000,0xbf3f3f2b0000000080003f8000000000
.octa 0xbf80bd620000000080003f80,0xbf2bbf3f0000000080003f80,0xbf80bd620000000080003f8000000000,0xbf2bbf3f0000000080003f8000000000
.octa 0x3d62bf800000000080003f80,0x3f3fbf2b0000000080003f80,0x3d62bf800000000080003f8000000000,0x3f3fbf2b0000000080003f8000000000
.octa 0x3f803d620000000080003f80,0x3f2b3f3f0000000080003f80,0x3f803d620000000080003f8000000000,0x3f2b3f3f0000000080003f8000000000
.octa 0xbe293f7c00000000bde23f7e,0xbf15bf5000000000bf7ebde2,0xbe293f7c00000000bde23f7e00000000,0xbf15bf5000000000bf7ebde200000000
.octa 0x3f7c3e29000000003de2bf7e,0xbf503f15000000003f7e3de2,0x3f7c3e29000000003de2bf7e00000000,0xbf503f15000000003f7e3de200000000
.octa 0x3e29bf7c00000000bde23f7e,0x3f153f5000000000bf7ebde2,0x3e29bf7c00000000bde23f7e00000000,0x3f153f5000000000bf7ebde200000000
.octa 0xbf7cbe29000000003de2bf7e,0x3f50bf15000000003f7e3de2,0xbf7cbe29000000003de2bf7e00000000,0x3f50bf15000000003f7e3de200000000
.octa 0xbe8c3f7600000000be603f7a,0x3f60befa000000003e60bf7a,0xbe8c3f7600000000be603f7a00000000,0x3f60befa000000003e60bf7a00000000
.octa 0xbf76be8c00000000be603f7a,0x3efa3f60000000003e60bf7a,0xbf76be8c00000000be603f7a00000000,0x3efa3f60000000003e60bf7a00000000
.octa 0x3e8cbf7600000000be603f7a,0xbf603efa000000003e60bf7a,0x3e8cbf7600000000be603f7a00000000,0xbf603efa000000003e60bf7a00000000
.octa 0x3f763e8c00000000be603f7a,0xbefabf60000000003e60bf7a,0x3f763e8c00000000be603f7a00000000,0xbefabf60000000003e60bf7a00000000
.octa 0xbec13f6d00000000bea73f72,0x3ec73f6c000000003f723ea7,0xbec13f6d00000000bea73f7200000000,0x3ec73f6c000000003f723ea700000000
.octa 0x3f6d3ec1000000003ea7bf72,0x3f6cbec700000000bf72bea7,0x3f6d3ec1000000003ea7bf7200000000,0x3f6cbec700000000bf72bea700000000
.octa 0x3ec1bf6d00000000bea73f72,0xbec7bf6c000000003f723ea7,0x3ec1bf6d00000000bea73f7200000000,0xbec7bf6c000000003f723ea700000000
.octa 0xbf6dbec1000000003ea7bf72,0xbf6c3ec700000000bf72bea7,0xbf6dbec1000000003ea7bf7200000000,0xbf6c3ec700000000bf72bea700000000
.octa 0x3f803d62000000003f800000,0x3f2b3f3f000000003f800000,0x3f803d62000000003f80000000000000,0x3f2b3f3f000000003f80000000000000
.octa 0xbd623f80000000003f800000,0xbf3f3f2b000000003f800000,0xbd623f80000000003f80000000000000,0xbf3f3f2b000000003f80000000000000
.octa 0xbf80bd62000000003f800000,0xbf2bbf3f000000003f800000,0xbf80bd62000000003f80000000000000,0xbf2bbf3f000000003f80000000000000
.octa 0x3d62bf80000000003f800000,0x3f3fbf2b000000003f800000,0x3d62bf80000000003f80000000000000,0x3f3fbf2b000000003f80000000000000
.octa 0x3f7c3e29000000003f7e3de2,0xbf503f1500000000bde23f7e,0x3f7c3e29000000003f7e3de200000000,0xbf503f1500000000bde23f7e00000000
.octa 0x3e29bf7c00000000bf7ebde2,0x3f153f50000000003de2bf7e,0x3e29bf7c00000000bf7ebde200000000,0x3f153f50000000003de2bf7e00000000
.octa 0xbf7cbe29000000003f7e3de2,0x3f50bf1500000000bde23f7e,0xbf7cbe29000000003f7e3de200000000,0x3f50bf1500000000bde23f7e00000000
.octa 0xbe293f7c00000000bf7ebde2,0xbf15bf50000000003de2bf7e,0xbe293f7c00000000bf7ebde200000000,0xbf15bf50000000003de2bf7e00000000
.octa 0x3f763e8c000000003f7a3e60,0xbefabf6000000000bf7abe60,0x3f763e8c000000003f7a3e6000000000,0xbefabf6000000000bf7abe6000000000
.octa 0xbe8c3f76000000003f7a3e60,0x3f60befa00000000bf7abe60,0xbe8c3f76000000003f7a3e6000000000,0x3f60befa00000000bf7abe6000000000
.octa 0xbf76be8c000000003f7a3e60,0x3efa3f6000000000bf7abe60,0xbf76be8c000000003f7a3e6000000000,0x3efa3f6000000000bf7abe6000000000
.octa 0x3e8cbf76000000003f7a3e60,0xbf603efa00000000bf7abe60,0x3e8cbf76000000003f7a3e6000000000,0xbf603efa00000000bf7abe6000000000
.octa 0x3f6d3ec1000000003f723ea7,0x3f6cbec7000000003ea7bf72,0x3f6d3ec1000000003f723ea700000000,0x3f6cbec7000000003ea7bf7200000000
.octa 0x3ec1bf6d00000000bf72bea7,0xbec7bf6c00000000bea73f72,0x3ec1bf6d00000000bf72bea700000000,0xbec7bf6c00000000bea73f7200000000
.octa 0xbf6dbec1000000003f723ea7,0xbf6c3ec7000000003ea7bf72,0xbf6dbec1000000003f723ea700000000,0xbf6c3ec7000000003ea7bf7200000000
.octa 0xbec13f6d00000000bf72bea7,0x3ec73f6c00000000bea73f72,0xbec13f6d00000000bf72bea700000000,0x3ec73f6c00000000bea73f7200000000
.octa 0xbd7b3f800000000080003f80,0xbf403f2a0000000080003f80,0xbd7b3f800000000080003f8000000000,0xbf403f2a0000000080003f8000000000
.octa 0xbf80bd7b0000000080003f80,0xbf2abf400000000080003f80,0xbf80bd7b0000000080003f8000000000,0xbf2abf400000000080003f8000000000
.octa 0x3d7bbf800000000080003f80,0x3f40bf2a0000000080003f80,0x3d7bbf800000000080003f8000000000,0x3f40bf2a0000000080003f8000000000
.octa 0x3f803d7b0000000080003f80,0x3f2a3f400000000080003f80,0x3f803d7b0000000080003f8000000000,0x3f2a3f400000000080003f8000000000
.octa 0xbe3b3f7c00000000bdfb3f7e,0xbf11bf5300000000bf7ebdfb,0xbe3b3f7c00000000bdfb3f7e00000000,0xbf11bf5300000000bf7ebdfb00000000
.octa 0x3f7c3e3b000000003dfbbf7e,0xbf533f11000000003f7e3dfb,0x3f7c3e3b000000003dfbbf7e00000000,0xbf533f11000000003f7e3dfb00000000
.octa 0x3e3bbf7c00000000bdfb3f7e,0x3f113f5300000000bf7ebdfb,0x3e3bbf7c00000000bdfb3f7e00000000,0x3f113f5300000000bf7ebdfb00000000
.octa 0xbf7cbe3b000000003dfbbf7e,0x3f53bf11000000003f7e3dfb,0xbf7cbe3b000000003dfbbf7e00000000,0x3f53bf11000000003f7e3dfb00000000
.octa 0xbe9b3f7400000000be793f78,0x3f63beec000000003e79bf78,0xbe9b3f7400000000be793f7800000000,0x3f63beec000000003e79bf7800000000
.octa 0xbf74be9b00000000be793f78,0x3eec3f63000000003e79bf78,0xbf74be9b00000000be793f7800000000,0x3eec3f63000000003e79bf7800000000
.octa 0x3e9bbf7400000000be793f78,0xbf633eec000000003e79bf78,0x3e9bbf7400000000be793f7800000000,0xbf633eec000000003e79bf7800000000
.octa 0x3f743e9b00000000be793f78,0xbeecbf63000000003e79bf78,0x3f743e9b00000000be793f7800000000,0xbeecbf63000000003e79bf7800000000
.octa 0xbed53f6900000000beb83f6f,0x3eb23f70000000003f6f3eb8,0xbed53f6900000000beb83f6f00000000,0x3eb23f70000000003f6f3eb800000000
.octa 0x3f693ed5000000003eb8bf6f,0x3f70beb200000000bf6fbeb8,0x3f693ed5000000003eb8bf6f00000000,0x3f70beb200000000bf6fbeb800000000
.octa 0x3ed5bf6900000000beb83f6f,0xbeb2bf70000000003f6f3eb8,0x3ed5bf6900000000beb83f6f00000000,0xbeb2bf70000000003f6f3eb800000000
.octa 0xbf69bed5000000003eb8bf6f,0xbf703eb200000000bf6fbeb8,0xbf69bed5000000003eb8bf6f00000000,0xbf703eb200000000bf6fbeb800000000
.octa 0x3f803d7b000000003f800000,0x3f2a3f40000000003f800000,0x3f803d7b000000003f80000000000000,0x3f2a3f40000000003f80000000000000
.octa 0xbd7b3f80000000003f800000,0xbf403f2a000000003f800000,0xbd7b3f80000000003f80000000000000,0xbf403f2a000000003f80000000000000
.octa 0xbf80bd7b000000003f800000,0xbf2abf40000000003f800000,0xbf80bd7b000000003f80000000000000,0xbf2abf40000000003f80000000000000
.octa 0x3d7bbf80000000003f800000,0x3f40bf2a000000003f800000,0x3d7bbf80000000003f80000000000000,0x3f40bf2a000000003f80000000000000
.octa 0x3f7c3e3b000000003f7e3dfb,0xbf533f1100000000bdfb3f7e,0x3f7c3e3b000000003f7e3dfb00000000,0xbf533f1100000000bdfb3f7e00000000
.octa 0x3e3bbf7c00000000bf7ebdfb,0x3f113f53000000003dfbbf7e,0x3e3bbf7c00000000bf7ebdfb00000000,0x3f113f53000000003dfbbf7e00000000
.octa 0xbf7cbe3b000000003f7e3dfb,0x3f53bf1100000000bdfb3f7e,0xbf7cbe3b000000003f7e3dfb00000000,0x3f53bf1100000000bdfb3f7e00000000
.octa 0xbe3b3f7c00000000bf7ebdfb,0xbf11bf53000000003dfbbf7e,0xbe3b3f7c00000000bf7ebdfb00000000,0xbf11bf53000000003dfbbf7e00000000
.octa 0x3f743e9b000000003f783e79,0xbeecbf6300000000bf78be79,0x3f743e9b000000003f783e7900000000,0xbeecbf6300000000bf78be7900000000
.octa 0xbe9b3f74000000003f783e79,0x3f63beec00000000bf78be79,0xbe9b3f74000000003f783e7900000000,0x3f63beec00000000bf78be7900000000
.octa 0xbf74be9b000000003f783e79,0x3eec3f6300000000bf78be79,0xbf74be9b000000003f783e7900000000,0x3eec3f6300000000bf78be7900000000
.octa 0x3e9bbf74000000003f783e79,0xbf633eec00000000bf78be79,0x3e9bbf74000000003f783e7900000000,0xbf633eec00000000bf78be7900000000
.octa 0x3f693ed5000000003f6f3eb8,0x3f70beb2000000003eb8bf6f,0x3f693ed5000000003f6f3eb800000000,0x3f70beb2000000003eb8bf6f00000000
.octa 0x3ed5bf6900000000bf6fbeb8,0xbeb2bf7000000000beb83f6f,0x3ed5bf6900000000bf6fbeb800000000,0xbeb2bf7000000000beb83f6f00000000
.octa 0xbf69bed5000000003f6f3eb8,0xbf703eb2000000003eb8bf6f,0xbf69bed5000000003f6f3eb800000000,0xbf703eb2000000003eb8bf6f00000000
.octa 0xbed53f6900000000bf6fbeb8,0x3eb23f7000000000beb83f6f,0xbed53f6900000000bf6fbeb800000000,0x3eb23f7000000000beb83f6f00000000
.octa 0xbd8a3f7f0000000080003f80,0xbf413f280000000080003f80,0xbd8a3f7f0000000080003f8000000000,0xbf413f280000000080003f8000000000
.octa 0xbf7fbd8a0000000080003f80,0xbf28bf410000000080003f80,0xbf7fbd8a0000000080003f8000000000,0xbf28bf410000000080003f8000000000
.octa 0x3d8abf7f0000000080003f80,0x3f41bf280000000080003f80,0x3d8abf7f0000000080003f8000000000,0x3f41bf280000000080003f8000000000
.octa 0x3f7f3d8a0000000080003f80,0x3f283f410000000080003f80,0x3f7f3d8a0000000080003f8000000000,0x3f283f410000000080003f8000000000
.octa 0xbe4e3f7b00000000be0a3f7e,0xbf0dbf5600000000bf7ebe0a,0xbe4e3f7b00000000be0a3f7e00000000,0xbf0dbf5600000000bf7ebe0a00000000
.octa 0x3f7b3e4e000000003e0abf7e,0xbf563f0d000000003f7e3e0a,0x3f7b3e4e000000003e0abf7e00000000,0xbf563f0d000000003f7e3e0a00000000
.octa 0x3e4ebf7b00000000be0a3f7e,0x3f0d3f5600000000bf7ebe0a,0x3e4ebf7b00000000be0a3f7e00000000,0x3f0d3f5600000000bf7ebe0a00000000
.octa 0xbf7bbe4e000000003e0abf7e,0x3f56bf0d000000003f7e3e0a,0xbf7bbe4e000000003e0abf7e00000000,0x3f56bf0d000000003f7e3e0a00000000
.octa 0xbeaa3f7200000000be893f77,0x3f67bede000000003e89bf77,0xbeaa3f7200000000be893f7700000000,0x3f67bede000000003e89bf7700000000
.octa 0xbf72beaa00000000be893f77,0x3ede3f67000000003e89bf77,0xbf72beaa00000000be893f7700000000,0x3ede3f67000000003e89bf7700000000
.octa 0x3eaabf7200000000be893f77,0xbf673ede000000003e89bf77,0x3eaabf7200000000be893f7700000000,0xbf673ede000000003e89bf7700000000
.octa 0x3f723eaa00000000be893f77,0xbedebf67000000003e89bf77,0x3f723eaa00000000be893f7700000000,0xbedebf67000000003e89bf7700000000
.octa 0xbee93f6400000000beca3f6b,0x3e9e3f74000000003f6b3eca,0xbee93f6400000000beca3f6b00000000,0x3e9e3f74000000003f6b3eca00000000
.octa 0x3f643ee9000000003ecabf6b,0x3f74be9e00000000bf6bbeca,0x3f643ee9000000003ecabf6b00000000,0x3f74be9e00000000bf6bbeca00000000
.octa 0x3ee9bf6400000000beca3f6b,0xbe9ebf74000000003f6b3eca,0x3ee9bf6400000000beca3f6b00000000,0xbe9ebf74000000003f6b3eca00000000
.octa 0xbf64bee9000000003ecabf6b,0xbf743e9e00000000bf6bbeca,0xbf64bee9000000003ecabf6b00000000,0xbf743e9e00000000bf6bbeca00000000
.octa 0x3f7f3d8a000000003f800000,0x3f283f41000000003f800000,0x3f7f3d8a000000003f80000000000000,0x3f283f41000000003f80000000000000
.octa 0xbd8a3f7f000000003f800000,0xbf413f28000000003f800000,0xbd8a3f7f000000003f80000000000000,0xbf413f28000000003f80000000000000
.octa 0xbf7fbd8a000000003f800000,0xbf28bf41000000003f800000,0xbf7fbd8a000000003f80000000000000,0xbf28bf41000000003f80000000000000
.octa 0x3d8abf7f000000003f800000,0x3f41bf28000000003f800000,0x3d8abf7f000000003f80000000000000,0x3f41bf28000000003f80000000000000
.octa 0x3f7b3e4e000000003f7e3e0a,0xbf563f0d00000000be0a3f7e,0x3f7b3e4e000000003f7e3e0a00000000,0xbf563f0d00000000be0a3f7e00000000
.octa 0x3e4ebf7b00000000bf7ebe0a,0x3f0d3f56000000003e0abf7e,0x3e4ebf7b00000000bf7ebe0a00000000,0x3f0d3f56000000003e0abf7e00000000
.octa 0xbf7bbe4e000000003f7e3e0a,0x3f56bf0d00000000be0a3f7e,0xbf7bbe4e000000003f7e3e0a00000000,0x3f56bf0d00000000be0a3f7e00000000
.octa 0xbe4e3f7b00000000bf7ebe0a,0xbf0dbf56000000003e0abf7e,0xbe4e3f7b00000000bf7ebe0a00000000,0xbf0dbf56000000003e0abf7e00000000
.octa 0x3f723eaa000000003f773e89,0xbedebf6700000000bf77be89,0x3f723eaa000000003f773e8900000000,0xbedebf6700000000bf77be8900000000
.octa 0xbeaa3f72000000003f773e89,0x3f67bede00000000bf77be89,0xbeaa3f72000000003f773e8900000000,0x3f67bede00000000bf77be8900000000
.octa 0xbf72beaa000000003f773e89,0x3ede3f6700000000bf77be89,0xbf72beaa000000003f773e8900000000,0x3ede3f6700000000bf77be8900000000
.octa 0x3eaabf72000000003f773e89,0xbf673ede00000000bf77be89,0x3eaabf72000000003f773e8900000000,0xbf673ede00000000bf77be8900000000
.octa 0x3f643ee9000000003f6b3eca,0x3f74be9e000000003ecabf6b,0x3f643ee9000000003f6b3eca00000000,0x3f74be9e000000003ecabf6b00000000
.octa 0x3ee9bf6400000000bf6bbeca,0xbe9ebf7400000000beca3f6b,0x3ee9bf6400000000bf6bbeca00000000,0xbe9ebf7400000000beca3f6b00000000
.octa 0xbf64bee9000000003f6b3eca,0xbf743e9e000000003ecabf6b,0xbf64bee9000000003f6b3eca00000000,0xbf743e9e000000003ecabf6b00000000
.octa 0xbee93f6400000000bf6bbeca,0x3e9e3f7400000000beca3f6b,0xbee93f6400000000bf6bbeca00000000,0x3e9e3f7400000000beca3f6b00000000
.octa 0xbd973f7f0000000080003f80,0xbf423f270000000080003f80,0xbd973f7f0000000080003f8000000000,0xbf423f270000000080003f8000000000
.octa 0xbf7fbd970000000080003f80,0xbf27bf420000000080003f80,0xbf7fbd970000000080003f8000000000,0xbf27bf420000000080003f8000000000
.octa 0x3d97bf7f0000000080003f80,0x3f42bf270000000080003f80,0x3d97bf7f0000000080003f8000000000,0x3f42bf270000000080003f8000000000
.octa 0x3f7f3d970000000080003f80,0x3f273f420000000080003f80,0x3f7f3d970000000080003f8000000000,0x3f273f420000000080003f8000000000
.octa 0xbe603f7a00000000be163f7d,0xbf09bf5800000000bf7dbe16,0xbe603f7a00000000be163f7d00000000,0xbf09bf5800000000bf7dbe1600000000
.octa 0x3f7a3e60000000003e16bf7d,0xbf583f09000000003f7d3e16,0x3f7a3e60000000003e16bf7d00000000,0xbf583f09000000003f7d3e1600000000
.octa 0x3e60bf7a00000000be163f7d,0x3f093f5800000000bf7dbe16,0x3e60bf7a00000000be163f7d00000000,0x3f093f5800000000bf7dbe1600000000
.octa 0xbf7abe60000000003e16bf7d,0x3f58bf09000000003f7d3e16,0xbf7abe60000000003e16bf7d00000000,0x3f58bf09000000003f7d3e1600000000
.octa 0xbeb83f6f00000000be953f75,0x3f6abecf000000003e95bf75,0xbeb83f6f00000000be953f7500000000,0x3f6abecf000000003e95bf7500000000
.octa 0xbf6fbeb800000000be953f75,0x3ecf3f6a000000003e95bf75,0xbf6fbeb800000000be953f7500000000,0x3ecf3f6a000000003e95bf7500000000
.octa 0x3eb8bf6f00000000be953f75,0xbf6a3ecf000000003e95bf75,0x3eb8bf6f00000000be953f7500000000,0xbf6a3ecf000000003e95bf7500000000
.octa 0x3f6f3eb800000000be953f75,0xbecfbf6a000000003e95bf75,0x3f6f3eb800000000be953f7500000000,0xbecfbf6a000000003e95bf7500000000
.octa 0xbefc3f5f00000000bedb3f67,0x3e893f77000000003f673edb,0xbefc3f5f00000000bedb3f6700000000,0x3e893f77000000003f673edb00000000
.octa 0x3f5f3efc000000003edbbf67,0x3f77be8900000000bf67bedb,0x3f5f3efc000000003edbbf6700000000,0x3f77be8900000000bf67bedb00000000
.octa 0x3efcbf5f00000000bedb3f67,0xbe89bf77000000003f673edb,0x3efcbf5f00000000bedb3f6700000000,0xbe89bf77000000003f673edb00000000
.octa 0xbf5fbefc000000003edbbf67,0xbf773e8900000000bf67bedb,0xbf5fbefc000000003edbbf6700000000,0xbf773e8900000000bf67bedb00000000
.octa 0x3f7f3d97000000003f800000,0x3f273f42000000003f800000,0x3f7f3d97000000003f80000000000000,0x3f273f42000000003f80000000000000
.octa 0xbd973f7f000000003f800000,0xbf423f27000000003f800000,0xbd973f7f000000003f80000000000000,0xbf423f27000000003f80000000000000
.octa 0xbf7fbd97000000003f800000,0xbf27bf42000000003f800000,0xbf7fbd97000000003f80000000000000,0xbf27bf42000000003f80000000000000
.octa 0x3d97bf7f000000003f800000,0x3f42bf27000000003f800000,0x3d97bf7f000000003f80000000000000,0x3f42bf27000000003f80000000000000
.octa 0x3f7a3e60000000003f7d3e16,0xbf583f0900000000be163f7d,0x3f7a3e60000000003f7d3e1600000000,0xbf583f0900000000be163f7d00000000
.octa 0x3e60bf7a00000000bf7dbe16,0x3f093f58000000003e16bf7d,0x3e60bf7a00000000bf7dbe1600000000,0x3f093f58000000003e16bf7d00000000
.octa 0xbf7abe60000000003f7d3e16,0x3f58bf0900000000be163f7d,0xbf7abe60000000003f7d3e1600000000,0x3f58bf0900000000be163f7d00000000
.octa 0xbe603f7a00000000bf7dbe16,0xbf09bf58000000003e16bf7d,0xbe603f7a00000000bf7dbe1600000000,0xbf09bf58000000003e16bf7d00000000
.octa 0x3f6f3eb8000000003f753e95,0xbecfbf6a00000000bf75be95,0x3f6f3eb8000000003f753e9500000000,0xbecfbf6a00000000bf75be9500000000
.octa 0xbeb83f6f000000003f753e95,0x3f6abecf00000000bf75be95,0xbeb83f6f000000003f753e9500000000,0x3f6abecf00000000bf75be9500000000
.octa 0xbf6fbeb8000000003f753e95,0x3ecf3f6a00000000bf75be95,0xbf6fbeb8000000003f753e9500000000,0x3ecf3f6a00000000bf75be9500000000
.octa 0x3eb8bf6f000000003f753e95,0xbf6a3ecf00000000bf75be95,0x3eb8bf6f000000003f753e9500000000,0xbf6a3ecf00000000bf75be9500000000
.octa 0x3f5f3efc000000003f673edb,0x3f77be89000000003edbbf67,0x3f5f3efc000000003f673edb00000000,0x3f77be89000000003edbbf6700000000
.octa 0x3efcbf5f00000000bf67bedb,0xbe89bf7700000000bedb3f67,0x3efcbf5f00000000bf67bedb00000000,0xbe89bf7700000000bedb3f6700000000
.octa 0xbf5fbefc000000003f673edb,0xbf773e89000000003edbbf67,0xbf5fbefc000000003f673edb00000000,0xbf773e89000000003edbbf6700000000
.octa 0xbefc3f5f00000000bf67bedb,0x3e893f7700000000bedb3f67,0xbefc3f5f00000000bf67bedb00000000,0x3e893f7700000000bedb3f6700000000
.octa 0xbda33f7f0000000080003f80,0xbf433f260000000080003f80,0xbda33f7f0000000080003f8000000000,0xbf433f260000000080003f8000000000
.octa 0xbf7fbda30000000080003f80,0xbf26bf430000000080003f80,0xbf7fbda30000000080003f8000000000,0xbf26bf430000000080003f8000000000
.octa 0x3da3bf7f0000000080003f80,0x3f43bf260000000080003f80,0x3da3bf7f0000000080003f8000000000,0x3f43bf260000000080003f8000000000
.octa 0x3f7f3da30000000080003f80,0x3f263f430000000080003f80,0x3f7f3da30000000080003f8000000000,0x3f263f430000000080003f8000000000
.octa 0xbe733f7900000000be233f7d,0xbf05bf5b00000000bf7dbe23,0xbe733f7900000000be233f7d00000000,0xbf05bf5b00000000bf7dbe2300000000
.octa 0x3f793e73000000003e23bf7d,0xbf5b3f05000000003f7d3e23,0x3f793e73000000003e23bf7d00000000,0xbf5b3f05000000003f7d3e2300000000
.octa 0x3e73bf7900000000be233f7d,0x3f053f5b00000000bf7dbe23,0x3e73bf7900000000be233f7d00000000,0x3f053f5b00000000bf7dbe2300000000
.octa 0xbf79be73000000003e23bf7d,0x3f5bbf05000000003f7d3e23,0xbf79be73000000003e23bf7d00000000,0x3f5bbf05000000003f7d3e2300000000
.octa 0xbec73f6c00000000bea13f73,0x3f6dbec1000000003ea1bf73,0xbec73f6c00000000bea13f7300000000,0x3f6dbec1000000003ea1bf7300000000
.octa 0xbf6cbec700000000bea13f73,0x3ec13f6d000000003ea1bf73,0xbf6cbec700000000bea13f7300000000,0x3ec13f6d000000003ea1bf7300000000
.octa 0x3ec7bf6c00000000bea13f73,0xbf6d3ec1000000003ea1bf73,0x3ec7bf6c00000000bea13f7300000000,0xbf6d3ec1000000003ea1bf7300000000
.octa 0x3f6c3ec700000000bea13f73,0xbec1bf6d000000003ea1bf73,0x3f6c3ec700000000bea13f7300000000,0xbec1bf6d000000003ea1bf7300000000
.octa 0xbf083f5900000000beec3f63,0x3e663f79000000003f633eec,0xbf083f5900000000beec3f6300000000,0x3e663f79000000003f633eec00000000
.octa 0x3f593f08000000003eecbf63,0x3f79be6600000000bf63beec,0x3f593f08000000003eecbf6300000000,0x3f79be6600000000bf63beec00000000
.octa 0x3f08bf5900000000beec3f63,0xbe66bf79000000003f633eec,0x3f08bf5900000000beec3f6300000000,0xbe66bf79000000003f633eec00000000
.octa 0xbf59bf08000000003eecbf63,0xbf793e6600000000bf63beec,0xbf59bf08000000003eecbf6300000000,0xbf793e6600000000bf63beec00000000
.octa 0x3f7f3da3000000003f800000,0x3f263f43000000003f800000,0x3f7f3da3000000003f80000000000000,0x3f263f43000000003f80000000000000
.octa 0xbda33f7f000000003f800000,0xbf433f26000000003f800000,0xbda33f7f000000003f80000000000000,0xbf433f26000000003f80000000000000
.octa 0xbf7fbda3000000003f800000,0xbf26bf43000000003f800000,0xbf7fbda3000000003f80000000000000,0xbf26bf43000000003f80000000000000
.octa 0x3da3bf7f000000003f800000,0x3f43bf26000000003f800000,0x3da3bf7f000000003f80000000000000,0x3f43bf26000000003f80000000000000
.octa 0x3f793e73000000003f7d3e23,0xbf5b3f0500000000be233f7d,0x3f793e73000000003f7d3e2300000000,0xbf5b3f0500000000be233f7d00000000
.octa 0x3e73bf7900000000bf7dbe23,0x3f053f5b000000003e23bf7d,0x3e73bf7900000000bf7dbe2300000000,0x3f053f5b000000003e23bf7d00000000
.octa 0xbf79be73000000003f7d3e23,0x3f5bbf0500000000be233f7d,0xbf79be73000000003f7d3e2300000000,0x3f5bbf0500000000be233f7d00000000
.octa 0xbe733f7900000000bf7dbe23,0xbf05bf5b000000003e23bf7d,0xbe733f7900000000bf7dbe2300000000,0xbf05bf5b000000003e23bf7d00000000
.octa 0x3f6c3ec7000000003f733ea1,0xbec1bf6d00000000bf73bea1,0x3f6c3ec7000000003f733ea100000000,0xbec1bf6d00000000bf73bea100000000
.octa 0xbec73f6c000000003f733ea1,0x3f6dbec100000000bf73bea1,0xbec73f6c000000003f733ea100000000,0x3f6dbec100000000bf73bea100000000
.octa 0xbf6cbec7000000003f733ea1,0x3ec13f6d00000000bf73bea1,0xbf6cbec7000000003f733ea100000000,0x3ec13f6d00000000bf73bea100000000
.octa 0x3ec7bf6c000000003f733ea1,0xbf6d3ec100000000bf73bea1,0x3ec7bf6c000000003f733ea100000000,0xbf6d3ec100000000bf73bea100000000
.octa 0x3f593f08000000003f633eec,0x3f79be66000000003eecbf63,0x3f593f08000000003f633eec00000000,0x3f79be66000000003eecbf6300000000
.octa 0x3f08bf5900000000bf63beec,0xbe66bf7900000000beec3f63,0x3f08bf5900000000bf63beec00000000,0xbe66bf7900000000beec3f6300000000
.octa 0xbf59bf08000000003f633eec,0xbf793e66000000003eecbf63,0xbf59bf08000000003f633eec00000000,0xbf793e66000000003eecbf6300000000
.octa 0xbf083f5900000000bf63beec,0x3e663f7900000000beec3f63,0xbf083f5900000000bf63beec00000000,0x3e663f7900000000beec3f6300000000
.octa 0xbdb03f7f0000000080003f80,0xbf443f250000000080003f80,0xbdb03f7f0000000080003f8000000000,0xbf443f250000000080003f8000000000
.octa 0xbf7fbdb00000000080003f80,0xbf25bf440000000080003f80,0xbf7fbdb00000000080003f8000000000,0xbf25bf440000000080003f8000000000
.octa 0x3db0bf7f0000000080003f80,0x3f44bf250000000080003f80,0x3db0bf7f0000000080003f8000000000,0x3f44bf250000000080003f8000000000
.octa 0x3f7f3db00000000080003f80,0x3f253f440000000080003f80,0x3f7f3db00000000080003f8000000000,0x3f253f440000000080003f8000000000
.octa 0xbe823f7800000000be2f3f7c,0xbf01bf5d00000000bf7cbe2f,0xbe823f7800000000be2f3f7c00000000,0xbf01bf5d00000000bf7cbe2f00000000
.octa 0x3f783e82000000003e2fbf7c,0xbf5d3f01000000003f7c3e2f,0x3f783e82000000003e2fbf7c00000000,0xbf5d3f01000000003f7c3e2f00000000
.octa 0x3e82bf7800000000be2f3f7c,0x3f013f5d00000000bf7cbe2f,0x3e82bf7800000000be2f3f7c00000000,0x3f013f5d00000000bf7cbe2f00000000
.octa 0xbf78be82000000003e2fbf7c,0x3f5dbf01000000003f7c3e2f,0xbf78be82000000003e2fbf7c00000000,0x3f5dbf01000000003f7c3e2f00000000
.octa 0xbed53f6900000000beac3f71,0x3f70beb2000000003eacbf71,0xbed53f6900000000beac3f7100000000,0x3f70beb2000000003eacbf7100000000
.octa 0xbf69bed500000000beac3f71,0x3eb23f70000000003eacbf71,0xbf69bed500000000beac3f7100000000,0x3eb23f70000000003eacbf7100000000
.octa 0x3ed5bf6900000000beac3f71,0xbf703eb2000000003eacbf71,0x3ed5bf6900000000beac3f7100000000,0xbf703eb2000000003eacbf7100000000
.octa 0x3f693ed500000000beac3f71,0xbeb2bf70000000003eacbf71,0x3f693ed500000000beac3f7100000000,0xbeb2bf70000000003eacbf7100000000
.octa 0xbf113f5300000000befc3f5f,0x3e3b3f7c000000003f5f3efc,0xbf113f5300000000befc3f5f00000000,0x3e3b3f7c000000003f5f3efc00000000
.octa 0x3f533f11000000003efcbf5f,0x3f7cbe3b00000000bf5fbefc,0x3f533f11000000003efcbf5f00000000,0x3f7cbe3b00000000bf5fbefc00000000
.octa 0x3f11bf5300000000befc3f5f,0xbe3bbf7c000000003f5f3efc,0x3f11bf5300000000befc3f5f00000000,0xbe3bbf7c000000003f5f3efc00000000
.octa 0xbf53bf11000000003efcbf5f,0xbf7c3e3b00000000bf5fbefc,0xbf53bf11000000003efcbf5f00000000,0xbf7c3e3b00000000bf5fbefc00000000
.octa 0x3f7f3db0000000003f800000,0x3f253f44000000003f800000,0x3f7f3db0000000003f80000000000000,0x3f253f44000000003f80000000000000
.octa 0xbdb03f7f000000003f800000,0xbf443f25000000003f800000,0xbdb03f7f000000003f80000000000000,0xbf443f25000000003f80000000000000
.octa 0xbf7fbdb0000000003f800000,0xbf25bf44000000003f800000,0xbf7fbdb0000000003f80000000000000,0xbf25bf44000000003f80000000000000
.octa 0x3db0bf7f000000003f800000,0x3f44bf25000000003f800000,0x3db0bf7f000000003f80000000000000,0x3f44bf25000000003f80000000000000
.octa 0x3f783e82000000003f7c3e2f,0xbf5d3f0100000000be2f3f7c,0x3f783e82000000003f7c3e2f00000000,0xbf5d3f0100000000be2f3f7c00000000
.octa 0x3e82bf7800000000bf7cbe2f,0x3f013f5d000000003e2fbf7c,0x3e82bf7800000000bf7cbe2f00000000,0x3f013f5d000000003e2fbf7c00000000
.octa 0xbf78be82000000003f7c3e2f,0x3f5dbf0100000000be2f3f7c,0xbf78be82000000003f7c3e2f00000000,0x3f5dbf0100000000be2f3f7c00000000
.octa 0xbe823f7800000000bf7cbe2f,0xbf01bf5d000000003e2fbf7c,0xbe823f7800000000bf7cbe2f00000000,0xbf01bf5d000000003e2fbf7c00000000
.octa 0x3f693ed5000000003f713eac,0xbeb2bf7000000000bf71beac,0x3f693ed5000000003f713eac00000000,0xbeb2bf7000000000bf71beac00000000
.octa 0xbed53f69000000003f713eac,0x3f70beb200000000bf71beac,0xbed53f69000000003f713eac00000000,0x3f70beb200000000bf71beac00000000
.octa 0xbf69bed5000000003f713eac,0x3eb23f7000000000bf71beac,0xbf69bed5000000003f713eac00000000,0x3eb23f7000000000bf71beac00000000
.octa 0x3ed5bf69000000003f713eac,0xbf703eb200000000bf71beac,0x3ed5bf69000000003f713eac00000000,0xbf703eb200000000bf71beac00000000
.octa 0x3f533f11000000003f5f3efc,0x3f7cbe3b000000003efcbf5f,0x3f533f11000000003f5f3efc00000000,0x3f7cbe3b000000003efcbf5f00000000
.octa 0x3f11bf5300000000bf5fbefc,0xbe3bbf7c00000000befc3f5f,0x3f11bf5300000000bf5fbefc00000000,0xbe3bbf7c00000000befc3f5f00000000
.octa 0xbf53bf11000000003f5f3efc,0xbf7c3e3b000000003efcbf5f,0xbf53bf11000000003f5f3efc00000000,0xbf7c3e3b000000003efcbf5f00000000
.octa 0xbf113f5300000000bf5fbefc,0x3e3b3f7c00000000befc3f5f,0xbf113f5300000000bf5fbefc00000000,0x3e3b3f7c00000000befc3f5f00000000
.octa 0xbdbc3f7f0000000080003f80,0xbf453f240000000080003f80,0xbdbc3f7f0000000080003f8000000000,0xbf453f240000000080003f8000000000
.octa 0xbf7fbdbc0000000080003f80,0xbf24bf450000000080003f80,0xbf7fbdbc0000000080003f8000000000,0xbf24bf450000000080003f8000000000
.octa 0x3dbcbf7f0000000080003f80,0x3f45bf240000000080003f80,0x3dbcbf7f0000000080003f8000000000,0x3f45bf240000000080003f8000000000
.octa 0x3f7f3dbc0000000080003f80,0x3f243f450000000080003f80,0x3f7f3dbc0000000080003f8000000000,0x3f243f450000000080003f8000000000
.octa 0xbe8c3f7600000000be3b3f7c,0xbefabf6000000000bf7cbe3b,0xbe8c3f7600000000be3b3f7c00000000,0xbefabf6000000000bf7cbe3b00000000
.octa 0x3f763e8c000000003e3bbf7c,0xbf603efa000000003f7c3e3b,0x3f763e8c000000003e3bbf7c00000000,0xbf603efa000000003f7c3e3b00000000
.octa 0x3e8cbf7600000000be3b3f7c,0x3efa3f6000000000bf7cbe3b,0x3e8cbf7600000000be3b3f7c00000000,0x3efa3f6000000000bf7cbe3b00000000
.octa 0xbf76be8c000000003e3bbf7c,0x3f60befa000000003f7c3e3b,0xbf76be8c000000003e3bbf7c00000000,0x3f60befa000000003f7c3e3b00000000
.octa 0xbee33f6500000000beb83f6f,0x3f73bea4000000003eb8bf6f,0xbee33f6500000000beb83f6f00000000,0x3f73bea4000000003eb8bf6f00000000
.octa 0xbf65bee300000000beb83f6f,0x3ea43f73000000003eb8bf6f,0xbf65bee300000000beb83f6f00000000,0x3ea43f73000000003eb8bf6f00000000
.octa 0x3ee3bf6500000000beb83f6f,0xbf733ea4000000003eb8bf6f,0x3ee3bf6500000000beb83f6f00000000,0xbf733ea4000000003eb8bf6f00000000
.octa 0x3f653ee300000000beb83f6f,0xbea4bf73000000003eb8bf6f,0x3f653ee300000000beb83f6f00000000,0xbea4bf73000000003eb8bf6f00000000
.octa 0xbf1a3f4d00000000bf063f5a,0x3e103f7d000000003f5a3f06,0xbf1a3f4d00000000bf063f5a00000000,0x3e103f7d000000003f5a3f0600000000
.octa 0x3f4d3f1a000000003f06bf5a,0x3f7dbe1000000000bf5abf06,0x3f4d3f1a000000003f06bf5a00000000,0x3f7dbe1000000000bf5abf0600000000
.octa 0x3f1abf4d00000000bf063f5a,0xbe10bf7d000000003f5a3f06,0x3f1abf4d00000000bf063f5a00000000,0xbe10bf7d000000003f5a3f0600000000
.octa 0xbf4dbf1a000000003f06bf5a,0xbf7d3e1000000000bf5abf06,0xbf4dbf1a000000003f06bf5a00000000,0xbf7d3e1000000000bf5abf0600000000
.octa 0x3f7f3dbc000000003f800000,0x3f243f45000000003f800000,0x3f7f3dbc000000003f80000000000000,0x3f243f45000000003f80000000000000
.octa 0xbdbc3f7f000000003f800000,0xbf453f24000000003f800000,0xbdbc3f7f000000003f80000000000000,0xbf453f24000000003f80000000000000
.octa 0xbf7fbdbc000000003f800000,0xbf24bf45000000003f800000,0xbf7fbdbc000000003f80000000000000,0xbf24bf45000000003f80000000000000
.octa 0x3dbcbf7f000000003f800000,0x3f45bf24000000003f800000,0x3dbcbf7f000000003f80000000000000,0x3f45bf24000000003f80000000000000
.octa 0x3f763e8c000000003f7c3e3b,0xbf603efa00000000be3b3f7c,0x3f763e8c000000003f7c3e3b00000000,0xbf603efa00000000be3b3f7c00000000
.octa 0x3e8cbf7600000000bf7cbe3b,0x3efa3f60000000003e3bbf7c,0x3e8cbf7600000000bf7cbe3b00000000,0x3efa3f60000000003e3bbf7c00000000
.octa 0xbf76be8c000000003f7c3e3b,0x3f60befa00000000be3b3f7c,0xbf76be8c000000003f7c3e3b00000000,0x3f60befa00000000be3b3f7c00000000
.octa 0xbe8c3f7600000000bf7cbe3b,0xbefabf60000000003e3bbf7c,0xbe8c3f7600000000bf7cbe3b00000000,0xbefabf60000000003e3bbf7c00000000
.octa 0x3f653ee3000000003f6f3eb8,0xbea4bf7300000000bf6fbeb8,0x3f653ee3000000003f6f3eb800000000,0xbea4bf7300000000bf6fbeb800000000
.octa 0xbee33f65000000003f6f3eb8,0x3f73bea400000000bf6fbeb8,0xbee33f65000000003f6f3eb800000000,0x3f73bea400000000bf6fbeb800000000
.octa 0xbf65bee3000000003f6f3eb8,0x3ea43f7300000000bf6fbeb8,0xbf65bee3000000003f6f3eb800000000,0x3ea43f7300000000bf6fbeb800000000
.octa 0x3ee3bf65000000003f6f3eb8,0xbf733ea400000000bf6fbeb8,0x3ee3bf65000000003f6f3eb800000000,0xbf733ea400000000bf6fbeb800000000
.octa 0x3f4d3f1a000000003f5a3f06,0x3f7dbe10000000003f06bf5a,0x3f4d3f1a000000003f5a3f0600000000,0x3f7dbe10000000003f06bf5a00000000
.octa 0x3f1abf4d00000000bf5abf06,0xbe10bf7d00000000bf063f5a,0x3f1abf4d00000000bf5abf0600000000,0xbe10bf7d00000000bf063f5a00000000
.octa 0xbf4dbf1a000000003f5a3f06,0xbf7d3e10000000003f06bf5a,0xbf4dbf1a000000003f5a3f0600000000,0xbf7d3e10000000003f06bf5a00000000
.octa 0xbf1a3f4d00000000bf5abf06,0x3e103f7d00000000bf063f5a,0xbf1a3f4d00000000bf5abf0600000000,0x3e103f7d00000000bf063f5a00000000
L_tabend:
.size L_tab, 189440
.section .rodata,"a"
.p2align 6
.amdhsa_kernel concat_heads__ssm_conv_s4d__spectral_gfnet__prompt_kernel
  .amdhsa_next_free_vgpr 128
  .amdhsa_next_free_sgpr 64
  .amdhsa_accum_offset 128
  .amdhsa_group_segment_fixed_size 0
  .amdhsa_kernarg_size 104
  .amdhsa_user_sgpr_count 2
  .amdhsa_user_sgpr_kernarg_segment_ptr 1
  .amdhsa_system_sgpr_workgroup_id_x 1
.end_amdhsa_kernel
```
